```python
import torch

def _softmax(x, axis=-1):
    return torch.softmax(x, dim=axis)

def _gelu(x):
    return torch.nn.functional.gelu(x, approximate='tanh')

def _silu(x):
    return torch.nn.functional.silu(x)

def _sigmoid(x):
    return torch.sigmoid(x)

def _layernorm(x, axis=-1, eps=1e-05):
    m = x.mean(dim=axis, keepdim=True)
    v = x.var(dim=axis, keepdim=True, unbiased=False)
    return (x - m) / torch.sqrt(v + eps)

def _scatter_add(tgt, idx, src, axis=0):
    return tgt.clone().index_add_(axis, idx, src)

def _segment_sum(src, seg, n):
    out = torch.zeros((n,) + src.shape[1:], dtype=src.dtype)
    return out.index_add_(0, seg, src)

def _pad(x, pw):
    flat = tuple((v for pair in reversed(pw) for v in pair))
    return torch.nn.functional.pad(x, flat)
kernel_name = 'gated_mix__linear_attn_block__mixer_gmlp__prompt'

def setup_inputs():

    _w = lambda a: (lambda t: t.to(torch.bfloat16) if t.is_floating_point() else t)(torch.as_tensor(a))

    def _A_setup():
        B, S, D = (1, 2048, 640)
        return {'x': _w((lambda *s: torch.randn(*s, dtype=torch.bfloat16) * 0.05)(B, S, D)), 'wqkv': _w((lambda *s: torch.randn(*s, dtype=torch.bfloat16) * 1.6)(D, 3 * D)), 'wo': _w((lambda *s: torch.randn(*s, dtype=torch.bfloat16) * 0.2)(D, D))}
    _A_in = _A_setup()

    def _B_setup():
        B, S, D, F = (1, 2048, 640, 1728)
        Fh = F // 2
        return {'x': _w((lambda *s: torch.randn(*s, dtype=torch.bfloat16) * 0.05)(B, S, D)), 'w_in': _w((lambda *s: torch.randn(*s, dtype=torch.bfloat16) * 0.4)(D, 2 * Fh)), 'w_sp': _w(0.01 * (lambda *s: torch.randn(*s, dtype=torch.bfloat16) * 0.4)(S, S)), 'b_sp': _w(1.0 + 0.01 * (lambda *s: torch.randn(*s, dtype=torch.bfloat16) * 0.05)(S)), 'w_out': _w((lambda *s: torch.randn(*s, dtype=torch.bfloat16) * 0.05)(Fh, D))}
    _B_in = _B_setup()
    return {'A_x': _A_in['x'], 'A_wqkv': _A_in['wqkv'], 'A_wo': _A_in['wo'], 'B_x': _B_in['x'], 'B_w_in': _B_in['w_in'], 'B_w_sp': _B_in['w_sp'], 'B_b_sp': _B_in['b_sp'], 'B_w_out': _B_in['w_out'], 'gate_w': _w((lambda *s: torch.randn(*s, dtype=torch.bfloat16) * 0.05)(640) * 16.0)}

def reference(A_x, A_wqkv, A_wo, B_x, B_w_in, B_w_sp, B_b_sp, B_w_out, gate_w):

    def _A_ref(x, wqkv, wo):
        B, S, D = x.shape
        H = 32
        Dh = D // H
        qkv = (lambda x, *d: x.permute(*d))((x @ wqkv).reshape(B, S, 3, H, Dh), 2, 0, 3, 1, 4)
        q, k, v = (qkv[0], qkv[1], qkv[2])
        phi = lambda t: torch.where(t > 0, t + 1, torch.exp(t)) + 1e-06
        pq, pk = (phi(q), phi(k))
        kv = torch.einsum('bhsd,bhse->bhde', pk, v)
        z = torch.einsum('bhsd->bhd', pk)
        num = torch.einsum('bhqd,bhde->bhqe', pq, kv)
        den = torch.einsum('bhqd,bhd->bhq', pq, z)[..., None] + 1e-06
        o = num / den
        return (lambda x, *d: x.permute(*d))(o, 0, 2, 1, 3).reshape(B, S, D) @ wo

    def _B_ref(x, w_in, w_sp, b_sp, w_out):
        B, S, D = x.shape
        F = w_in.shape[-1]
        Fh = F // 2
        z = _gelu(torch.einsum('bsd,df->bsf', x, w_in))
        z1 = z[..., :Fh].clone()
        z2 = _layernorm(z[..., Fh:], axis=-1)
        g = torch.einsum('ts,bsf->btf', w_sp, z2) + b_sp[None, :, None]
        return torch.einsum('bsf,fd->bsd', z1 * g, w_out)
    x = A_x
    g = _sigmoid((x * gate_w).sum(-1, keepdims=True))
    a = _A_ref(x, A_wqkv, A_wo)
    b = _B_ref(x, B_w_in, B_w_sp, B_b_sp, B_w_out)
    return g * a + (1 - g) * b
```

```asm
; @launch grid=(256,1,1) block=(256,1,1) lds=163840
.amdgcn_target "amdgcn-amd-amdhsa--gfx950"
.text
.globl gated_mix__linear_attn_block__mixer_gmlp__prompt_kernel
.p2align 8
.type gated_mix__linear_attn_block__mixer_gmlp__prompt_kernel,@function
gated_mix__linear_attn_block__mixer_gmlp__prompt_kernel:
    s_cmp_ge_u32 s2, 256
    s_cbranch_scc1 L_end
    s_load_dwordx2 s[8:9], s[0:1], 0
    s_load_dwordx2 s[20:21], s[0:1], 32
    s_load_dwordx2 s[48:49], s[0:1], 88
    s_load_dwordx2 s[12:13], s[0:1], 8
    s_load_dwordx2 s[44:45], s[0:1], 80
    s_load_dwordx2 s[24:25], s[0:1], 40
    s_load_dwordx2 s[16:17], s[0:1], 16
    s_load_dwordx2 s[28:29], s[0:1], 48
    s_load_dwordx2 s[32:33], s[0:1], 56
    s_load_dwordx2 s[36:37], s[0:1], 64
    s_load_dwordx2 s[40:41], s[0:1], 72
    s_getpc_b64 s[52:53]
L_pc:
    v_lshrrev_b32 v1, 6, v0
    v_and_b32 v0, 63, v0
    s_lshr_b32 s76, s2, 3
    v_readfirstlane_b32 s56, v1
    s_mov_b32 s54, L_code_end-L_pc
    s_mov_b32 s55, 0x20000
    s_nop 0
    s_lshl2_add_u32 s77, s76, s56
    s_lshl_b32 s77, s77, 10
    v_and_b32 v2, 7, v0
    v_lshlrev_b32 v2, 7, v2
    buffer_load_dword v6, v2, s[52:55], s77 offen
    s_and_b32 s59, s2, 1
    s_bfe_u32 s75, s2, 0x20001
    s_and_b32 s77, s76, 3
    s_lshl2_add_u32 s57, s75, s77
    s_lshr_b32 s58, s76, 2
    s_mul_i32 s77, s77, 5
    s_add_u32 s77, s77, s75
    s_lshr_b32 s77, s77, 1
    s_mul_i32 s99, s59, 5
    s_add_u32 s99, s99, s77
    s_cmp_ge_u32 s99, 10
    s_cselect_b32 s77, 10, 0
    s_sub_u32 s99, s99, s77
    s_mul_i32 s60, s59, 7
    s_add_u32 s60, s60, s58
    s_mul_i32 s61, s56, 40960
    s_brev_b32 s62, s56
    s_lshr_b32 s62, s62, 30
    s_lshl2_add_u32 s64, s57, s56
    s_mul_i32 s64, s64, 40960
    s_mov_b32 s82, 0x76543210
    s_mov_b32 s83, 0x98
    s_lshl_b32 s75, s99, 2
    s_sub_u32 s77, 40, s75
    s_lshl_b64 s[84:85], s[82:83], s77
    s_lshr_b64 s[82:83], s[82:83], s75
    s_or_b64 s[82:83], s[82:83], s[84:85]
    s_lshr_b32 s75, s76, 2
    s_lshl_b32 s77, s75, 2
    s_cmp_ge_u32 s75, 2
    s_cselect_b32 s77, 40, s77
    s_mov_b32 s86, 0xf0f0f0f
    s_mov_b32 s87, 0xf
    s_lshl_b64 s[86:87], s[86:87], s77
    s_and_b32 s87, s87, 15
    s_lshr_b64 s[84:85], s[82:83], 4
    s_xor_b64 s[84:85], s[84:85], s[82:83]
    s_and_b64 s[84:85], s[84:85], s[86:87]
    s_xor_b64 s[82:83], s[82:83], s[84:85]
    s_lshl_b64 s[84:85], s[84:85], 4
    s_xor_b64 s[82:83], s[82:83], s[84:85]
    s_mov_b32 s99, s82
    s_mov_b32 s65, s83
    s_bfe_u32 s63, s99, 0x40000
    s_mul_i32 s63, s63, 128
    s_add_u32 s63, s63, s64
    s_mov_b32 s10, 2621440
    s_mov_b32 s11, 0x20000
    s_mov_b32 s22, 2211840
    s_mov_b32 s23, 0x20000
    s_mov_b32 s50, 30408704
    s_mov_b32 s51, 0x20000
    v_lshrrev_b32 v1, 3, v0
    v_and_b32 v2, 7, v0
    v_lshrrev_b32 v3, 4, v0
    v_xor_b32 v4, v2, v3
    v_lshlrev_b32 v4, 4, v4
    v_xor_b32 v5, 64, v4
    v_mul_u32_u24 v36, 1280, v1
    v_add_u32 v8, v36, v4
    v_add_u32 v9, v36, v5
    v_add_u32 v9, 9216, v9
    v_add_u32 v10, v36, v4
    v_add_u32 v10, 18432, v10
    v_add_u32 v11, v36, v5
    v_add_u32 v11, 27648, v11
    v_lshlrev_b32 v29, 4, v0
    s_waitcnt lgkmcnt(0)
    s_cmp_eq_u32 s58, 7
    s_cbranch_scc0 L_noclear
    v_mov_b32 v240, -1
    v_mov_b32 v241, -1
    v_mov_b32 v242, -1
    v_mov_b32 v243, -1
    s_lshl1_add_u32 s75, s57, s59
    s_lshl2_add_u32 s75, s75, s56
    s_mul_i32 s75, s75, 6144
    buffer_store_dwordx4 v[240:243], v29, s[48:51], s75 offen offset:0 sc1
    buffer_store_dwordx4 v[240:243], v29, s[48:51], s75 offen offset:1024 sc1
    buffer_store_dwordx4 v[240:243], v29, s[48:51], s75 offen offset:2048 sc1
    buffer_store_dwordx4 v[240:243], v29, s[48:51], s75 offen offset:3072 sc1
    s_add_u32 s75, s75, 4096
    buffer_store_dwordx4 v[240:243], v29, s[48:51], s75 offen offset:0 sc1
    buffer_store_dwordx4 v[240:243], v29, s[48:51], s75 offen offset:1024 sc1
L_noclear:
    s_add_u32 m0, s61, 0
    s_nop 0
    buffer_load_dwordx4 v8, s[8:11], s63 offen offset:0 lds
    buffer_load_dwordx4 v9, s[8:11], s63 offen offset:1024 lds
    buffer_load_dwordx4 v10, s[8:11], s63 offen offset:2048 lds
    buffer_load_dwordx4 v11, s[8:11], s63 offen offset:3072 lds
    s_bfe_u32 s63, s99, 0x40004
    s_mul_i32 s63, s63, 128
    s_add_u32 s63, s63, s64
    v_and_b32 v37, 1, v3
    v_lshlrev_b32 v37, 2, v37
    v_xor_b32 v37, v2, v37
    v_lshlrev_b32 v37, 4, v37
    s_cmp_eq_u32 s58, 7
    s_cbranch_scc1 L_role_h
    s_lshl_b32 s75, s62, 4
    v_add_u32 v38, s75, v1
    v_mul_u32_u24 v38, 3456, v38
    v_add_u32 v16, v38, v37
    v_xad_u32 v17, v37, 16, v38
    v_add_u32 v17, 26624, v17
    s_add_u32 s67, s60, 13
    s_lshl_b32 s67, s67, 7
    s_bfe_u32 s66, s99, 0x40000
    s_mul_i32 s66, s66, 221184
    s_add_u32 s66, s66, s67
    s_add_u32 m0, s61, 32768
    s_nop 0
    buffer_load_dwordx4 v16, s[20:23], s66 offen offset:0 lds
    buffer_load_dwordx4 v17, s[20:23], s66 offen offset:1024 lds
    s_bfe_u32 s66, s99, 0x40004
    s_mul_i32 s66, s66, 221184
    s_add_u32 s66, s66, s67
    s_mov_b32 s14, 2457600
    s_mov_b32 s15, 0x20000
    s_mov_b32 s46, 256
    s_mov_b32 s47, 0x20000
    s_mov_b32 s26, 8388608
    s_mov_b32 s27, 0x20000
    s_mov_b32 s18, 819200
    s_mov_b32 s19, 0x20000
    s_mov_b32 s30, 4096
    s_mov_b32 s31, 0x20000
    s_mov_b32 s34, 1105920
    s_mov_b32 s35, 0x20000
    s_mov_b32 s38, 1280
    s_mov_b32 s39, 0x20000
    s_mov_b32 s42, 2621440
    s_mov_b32 s43, 0x20000
    s_mov_b32 s68, 0xc0135761
    s_mov_b32 s69, 0xbdd2d3e8
    s_mov_b32 s74, 0
    v_add_u32 v30, 0x1000, v29
    v_lshlrev_b32 v31, 2, v0
    s_bfe_u32 s75, s2, 0x20001
    s_and_b32 s77, s2, 1
    s_bfe_u32 s76, s2, 0x20003
    s_lshl2_add_u32 s16, s75, s76
    s_lshr_b32 s76, s2, 5
    s_lshl1_add_u32 s17, s76, s77
    s_bfe_u32 s4, s2, 0x30003
    s_lshl3_add_u32 s4, s75, s4
    s_lshr_b32 s5, s2, 6
    s_lshl2_add_u32 s5, s77, s5
    v_lshlrev_b32 v36, 12, v1
    v_add_u32 v32, v36, v4
    v_add_u32 v33, v36, v5
    v_add_u32 v33, 31744, v33
    v_add_u32 v34, v36, v4
    v_add_u32 v34, 63488, v34
    v_add_u32 v35, v36, v5
    v_add_u32 v35, 95232, v35
    v_lshrrev_b32 v4, 4, v0
    v_bfe_u32 v5, v0, 1, 3
    v_xor_b32 v4, v4, v5
    v_lshlrev_b32 v4, 4, v4
    v_and_b32 v5, 15, v0
    v_lshl_add_u32 v4, v5, 7, v4
    v_add_u32 v4, s61, v4
    v_xor_b32 v5, 64, v4
    v_bfe_u32 v12, v0, 2, 2
    v_bfe_u32 v3, v0, 4, 1
    v_lshl_add_u32 v12, v3, 3, v12
    v_lshrrev_b32 v13, 5, v0
    v_mul_u32_u24 v13, 81920, v13
    v_add_u32 v13, 16384, v13
    v_and_or_b32 v14, v0, 2, v3
    v_lshlrev_b32 v14, 1, v14
    v_and_or_b32 v14, v0, 1, v14
    v_lshlrev_b32 v14, 3, v14
    v_bfe_u32 v1, v0, 3, 1
    v_lshl_add_u32 v1, v1, 6, v14
    v_lshl_add_u32 v1, v12, 7, v1
    v_add_u32 v20, v1, v13
    v_xor_b32 v21, 16, v20
    v_xor_b32 v22, 64, v20
    v_xor_b32 v23, 80, v20
    v_lshlrev_b32 v2, 7, v0
    s_cmp_eq_u32 s60, 13
    s_cbranch_scc1 L_role_l
    s_cmp_ge_u32 s58, 4
    s_cbranch_scc1 L_role_b
    s_lshl2_add_u32 s98, s59, s58
    s_mul_i32 s72, s98, 160
    s_add_u32 s72, s72, 1280
    s_bfe_u32 s71, s99, 0x40000
    s_mul_i32 s71, s71, 245760
    s_add_u32 s71, s71, s72
    s_mul_i32 s77, s62, 61440
    v_add_u32 v36, 0, v0
    v_mul_u32_u24 v37, 0xccd, v36
    v_lshrrev_b32 v37, 16, v37
    v_mul_u32_u24 v24, 1280, v37
    v_lshl_add_u32 v24, v36, 4, v24
    v_mul_u32_u24 v37, 0x199a, v36
    v_lshrrev_b32 v37, 16, v37
    v_mul_u32_u24 v37, 1120, v37
    v_add_u32 v24, v24, v37
    v_add_u32 v24, s77, v24
    v_add_u32 v36, 64, v0
    v_mul_u32_u24 v37, 0xccd, v36
    v_lshrrev_b32 v37, 16, v37
    v_mul_u32_u24 v25, 1280, v37
    v_lshl_add_u32 v25, v36, 4, v25
    v_mul_u32_u24 v37, 0x199a, v36
    v_lshrrev_b32 v37, 16, v37
    v_mul_u32_u24 v37, 1120, v37
    v_add_u32 v25, v25, v37
    v_add_u32 v25, s77, v25
    v_subrev_u32 v25, 1024, v25
    v_add_u32 v36, 128, v0
    v_mul_u32_u24 v37, 0xccd, v36
    v_lshrrev_b32 v37, 16, v37
    v_lshrrev_b32 v26, 5, v0
    v_mul_u32_u24 v26, 2, v26
    v_xor_b32 v36, v36, v26
    v_mul_u32_u24 v26, 1280, v37
    v_lshl_add_u32 v26, v36, 4, v26
    v_mul_u32_u24 v37, 0x199a, v36
    v_lshrrev_b32 v37, 16, v37
    v_mul_u32_u24 v37, 1120, v37
    v_add_u32 v26, v26, v37
    v_add_u32 v26, s77, v26
    v_subrev_u32 v26, 2048, v26
    v_add_u32 v36, 192, v0
    v_mul_u32_u24 v37, 0xccd, v36
    v_lshrrev_b32 v37, 16, v37
    v_xor_b32 v36, 2, v36
    v_mul_u32_u24 v27, 1280, v37
    v_lshl_add_u32 v27, v36, 4, v27
    v_mul_u32_u24 v37, 0x199a, v36
    v_lshrrev_b32 v37, 16, v37
    v_mul_u32_u24 v37, 1120, v37
    v_add_u32 v27, v27, v37
    v_add_u32 v27, s77, v27
    v_subrev_u32 v27, 3072, v27
    v_add_u32 v36, 256, v0
    v_mul_u32_u24 v37, 0xccd, v36
    v_lshrrev_b32 v37, 16, v37
    v_xor_b32 v36, 2, v36
    v_mul_u32_u24 v28, 1280, v37
    v_lshl_add_u32 v28, v36, 4, v28
    s_add_u32 m0, s61, 4096
    s_nop 0
    buffer_load_dwordx4 v8, s[8:11], s63 offen offset:0 lds
    buffer_load_dwordx4 v9, s[8:11], s63 offen offset:1024 lds
    buffer_load_dwordx4 v10, s[8:11], s63 offen offset:2048 lds
    buffer_load_dwordx4 v11, s[8:11], s63 offen offset:3072 lds
    s_bfe_u32 s63, s99, 0x40008
    s_mul_i32 s63, s63, 128
    s_add_u32 s63, s63, s64
    s_add_u32 m0, s61, 34816
    s_nop 0
    buffer_load_dwordx4 v16, s[20:23], s66 offen offset:0 lds
    buffer_load_dwordx4 v17, s[20:23], s66 offen offset:1024 lds
    v_mul_u32_u24 v37, 0x199a, v36
    v_lshrrev_b32 v37, 16, v37
    v_mul_u32_u24 v37, 1120, v37
    v_add_u32 v28, v28, v37
    v_add_u32 v28, s77, v28
    v_and_b32 v14, 3, v0
    v_lshl_or_b32 v14, v3, 2, v14
    v_lshlrev_b32 v14, 3, v14
    v_mul_u32_u24 v18, 320, v12
    v_add3_u32 v18, v18, v13, v14
    v_xor_b32 v19, 32, v18
    s_lshl2_add_u32 s75, s16, s56
    s_lshl_b32 s75, s75, 17
    s_and_b32 s3, s17, 1
    s_lshl_b32 s76, s3, 11
    s_add_u32 s75, s75, s76
    s_xor_b32 s77, s17, 1
    s_lshl1_add_u32 s77, s77, s3
    s_lshl_b32 s77, s77, 17
    s_lshl_b32 s76, s56, 12
    s_add_u32 s77, s77, s76
    s_add_u32 s77, s77, 2097152
    s_lshl_b32 s78, s3, 19
    s_sub_u32 s78, s78, 0x40000
    s_lshr_b32 s3, s17, 1
    s_mov_b32 s79, 0x76453201
    s_and_b32 s76, s16, 3
    s_cmp_eq_u32 s76, 1
    s_cselect_b32 s79, 0x75643120, s79
    s_cmp_eq_u32 s76, 2
    s_cselect_b32 s79, 0x67542310, s79
    s_cmp_eq_u32 s76, 3
    s_cselect_b32 s79, 0x76534210, s79
    s_and_b32 s3, s3, 7
    s_mul_i32 s3, s3, 0x11111111
    s_add_u32 s79, s79, s3
    s_bfe_u32 s76, s79, 0x30000
    s_lshl_b32 s76, s76, 8
    s_add_u32 s82, s76, s75
    s_lshl_b32 s76, s76, 6
    s_add_u32 s90, s76, s77
    s_bfe_u32 s76, s79, 0x30004
    s_lshl_b32 s76, s76, 8
    s_add_u32 s83, s76, s75
    s_lshl_b32 s76, s76, 6
    s_add_u32 s91, s76, s77
    s_bfe_u32 s76, s79, 0x30008
    s_lshl_b32 s76, s76, 8
    s_add_u32 s84, s76, s75
    s_lshl_b32 s76, s76, 6
    s_add_u32 s92, s76, s77
    s_bfe_u32 s76, s79, 0x3000c
    s_lshl_b32 s76, s76, 8
    s_add_u32 s85, s76, s75
    s_lshl_b32 s76, s76, 6
    s_add_u32 s93, s76, s77
    s_bfe_u32 s76, s79, 0x30010
    s_lshl_b32 s76, s76, 8
    s_add_u32 s86, s76, s75
    s_lshl_b32 s76, s76, 6
    s_add_u32 s94, s76, s77
    s_bfe_u32 s76, s79, 0x30014
    s_lshl_b32 s76, s76, 8
    s_add_u32 s87, s76, s75
    s_lshl_b32 s76, s76, 6
    s_add_u32 s95, s76, s77
    s_bfe_u32 s76, s79, 0x30018
    s_lshl_b32 s76, s76, 8
    s_add_u32 s88, s76, s75
    s_lshl_b32 s76, s76, 6
    s_add_u32 s96, s76, s77
    s_bfe_u32 s76, s79, 0x3001c
    s_lshl_b32 s76, s76, 8
    s_add_u32 s89, s76, s75
    s_lshl_b32 s76, s76, 6
    s_add_u32 s97, s76, s77
    s_and_b32 s77, s17, 1
    s_andn2_b32 s75, s17, 1
    s_lshl1_add_u32 s75, s75, s77
    s_lshl_b32 s75, s75, 5
    s_add_u32 s75, s75, s56
    s_lshl_b32 s75, s75, 7
    s_add_u32 s75, s75, 229376
    v_and_b32 v44, 7, v0
    v_bfe_u32 v43, v0, 3, 1
    v_lshl_add_u32 v44, v43, 4, v44
    v_lshl_add_u32 v44, v44, 9, s75
    s_lshl2_add_u32 s77, s16, s56
    s_lshl_b32 s77, s77, 6
    v_and_b32 v43, 15, v0
    v_lshl_add_u32 v43, v43, 1, s77
    v_bfe_u32 v240, v0, 1, 1
    v_bfe_u32 v241, v0, 2, 2
    v_and_b32 v242, 1, v0
    v_lshl_or_b32 v241, v241, 1, v242
    v_lshl_or_b32 v240, v240, 3, v241
    v_lshrrev_b32 v241, 5, v0
    v_lshl_or_b32 v241, v241, 2, v3
    v_xor_b32 v240, v240, v241
    v_lshlrev_b32 v240, 3, v240
    v_and_b32 v242, 15, v0
    v_lshl_add_u32 v240, v242, 7, v240
    v_add_u32 v240, s61, v240
    v_xor_b32 v241, 16, v240
    v_xor_b32 v242, 64, v240
    v_xor_b32 v243, 80, v240
    v_bfe_u32 v245, v0, 3, 1
    v_lshlrev_b32 v245, 3, v245
    v_bfe_u32 v246, v0, 4, 1
    v_bfe_u32 v247, v0, 1, 1
    v_xor_b32 v246, v246, v247
    v_lshl_or_b32 v245, v246, 2, v245
    v_lshrrev_b32 v246, 2, v0
    v_xor_b32 v247, v0, v246
    v_and_or_b32 v245, v247, 1, v245
    v_lshlrev_b32 v245, 3, v245
    v_and_b32 v246, 3, v246
    v_lshrrev_b32 v247, 4, v0
    v_lshl_add_u32 v246, v247, 3, v246
    v_lshl_add_u32 v245, v246, 7, v245
    v_add_u32 v245, s61, v245
    v_xor_b32 v246, 16, v245
    v_xor_b32 v247, 64, v245
    v_xor_b32 v248, 80, v245
    s_lshl2_add_u32 s75, s57, s56
    s_lshl_b32 s75, s75, 12
    s_lshl_b32 s76, s60, 18
    s_add_u32 s75, s75, s76
    s_add_u32 s80, s75, 2097152
    s_lshl4_add_u32 s76, s60, s57
    s_lshl2_add_u32 s76, s76, s56
    s_lshl_b32 s76, s76, 7
    s_add_u32 s81, s76, 229376
    v_add_u32 v36, s61, v29
    s_lshl4_add_u32 s73, s98, s57
    s_mul_i32 s73, s73, 13312
    s_add_u32 s73, s73, 26214400
    s_lshl3_add_u32 s7, s57, s98
    s_mul_i32 s7, s7, 640
    s_add_u32 s7, s7, 802816
    s_add_u32 s75, s56, 1
    s_add_u32 s76, s56, 0
    s_cmp_eq_u32 s56, 3
    s_cselect_b32 s75, 0, s75
    s_cselect_b32 s76, 0, s76
    s_lshl1_add_u32 s77, s75, s76
    s_lshl_b32 s77, s77, 10
    s_add_u32 s32, s77, s73
    s_lshl_b32 s77, s75, 7
    s_add_u32 s34, s77, s7
    s_lshl_b32 s77, s75, 10
    v_add_u32 v37, s77, v29
    s_lshl_b32 s77, s76, 10
    v_add_u32 v38, s77, v29
    s_add_u32 s75, s56, 1
    s_add_u32 s76, s56, 2
    s_cmp_eq_u32 s56, 3
    s_cselect_b32 s75, 4, s75
    s_cselect_b32 s76, 3, s76
    s_lshl1_add_u32 s77, s75, s76
    s_lshl_b32 s77, s77, 10
    s_add_u32 s33, s77, s73
    s_lshl_b32 s77, s75, 7
    s_add_u32 s35, s77, s7
    s_lshl_b32 s77, s75, 10
    v_add_u32 v39, s77, v29
    s_lshl_b32 s77, s76, 10
    v_add_u32 v40, s77, v29
    s_cmp_eq_u32 s56, 3
    s_cselect_b32 s62, s33, 0x80000000
    s_cselect_b32 s35, s35, 0x80000000
    v_mov_b32 v12, 0x3f803f80
    v_mov_b32 v13, 0x3f803f80
    v_mov_b32 v14, 0x3f803f80
    v_mov_b32 v15, 0x3f803f80
    s_lshl4_add_u32 s70, s59, s57
    s_lshl2_add_u32 s70, s70, s58
    s_lshl2_add_u32 s70, s70, s56
    s_lshl_b32 s70, s70, 7
    s_add_u32 s70, s70, 409600
    s_waitcnt vmcnt(6)
    s_barrier
    ds_read_b128 a[0:3], v4 offset:0
    ds_read_b128 a[4:7], v4 offset:2048
    ds_read_b128 a[8:11], v5 offset:0
    ds_read_b128 a[12:15], v5 offset:2048
    ds_read_b64_tr_b16 v[160:161], v20 offset:16384
    ds_read_b64_tr_b16 v[162:163], v20 offset:16896
    ds_read_b64_tr_b16 v[164:165], v21 offset:16384
    ds_read_b64_tr_b16 v[166:167], v21 offset:16896
    ds_read_b64_tr_b16 v[168:169], v22 offset:16384
    ds_read_b64_tr_b16 v[170:171], v22 offset:16896
    ds_read_b64_tr_b16 v[172:173], v23 offset:16384
    ds_read_b64_tr_b16 v[174:175], v23 offset:16896
    ds_read_b64_tr_b16 v[176:177], v20 offset:57344
    ds_read_b64_tr_b16 v[178:179], v20 offset:57856
    ds_read_b64_tr_b16 v[180:181], v21 offset:57344
    ds_read_b64_tr_b16 v[182:183], v21 offset:57856
    s_waitcnt lgkmcnt(10)
    v_mfma_f32_16x16x32_bf16 v[48:51], v[160:163], a[0:3], 0
    ds_read_b64_tr_b16 v[184:185], v22 offset:57344
    ds_read_b64_tr_b16 v[186:187], v22 offset:57856
    ds_read_b64_tr_b16 v[188:189], v23 offset:57344
    ds_read_b64_tr_b16 v[190:191], v23 offset:57856
    v_mfma_f32_16x16x32_bf16 v[56:59], v[160:163], a[4:7], 0
    s_bfe_u32 s66, s99, 0x40008
    s_mul_i32 s66, s66, 221184
    s_add_u32 s66, s66, s67
    s_add_u32 m0, s61, 8192
    s_waitcnt lgkmcnt(12)
    v_mfma_f32_16x16x32_bf16 v[52:55], v[164:167], a[0:3], 0
    v_mfma_f32_16x16x32_bf16 v[60:63], v[164:167], a[4:7], 0
    buffer_load_dwordx4 v8, s[8:11], s63 offen offset:0 lds
    s_waitcnt lgkmcnt(4)
    v_mfma_f32_16x16x32_bf16 v[64:67], v[168:171], a[0:3], 0
    v_mfma_f32_16x16x32_bf16 v[72:75], v[168:171], a[4:7], 0
    buffer_load_dwordx4 v9, s[8:11], s63 offen offset:1024 lds
    s_waitcnt vmcnt(2) lgkmcnt(0)
    s_barrier
    ds_read_b128 a[16:19], v4 offset:4096
    ds_read_b128 a[20:23], v4 offset:6144
    ds_read_b128 a[24:27], v5 offset:4096
    ds_read_b128 a[28:31], v5 offset:6144
    v_mfma_f32_16x16x32_bf16 v[68:71], v[172:175], a[0:3], 0
    ds_read_b64_tr_b16 v[160:161], v20 offset:18432
    ds_read_b64_tr_b16 v[162:163], v20 offset:18944
    ds_read_b64_tr_b16 v[164:165], v21 offset:18432
    ds_read_b64_tr_b16 v[166:167], v21 offset:18944
    v_mfma_f32_16x16x32_bf16 v[76:79], v[172:175], a[4:7], 0
    buffer_load_dwordx4 v10, s[8:11], s63 offen offset:2048 lds
    v_mfma_f32_16x16x32_bf16 v[48:51], v[176:179], a[8:11], v[48:51]
    ds_read_b64_tr_b16 v[168:169], v22 offset:18432
    ds_read_b64_tr_b16 v[170:171], v22 offset:18944
    ds_read_b64_tr_b16 v[172:173], v23 offset:18432
    ds_read_b64_tr_b16 v[174:175], v23 offset:18944
    v_mfma_f32_16x16x32_bf16 v[56:59], v[176:179], a[12:15], v[56:59]
    buffer_load_dwordx4 v11, s[8:11], s63 offen offset:3072 lds
    s_bfe_u32 s63, s99, 0x4000c
    s_mul_i32 s63, s63, 128
    s_add_u32 s63, s63, s64
    s_add_u32 m0, s61, 36864
    v_mfma_f32_16x16x32_bf16 v[52:55], v[180:183], a[8:11], v[52:55]
    ds_read_b64_tr_b16 v[176:177], v20 offset:59392
    ds_read_b64_tr_b16 v[178:179], v20 offset:59904
    v_mfma_f32_16x16x32_bf16 v[60:63], v[180:183], a[12:15], v[60:63]
    buffer_load_dwordx4 v16, s[20:23], s66 offen offset:0 lds
    v_mfma_f32_16x16x32_bf16 v[64:67], v[184:187], a[8:11], v[64:67]
    ds_read_b64_tr_b16 v[180:181], v21 offset:59392
    ds_read_b64_tr_b16 v[182:183], v21 offset:59904
    v_mfma_f32_16x16x32_bf16 v[72:75], v[184:187], a[12:15], v[72:75]
    buffer_load_dwordx4 v17, s[20:23], s66 offen offset:1024 lds
    s_bfe_u32 s66, s99, 0x4000c
    s_mul_i32 s66, s66, 221184
    s_add_u32 s66, s66, s67
    s_add_u32 m0, s61, 12288
    v_mfma_f32_16x16x32_bf16 v[68:71], v[188:191], a[8:11], v[68:71]
    ds_read_b64_tr_b16 v[184:185], v22 offset:59392
    ds_read_b64_tr_b16 v[186:187], v22 offset:59904
    v_mfma_f32_16x16x32_bf16 v[76:79], v[188:191], a[12:15], v[76:79]
    buffer_load_dwordx4 v8, s[8:11], s63 offen offset:0 lds
    s_waitcnt lgkmcnt(6)
    v_mfma_f32_16x16x32_bf16 v[48:51], v[160:163], a[16:19], v[48:51]
    ds_read_b64_tr_b16 v[188:189], v23 offset:59392
    ds_read_b64_tr_b16 v[190:191], v23 offset:59904
    v_mfma_f32_16x16x32_bf16 v[56:59], v[160:163], a[20:23], v[56:59]
    buffer_load_dwordx4 v9, s[8:11], s63 offen offset:1024 lds
    v_mfma_f32_16x16x32_bf16 v[52:55], v[164:167], a[16:19], v[52:55]
    v_mfma_f32_16x16x32_bf16 v[60:63], v[164:167], a[20:23], v[60:63]
    buffer_load_dwordx4 v10, s[8:11], s63 offen offset:2048 lds
    v_mfma_f32_16x16x32_bf16 v[64:67], v[168:171], a[16:19], v[64:67]
    v_mfma_f32_16x16x32_bf16 v[72:75], v[168:171], a[20:23], v[72:75]
    buffer_load_dwordx4 v11, s[8:11], s63 offen offset:3072 lds
    s_bfe_u32 s63, s99, 0x40010
    s_mul_i32 s63, s63, 128
    s_add_u32 s63, s63, s64
    s_add_u32 m0, s61, 38912
    s_waitcnt vmcnt(4) lgkmcnt(0)
    s_barrier
    ds_read_b128 a[32:35], v4 offset:8192
    ds_read_b128 a[36:39], v4 offset:10240
    ds_read_b128 a[40:43], v5 offset:8192
    ds_read_b128 a[44:47], v5 offset:10240
    v_mfma_f32_16x16x32_bf16 v[68:71], v[172:175], a[16:19], v[68:71]
    ds_read_b64_tr_b16 v[160:161], v20 offset:20480
    ds_read_b64_tr_b16 v[162:163], v20 offset:20992
    ds_read_b64_tr_b16 v[164:165], v21 offset:20480
    ds_read_b64_tr_b16 v[166:167], v21 offset:20992
    v_mfma_f32_16x16x32_bf16 v[76:79], v[172:175], a[20:23], v[76:79]
    buffer_load_dwordx4 v16, s[20:23], s66 offen offset:0 lds
    v_mfma_f32_16x16x32_bf16 v[48:51], v[176:179], a[24:27], v[48:51]
    ds_read_b64_tr_b16 v[168:169], v22 offset:20480
    ds_read_b64_tr_b16 v[170:171], v22 offset:20992
    ds_read_b64_tr_b16 v[172:173], v23 offset:20480
    ds_read_b64_tr_b16 v[174:175], v23 offset:20992
    v_mfma_f32_16x16x32_bf16 v[56:59], v[176:179], a[28:31], v[56:59]
    buffer_load_dwordx4 v17, s[20:23], s66 offen offset:1024 lds
    s_bfe_u32 s66, s99, 0x40010
    s_mul_i32 s66, s66, 221184
    s_add_u32 s66, s66, s67
    s_add_u32 m0, s61, 0
    v_mfma_f32_16x16x32_bf16 v[52:55], v[180:183], a[24:27], v[52:55]
    ds_read_b64_tr_b16 v[176:177], v20 offset:61440
    ds_read_b64_tr_b16 v[178:179], v20 offset:61952
    v_mfma_f32_16x16x32_bf16 v[60:63], v[180:183], a[28:31], v[60:63]
    buffer_load_dwordx4 v8, s[8:11], s63 offen offset:0 lds
    v_mfma_f32_16x16x32_bf16 v[64:67], v[184:187], a[24:27], v[64:67]
    ds_read_b64_tr_b16 v[180:181], v21 offset:61440
    ds_read_b64_tr_b16 v[182:183], v21 offset:61952
    v_mfma_f32_16x16x32_bf16 v[72:75], v[184:187], a[28:31], v[72:75]
    buffer_load_dwordx4 v9, s[8:11], s63 offen offset:1024 lds
    v_mfma_f32_16x16x32_bf16 v[68:71], v[188:191], a[24:27], v[68:71]
    ds_read_b64_tr_b16 v[184:185], v22 offset:61440
    ds_read_b64_tr_b16 v[186:187], v22 offset:61952
    v_mfma_f32_16x16x32_bf16 v[76:79], v[188:191], a[28:31], v[76:79]
    buffer_load_dwordx4 v10, s[8:11], s63 offen offset:2048 lds
    s_waitcnt lgkmcnt(6)
    v_mfma_f32_16x16x32_bf16 v[48:51], v[160:163], a[32:35], v[48:51]
    ds_read_b64_tr_b16 v[188:189], v23 offset:61440
    ds_read_b64_tr_b16 v[190:191], v23 offset:61952
    v_mfma_f32_16x16x32_bf16 v[56:59], v[160:163], a[36:39], v[56:59]
    buffer_load_dwordx4 v11, s[8:11], s63 offen offset:3072 lds
    s_bfe_u32 s63, s99, 0x40014
    s_mul_i32 s63, s63, 128
    s_add_u32 s63, s63, s64
    s_add_u32 m0, s61, 32768
    v_mfma_f32_16x16x32_bf16 v[52:55], v[164:167], a[32:35], v[52:55]
    v_mfma_f32_16x16x32_bf16 v[60:63], v[164:167], a[36:39], v[60:63]
    buffer_load_dwordx4 v16, s[20:23], s66 offen offset:0 lds
    v_mfma_f32_16x16x32_bf16 v[64:67], v[168:171], a[32:35], v[64:67]
    v_mfma_f32_16x16x32_bf16 v[72:75], v[168:171], a[36:39], v[72:75]
    buffer_load_dwordx4 v17, s[20:23], s66 offen offset:1024 lds
    s_bfe_u32 s66, s99, 0x40014
    s_mul_i32 s66, s66, 221184
    s_add_u32 s66, s66, s67
    s_add_u32 m0, s61, 4096
    s_waitcnt vmcnt(6) lgkmcnt(0)
    s_barrier
    ds_read_b128 a[48:51], v4 offset:12288
    ds_read_b128 a[52:55], v4 offset:14336
    ds_read_b128 a[56:59], v5 offset:12288
    ds_read_b128 a[60:63], v5 offset:14336
    v_mfma_f32_16x16x32_bf16 v[68:71], v[172:175], a[32:35], v[68:71]
    ds_read_b64_tr_b16 v[160:161], v20 offset:22528
    ds_read_b64_tr_b16 v[162:163], v20 offset:23040
    ds_read_b64_tr_b16 v[164:165], v21 offset:22528
    ds_read_b64_tr_b16 v[166:167], v21 offset:23040
    v_mfma_f32_16x16x32_bf16 v[76:79], v[172:175], a[36:39], v[76:79]
    buffer_load_dwordx4 v8, s[8:11], s63 offen offset:0 lds
    v_mfma_f32_16x16x32_bf16 v[48:51], v[176:179], a[40:43], v[48:51]
    ds_read_b64_tr_b16 v[168:169], v22 offset:22528
    ds_read_b64_tr_b16 v[170:171], v22 offset:23040
    ds_read_b64_tr_b16 v[172:173], v23 offset:22528
    ds_read_b64_tr_b16 v[174:175], v23 offset:23040
    v_mfma_f32_16x16x32_bf16 v[56:59], v[176:179], a[44:47], v[56:59]
    buffer_load_dwordx4 v9, s[8:11], s63 offen offset:1024 lds
    v_mfma_f32_16x16x32_bf16 v[52:55], v[180:183], a[40:43], v[52:55]
    ds_read_b64_tr_b16 v[176:177], v20 offset:63488
    ds_read_b64_tr_b16 v[178:179], v20 offset:64000
    v_mfma_f32_16x16x32_bf16 v[60:63], v[180:183], a[44:47], v[60:63]
    buffer_load_dwordx4 v10, s[8:11], s63 offen offset:2048 lds
    v_mfma_f32_16x16x32_bf16 v[64:67], v[184:187], a[40:43], v[64:67]
    ds_read_b64_tr_b16 v[180:181], v21 offset:63488
    ds_read_b64_tr_b16 v[182:183], v21 offset:64000
    v_mfma_f32_16x16x32_bf16 v[72:75], v[184:187], a[44:47], v[72:75]
    buffer_load_dwordx4 v11, s[8:11], s63 offen offset:3072 lds
    s_bfe_u32 s63, s99, 0x40018
    s_mul_i32 s63, s63, 128
    s_add_u32 s63, s63, s64
    s_add_u32 m0, s61, 34816
    v_mfma_f32_16x16x32_bf16 v[68:71], v[188:191], a[40:43], v[68:71]
    ds_read_b64_tr_b16 v[184:185], v22 offset:63488
    ds_read_b64_tr_b16 v[186:187], v22 offset:64000
    v_mfma_f32_16x16x32_bf16 v[76:79], v[188:191], a[44:47], v[76:79]
    buffer_load_dwordx4 v16, s[20:23], s66 offen offset:0 lds
    s_waitcnt lgkmcnt(6)
    v_mfma_f32_16x16x32_bf16 v[48:51], v[160:163], a[48:51], v[48:51]
    ds_read_b64_tr_b16 v[188:189], v23 offset:63488
    ds_read_b64_tr_b16 v[190:191], v23 offset:64000
    v_mfma_f32_16x16x32_bf16 v[56:59], v[160:163], a[52:55], v[56:59]
    buffer_load_dwordx4 v17, s[20:23], s66 offen offset:1024 lds
    s_bfe_u32 s66, s99, 0x40018
    s_mul_i32 s66, s66, 221184
    s_add_u32 s66, s66, s67
    s_add_u32 m0, s61, 8192
    v_mfma_f32_16x16x32_bf16 v[52:55], v[164:167], a[48:51], v[52:55]
    v_mfma_f32_16x16x32_bf16 v[60:63], v[164:167], a[52:55], v[60:63]
    buffer_load_dwordx4 v8, s[8:11], s63 offen offset:0 lds
    v_mfma_f32_16x16x32_bf16 v[64:67], v[168:171], a[48:51], v[64:67]
    v_mfma_f32_16x16x32_bf16 v[72:75], v[168:171], a[52:55], v[72:75]
    buffer_load_dwordx4 v9, s[8:11], s63 offen offset:1024 lds
    s_waitcnt vmcnt(8) lgkmcnt(0)
    s_barrier
    ds_read_b128 a[64:67], v4 offset:0
    ds_read_b128 a[68:71], v4 offset:2048
    ds_read_b128 a[72:75], v5 offset:0
    ds_read_b128 a[76:79], v5 offset:2048
    v_mfma_f32_16x16x32_bf16 v[68:71], v[172:175], a[48:51], v[68:71]
    ds_read_b64_tr_b16 v[160:161], v20 offset:16384
    ds_read_b64_tr_b16 v[162:163], v20 offset:16896
    ds_read_b64_tr_b16 v[164:165], v21 offset:16384
    ds_read_b64_tr_b16 v[166:167], v21 offset:16896
    v_mfma_f32_16x16x32_bf16 v[76:79], v[172:175], a[52:55], v[76:79]
    buffer_load_dwordx4 v10, s[8:11], s63 offen offset:2048 lds
    v_mfma_f32_16x16x32_bf16 v[48:51], v[176:179], a[56:59], v[48:51]
    ds_read_b64_tr_b16 v[168:169], v22 offset:16384
    ds_read_b64_tr_b16 v[170:171], v22 offset:16896
    ds_read_b64_tr_b16 v[172:173], v23 offset:16384
    ds_read_b64_tr_b16 v[174:175], v23 offset:16896
    v_mfma_f32_16x16x32_bf16 v[56:59], v[176:179], a[60:63], v[56:59]
    buffer_load_dwordx4 v11, s[8:11], s63 offen offset:3072 lds
    s_bfe_u32 s63, s99, 0x4001c
    s_mul_i32 s63, s63, 128
    s_add_u32 s63, s63, s64
    s_add_u32 m0, s61, 36864
    v_mfma_f32_16x16x32_bf16 v[52:55], v[180:183], a[56:59], v[52:55]
    ds_read_b64_tr_b16 v[176:177], v20 offset:57344
    ds_read_b64_tr_b16 v[178:179], v20 offset:57856
    v_mfma_f32_16x16x32_bf16 v[60:63], v[180:183], a[60:63], v[60:63]
    buffer_load_dwordx4 v16, s[20:23], s66 offen offset:0 lds
    v_mfma_f32_16x16x32_bf16 v[64:67], v[184:187], a[56:59], v[64:67]
    ds_read_b64_tr_b16 v[180:181], v21 offset:57344
    ds_read_b64_tr_b16 v[182:183], v21 offset:57856
    v_mfma_f32_16x16x32_bf16 v[72:75], v[184:187], a[60:63], v[72:75]
    buffer_load_dwordx4 v17, s[20:23], s66 offen offset:1024 lds
    s_bfe_u32 s66, s99, 0x4001c
    s_mul_i32 s66, s66, 221184
    s_add_u32 s66, s66, s67
    s_add_u32 m0, s61, 12288
    v_mfma_f32_16x16x32_bf16 v[68:71], v[188:191], a[56:59], v[68:71]
    ds_read_b64_tr_b16 v[184:185], v22 offset:57344
    ds_read_b64_tr_b16 v[186:187], v22 offset:57856
    v_mfma_f32_16x16x32_bf16 v[76:79], v[188:191], a[60:63], v[76:79]
    buffer_load_dwordx4 v8, s[8:11], s63 offen offset:0 lds
    s_waitcnt lgkmcnt(6)
    v_mfma_f32_16x16x32_bf16 v[48:51], v[160:163], a[64:67], v[48:51]
    ds_read_b64_tr_b16 v[188:189], v23 offset:57344
    ds_read_b64_tr_b16 v[190:191], v23 offset:57856
    v_mfma_f32_16x16x32_bf16 v[56:59], v[160:163], a[68:71], v[56:59]
    buffer_load_dwordx4 v9, s[8:11], s63 offen offset:1024 lds
    v_mfma_f32_16x16x32_bf16 v[52:55], v[164:167], a[64:67], v[52:55]
    v_mfma_f32_16x16x32_bf16 v[60:63], v[164:167], a[68:71], v[60:63]
    buffer_load_dwordx4 v10, s[8:11], s63 offen offset:2048 lds
    v_mfma_f32_16x16x32_bf16 v[64:67], v[168:171], a[64:67], v[64:67]
    v_mfma_f32_16x16x32_bf16 v[72:75], v[168:171], a[68:71], v[72:75]
    buffer_load_dwordx4 v11, s[8:11], s63 offen offset:3072 lds
    s_bfe_u32 s63, s65, 0x40000
    s_mul_i32 s63, s63, 128
    s_add_u32 s63, s63, s64
    s_add_u32 m0, s61, 38912
    s_waitcnt vmcnt(10) lgkmcnt(0)
    s_barrier
    ds_read_b128 a[80:83], v4 offset:4096
    ds_read_b128 a[84:87], v4 offset:6144
    ds_read_b128 a[88:91], v5 offset:4096
    ds_read_b128 a[92:95], v5 offset:6144
    v_mfma_f32_16x16x32_bf16 v[68:71], v[172:175], a[64:67], v[68:71]
    ds_read_b64_tr_b16 v[160:161], v20 offset:18432
    ds_read_b64_tr_b16 v[162:163], v20 offset:18944
    ds_read_b64_tr_b16 v[164:165], v21 offset:18432
    ds_read_b64_tr_b16 v[166:167], v21 offset:18944
    v_mfma_f32_16x16x32_bf16 v[76:79], v[172:175], a[68:71], v[76:79]
    buffer_load_dwordx4 v16, s[20:23], s66 offen offset:0 lds
    v_mfma_f32_16x16x32_bf16 v[48:51], v[176:179], a[72:75], v[48:51]
    ds_read_b64_tr_b16 v[168:169], v22 offset:18432
    ds_read_b64_tr_b16 v[170:171], v22 offset:18944
    ds_read_b64_tr_b16 v[172:173], v23 offset:18432
    ds_read_b64_tr_b16 v[174:175], v23 offset:18944
    v_mfma_f32_16x16x32_bf16 v[56:59], v[176:179], a[76:79], v[56:59]
    buffer_load_dwordx4 v17, s[20:23], s66 offen offset:1024 lds
    s_bfe_u32 s66, s65, 0x40000
    s_mul_i32 s66, s66, 221184
    s_add_u32 s66, s66, s67
    s_add_u32 m0, s61, 0
    v_mfma_f32_16x16x32_bf16 v[52:55], v[180:183], a[72:75], v[52:55]
    ds_read_b64_tr_b16 v[176:177], v20 offset:59392
    ds_read_b64_tr_b16 v[178:179], v20 offset:59904
    v_mfma_f32_16x16x32_bf16 v[60:63], v[180:183], a[76:79], v[60:63]
    buffer_load_dwordx4 v8, s[8:11], s63 offen offset:0 lds
    v_mfma_f32_16x16x32_bf16 v[64:67], v[184:187], a[72:75], v[64:67]
    ds_read_b64_tr_b16 v[180:181], v21 offset:59392
    ds_read_b64_tr_b16 v[182:183], v21 offset:59904
    v_mfma_f32_16x16x32_bf16 v[72:75], v[184:187], a[76:79], v[72:75]
    buffer_load_dwordx4 v9, s[8:11], s63 offen offset:1024 lds
    v_mfma_f32_16x16x32_bf16 v[68:71], v[188:191], a[72:75], v[68:71]
    ds_read_b64_tr_b16 v[184:185], v22 offset:59392
    ds_read_b64_tr_b16 v[186:187], v22 offset:59904
    v_mfma_f32_16x16x32_bf16 v[76:79], v[188:191], a[76:79], v[76:79]
    buffer_load_dwordx4 v10, s[8:11], s63 offen offset:2048 lds
    s_waitcnt lgkmcnt(6)
    v_mfma_f32_16x16x32_bf16 v[48:51], v[160:163], a[80:83], v[48:51]
    ds_read_b64_tr_b16 v[188:189], v23 offset:59392
    ds_read_b64_tr_b16 v[190:191], v23 offset:59904
    v_mfma_f32_16x16x32_bf16 v[56:59], v[160:163], a[84:87], v[56:59]
    buffer_load_dwordx4 v11, s[8:11], s63 offen offset:3072 lds
    s_bfe_u32 s63, s65, 0x40004
    s_mul_i32 s63, s63, 128
    s_add_u32 s63, s63, s64
    s_add_u32 m0, s61, 32768
    v_mfma_f32_16x16x32_bf16 v[52:55], v[164:167], a[80:83], v[52:55]
    v_mfma_f32_16x16x32_bf16 v[60:63], v[164:167], a[84:87], v[60:63]
    buffer_load_dwordx4 v16, s[20:23], s66 offen offset:0 lds
    v_mfma_f32_16x16x32_bf16 v[64:67], v[168:171], a[80:83], v[64:67]
    v_mfma_f32_16x16x32_bf16 v[72:75], v[168:171], a[84:87], v[72:75]
    buffer_load_dwordx4 v17, s[20:23], s66 offen offset:1024 lds
    s_waitcnt vmcnt(12) lgkmcnt(0)
    s_barrier
    ds_read_b128 a[96:99], v4 offset:8192
    ds_read_b128 a[100:103], v4 offset:10240
    ds_read_b128 a[104:107], v5 offset:8192
    ds_read_b128 a[108:111], v5 offset:10240
    v_mfma_f32_16x16x32_bf16 v[68:71], v[172:175], a[80:83], v[68:71]
    ds_read_b64_tr_b16 v[160:161], v20 offset:20480
    ds_read_b64_tr_b16 v[162:163], v20 offset:20992
    ds_read_b64_tr_b16 v[164:165], v21 offset:20480
    ds_read_b64_tr_b16 v[166:167], v21 offset:20992
    v_mfma_f32_16x16x32_bf16 v[76:79], v[172:175], a[84:87], v[76:79]
    s_bfe_u32 s66, s65, 0x40004
    s_mul_i32 s66, s66, 221184
    s_add_u32 s66, s66, s67
    s_add_u32 m0, s61, 4096
    v_mfma_f32_16x16x32_bf16 v[48:51], v[176:179], a[88:91], v[48:51]
    ds_read_b64_tr_b16 v[168:169], v22 offset:20480
    ds_read_b64_tr_b16 v[170:171], v22 offset:20992
    ds_read_b64_tr_b16 v[172:173], v23 offset:20480
    ds_read_b64_tr_b16 v[174:175], v23 offset:20992
    v_mfma_f32_16x16x32_bf16 v[56:59], v[176:179], a[92:95], v[56:59]
    buffer_load_dwordx4 v8, s[8:11], s63 offen offset:0 lds
    v_mfma_f32_16x16x32_bf16 v[52:55], v[180:183], a[88:91], v[52:55]
    ds_read_b64_tr_b16 v[176:177], v20 offset:61440
    ds_read_b64_tr_b16 v[178:179], v20 offset:61952
    v_mfma_f32_16x16x32_bf16 v[60:63], v[180:183], a[92:95], v[60:63]
    buffer_load_dwordx4 v9, s[8:11], s63 offen offset:1024 lds
    v_mfma_f32_16x16x32_bf16 v[64:67], v[184:187], a[88:91], v[64:67]
    ds_read_b64_tr_b16 v[180:181], v21 offset:61440
    ds_read_b64_tr_b16 v[182:183], v21 offset:61952
    v_mfma_f32_16x16x32_bf16 v[72:75], v[184:187], a[92:95], v[72:75]
    buffer_load_dwordx4 v10, s[8:11], s63 offen offset:2048 lds
    v_mfma_f32_16x16x32_bf16 v[68:71], v[188:191], a[88:91], v[68:71]
    ds_read_b64_tr_b16 v[184:185], v22 offset:61440
    ds_read_b64_tr_b16 v[186:187], v22 offset:61952
    v_mfma_f32_16x16x32_bf16 v[76:79], v[188:191], a[92:95], v[76:79]
    buffer_load_dwordx4 v11, s[8:11], s63 offen offset:3072 lds
    s_add_u32 m0, s61, 34816
    s_waitcnt lgkmcnt(6)
    v_mfma_f32_16x16x32_bf16 v[48:51], v[160:163], a[96:99], v[48:51]
    ds_read_b64_tr_b16 v[188:189], v23 offset:61440
    ds_read_b64_tr_b16 v[190:191], v23 offset:61952
    v_mfma_f32_16x16x32_bf16 v[56:59], v[160:163], a[100:103], v[56:59]
    buffer_load_dwordx4 v16, s[20:23], s66 offen offset:0 lds
    v_mfma_f32_16x16x32_bf16 v[52:55], v[164:167], a[96:99], v[52:55]
    v_mfma_f32_16x16x32_bf16 v[60:63], v[164:167], a[100:103], v[60:63]
    buffer_load_dwordx4 v17, s[20:23], s66 offen offset:1024 lds
    s_add_u32 m0, s61, 16384
    v_mfma_f32_16x16x32_bf16 v[64:67], v[168:171], a[96:99], v[64:67]
    v_mfma_f32_16x16x32_bf16 v[72:75], v[168:171], a[100:103], v[72:75]
    buffer_load_dwordx4 v24, s[12:15], s71 offen offset:0 lds
    s_waitcnt vmcnt(13) lgkmcnt(0)
    s_barrier
    ds_read_b128 a[112:115], v4 offset:12288
    ds_read_b128 a[116:119], v4 offset:14336
    ds_read_b128 a[120:123], v5 offset:12288
    ds_read_b128 a[124:127], v5 offset:14336
    v_mfma_f32_16x16x32_bf16 v[68:71], v[172:175], a[96:99], v[68:71]
    ds_read_b64_tr_b16 v[160:161], v20 offset:22528
    ds_read_b64_tr_b16 v[162:163], v20 offset:23040
    ds_read_b64_tr_b16 v[164:165], v21 offset:22528
    ds_read_b64_tr_b16 v[166:167], v21 offset:23040
    v_mfma_f32_16x16x32_bf16 v[76:79], v[172:175], a[100:103], v[76:79]
    buffer_load_dwordx4 v25, s[12:15], s71 offen offset:1024 lds
    v_mfma_f32_16x16x32_bf16 v[48:51], v[176:179], a[104:107], v[48:51]
    ds_read_b64_tr_b16 v[168:169], v22 offset:22528
    ds_read_b64_tr_b16 v[170:171], v22 offset:23040
    ds_read_b64_tr_b16 v[172:173], v23 offset:22528
    ds_read_b64_tr_b16 v[174:175], v23 offset:23040
    v_mfma_f32_16x16x32_bf16 v[56:59], v[176:179], a[108:111], v[56:59]
    buffer_load_dwordx4 v26, s[12:15], s71 offen offset:2048 lds
    v_mfma_f32_16x16x32_bf16 v[52:55], v[180:183], a[104:107], v[52:55]
    ds_read_b64_tr_b16 v[176:177], v20 offset:63488
    ds_read_b64_tr_b16 v[178:179], v20 offset:64000
    v_mfma_f32_16x16x32_bf16 v[60:63], v[180:183], a[108:111], v[60:63]
    buffer_load_dwordx4 v27, s[12:15], s71 offen offset:3072 lds
    s_add_u32 m0, s61, 20480
    v_mfma_f32_16x16x32_bf16 v[64:67], v[184:187], a[104:107], v[64:67]
    ds_read_b64_tr_b16 v[180:181], v21 offset:63488
    ds_read_b64_tr_b16 v[182:183], v21 offset:64000
    v_mfma_f32_16x16x32_bf16 v[72:75], v[184:187], a[108:111], v[72:75]
    buffer_load_dwordx4 v28, s[12:15], s71 offen offset:0 lds
    v_mfma_f32_16x16x32_bf16 v[68:71], v[188:191], a[104:107], v[68:71]
    ds_read_b64_tr_b16 v[184:185], v22 offset:63488
    ds_read_b64_tr_b16 v[186:187], v22 offset:64000
    v_mfma_f32_16x16x32_bf16 v[76:79], v[188:191], a[108:111], v[76:79]
    buffer_load_dword v47, off, s[44:47], 0 sc1
    s_waitcnt lgkmcnt(6)
    v_mfma_f32_16x16x32_bf16 v[48:51], v[160:163], a[112:115], v[48:51]
    ds_read_b64_tr_b16 v[188:189], v23 offset:63488
    ds_read_b64_tr_b16 v[190:191], v23 offset:64000
    v_mfma_f32_16x16x32_bf16 v[56:59], v[160:163], a[116:119], v[56:59]
    v_mfma_f32_16x16x32_bf16 v[52:55], v[164:167], a[112:115], v[52:55]
    v_mfma_f32_16x16x32_bf16 v[60:63], v[164:167], a[116:119], v[60:63]
    v_mfma_f32_16x16x32_bf16 v[64:67], v[168:171], a[112:115], v[64:67]
    v_mfma_f32_16x16x32_bf16 v[72:75], v[168:171], a[116:119], v[72:75]
    s_waitcnt vmcnt(12) lgkmcnt(0)
    s_barrier
    ds_read_b128 a[128:131], v4 offset:0
    ds_read_b128 a[132:135], v4 offset:2048
    ds_read_b128 a[136:139], v5 offset:0
    ds_read_b128 a[140:143], v5 offset:2048
    v_mfma_f32_16x16x32_bf16 v[68:71], v[172:175], a[112:115], v[68:71]
    ds_read_b64_tr_b16 v[160:161], v20 offset:16384
    ds_read_b64_tr_b16 v[162:163], v20 offset:16896
    ds_read_b64_tr_b16 v[164:165], v21 offset:16384
    ds_read_b64_tr_b16 v[166:167], v21 offset:16896
    v_mfma_f32_16x16x32_bf16 v[76:79], v[172:175], a[116:119], v[76:79]
    v_mfma_f32_16x16x32_bf16 v[48:51], v[176:179], a[120:123], v[48:51]
    ds_read_b64_tr_b16 v[168:169], v22 offset:16384
    ds_read_b64_tr_b16 v[170:171], v22 offset:16896
    ds_read_b64_tr_b16 v[172:173], v23 offset:16384
    ds_read_b64_tr_b16 v[174:175], v23 offset:16896
    v_mfma_f32_16x16x32_bf16 v[56:59], v[176:179], a[124:127], v[56:59]
    v_mfma_f32_16x16x32_bf16 v[52:55], v[180:183], a[120:123], v[52:55]
    ds_read_b64_tr_b16 v[176:177], v20 offset:57344
    ds_read_b64_tr_b16 v[178:179], v20 offset:57856
    v_mfma_f32_16x16x32_bf16 v[60:63], v[180:183], a[124:127], v[60:63]
    v_mfma_f32_16x16x32_bf16 v[64:67], v[184:187], a[120:123], v[64:67]
    ds_read_b64_tr_b16 v[180:181], v21 offset:57344
    ds_read_b64_tr_b16 v[182:183], v21 offset:57856
    v_mfma_f32_16x16x32_bf16 v[72:75], v[184:187], a[124:127], v[72:75]
    v_mfma_f32_16x16x32_bf16 v[68:71], v[188:191], a[120:123], v[68:71]
    ds_read_b64_tr_b16 v[184:185], v22 offset:57344
    ds_read_b64_tr_b16 v[186:187], v22 offset:57856
    v_mfma_f32_16x16x32_bf16 v[76:79], v[188:191], a[124:127], v[76:79]
    s_waitcnt lgkmcnt(6)
    v_mfma_f32_16x16x32_bf16 v[48:51], v[160:163], a[128:131], v[48:51]
    ds_read_b64_tr_b16 v[188:189], v23 offset:57344
    ds_read_b64_tr_b16 v[190:191], v23 offset:57856
    v_mfma_f32_16x16x32_bf16 v[56:59], v[160:163], a[132:135], v[56:59]
    v_mfma_f32_16x16x32_bf16 v[52:55], v[164:167], a[128:131], v[52:55]
    v_mfma_f32_16x16x32_bf16 v[60:63], v[164:167], a[132:135], v[60:63]
    v_mfma_f32_16x16x32_bf16 v[64:67], v[168:171], a[128:131], v[64:67]
    v_mfma_f32_16x16x32_bf16 v[72:75], v[168:171], a[132:135], v[72:75]
    s_waitcnt vmcnt(6) lgkmcnt(0)
    s_barrier
    ds_read_b128 a[144:147], v4 offset:4096
    ds_read_b128 a[148:151], v4 offset:6144
    ds_read_b128 a[152:155], v5 offset:4096
    ds_read_b128 a[156:159], v5 offset:6144
    v_mfma_f32_16x16x32_bf16 v[68:71], v[172:175], a[128:131], v[68:71]
    ds_read_b64_tr_b16 v[160:161], v20 offset:18432
    ds_read_b64_tr_b16 v[162:163], v20 offset:18944
    ds_read_b64_tr_b16 v[164:165], v21 offset:18432
    ds_read_b64_tr_b16 v[166:167], v21 offset:18944
    v_mfma_f32_16x16x32_bf16 v[76:79], v[172:175], a[132:135], v[76:79]
    v_mfma_f32_16x16x32_bf16 v[48:51], v[176:179], a[136:139], v[48:51]
    ds_read_b64_tr_b16 v[168:169], v22 offset:18432
    ds_read_b64_tr_b16 v[170:171], v22 offset:18944
    ds_read_b64_tr_b16 v[172:173], v23 offset:18432
    ds_read_b64_tr_b16 v[174:175], v23 offset:18944
    v_mfma_f32_16x16x32_bf16 v[56:59], v[176:179], a[140:143], v[56:59]
    v_mfma_f32_16x16x32_bf16 v[52:55], v[180:183], a[136:139], v[52:55]
    ds_read_b64_tr_b16 v[176:177], v20 offset:59392
    ds_read_b64_tr_b16 v[178:179], v20 offset:59904
    v_mfma_f32_16x16x32_bf16 v[60:63], v[180:183], a[140:143], v[60:63]
    v_mfma_f32_16x16x32_bf16 v[64:67], v[184:187], a[136:139], v[64:67]
    ds_read_b64_tr_b16 v[180:181], v21 offset:59392
    ds_read_b64_tr_b16 v[182:183], v21 offset:59904
    v_mfma_f32_16x16x32_bf16 v[72:75], v[184:187], a[140:143], v[72:75]
    v_mfma_f32_16x16x32_bf16 v[68:71], v[188:191], a[136:139], v[68:71]
    ds_read_b64_tr_b16 v[184:185], v22 offset:59392
    ds_read_b64_tr_b16 v[186:187], v22 offset:59904
    v_mfma_f32_16x16x32_bf16 v[76:79], v[188:191], a[140:143], v[76:79]
    s_waitcnt lgkmcnt(6)
    v_mfma_f32_16x16x32_bf16 v[48:51], v[160:163], a[144:147], v[48:51]
    ds_read_b64_tr_b16 v[188:189], v23 offset:59392
    ds_read_b64_tr_b16 v[190:191], v23 offset:59904
    v_mfma_f32_16x16x32_bf16 v[56:59], v[160:163], a[148:151], v[56:59]
    v_mfma_f32_16x16x32_bf16 v[52:55], v[164:167], a[144:147], v[52:55]
    v_mfma_f32_16x16x32_bf16 v[60:63], v[164:167], a[148:151], v[60:63]
    v_mfma_f32_16x16x32_bf16 v[64:67], v[168:171], a[144:147], v[64:67]
    v_mfma_f32_16x16x32_bf16 v[72:75], v[168:171], a[148:151], v[72:75]
    v_mfma_f32_16x16x32_bf16 v[68:71], v[172:175], a[144:147], v[68:71]
    v_mfma_f32_16x16x32_bf16 v[76:79], v[172:175], a[148:151], v[76:79]
    s_waitcnt lgkmcnt(0)
    v_mfma_f32_16x16x32_bf16 v[48:51], v[176:179], a[152:155], v[48:51]
    v_mfma_f32_16x16x32_bf16 v[56:59], v[176:179], a[156:159], v[56:59]
    v_mfma_f32_16x16x32_bf16 v[52:55], v[180:183], a[152:155], v[52:55]
    v_mfma_f32_16x16x32_bf16 v[60:63], v[180:183], a[156:159], v[60:63]
    v_mfma_f32_16x16x32_bf16 v[64:67], v[184:187], a[152:155], v[64:67]
    v_mfma_f32_16x16x32_bf16 v[72:75], v[184:187], a[156:159], v[72:75]
    v_mfma_f32_16x16x32_bf16 v[68:71], v[188:191], a[152:155], v[68:71]
    v_mfma_f32_16x16x32_bf16 v[76:79], v[188:191], a[156:159], v[76:79]
    s_bfe_u32 s71, s99, 0x40004
    s_mul_i32 s71, s71, 245760
    s_add_u32 s71, s71, s72
    v_pk_mul_f32 v[80:81], v[48:49], v[48:49]
    s_add_u32 m0, s61, 21504
    s_nop 0
    buffer_load_dwordx4 v24, s[12:15], s71 offen offset:0 lds
    v_pk_mul_f32 v[82:83], v[50:51], v[50:51]
    v_pk_mul_f32 v[84:85], v[52:53], v[52:53]
    v_pk_mul_f32 v[86:87], v[54:55], v[54:55]
    v_pk_fma_f32 v[80:81], v[80:81], s[68:69], s[68:69] op_sel:[0,1,0] op_sel_hi:[1,1,0]
    v_pk_fma_f32 v[82:83], v[82:83], s[68:69], s[68:69] op_sel:[0,1,0] op_sel_hi:[1,1,0]
    v_pk_fma_f32 v[84:85], v[84:85], s[68:69], s[68:69] op_sel:[0,1,0] op_sel_hi:[1,1,0]
    v_pk_fma_f32 v[86:87], v[86:87], s[68:69], s[68:69] op_sel:[0,1,0] op_sel_hi:[1,1,0]
    v_pk_mul_f32 v[80:81], v[80:81], v[48:49]
    v_pk_mul_f32 v[82:83], v[82:83], v[50:51]
    v_pk_mul_f32 v[84:85], v[84:85], v[52:53]
    v_pk_mul_f32 v[86:87], v[86:87], v[54:55]
    v_exp_f32 v80, v80
    v_exp_f32 v81, v81
    v_exp_f32 v82, v82
    v_exp_f32 v83, v83
    v_exp_f32 v84, v84
    buffer_load_dwordx4 v25, s[12:15], s71 offen offset:1024 lds
    v_exp_f32 v85, v85
    v_exp_f32 v86, v86
    v_exp_f32 v87, v87
    v_pk_add_f32 v[80:81], v[80:81], 1.0 op_sel_hi:[1,0]
    v_pk_add_f32 v[82:83], v[82:83], 1.0 op_sel_hi:[1,0]
    v_pk_add_f32 v[84:85], v[84:85], 1.0 op_sel_hi:[1,0]
    v_pk_add_f32 v[86:87], v[86:87], 1.0 op_sel_hi:[1,0]
    v_rcp_f32 v80, v80
    v_rcp_f32 v81, v81
    v_rcp_f32 v82, v82
    v_rcp_f32 v83, v83
    v_rcp_f32 v84, v84
    v_rcp_f32 v85, v85
    v_rcp_f32 v86, v86
    buffer_load_dwordx4 v26, s[12:15], s71 offen offset:2048 lds
    v_rcp_f32 v87, v87
    v_pk_mul_f32 v[48:49], v[80:81], v[48:49]
    v_pk_mul_f32 v[50:51], v[82:83], v[50:51]
    v_pk_mul_f32 v[52:53], v[84:85], v[52:53]
    v_pk_mul_f32 v[54:55], v[86:87], v[54:55]
    v_pk_mul_f32 v[80:81], v[56:57], v[56:57]
    v_pk_mul_f32 v[82:83], v[58:59], v[58:59]
    v_pk_mul_f32 v[84:85], v[60:61], v[60:61]
    v_pk_mul_f32 v[86:87], v[62:63], v[62:63]
    v_pk_fma_f32 v[80:81], v[80:81], s[68:69], s[68:69] op_sel:[0,1,0] op_sel_hi:[1,1,0]
    v_pk_fma_f32 v[82:83], v[82:83], s[68:69], s[68:69] op_sel:[0,1,0] op_sel_hi:[1,1,0]
    v_pk_fma_f32 v[84:85], v[84:85], s[68:69], s[68:69] op_sel:[0,1,0] op_sel_hi:[1,1,0]
    v_pk_fma_f32 v[86:87], v[86:87], s[68:69], s[68:69] op_sel:[0,1,0] op_sel_hi:[1,1,0]
    v_pk_mul_f32 v[80:81], v[80:81], v[56:57]
    v_pk_mul_f32 v[82:83], v[82:83], v[58:59]
    v_pk_mul_f32 v[84:85], v[84:85], v[60:61]
    v_pk_mul_f32 v[86:87], v[86:87], v[62:63]
    v_exp_f32 v80, v80
    v_exp_f32 v81, v81
    v_exp_f32 v82, v82
    buffer_load_dwordx4 v27, s[12:15], s71 offen offset:3072 lds
    v_exp_f32 v83, v83
    v_exp_f32 v84, v84
    v_exp_f32 v85, v85
    v_exp_f32 v86, v86
    v_exp_f32 v87, v87
    v_pk_add_f32 v[80:81], v[80:81], 1.0 op_sel_hi:[1,0]
    v_pk_add_f32 v[82:83], v[82:83], 1.0 op_sel_hi:[1,0]
    v_pk_add_f32 v[84:85], v[84:85], 1.0 op_sel_hi:[1,0]
    v_pk_add_f32 v[86:87], v[86:87], 1.0 op_sel_hi:[1,0]
    v_rcp_f32 v80, v80
    v_rcp_f32 v81, v81
    v_rcp_f32 v82, v82
    v_rcp_f32 v83, v83
    v_rcp_f32 v84, v84
    s_add_u32 m0, s61, 25600
    s_nop 0
    buffer_load_dwordx4 v28, s[12:15], s71 offen offset:0 lds
    v_rcp_f32 v85, v85
    v_rcp_f32 v86, v86
    v_rcp_f32 v87, v87
    v_pk_mul_f32 v[56:57], v[80:81], v[56:57]
    v_pk_mul_f32 v[58:59], v[82:83], v[58:59]
    v_pk_mul_f32 v[60:61], v[84:85], v[60:61]
    v_pk_mul_f32 v[62:63], v[86:87], v[62:63]
    v_pk_mul_f32 v[80:81], v[64:65], v[64:65]
    v_pk_mul_f32 v[82:83], v[66:67], v[66:67]
    v_pk_mul_f32 v[84:85], v[68:69], v[68:69]
    v_pk_mul_f32 v[86:87], v[70:71], v[70:71]
    v_pk_fma_f32 v[80:81], v[80:81], s[68:69], s[68:69] op_sel:[0,1,0] op_sel_hi:[1,1,0]
    v_pk_fma_f32 v[82:83], v[82:83], s[68:69], s[68:69] op_sel:[0,1,0] op_sel_hi:[1,1,0]
    v_pk_fma_f32 v[84:85], v[84:85], s[68:69], s[68:69] op_sel:[0,1,0] op_sel_hi:[1,1,0]
    v_pk_fma_f32 v[86:87], v[86:87], s[68:69], s[68:69] op_sel:[0,1,0] op_sel_hi:[1,1,0]
    v_pk_mul_f32 v[80:81], v[80:81], v[64:65]
    v_pk_mul_f32 v[82:83], v[82:83], v[66:67]
    v_pk_mul_f32 v[84:85], v[84:85], v[68:69]
    v_pk_mul_f32 v[86:87], v[86:87], v[70:71]
    v_exp_f32 v80, v80
    v_exp_f32 v81, v81
    v_exp_f32 v82, v82
    v_exp_f32 v83, v83
    v_exp_f32 v84, v84
    v_exp_f32 v85, v85
    v_exp_f32 v86, v86
    v_exp_f32 v87, v87
    v_pk_add_f32 v[80:81], v[80:81], 1.0 op_sel_hi:[1,0]
    v_pk_add_f32 v[82:83], v[82:83], 1.0 op_sel_hi:[1,0]
    v_pk_add_f32 v[84:85], v[84:85], 1.0 op_sel_hi:[1,0]
    v_pk_add_f32 v[86:87], v[86:87], 1.0 op_sel_hi:[1,0]
    v_rcp_f32 v80, v80
    v_rcp_f32 v81, v81
    v_rcp_f32 v82, v82
    v_rcp_f32 v83, v83
    v_rcp_f32 v84, v84
    v_rcp_f32 v85, v85
    v_rcp_f32 v86, v86
    v_rcp_f32 v87, v87
    v_pk_mul_f32 v[64:65], v[80:81], v[64:65]
    v_pk_mul_f32 v[66:67], v[82:83], v[66:67]
    v_pk_mul_f32 v[68:69], v[84:85], v[68:69]
    v_pk_mul_f32 v[70:71], v[86:87], v[70:71]
    v_pk_mul_f32 v[80:81], v[72:73], v[72:73]
    v_pk_mul_f32 v[82:83], v[74:75], v[74:75]
    v_pk_mul_f32 v[84:85], v[76:77], v[76:77]
    v_pk_mul_f32 v[86:87], v[78:79], v[78:79]
    v_pk_fma_f32 v[80:81], v[80:81], s[68:69], s[68:69] op_sel:[0,1,0] op_sel_hi:[1,1,0]
    v_pk_fma_f32 v[82:83], v[82:83], s[68:69], s[68:69] op_sel:[0,1,0] op_sel_hi:[1,1,0]
    v_pk_fma_f32 v[84:85], v[84:85], s[68:69], s[68:69] op_sel:[0,1,0] op_sel_hi:[1,1,0]
    v_pk_fma_f32 v[86:87], v[86:87], s[68:69], s[68:69] op_sel:[0,1,0] op_sel_hi:[1,1,0]
    v_pk_mul_f32 v[80:81], v[80:81], v[72:73]
    v_pk_mul_f32 v[82:83], v[82:83], v[74:75]
    v_pk_mul_f32 v[84:85], v[84:85], v[76:77]
    v_pk_mul_f32 v[86:87], v[86:87], v[78:79]
    v_exp_f32 v80, v80
    v_exp_f32 v81, v81
    v_exp_f32 v82, v82
    v_exp_f32 v83, v83
    v_exp_f32 v84, v84
    v_exp_f32 v85, v85
    v_exp_f32 v86, v86
    v_exp_f32 v87, v87
    v_pk_add_f32 v[80:81], v[80:81], 1.0 op_sel_hi:[1,0]
    v_pk_add_f32 v[82:83], v[82:83], 1.0 op_sel_hi:[1,0]
    v_pk_add_f32 v[84:85], v[84:85], 1.0 op_sel_hi:[1,0]
    v_pk_add_f32 v[86:87], v[86:87], 1.0 op_sel_hi:[1,0]
    v_rcp_f32 v80, v80
    v_rcp_f32 v81, v81
    v_rcp_f32 v82, v82
    v_rcp_f32 v83, v83
    v_rcp_f32 v84, v84
    v_rcp_f32 v85, v85
    v_rcp_f32 v86, v86
    v_rcp_f32 v87, v87
    v_pk_mul_f32 v[72:73], v[80:81], v[72:73]
    v_pk_mul_f32 v[74:75], v[82:83], v[74:75]
    v_pk_mul_f32 v[76:77], v[84:85], v[76:77]
    v_pk_mul_f32 v[78:79], v[86:87], v[78:79]
    v_pk_add_f32 v[88:89], v[48:49], v[50:51]
    v_pk_mul_f32 v[96:97], v[48:49], v[48:49]
    v_pk_fma_f32 v[96:97], v[50:51], v[50:51], v[96:97]
    v_pk_add_f32 v[88:89], v[88:89], v[52:53]
    v_pk_fma_f32 v[96:97], v[52:53], v[52:53], v[96:97]
    v_pk_add_f32 v[88:89], v[88:89], v[54:55]
    v_pk_fma_f32 v[96:97], v[54:55], v[54:55], v[96:97]
    v_pk_add_f32 v[90:91], v[56:57], v[58:59]
    v_pk_mul_f32 v[98:99], v[56:57], v[56:57]
    v_pk_fma_f32 v[98:99], v[58:59], v[58:59], v[98:99]
    v_pk_add_f32 v[90:91], v[90:91], v[60:61]
    v_pk_fma_f32 v[98:99], v[60:61], v[60:61], v[98:99]
    v_pk_add_f32 v[90:91], v[90:91], v[62:63]
    v_pk_fma_f32 v[98:99], v[62:63], v[62:63], v[98:99]
    v_pk_add_f32 v[92:93], v[64:65], v[66:67]
    v_pk_mul_f32 v[100:101], v[64:65], v[64:65]
    v_pk_fma_f32 v[100:101], v[66:67], v[66:67], v[100:101]
    v_pk_add_f32 v[92:93], v[92:93], v[68:69]
    v_pk_fma_f32 v[100:101], v[68:69], v[68:69], v[100:101]
    v_pk_add_f32 v[92:93], v[92:93], v[70:71]
    v_pk_fma_f32 v[100:101], v[70:71], v[70:71], v[100:101]
    v_pk_add_f32 v[94:95], v[72:73], v[74:75]
    v_pk_mul_f32 v[102:103], v[72:73], v[72:73]
    v_pk_fma_f32 v[102:103], v[74:75], v[74:75], v[102:103]
    v_pk_add_f32 v[94:95], v[94:95], v[76:77]
    v_pk_fma_f32 v[102:103], v[76:77], v[76:77], v[102:103]
    v_pk_add_f32 v[94:95], v[94:95], v[78:79]
    v_pk_fma_f32 v[102:103], v[78:79], v[78:79], v[102:103]
    s_cmp_eq_u32 s60, 0
    s_cselect_b32 s100, 0, 1.0
    v_pk_fma_f32 v[88:89], v[88:89], s[100:101], v[92:93] op_sel_hi:[1,0,1]
    v_pk_fma_f32 v[90:91], v[90:91], s[100:101], v[94:95] op_sel_hi:[1,0,1]
    v_pk_fma_f32 v[96:97], v[96:97], s[100:101], v[100:101] op_sel_hi:[1,0,1]
    v_pk_fma_f32 v[98:99], v[98:99], s[100:101], v[102:103] op_sel_hi:[1,0,1]
    v_add_f32 v88, v88, v89
    v_add_f32 v90, v90, v91
    v_add_f32 v96, v96, v97
    v_add_f32 v98, v98, v99
    s_lshl2_add_u32 s76, s57, s56
    s_mul_i32 s7, s76, 3584
    v_permlane32_swap_b32 v88, v96
    v_permlane32_swap_b32 v90, v98
    v_add_f32 v88, v88, v96
    v_add_f32 v90, v90, v98
    s_lshl_b32 s76, s60, 8
    s_add_u32 s76, s76, s7
    v_permlane16_swap_b32 v88, v90
    v_add_f32 v90, v90, v88
    s_waitcnt vmcnt(5)
    v_cmp_gt_u32 vcc, 32, v47
    s_nop 1
    s_cbranch_vccnz Lslow_1
Lback_2:
    buffer_store_dword v90, v31, s[48:51], s76 offen sc1
    s_barrier
    ds_read_b64_tr_b16 v[160:161], v18 offset:0
    ds_read_b64_tr_b16 v[162:163], v18 offset:1280
    ds_read_b64_tr_b16 v[164:165], v19 offset:0
    ds_read_b64_tr_b16 v[166:167], v19 offset:1280
    ds_read_b64_tr_b16 v[168:169], v18 offset:64
    ds_read_b64_tr_b16 v[170:171], v18 offset:1344
    ds_read_b64_tr_b16 v[172:173], v19 offset:64
    ds_read_b64_tr_b16 v[174:175], v19 offset:1344
    ds_read_b64_tr_b16 v[176:177], v18 offset:128
    ds_read_b64_tr_b16 v[178:179], v18 offset:1408
    ds_read_b64_tr_b16 v[180:181], v19 offset:128
    ds_read_b64_tr_b16 v[182:183], v19 offset:1408
    s_waitcnt lgkmcnt(10)
    v_mfma_f32_16x16x32_bf16 v[80:83], a[0:3], v[160:163], 0
    ds_read_b64_tr_b16 v[184:185], v18 offset:192
    ds_read_b64_tr_b16 v[186:187], v18 offset:1472
    ds_read_b64_tr_b16 v[188:189], v19 offset:192
    ds_read_b64_tr_b16 v[190:191], v19 offset:1472
    v_mfma_f32_16x16x32_bf16 v[84:87], a[4:7], v[160:163], 0
    s_bfe_u32 s71, s99, 0x40008
    s_mul_i32 s71, s71, 245760
    s_add_u32 s71, s71, s72
    s_add_u32 m0, s61, 26624
    s_nop 0
    buffer_load_dwordx4 v24, s[12:15], s71 offen offset:0 lds
    s_waitcnt lgkmcnt(12)
    v_mfma_f32_16x16x32_bf16 v[88:91], a[0:3], v[164:167], 0
    ds_read_b64_tr_b16 v[160:161], v18 offset:256
    ds_read_b64_tr_b16 v[162:163], v18 offset:1536
    v_mfma_f32_16x16x32_bf16 v[92:95], a[4:7], v[164:167], 0
    buffer_load_dwordx4 v25, s[12:15], s71 offen offset:1024 lds
    s_waitcnt lgkmcnt(6)
    v_mfma_f32_16x16x32_bf16 v[96:99], a[0:3], v[168:171], 0
    ds_read_b64_tr_b16 v[164:165], v19 offset:256
    ds_read_b64_tr_b16 v[166:167], v19 offset:1536
    v_mfma_f32_16x16x32_bf16 v[100:103], a[4:7], v[168:171], 0
    buffer_load_dwordx4 v26, s[12:15], s71 offen offset:2048 lds
    v_mfma_f32_16x16x32_bf16 v[104:107], a[0:3], v[172:175], 0
    ds_read_b64_tr_b16 v[168:169], v18 offset:40960
    ds_read_b64_tr_b16 v[170:171], v18 offset:42240
    v_mfma_f32_16x16x32_bf16 v[108:111], a[4:7], v[172:175], 0
    buffer_load_dwordx4 v27, s[12:15], s71 offen offset:3072 lds
    s_add_u32 m0, s61, 30720
    v_mfma_f32_16x16x32_bf16 v[112:115], a[0:3], v[176:179], 0
    ds_read_b64_tr_b16 v[172:173], v19 offset:40960
    ds_read_b64_tr_b16 v[174:175], v19 offset:42240
    v_mfma_f32_16x16x32_bf16 v[116:119], a[4:7], v[176:179], 0
    buffer_load_dwordx4 v28, s[12:15], s71 offen offset:0 lds
    s_bfe_u32 s71, s99, 0x4000c
    s_mul_i32 s71, s71, 245760
    s_add_u32 s71, s71, s72
    s_add_u32 m0, s61, 31744
    v_mfma_f32_16x16x32_bf16 v[120:123], a[0:3], v[180:183], 0
    ds_read_b64_tr_b16 v[176:177], v18 offset:41024
    ds_read_b64_tr_b16 v[178:179], v18 offset:42304
    v_mfma_f32_16x16x32_bf16 v[124:127], a[4:7], v[180:183], 0
    s_waitcnt lgkmcnt(6)
    v_mfma_f32_16x16x32_bf16 v[128:131], a[0:3], v[184:187], 0
    ds_read_b64_tr_b16 v[180:181], v19 offset:41024
    ds_read_b64_tr_b16 v[182:183], v19 offset:42304
    v_mfma_f32_16x16x32_bf16 v[132:135], a[4:7], v[184:187], 0
    v_mfma_f32_16x16x32_bf16 v[136:139], a[0:3], v[188:191], 0
    ds_read_b64_tr_b16 v[184:185], v18 offset:41088
    ds_read_b64_tr_b16 v[186:187], v18 offset:42368
    v_mfma_f32_16x16x32_bf16 v[140:143], a[4:7], v[188:191], 0
    v_mfma_f32_16x16x32_bf16 v[144:147], a[0:3], v[160:163], 0
    ds_read_b64_tr_b16 v[188:189], v19 offset:41088
    ds_read_b64_tr_b16 v[190:191], v19 offset:42368
    v_mfma_f32_16x16x32_bf16 v[148:151], a[4:7], v[160:163], 0
    v_mfma_f32_16x16x32_bf16 v[152:155], a[0:3], v[164:167], 0
    ds_read_b64_tr_b16 v[160:161], v18 offset:41152
    ds_read_b64_tr_b16 v[162:163], v18 offset:42432
    v_mfma_f32_16x16x32_bf16 v[156:159], a[4:7], v[164:167], 0
    s_waitcnt lgkmcnt(6)
    v_mfma_f32_16x16x32_bf16 v[80:83], a[8:11], v[168:171], v[80:83]
    ds_read_b64_tr_b16 v[164:165], v19 offset:41152
    ds_read_b64_tr_b16 v[166:167], v19 offset:42432
    v_mfma_f32_16x16x32_bf16 v[84:87], a[12:15], v[168:171], v[84:87]
    v_mfma_f32_16x16x32_bf16 v[88:91], a[8:11], v[172:175], v[88:91]
    ds_read_b64_tr_b16 v[168:169], v18 offset:41216
    ds_read_b64_tr_b16 v[170:171], v18 offset:42496
    v_mfma_f32_16x16x32_bf16 v[92:95], a[12:15], v[172:175], v[92:95]
    v_mfma_f32_16x16x32_bf16 v[96:99], a[8:11], v[176:179], v[96:99]
    ds_read_b64_tr_b16 v[172:173], v19 offset:41216
    ds_read_b64_tr_b16 v[174:175], v19 offset:42496
    v_mfma_f32_16x16x32_bf16 v[100:103], a[12:15], v[176:179], v[100:103]
    v_mfma_f32_16x16x32_bf16 v[104:107], a[8:11], v[180:183], v[104:107]
    v_mfma_f32_16x16x32_bf16 v[108:111], a[12:15], v[180:183], v[108:111]
    buffer_load_dwordx4 v24, s[12:15], s71 offen offset:0 lds
    s_waitcnt lgkmcnt(4)
    v_mfma_f32_16x16x32_bf16 v[112:115], a[8:11], v[184:187], v[112:115]
    v_mfma_f32_16x16x32_bf16 v[116:119], a[12:15], v[184:187], v[116:119]
    s_waitcnt vmcnt(7) lgkmcnt(0)
    s_barrier
    v_mfma_f32_16x16x32_bf16 v[120:123], a[8:11], v[188:191], v[120:123]
    ds_read_b64_tr_b16 v[176:177], v18 offset:5120
    ds_read_b64_tr_b16 v[178:179], v18 offset:6400
    ds_read_b64_tr_b16 v[180:181], v19 offset:5120
    ds_read_b64_tr_b16 v[182:183], v19 offset:6400
    v_mfma_f32_16x16x32_bf16 v[124:127], a[12:15], v[188:191], v[124:127]
    buffer_load_dwordx4 v25, s[12:15], s71 offen offset:1024 lds
    v_mfma_f32_16x16x32_bf16 v[128:131], a[8:11], v[160:163], v[128:131]
    ds_read_b64_tr_b16 v[184:185], v18 offset:5184
    ds_read_b64_tr_b16 v[186:187], v18 offset:6464
    ds_read_b64_tr_b16 v[188:189], v19 offset:5184
    ds_read_b64_tr_b16 v[190:191], v19 offset:6464
    v_mfma_f32_16x16x32_bf16 v[132:135], a[12:15], v[160:163], v[132:135]
    v_mfma_f32_16x16x32_bf16 v[136:139], a[8:11], v[164:167], v[136:139]
    ds_read_b64_tr_b16 v[160:161], v18 offset:5248
    ds_read_b64_tr_b16 v[162:163], v18 offset:6528
    v_mfma_f32_16x16x32_bf16 v[140:143], a[12:15], v[164:167], v[140:143]
    v_mfma_f32_16x16x32_bf16 v[144:147], a[8:11], v[168:171], v[144:147]
    ds_read_b64_tr_b16 v[164:165], v19 offset:5248
    ds_read_b64_tr_b16 v[166:167], v19 offset:6528
    v_mfma_f32_16x16x32_bf16 v[148:151], a[12:15], v[168:171], v[148:151]
    buffer_load_dwordx4 v26, s[12:15], s71 offen offset:2048 lds
    v_mfma_f32_16x16x32_bf16 v[152:155], a[8:11], v[172:175], v[152:155]
    ds_read_b64_tr_b16 v[168:169], v18 offset:5312
    ds_read_b64_tr_b16 v[170:171], v18 offset:6592
    v_mfma_f32_16x16x32_bf16 v[156:159], a[12:15], v[172:175], v[156:159]
    buffer_load_dwordx4 v27, s[12:15], s71 offen offset:3072 lds
    s_add_u32 m0, s61, 35840
    s_waitcnt lgkmcnt(6)
    v_mfma_f32_16x16x32_bf16 v[80:83], a[16:19], v[176:179], v[80:83]
    ds_read_b64_tr_b16 v[172:173], v19 offset:5312
    ds_read_b64_tr_b16 v[174:175], v19 offset:6592
    v_mfma_f32_16x16x32_bf16 v[84:87], a[20:23], v[176:179], v[84:87]
    buffer_load_dwordx4 v28, s[12:15], s71 offen offset:0 lds
    s_bfe_u32 s71, s99, 0x40010
    s_mul_i32 s71, s71, 245760
    s_add_u32 s71, s71, s72
    s_add_u32 m0, s61, 16384
    v_mfma_f32_16x16x32_bf16 v[88:91], a[16:19], v[180:183], v[88:91]
    ds_read_b64_tr_b16 v[176:177], v18 offset:5376
    ds_read_b64_tr_b16 v[178:179], v18 offset:6656
    v_mfma_f32_16x16x32_bf16 v[92:95], a[20:23], v[180:183], v[92:95]
    v_mfma_f32_16x16x32_bf16 v[96:99], a[16:19], v[184:187], v[96:99]
    ds_read_b64_tr_b16 v[180:181], v19 offset:5376
    ds_read_b64_tr_b16 v[182:183], v19 offset:6656
    v_mfma_f32_16x16x32_bf16 v[100:103], a[20:23], v[184:187], v[100:103]
    v_mfma_f32_16x16x32_bf16 v[104:107], a[16:19], v[188:191], v[104:107]
    ds_read_b64_tr_b16 v[184:185], v18 offset:46080
    ds_read_b64_tr_b16 v[186:187], v18 offset:47360
    v_mfma_f32_16x16x32_bf16 v[108:111], a[20:23], v[188:191], v[108:111]
    s_waitcnt lgkmcnt(6)
    v_mfma_f32_16x16x32_bf16 v[112:115], a[16:19], v[160:163], v[112:115]
    ds_read_b64_tr_b16 v[188:189], v19 offset:46080
    ds_read_b64_tr_b16 v[190:191], v19 offset:47360
    v_mfma_f32_16x16x32_bf16 v[116:119], a[20:23], v[160:163], v[116:119]
    v_mfma_f32_16x16x32_bf16 v[120:123], a[16:19], v[164:167], v[120:123]
    ds_read_b64_tr_b16 v[160:161], v18 offset:46144
    ds_read_b64_tr_b16 v[162:163], v18 offset:47424
    v_mfma_f32_16x16x32_bf16 v[124:127], a[20:23], v[164:167], v[124:127]
    buffer_load_dword v192, v31, s[48:51], s7 offen offset:0 sc1
    buffer_load_dword v193, v31, s[48:51], s7 offen offset:256 sc1
    v_mfma_f32_16x16x32_bf16 v[128:131], a[16:19], v[168:171], v[128:131]
    ds_read_b64_tr_b16 v[164:165], v19 offset:46144
    ds_read_b64_tr_b16 v[166:167], v19 offset:47424
    v_mfma_f32_16x16x32_bf16 v[132:135], a[20:23], v[168:171], v[132:135]
    buffer_load_dword v194, v31, s[48:51], s7 offen offset:512 sc1
    buffer_load_dword v195, v31, s[48:51], s7 offen offset:768 sc1
    v_mfma_f32_16x16x32_bf16 v[136:139], a[16:19], v[172:175], v[136:139]
    ds_read_b64_tr_b16 v[168:169], v18 offset:46208
    ds_read_b64_tr_b16 v[170:171], v18 offset:47488
    v_mfma_f32_16x16x32_bf16 v[140:143], a[20:23], v[172:175], v[140:143]
    buffer_load_dword v196, v31, s[48:51], s7 offen offset:1024 sc1
    s_waitcnt lgkmcnt(6)
    v_mfma_f32_16x16x32_bf16 v[144:147], a[16:19], v[176:179], v[144:147]
    ds_read_b64_tr_b16 v[172:173], v19 offset:46208
    ds_read_b64_tr_b16 v[174:175], v19 offset:47488
    v_mfma_f32_16x16x32_bf16 v[148:151], a[20:23], v[176:179], v[148:151]
    buffer_load_dword v197, v31, s[48:51], s7 offen offset:1280 sc1
    buffer_load_dword v198, v31, s[48:51], s7 offen offset:1536 sc1
    v_mfma_f32_16x16x32_bf16 v[152:155], a[16:19], v[180:183], v[152:155]
    ds_read_b64_tr_b16 v[176:177], v18 offset:46272
    ds_read_b64_tr_b16 v[178:179], v18 offset:47552
    v_mfma_f32_16x16x32_bf16 v[156:159], a[20:23], v[180:183], v[156:159]
    buffer_load_dword v199, v31, s[48:51], s7 offen offset:1792 sc1
    buffer_load_dword v200, v31, s[48:51], s7 offen offset:2048 sc1
    v_mfma_f32_16x16x32_bf16 v[80:83], a[24:27], v[184:187], v[80:83]
    ds_read_b64_tr_b16 v[180:181], v19 offset:46272
    ds_read_b64_tr_b16 v[182:183], v19 offset:47552
    v_mfma_f32_16x16x32_bf16 v[84:87], a[28:31], v[184:187], v[84:87]
    buffer_load_dword v201, v31, s[48:51], s7 offen offset:2304 sc1
    buffer_load_dword v202, v31, s[48:51], s7 offen offset:2560 sc1
    v_mfma_f32_16x16x32_bf16 v[88:91], a[24:27], v[188:191], v[88:91]
    ds_read_b64_tr_b16 v[184:185], v18 offset:46336
    ds_read_b64_tr_b16 v[186:187], v18 offset:47616
    v_mfma_f32_16x16x32_bf16 v[92:95], a[28:31], v[188:191], v[92:95]
    buffer_load_dword v203, v31, s[48:51], s7 offen offset:2816 sc1
    s_waitcnt lgkmcnt(6)
    v_mfma_f32_16x16x32_bf16 v[96:99], a[24:27], v[160:163], v[96:99]
    ds_read_b64_tr_b16 v[188:189], v19 offset:46336
    ds_read_b64_tr_b16 v[190:191], v19 offset:47616
    v_mfma_f32_16x16x32_bf16 v[100:103], a[28:31], v[160:163], v[100:103]
    buffer_load_dword v204, v31, s[48:51], s7 offen offset:3072 sc1
    buffer_load_dword v205, v31, s[48:51], s7 offen offset:3328 sc1
    v_mfma_f32_16x16x32_bf16 v[104:107], a[24:27], v[164:167], v[104:107]
    v_mfma_f32_16x16x32_bf16 v[108:111], a[28:31], v[164:167], v[108:111]
    buffer_load_dwordx4 v24, s[12:15], s71 offen offset:0 lds
    v_mfma_f32_16x16x32_bf16 v[112:115], a[24:27], v[168:171], v[112:115]
    v_mfma_f32_16x16x32_bf16 v[116:119], a[28:31], v[168:171], v[116:119]
    s_waitcnt vmcnt(20) lgkmcnt(0)
    s_barrier
    v_mfma_f32_16x16x32_bf16 v[120:123], a[24:27], v[172:175], v[120:123]
    ds_read_b64_tr_b16 v[160:161], v18 offset:10240
    ds_read_b64_tr_b16 v[162:163], v18 offset:11520
    ds_read_b64_tr_b16 v[164:165], v19 offset:10240
    ds_read_b64_tr_b16 v[166:167], v19 offset:11520
    v_mfma_f32_16x16x32_bf16 v[124:127], a[28:31], v[172:175], v[124:127]
    v_mfma_f32_16x16x32_bf16 v[128:131], a[24:27], v[176:179], v[128:131]
    ds_read_b64_tr_b16 v[168:169], v18 offset:10304
    ds_read_b64_tr_b16 v[170:171], v18 offset:11584
    ds_read_b64_tr_b16 v[172:173], v19 offset:10304
    ds_read_b64_tr_b16 v[174:175], v19 offset:11584
    v_mfma_f32_16x16x32_bf16 v[132:135], a[28:31], v[176:179], v[132:135]
    buffer_load_dwordx4 v25, s[12:15], s71 offen offset:1024 lds
    v_mfma_f32_16x16x32_bf16 v[136:139], a[24:27], v[180:183], v[136:139]
    ds_read_b64_tr_b16 v[176:177], v18 offset:10368
    ds_read_b64_tr_b16 v[178:179], v18 offset:11648
    v_mfma_f32_16x16x32_bf16 v[140:143], a[28:31], v[180:183], v[140:143]
    v_mfma_f32_16x16x32_bf16 v[144:147], a[24:27], v[184:187], v[144:147]
    ds_read_b64_tr_b16 v[180:181], v19 offset:10368
    ds_read_b64_tr_b16 v[182:183], v19 offset:11648
    v_mfma_f32_16x16x32_bf16 v[148:151], a[28:31], v[184:187], v[148:151]
    buffer_load_dwordx4 v26, s[12:15], s71 offen offset:2048 lds
    v_mfma_f32_16x16x32_bf16 v[152:155], a[24:27], v[188:191], v[152:155]
    ds_read_b64_tr_b16 v[184:185], v18 offset:10432
    ds_read_b64_tr_b16 v[186:187], v18 offset:11712
    v_mfma_f32_16x16x32_bf16 v[156:159], a[28:31], v[188:191], v[156:159]
    buffer_load_dwordx4 v27, s[12:15], s71 offen offset:3072 lds
    s_add_u32 m0, s61, 20480
    s_waitcnt lgkmcnt(6)
    v_mfma_f32_16x16x32_bf16 v[80:83], a[32:35], v[160:163], v[80:83]
    ds_read_b64_tr_b16 v[188:189], v19 offset:10432
    ds_read_b64_tr_b16 v[190:191], v19 offset:11712
    v_mfma_f32_16x16x32_bf16 v[84:87], a[36:39], v[160:163], v[84:87]
    buffer_load_dwordx4 v28, s[12:15], s71 offen offset:0 lds
    s_bfe_u32 s71, s99, 0x40014
    s_mul_i32 s71, s71, 245760
    s_add_u32 s71, s71, s72
    s_add_u32 m0, s61, 21504
    v_mfma_f32_16x16x32_bf16 v[88:91], a[32:35], v[164:167], v[88:91]
    ds_read_b64_tr_b16 v[160:161], v18 offset:10496
    ds_read_b64_tr_b16 v[162:163], v18 offset:11776
    v_mfma_f32_16x16x32_bf16 v[92:95], a[36:39], v[164:167], v[92:95]
    v_mfma_f32_16x16x32_bf16 v[96:99], a[32:35], v[168:171], v[96:99]
    ds_read_b64_tr_b16 v[164:165], v19 offset:10496
    ds_read_b64_tr_b16 v[166:167], v19 offset:11776
    v_mfma_f32_16x16x32_bf16 v[100:103], a[36:39], v[168:171], v[100:103]
    v_mfma_f32_16x16x32_bf16 v[104:107], a[32:35], v[172:175], v[104:107]
    ds_read_b64_tr_b16 v[168:169], v18 offset:51200
    ds_read_b64_tr_b16 v[170:171], v18 offset:52480
    v_mfma_f32_16x16x32_bf16 v[108:111], a[36:39], v[172:175], v[108:111]
    s_waitcnt lgkmcnt(6)
    v_mfma_f32_16x16x32_bf16 v[112:115], a[32:35], v[176:179], v[112:115]
    ds_read_b64_tr_b16 v[172:173], v19 offset:51200
    ds_read_b64_tr_b16 v[174:175], v19 offset:52480
    v_mfma_f32_16x16x32_bf16 v[116:119], a[36:39], v[176:179], v[116:119]
    v_mfma_f32_16x16x32_bf16 v[120:123], a[32:35], v[180:183], v[120:123]
    ds_read_b64_tr_b16 v[176:177], v18 offset:51264
    ds_read_b64_tr_b16 v[178:179], v18 offset:52544
    v_mfma_f32_16x16x32_bf16 v[124:127], a[36:39], v[180:183], v[124:127]
    v_mfma_f32_16x16x32_bf16 v[128:131], a[32:35], v[184:187], v[128:131]
    ds_read_b64_tr_b16 v[180:181], v19 offset:51264
    ds_read_b64_tr_b16 v[182:183], v19 offset:52544
    v_mfma_f32_16x16x32_bf16 v[132:135], a[36:39], v[184:187], v[132:135]
    v_mfma_f32_16x16x32_bf16 v[136:139], a[32:35], v[188:191], v[136:139]
    ds_read_b64_tr_b16 v[184:185], v18 offset:51328
    ds_read_b64_tr_b16 v[186:187], v18 offset:52608
    v_mfma_f32_16x16x32_bf16 v[140:143], a[36:39], v[188:191], v[140:143]
    buffer_load_dwordx4 v24, s[12:15], s71 offen offset:0 lds
    s_waitcnt lgkmcnt(6)
    v_mfma_f32_16x16x32_bf16 v[144:147], a[32:35], v[160:163], v[144:147]
    ds_read_b64_tr_b16 v[188:189], v19 offset:51328
    ds_read_b64_tr_b16 v[190:191], v19 offset:52608
    v_mfma_f32_16x16x32_bf16 v[148:151], a[36:39], v[160:163], v[148:151]
    v_mfma_f32_16x16x32_bf16 v[152:155], a[32:35], v[164:167], v[152:155]
    ds_read_b64_tr_b16 v[160:161], v18 offset:51392
    ds_read_b64_tr_b16 v[162:163], v18 offset:52672
    v_mfma_f32_16x16x32_bf16 v[156:159], a[36:39], v[164:167], v[156:159]
    s_waitcnt vmcnt(6)
    v_add_f32 v192, v192, v194
    v_add_f32 v193, v193, v195
    v_add_f32 v192, v192, v196
    v_mfma_f32_16x16x32_bf16 v[80:83], a[40:43], v[168:171], v[80:83]
    ds_read_b64_tr_b16 v[164:165], v19 offset:51392
    ds_read_b64_tr_b16 v[166:167], v19 offset:52672
    v_mfma_f32_16x16x32_bf16 v[84:87], a[44:47], v[168:171], v[84:87]
    buffer_load_dwordx4 v25, s[12:15], s71 offen offset:1024 lds
    v_add_f32 v193, v193, v197
    v_add_f32 v192, v192, v198
    v_add_f32 v193, v193, v199
    v_add_f32 v192, v192, v200
    v_add_f32 v193, v193, v201
    v_mfma_f32_16x16x32_bf16 v[88:91], a[40:43], v[172:175], v[88:91]
    ds_read_b64_tr_b16 v[168:169], v18 offset:51456
    ds_read_b64_tr_b16 v[170:171], v18 offset:52736
    v_mfma_f32_16x16x32_bf16 v[92:95], a[44:47], v[172:175], v[92:95]
    v_add_f32 v192, v192, v202
    v_add_f32 v193, v193, v203
    v_add_f32 v192, v192, v204
    v_add_f32 v193, v193, v205
    v_cmp_u_f32 vcc, v192, v193
    s_nop 1
    s_cbranch_vccnz Lslow_4
Lback_5:
    s_waitcnt lgkmcnt(6)
    v_mfma_f32_16x16x32_bf16 v[96:99], a[40:43], v[176:179], v[96:99]
    ds_read_b64_tr_b16 v[172:173], v19 offset:51456
    ds_read_b64_tr_b16 v[174:175], v19 offset:52736
    v_mfma_f32_16x16x32_bf16 v[100:103], a[44:47], v[176:179], v[100:103]
    buffer_load_dwordx4 v26, s[12:15], s71 offen offset:2048 lds
    v_add_f32 v192, v192, v193
    v_mul_f32 v192, 0x3a97b426, v192
    v_mov_b32 v193, v192
    v_mfma_f32_16x16x32_bf16 v[104:107], a[40:43], v[180:183], v[104:107]
    v_mfma_f32_16x16x32_bf16 v[108:111], a[44:47], v[180:183], v[108:111]
    v_permlane32_swap_b32 v192, v193
    v_fma_f32 v193, -v192, v192, v193
    v_max_f32 v193, 0, v193
    v_add_f32 v193, 0x3727c5ac, v193
    v_rsq_f32 v194, v193
    s_nop 0
    v_mfma_f32_16x16x32_bf16 v[112:115], a[40:43], v[184:187], v[112:115]
    v_mul_f32_e64 v195, -v192, v194
    v_mov_b32 v196, v194
    v_mfma_f32_16x16x32_bf16 v[116:119], a[44:47], v[184:187], v[116:119]
    buffer_load_dwordx4 v27, s[12:15], s71 offen offset:3072 lds
    v_mov_b32 v197, v195
    v_permlane16_swap_b32 v194, v196
    s_waitcnt lgkmcnt(0)
    s_barrier
    v_mfma_f32_16x16x32_bf16 v[120:123], a[40:43], v[188:191], v[120:123]
    ds_read_b64_tr_b16 v[176:177], v18 offset:15360
    ds_read_b64_tr_b16 v[178:179], v18 offset:16640
    ds_read_b64_tr_b16 v[180:181], v19 offset:15360
    ds_read_b64_tr_b16 v[182:183], v19 offset:16640
    v_mfma_f32_16x16x32_bf16 v[124:127], a[44:47], v[188:191], v[124:127]
    s_add_u32 m0, s61, 25600
    v_permlane16_swap_b32 v195, v197
    v_fma_f32 v48, v48, v194, v195
    v_fma_f32 v49, v49, v194, v195
    v_fma_f32 v50, v50, v194, v195
    v_fma_f32 v51, v51, v194, v195
    v_cvt_pk_bf16_f32 v208, v48, v49
    v_mfma_f32_16x16x32_bf16 v[128:131], a[40:43], v[160:163], v[128:131]
    ds_read_b64_tr_b16 v[184:185], v18 offset:15424
    ds_read_b64_tr_b16 v[186:187], v18 offset:16704
    ds_read_b64_tr_b16 v[188:189], v19 offset:15424
    ds_read_b64_tr_b16 v[190:191], v19 offset:16704
    v_mfma_f32_16x16x32_bf16 v[132:135], a[44:47], v[160:163], v[132:135]
    buffer_load_dwordx4 v28, s[12:15], s71 offen offset:0 lds
    s_bfe_u32 s71, s99, 0x40018
    s_mul_i32 s71, s71, 245760
    s_add_u32 s71, s71, s72
    v_cvt_pk_bf16_f32 v209, v50, v51
    v_mfma_f32_16x16x32_bf16 v[136:139], a[40:43], v[164:167], v[136:139]
    ds_read_b64_tr_b16 v[160:161], v18 offset:15488
    ds_read_b64_tr_b16 v[162:163], v18 offset:16768
    v_mfma_f32_16x16x32_bf16 v[140:143], a[44:47], v[164:167], v[140:143]
    ds_write_b64 v240, v[208:209] offset:12288
    s_add_u32 m0, s61, 26624
    v_fma_f32 v52, v52, v194, v195
    v_fma_f32 v53, v53, v194, v195
    v_fma_f32 v54, v54, v194, v195
    v_fma_f32 v55, v55, v194, v195
    v_mfma_f32_16x16x32_bf16 v[144:147], a[40:43], v[168:171], v[144:147]
    ds_read_b64_tr_b16 v[164:165], v19 offset:15488
    ds_read_b64_tr_b16 v[166:167], v19 offset:16768
    v_mfma_f32_16x16x32_bf16 v[148:151], a[44:47], v[168:171], v[148:151]
    buffer_load_dwordx4 v24, s[12:15], s71 offen offset:0 lds
    v_cvt_pk_bf16_f32 v210, v52, v53
    v_cvt_pk_bf16_f32 v211, v54, v55
    v_mfma_f32_16x16x32_bf16 v[152:155], a[40:43], v[172:175], v[152:155]
    ds_read_b64_tr_b16 v[168:169], v18 offset:15552
    ds_read_b64_tr_b16 v[170:171], v18 offset:16832
    v_mfma_f32_16x16x32_bf16 v[156:159], a[44:47], v[172:175], v[156:159]
    ds_write_b64 v241, v[210:211] offset:12288
    v_fma_f32 v56, v56, v196, v197
    v_fma_f32 v57, v57, v196, v197
    v_fma_f32 v58, v58, v196, v197
    v_fma_f32 v59, v59, v196, v197
    v_cvt_pk_bf16_f32 v212, v56, v57
    s_waitcnt lgkmcnt(8)
    v_mfma_f32_16x16x32_bf16 v[80:83], a[48:51], v[176:179], v[80:83]
    ds_read_b64_tr_b16 v[172:173], v19 offset:15552
    ds_read_b64_tr_b16 v[174:175], v19 offset:16832
    v_mfma_f32_16x16x32_bf16 v[84:87], a[52:55], v[176:179], v[84:87]
    buffer_load_dwordx4 v25, s[12:15], s71 offen offset:1024 lds
    v_cvt_pk_bf16_f32 v213, v58, v59
    v_mfma_f32_16x16x32_bf16 v[88:91], a[48:51], v[180:183], v[88:91]
    ds_read_b64_tr_b16 v[176:177], v18 offset:15616
    ds_read_b64_tr_b16 v[178:179], v18 offset:16896
    v_mfma_f32_16x16x32_bf16 v[92:95], a[52:55], v[180:183], v[92:95]
    ds_write_b64 v240, v[212:213] offset:14336
    v_fma_f32 v60, v60, v196, v197
    v_fma_f32 v61, v61, v196, v197
    v_fma_f32 v62, v62, v196, v197
    v_fma_f32 v63, v63, v196, v197
    v_cvt_pk_bf16_f32 v214, v60, v61
    v_mfma_f32_16x16x32_bf16 v[96:99], a[48:51], v[184:187], v[96:99]
    ds_read_b64_tr_b16 v[180:181], v19 offset:15616
    ds_read_b64_tr_b16 v[182:183], v19 offset:16896
    v_mfma_f32_16x16x32_bf16 v[100:103], a[52:55], v[184:187], v[100:103]
    buffer_load_dwordx4 v26, s[12:15], s71 offen offset:2048 lds
    v_cvt_pk_bf16_f32 v215, v62, v63
    v_mfma_f32_16x16x32_bf16 v[104:107], a[48:51], v[188:191], v[104:107]
    ds_read_b64_tr_b16 v[184:185], v18 offset:56320
    ds_read_b64_tr_b16 v[186:187], v18 offset:57600
    v_mfma_f32_16x16x32_bf16 v[108:111], a[52:55], v[188:191], v[108:111]
    ds_write_b64 v241, v[214:215] offset:14336
    v_fma_f32 v64, v64, v194, v195
    v_fma_f32 v65, v65, v194, v195
    v_fma_f32 v66, v66, v194, v195
    v_fma_f32 v67, v67, v194, v195
    v_cvt_pk_bf16_f32 v216, v64, v65
    s_waitcnt lgkmcnt(8)
    v_mfma_f32_16x16x32_bf16 v[112:115], a[48:51], v[160:163], v[112:115]
    ds_read_b64_tr_b16 v[188:189], v19 offset:56320
    ds_read_b64_tr_b16 v[190:191], v19 offset:57600
    v_mfma_f32_16x16x32_bf16 v[116:119], a[52:55], v[160:163], v[116:119]
    buffer_load_dwordx4 v27, s[12:15], s71 offen offset:3072 lds
    v_cvt_pk_bf16_f32 v217, v66, v67
    v_mfma_f32_16x16x32_bf16 v[120:123], a[48:51], v[164:167], v[120:123]
    ds_read_b64_tr_b16 v[160:161], v18 offset:56384
    ds_read_b64_tr_b16 v[162:163], v18 offset:57664
    v_mfma_f32_16x16x32_bf16 v[124:127], a[52:55], v[164:167], v[124:127]
    ds_write_b64 v242, v[216:217] offset:12288
    s_add_u32 m0, s61, 30720
    v_fma_f32 v68, v68, v194, v195
    v_fma_f32 v69, v69, v194, v195
    v_fma_f32 v70, v70, v194, v195
    v_fma_f32 v71, v71, v194, v195
    v_mfma_f32_16x16x32_bf16 v[128:131], a[48:51], v[168:171], v[128:131]
    ds_read_b64_tr_b16 v[164:165], v19 offset:56384
    ds_read_b64_tr_b16 v[166:167], v19 offset:57664
    v_mfma_f32_16x16x32_bf16 v[132:135], a[52:55], v[168:171], v[132:135]
    buffer_load_dwordx4 v28, s[12:15], s71 offen offset:0 lds
    s_bfe_u32 s71, s99, 0x4001c
    s_mul_i32 s71, s71, 245760
    s_add_u32 s71, s71, s72
    v_cvt_pk_bf16_f32 v218, v68, v69
    v_cvt_pk_bf16_f32 v219, v70, v71
    v_mfma_f32_16x16x32_bf16 v[136:139], a[48:51], v[172:175], v[136:139]
    ds_read_b64_tr_b16 v[168:169], v18 offset:56448
    ds_read_b64_tr_b16 v[170:171], v18 offset:57728
    v_mfma_f32_16x16x32_bf16 v[140:143], a[52:55], v[172:175], v[140:143]
    ds_write_b64 v243, v[218:219] offset:12288
    s_add_u32 m0, s61, 0
    v_fma_f32 v72, v72, v196, v197
    v_fma_f32 v73, v73, v196, v197
    v_fma_f32 v74, v74, v196, v197
    v_fma_f32 v75, v75, v196, v197
    s_waitcnt lgkmcnt(8)
    v_mfma_f32_16x16x32_bf16 v[144:147], a[48:51], v[176:179], v[144:147]
    ds_read_b64_tr_b16 v[172:173], v19 offset:56448
    ds_read_b64_tr_b16 v[174:175], v19 offset:57728
    v_mfma_f32_16x16x32_bf16 v[148:151], a[52:55], v[176:179], v[148:151]
    buffer_load_dwordx4 v32, s[24:27], s82 offen offset:0 lds
    v_cvt_pk_bf16_f32 v220, v72, v73
    v_cvt_pk_bf16_f32 v221, v74, v75
    v_mfma_f32_16x16x32_bf16 v[152:155], a[48:51], v[180:183], v[152:155]
    ds_read_b64_tr_b16 v[176:177], v18 offset:56512
    ds_read_b64_tr_b16 v[178:179], v18 offset:57792
    v_mfma_f32_16x16x32_bf16 v[156:159], a[52:55], v[180:183], v[156:159]
    ds_write_b64 v242, v[220:221] offset:14336
    buffer_load_dwordx4 v33, s[24:27], s82 offen offset:1024 lds
    v_fma_f32 v76, v76, v196, v197
    v_fma_f32 v77, v77, v196, v197
    v_fma_f32 v78, v78, v196, v197
    v_fma_f32 v79, v79, v196, v197
    v_mfma_f32_16x16x32_bf16 v[80:83], a[56:59], v[184:187], v[80:83]
    ds_read_b64_tr_b16 v[180:181], v19 offset:56512
    ds_read_b64_tr_b16 v[182:183], v19 offset:57792
    v_mfma_f32_16x16x32_bf16 v[84:87], a[60:63], v[184:187], v[84:87]
    v_cvt_pk_bf16_f32 v222, v76, v77
    v_cvt_pk_bf16_f32 v223, v78, v79
    v_mfma_f32_16x16x32_bf16 v[88:91], a[56:59], v[188:191], v[88:91]
    ds_read_b64_tr_b16 v[184:185], v18 offset:56576
    ds_read_b64_tr_b16 v[186:187], v18 offset:57856
    v_mfma_f32_16x16x32_bf16 v[92:95], a[60:63], v[188:191], v[92:95]
    ds_write_b64 v243, v[222:223] offset:14336
    ds_read_b64_tr_b16 v[224:225], v245 offset:12288
    ds_read_b64_tr_b16 v[226:227], v246 offset:12800
    ds_read_b64_tr_b16 v[228:229], v246 offset:12288
    buffer_load_dwordx4 v34, s[24:27], s82 offen offset:2048 lds
    s_waitcnt lgkmcnt(11)
    v_mfma_f32_16x16x32_bf16 v[96:99], a[56:59], v[160:163], v[96:99]
    ds_read_b64_tr_b16 v[188:189], v19 offset:56576
    ds_read_b64_tr_b16 v[190:191], v19 offset:57856
    v_mfma_f32_16x16x32_bf16 v[100:103], a[60:63], v[160:163], v[100:103]
    ds_read_b64_tr_b16 v[230:231], v245 offset:12800
    ds_read_b64_tr_b16 v[232:233], v247 offset:12288
    ds_read_b64_tr_b16 v[234:235], v248 offset:12800
    ds_read_b64_tr_b16 v[236:237], v248 offset:12288
    buffer_load_dwordx4 v35, s[24:27], s82 offen offset:3072 lds
    v_mfma_f32_16x16x32_bf16 v[104:107], a[56:59], v[164:167], v[104:107]
    v_mfma_f32_16x16x32_bf16 v[108:111], a[60:63], v[164:167], v[108:111]
    ds_read_b64_tr_b16 v[238:239], v247 offset:12800
    s_add_u32 m0, s61, 4096
    s_add_u32 s6, s82, 128
    v_mfma_f32_16x16x32_bf16 v[112:115], a[56:59], v[168:171], v[112:115]
    v_mfma_f32_16x16x32_bf16 v[116:119], a[60:63], v[168:171], v[116:119]
    buffer_load_dwordx4 v32, s[24:27], s6 offen offset:0 lds
    s_waitcnt vmcnt(15) lgkmcnt(0)
    s_barrier
    v_mfma_f32_16x16x32_bf16 v[120:123], a[56:59], v[172:175], v[120:123]
    ds_read_b64_tr_b16 v[160:161], v18 offset:0
    ds_read_b64_tr_b16 v[162:163], v18 offset:1280
    ds_read_b64_tr_b16 v[164:165], v19 offset:0
    ds_read_b64_tr_b16 v[166:167], v19 offset:1280
    v_mfma_f32_16x16x32_bf16 v[124:127], a[60:63], v[172:175], v[124:127]
    v_mfma_f32_16x16x32_bf16 v[128:131], a[56:59], v[176:179], v[128:131]
    ds_read_b64_tr_b16 v[168:169], v18 offset:64
    ds_read_b64_tr_b16 v[170:171], v18 offset:1344
    ds_read_b64_tr_b16 v[172:173], v19 offset:64
    ds_read_b64_tr_b16 v[174:175], v19 offset:1344
    v_mfma_f32_16x16x32_bf16 v[132:135], a[60:63], v[176:179], v[132:135]
    buffer_store_dwordx4 v[224:227], v29, s[48:51], s80 offen offset:0 sc1
    v_mfma_f32_16x16x32_bf16 v[136:139], a[56:59], v[180:183], v[136:139]
    ds_read_b64_tr_b16 v[176:177], v18 offset:128
    ds_read_b64_tr_b16 v[178:179], v18 offset:1408
    v_mfma_f32_16x16x32_bf16 v[140:143], a[60:63], v[180:183], v[140:143]
    v_mfma_f32_16x16x32_bf16 v[144:147], a[56:59], v[184:187], v[144:147]
    ds_read_b64_tr_b16 v[180:181], v19 offset:128
    ds_read_b64_tr_b16 v[182:183], v19 offset:1408
    v_mfma_f32_16x16x32_bf16 v[148:151], a[60:63], v[184:187], v[148:151]
    v_mfma_f32_16x16x32_bf16 v[152:155], a[56:59], v[188:191], v[152:155]
    ds_read_b64_tr_b16 v[184:185], v18 offset:192
    ds_read_b64_tr_b16 v[186:187], v18 offset:1472
    v_mfma_f32_16x16x32_bf16 v[156:159], a[60:63], v[188:191], v[156:159]
    buffer_store_dwordx4 v[228:231], v29, s[48:51], s80 offen offset:1024 sc1
    s_waitcnt lgkmcnt(6)
    v_mfma_f32_16x16x32_bf16 v[80:83], a[64:67], v[160:163], v[80:83]
    ds_read_b64_tr_b16 v[188:189], v19 offset:192
    ds_read_b64_tr_b16 v[190:191], v19 offset:1472
    v_mfma_f32_16x16x32_bf16 v[84:87], a[68:71], v[160:163], v[84:87]
    v_mfma_f32_16x16x32_bf16 v[88:91], a[64:67], v[164:167], v[88:91]
    ds_read_b64_tr_b16 v[160:161], v18 offset:256
    ds_read_b64_tr_b16 v[162:163], v18 offset:1536
    v_mfma_f32_16x16x32_bf16 v[92:95], a[68:71], v[164:167], v[92:95]
    v_mfma_f32_16x16x32_bf16 v[96:99], a[64:67], v[168:171], v[96:99]
    ds_read_b64_tr_b16 v[164:165], v19 offset:256
    ds_read_b64_tr_b16 v[166:167], v19 offset:1536
    v_mfma_f32_16x16x32_bf16 v[100:103], a[68:71], v[168:171], v[100:103]
    buffer_store_dwordx4 v[232:235], v29, s[48:51], s80 offen offset:2048 sc1
    v_mfma_f32_16x16x32_bf16 v[104:107], a[64:67], v[172:175], v[104:107]
    ds_read_b64_tr_b16 v[168:169], v18 offset:40960
    ds_read_b64_tr_b16 v[170:171], v18 offset:42240
    v_mfma_f32_16x16x32_bf16 v[108:111], a[68:71], v[172:175], v[108:111]
    s_waitcnt lgkmcnt(6)
    v_mfma_f32_16x16x32_bf16 v[112:115], a[64:67], v[176:179], v[112:115]
    ds_read_b64_tr_b16 v[172:173], v19 offset:40960
    ds_read_b64_tr_b16 v[174:175], v19 offset:42240
    v_mfma_f32_16x16x32_bf16 v[116:119], a[68:71], v[176:179], v[116:119]
    v_mfma_f32_16x16x32_bf16 v[120:123], a[64:67], v[180:183], v[120:123]
    ds_read_b64_tr_b16 v[176:177], v18 offset:41024
    ds_read_b64_tr_b16 v[178:179], v18 offset:42304
    v_mfma_f32_16x16x32_bf16 v[124:127], a[68:71], v[180:183], v[124:127]
    buffer_store_dwordx4 v[236:239], v29, s[48:51], s80 offen offset:3072 sc1
    v_mfma_f32_16x16x32_bf16 v[128:131], a[64:67], v[184:187], v[128:131]
    ds_read_b64_tr_b16 v[180:181], v19 offset:41024
    ds_read_b64_tr_b16 v[182:183], v19 offset:42304
    v_mfma_f32_16x16x32_bf16 v[132:135], a[68:71], v[184:187], v[132:135]
    v_mfma_f32_16x16x32_bf16 v[136:139], a[64:67], v[188:191], v[136:139]
    ds_read_b64_tr_b16 v[184:185], v18 offset:41088
    ds_read_b64_tr_b16 v[186:187], v18 offset:42368
    v_mfma_f32_16x16x32_bf16 v[140:143], a[68:71], v[188:191], v[140:143]
    s_waitcnt lgkmcnt(6)
    v_mfma_f32_16x16x32_bf16 v[144:147], a[64:67], v[160:163], v[144:147]
    ds_read_b64_tr_b16 v[188:189], v19 offset:41088
    ds_read_b64_tr_b16 v[190:191], v19 offset:42368
    v_mfma_f32_16x16x32_bf16 v[148:151], a[68:71], v[160:163], v[148:151]
    buffer_load_dwordx4 v33, s[24:27], s6 offen offset:1024 lds
    v_mfma_f32_16x16x32_bf16 v[152:155], a[64:67], v[164:167], v[152:155]
    ds_read_b64_tr_b16 v[160:161], v18 offset:41152
    ds_read_b64_tr_b16 v[162:163], v18 offset:42432
    v_mfma_f32_16x16x32_bf16 v[156:159], a[68:71], v[164:167], v[156:159]
    v_mfma_f32_16x16x32_bf16 v[80:83], a[72:75], v[168:171], v[80:83]
    ds_read_b64_tr_b16 v[164:165], v19 offset:41152
    ds_read_b64_tr_b16 v[166:167], v19 offset:42432
    v_mfma_f32_16x16x32_bf16 v[84:87], a[76:79], v[168:171], v[84:87]
    buffer_load_dwordx4 v34, s[24:27], s6 offen offset:2048 lds
    s_waitcnt vmcnt(7)
    ds_read_b128 a[160:163], v4 offset:0
    ds_read_b128 a[164:167], v4 offset:2048
    v_mfma_f32_16x16x32_bf16 v[88:91], a[72:75], v[172:175], v[88:91]
    ds_read_b64_tr_b16 v[168:169], v18 offset:41216
    ds_read_b64_tr_b16 v[170:171], v18 offset:42496
    v_mfma_f32_16x16x32_bf16 v[92:95], a[76:79], v[172:175], v[92:95]
    ds_read_b128 a[168:171], v5 offset:0
    ds_read_b128 a[172:175], v5 offset:2048
    s_waitcnt lgkmcnt(10)
    v_mfma_f32_16x16x32_bf16 v[96:99], a[72:75], v[176:179], v[96:99]
    ds_read_b64_tr_b16 v[172:173], v19 offset:41216
    ds_read_b64_tr_b16 v[174:175], v19 offset:42496
    v_mfma_f32_16x16x32_bf16 v[100:103], a[76:79], v[176:179], v[100:103]
    buffer_load_dwordx4 v35, s[24:27], s6 offen offset:3072 lds
    v_mfma_f32_16x16x32_bf16 v[104:107], a[72:75], v[180:183], v[104:107]
    v_mfma_f32_16x16x32_bf16 v[108:111], a[76:79], v[180:183], v[108:111]
    s_add_u32 m0, s61, 31744
    v_mfma_f32_16x16x32_bf16 v[112:115], a[72:75], v[184:187], v[112:115]
    v_mfma_f32_16x16x32_bf16 v[116:119], a[76:79], v[184:187], v[116:119]
    buffer_load_dwordx4 v24, s[12:15], s71 offen offset:0 lds
    s_waitcnt lgkmcnt(0)
    s_barrier
    v_mfma_f32_16x16x32_bf16 v[120:123], a[72:75], v[188:191], v[120:123]
    ds_read_b64_tr_b16 v[176:177], v18 offset:5120
    ds_read_b64_tr_b16 v[178:179], v18 offset:6400
    ds_read_b64_tr_b16 v[180:181], v19 offset:5120
    ds_read_b64_tr_b16 v[182:183], v19 offset:6400
    v_mfma_f32_16x16x32_bf16 v[124:127], a[76:79], v[188:191], v[124:127]
    v_mfma_f32_16x16x32_bf16 v[128:131], a[72:75], v[160:163], v[128:131]
    ds_read_b64_tr_b16 v[184:185], v18 offset:5184
    ds_read_b64_tr_b16 v[186:187], v18 offset:6464
    ds_read_b64_tr_b16 v[188:189], v19 offset:5184
    ds_read_b64_tr_b16 v[190:191], v19 offset:6464
    v_mfma_f32_16x16x32_bf16 v[132:135], a[76:79], v[160:163], v[132:135]
    buffer_load_dwordx4 v25, s[12:15], s71 offen offset:1024 lds
    v_mfma_f32_16x16x32_bf16 v[136:139], a[72:75], v[164:167], v[136:139]
    ds_read_b64_tr_b16 v[160:161], v18 offset:5248
    ds_read_b64_tr_b16 v[162:163], v18 offset:6528
    v_mfma_f32_16x16x32_bf16 v[140:143], a[76:79], v[164:167], v[140:143]
    v_mfma_f32_16x16x32_bf16 v[144:147], a[72:75], v[168:171], v[144:147]
    ds_read_b64_tr_b16 v[164:165], v19 offset:5248
    ds_read_b64_tr_b16 v[166:167], v19 offset:6528
    v_mfma_f32_16x16x32_bf16 v[148:151], a[76:79], v[168:171], v[148:151]
    buffer_load_dwordx4 v26, s[12:15], s71 offen offset:2048 lds
    v_mfma_f32_16x16x32_bf16 v[152:155], a[72:75], v[172:175], v[152:155]
    ds_read_b64_tr_b16 v[168:169], v18 offset:5312
    ds_read_b64_tr_b16 v[170:171], v18 offset:6592
    v_mfma_f32_16x16x32_bf16 v[156:159], a[76:79], v[172:175], v[156:159]
    buffer_load_dwordx4 v27, s[12:15], s71 offen offset:3072 lds
    s_add_u32 m0, s61, 35840
    s_waitcnt lgkmcnt(6)
    v_mfma_f32_16x16x32_bf16 v[80:83], a[80:83], v[176:179], v[80:83]
    ds_read_b64_tr_b16 v[172:173], v19 offset:5312
    ds_read_b64_tr_b16 v[174:175], v19 offset:6592
    v_mfma_f32_16x16x32_bf16 v[84:87], a[84:87], v[176:179], v[84:87]
    buffer_load_dwordx4 v28, s[12:15], s71 offen offset:0 lds
    s_bfe_u32 s71, s65, 0x40000
    s_mul_i32 s71, s71, 245760
    s_add_u32 s71, s71, s72
    s_add_u32 m0, s61, 16384
    v_mfma_f32_16x16x32_bf16 v[88:91], a[80:83], v[180:183], v[88:91]
    ds_read_b64_tr_b16 v[176:177], v18 offset:5376
    ds_read_b64_tr_b16 v[178:179], v18 offset:6656
    v_mfma_f32_16x16x32_bf16 v[92:95], a[84:87], v[180:183], v[92:95]
    v_mfma_f32_16x16x32_bf16 v[96:99], a[80:83], v[184:187], v[96:99]
    ds_read_b64_tr_b16 v[180:181], v19 offset:5376
    ds_read_b64_tr_b16 v[182:183], v19 offset:6656
    v_mfma_f32_16x16x32_bf16 v[100:103], a[84:87], v[184:187], v[100:103]
    v_mfma_f32_16x16x32_bf16 v[104:107], a[80:83], v[188:191], v[104:107]
    ds_read_b64_tr_b16 v[184:185], v18 offset:46080
    ds_read_b64_tr_b16 v[186:187], v18 offset:47360
    v_mfma_f32_16x16x32_bf16 v[108:111], a[84:87], v[188:191], v[108:111]
    s_waitcnt lgkmcnt(6)
    v_mfma_f32_16x16x32_bf16 v[112:115], a[80:83], v[160:163], v[112:115]
    ds_read_b64_tr_b16 v[188:189], v19 offset:46080
    ds_read_b64_tr_b16 v[190:191], v19 offset:47360
    v_mfma_f32_16x16x32_bf16 v[116:119], a[84:87], v[160:163], v[116:119]
    v_mfma_f32_16x16x32_bf16 v[120:123], a[80:83], v[164:167], v[120:123]
    ds_read_b64_tr_b16 v[160:161], v18 offset:46144
    ds_read_b64_tr_b16 v[162:163], v18 offset:47424
    v_mfma_f32_16x16x32_bf16 v[124:127], a[84:87], v[164:167], v[124:127]
    v_mfma_f32_16x16x32_bf16 v[128:131], a[80:83], v[168:171], v[128:131]
    ds_read_b64_tr_b16 v[164:165], v19 offset:46144
    ds_read_b64_tr_b16 v[166:167], v19 offset:47424
    v_mfma_f32_16x16x32_bf16 v[132:135], a[84:87], v[168:171], v[132:135]
    v_mfma_f32_16x16x32_bf16 v[136:139], a[80:83], v[172:175], v[136:139]
    ds_read_b64_tr_b16 v[168:169], v18 offset:46208
    ds_read_b64_tr_b16 v[170:171], v18 offset:47488
    v_mfma_f32_16x16x32_bf16 v[140:143], a[84:87], v[172:175], v[140:143]
    buffer_load_dwordx4 v24, s[12:15], s71 offen offset:0 lds
    s_waitcnt lgkmcnt(6)
    v_mfma_f32_16x16x32_bf16 v[144:147], a[80:83], v[176:179], v[144:147]
    ds_read_b64_tr_b16 v[172:173], v19 offset:46208
    ds_read_b64_tr_b16 v[174:175], v19 offset:47488
    v_mfma_f32_16x16x32_bf16 v[148:151], a[84:87], v[176:179], v[148:151]
    v_mfma_f32_16x16x32_bf16 v[152:155], a[80:83], v[180:183], v[152:155]
    ds_read_b64_tr_b16 v[176:177], v18 offset:46272
    ds_read_b64_tr_b16 v[178:179], v18 offset:47552
    v_mfma_f32_16x16x32_bf16 v[156:159], a[84:87], v[180:183], v[156:159]
    v_mfma_f32_16x16x32_bf16 v[80:83], a[88:91], v[184:187], v[80:83]
    ds_read_b64_tr_b16 v[180:181], v19 offset:46272
    ds_read_b64_tr_b16 v[182:183], v19 offset:47552
    v_mfma_f32_16x16x32_bf16 v[84:87], a[92:95], v[184:187], v[84:87]
    buffer_load_dwordx4 v25, s[12:15], s71 offen offset:1024 lds
    v_mfma_f32_16x16x32_bf16 v[88:91], a[88:91], v[188:191], v[88:91]
    ds_read_b64_tr_b16 v[184:185], v18 offset:46336
    ds_read_b64_tr_b16 v[186:187], v18 offset:47616
    v_mfma_f32_16x16x32_bf16 v[92:95], a[92:95], v[188:191], v[92:95]
    s_waitcnt lgkmcnt(6)
    v_mfma_f32_16x16x32_bf16 v[96:99], a[88:91], v[160:163], v[96:99]
    ds_read_b64_tr_b16 v[188:189], v19 offset:46336
    ds_read_b64_tr_b16 v[190:191], v19 offset:47616
    v_mfma_f32_16x16x32_bf16 v[100:103], a[92:95], v[160:163], v[100:103]
    v_mfma_f32_16x16x32_bf16 v[104:107], a[88:91], v[164:167], v[104:107]
    s_waitcnt vmcnt(7)
    ds_read_b128 a[176:179], v4 offset:4096
    v_mfma_f32_16x16x32_bf16 v[108:111], a[92:95], v[164:167], v[108:111]
    buffer_load_dwordx4 v26, s[12:15], s71 offen offset:2048 lds
    ds_read_b128 a[180:183], v4 offset:6144
    ds_read_b128 a[184:187], v5 offset:4096
    v_mfma_f32_16x16x32_bf16 v[112:115], a[88:91], v[168:171], v[112:115]
    v_mfma_f32_16x16x32_bf16 v[116:119], a[92:95], v[168:171], v[116:119]
    s_mov_b64 exec, 1
    buffer_store_dword v31, off, s[48:51], s81 sc1
    s_mov_b64 exec, -1
    s_waitcnt lgkmcnt(0)
    s_barrier
    v_mfma_f32_16x16x32_bf16 v[120:123], a[88:91], v[172:175], v[120:123]
    ds_read_b64_tr_b16 v[160:161], v18 offset:10240
    ds_read_b64_tr_b16 v[162:163], v18 offset:11520
    ds_read_b64_tr_b16 v[164:165], v19 offset:10240
    ds_read_b64_tr_b16 v[166:167], v19 offset:11520
    v_mfma_f32_16x16x32_bf16 v[124:127], a[92:95], v[172:175], v[124:127]
    ds_read_b128 a[188:191], v5 offset:6144
    v_mfma_f32_16x16x32_bf16 v[128:131], a[88:91], v[176:179], v[128:131]
    ds_read_b64_tr_b16 v[168:169], v18 offset:10304
    ds_read_b64_tr_b16 v[170:171], v18 offset:11584
    ds_read_b64_tr_b16 v[172:173], v19 offset:10304
    ds_read_b64_tr_b16 v[174:175], v19 offset:11584
    v_mfma_f32_16x16x32_bf16 v[132:135], a[92:95], v[176:179], v[132:135]
    buffer_load_dwordx4 v27, s[12:15], s71 offen offset:3072 lds
    v_mfma_f32_16x16x32_bf16 v[136:139], a[88:91], v[180:183], v[136:139]
    ds_read_b64_tr_b16 v[176:177], v18 offset:10368
    ds_read_b64_tr_b16 v[178:179], v18 offset:11648
    v_mfma_f32_16x16x32_bf16 v[140:143], a[92:95], v[180:183], v[140:143]
    v_mfma_f32_16x16x32_bf16 v[144:147], a[88:91], v[184:187], v[144:147]
    ds_read_b64_tr_b16 v[180:181], v19 offset:10368
    ds_read_b64_tr_b16 v[182:183], v19 offset:11648
    v_mfma_f32_16x16x32_bf16 v[148:151], a[92:95], v[184:187], v[148:151]
    s_add_u32 m0, s61, 20480
    v_mfma_f32_16x16x32_bf16 v[152:155], a[88:91], v[188:191], v[152:155]
    ds_read_b64_tr_b16 v[184:185], v18 offset:10432
    ds_read_b64_tr_b16 v[186:187], v18 offset:11712
    v_mfma_f32_16x16x32_bf16 v[156:159], a[92:95], v[188:191], v[156:159]
    buffer_load_dwordx4 v28, s[12:15], s71 offen offset:0 lds
    s_bfe_u32 s71, s65, 0x40004
    s_mul_i32 s71, s71, 245760
    s_add_u32 s71, s71, s72
    s_add_u32 m0, s61, 21504
    s_waitcnt lgkmcnt(6)
    v_mfma_f32_16x16x32_bf16 v[80:83], a[96:99], v[160:163], v[80:83]
    ds_read_b64_tr_b16 v[188:189], v19 offset:10432
    ds_read_b64_tr_b16 v[190:191], v19 offset:11712
    v_mfma_f32_16x16x32_bf16 v[84:87], a[100:103], v[160:163], v[84:87]
    v_mfma_f32_16x16x32_bf16 v[88:91], a[96:99], v[164:167], v[88:91]
    ds_read_b64_tr_b16 v[160:161], v18 offset:10496
    ds_read_b64_tr_b16 v[162:163], v18 offset:11776
    v_mfma_f32_16x16x32_bf16 v[92:95], a[100:103], v[164:167], v[92:95]
    buffer_load_dwordx4 v24, s[12:15], s71 offen offset:0 lds
    v_mfma_f32_16x16x32_bf16 v[96:99], a[96:99], v[168:171], v[96:99]
    ds_read_b64_tr_b16 v[164:165], v19 offset:10496
    ds_read_b64_tr_b16 v[166:167], v19 offset:11776
    v_mfma_f32_16x16x32_bf16 v[100:103], a[100:103], v[168:171], v[100:103]
    v_mfma_f32_16x16x32_bf16 v[104:107], a[96:99], v[172:175], v[104:107]
    ds_read_b64_tr_b16 v[168:169], v18 offset:51200
    ds_read_b64_tr_b16 v[170:171], v18 offset:52480
    v_mfma_f32_16x16x32_bf16 v[108:111], a[100:103], v[172:175], v[108:111]
    s_waitcnt lgkmcnt(6)
    v_mfma_f32_16x16x32_bf16 v[112:115], a[96:99], v[176:179], v[112:115]
    ds_read_b64_tr_b16 v[172:173], v19 offset:51200
    ds_read_b64_tr_b16 v[174:175], v19 offset:52480
    v_mfma_f32_16x16x32_bf16 v[116:119], a[100:103], v[176:179], v[116:119]
    buffer_load_dwordx4 v25, s[12:15], s71 offen offset:1024 lds
    v_mfma_f32_16x16x32_bf16 v[120:123], a[96:99], v[180:183], v[120:123]
    ds_read_b64_tr_b16 v[176:177], v18 offset:51264
    ds_read_b64_tr_b16 v[178:179], v18 offset:52544
    v_mfma_f32_16x16x32_bf16 v[124:127], a[100:103], v[180:183], v[124:127]
    v_mfma_f32_16x16x32_bf16 v[128:131], a[96:99], v[184:187], v[128:131]
    ds_read_b64_tr_b16 v[180:181], v19 offset:51264
    ds_read_b64_tr_b16 v[182:183], v19 offset:52544
    v_mfma_f32_16x16x32_bf16 v[132:135], a[100:103], v[184:187], v[132:135]
    v_mfma_f32_16x16x32_bf16 v[136:139], a[96:99], v[188:191], v[136:139]
    ds_read_b64_tr_b16 v[184:185], v18 offset:51328
    ds_read_b64_tr_b16 v[186:187], v18 offset:52608
    v_mfma_f32_16x16x32_bf16 v[140:143], a[100:103], v[188:191], v[140:143]
    buffer_load_dwordx4 v26, s[12:15], s71 offen offset:2048 lds
    s_waitcnt lgkmcnt(6)
    v_mfma_f32_16x16x32_bf16 v[144:147], a[96:99], v[160:163], v[144:147]
    ds_read_b64_tr_b16 v[188:189], v19 offset:51328
    ds_read_b64_tr_b16 v[190:191], v19 offset:52608
    v_mfma_f32_16x16x32_bf16 v[148:151], a[100:103], v[160:163], v[148:151]
    v_mfma_f32_16x16x32_bf16 v[152:155], a[96:99], v[164:167], v[152:155]
    ds_read_b64_tr_b16 v[160:161], v18 offset:51392
    ds_read_b64_tr_b16 v[162:163], v18 offset:52672
    v_mfma_f32_16x16x32_bf16 v[156:159], a[100:103], v[164:167], v[156:159]
    v_mfma_f32_16x16x32_bf16 v[80:83], a[104:107], v[168:171], v[80:83]
    ds_read_b64_tr_b16 v[164:165], v19 offset:51392
    ds_read_b64_tr_b16 v[166:167], v19 offset:52672
    v_mfma_f32_16x16x32_bf16 v[84:87], a[108:111], v[168:171], v[84:87]
    buffer_load_dwordx4 v27, s[12:15], s71 offen offset:3072 lds
    v_mfma_f32_16x16x32_bf16 v[88:91], a[104:107], v[172:175], v[88:91]
    ds_read_b64_tr_b16 v[168:169], v18 offset:51456
    ds_read_b64_tr_b16 v[170:171], v18 offset:52736
    v_mfma_f32_16x16x32_bf16 v[92:95], a[108:111], v[172:175], v[92:95]
    s_waitcnt lgkmcnt(6)
    v_mfma_f32_16x16x32_bf16 v[96:99], a[104:107], v[176:179], v[96:99]
    ds_read_b64_tr_b16 v[172:173], v19 offset:51456
    ds_read_b64_tr_b16 v[174:175], v19 offset:52736
    v_mfma_f32_16x16x32_bf16 v[100:103], a[108:111], v[176:179], v[100:103]
    s_add_u32 m0, s61, 25600
    v_mfma_f32_16x16x32_bf16 v[104:107], a[104:107], v[180:183], v[104:107]
    v_mfma_f32_16x16x32_bf16 v[108:111], a[108:111], v[180:183], v[108:111]
    buffer_load_dwordx4 v28, s[12:15], s71 offen offset:0 lds
    v_mfma_f32_16x16x32_bf16 v[112:115], a[104:107], v[184:187], v[112:115]
    v_mfma_f32_16x16x32_bf16 v[116:119], a[108:111], v[184:187], v[116:119]
    s_waitcnt vmcnt(11) lgkmcnt(0)
    s_barrier
    v_mfma_f32_16x16x32_bf16 v[120:123], a[104:107], v[188:191], v[120:123]
    ds_read_b64_tr_b16 v[176:177], v18 offset:15360
    ds_read_b64_tr_b16 v[178:179], v18 offset:16640
    ds_read_b64_tr_b16 v[180:181], v19 offset:15360
    ds_read_b64_tr_b16 v[182:183], v19 offset:16640
    v_mfma_f32_16x16x32_bf16 v[124:127], a[108:111], v[188:191], v[124:127]
    s_add_u32 m0, s61, 8192
    v_mfma_f32_16x16x32_bf16 v[128:131], a[104:107], v[160:163], v[128:131]
    ds_read_b64_tr_b16 v[184:185], v18 offset:15424
    ds_read_b64_tr_b16 v[186:187], v18 offset:16704
    ds_read_b64_tr_b16 v[188:189], v19 offset:15424
    ds_read_b64_tr_b16 v[190:191], v19 offset:16704
    v_mfma_f32_16x16x32_bf16 v[132:135], a[108:111], v[160:163], v[132:135]
    buffer_load_dwordx4 v32, s[24:27], s83 offen offset:0 lds
    v_mfma_f32_16x16x32_bf16 v[136:139], a[104:107], v[164:167], v[136:139]
    ds_read_b64_tr_b16 v[160:161], v18 offset:15488
    ds_read_b64_tr_b16 v[162:163], v18 offset:16768
    v_mfma_f32_16x16x32_bf16 v[140:143], a[108:111], v[164:167], v[140:143]
    v_mfma_f32_16x16x32_bf16 v[144:147], a[104:107], v[168:171], v[144:147]
    ds_read_b64_tr_b16 v[164:165], v19 offset:15488
    ds_read_b64_tr_b16 v[166:167], v19 offset:16768
    v_mfma_f32_16x16x32_bf16 v[148:151], a[108:111], v[168:171], v[148:151]
    buffer_load_dwordx4 v33, s[24:27], s83 offen offset:1024 lds
    v_mfma_f32_16x16x32_bf16 v[152:155], a[104:107], v[172:175], v[152:155]
    ds_read_b64_tr_b16 v[168:169], v18 offset:15552
    ds_read_b64_tr_b16 v[170:171], v18 offset:16832
    v_mfma_f32_16x16x32_bf16 v[156:159], a[108:111], v[172:175], v[156:159]
    s_waitcnt lgkmcnt(6)
    v_mfma_f32_16x16x32_bf16 v[80:83], a[112:115], v[176:179], v[80:83]
    ds_read_b64_tr_b16 v[172:173], v19 offset:15552
    ds_read_b64_tr_b16 v[174:175], v19 offset:16832
    v_mfma_f32_16x16x32_bf16 v[84:87], a[116:119], v[176:179], v[84:87]
    buffer_load_dwordx4 v34, s[24:27], s83 offen offset:2048 lds
    v_mfma_f32_16x16x32_bf16 v[88:91], a[112:115], v[180:183], v[88:91]
    ds_read_b64_tr_b16 v[176:177], v18 offset:15616
    ds_read_b64_tr_b16 v[178:179], v18 offset:16896
    v_mfma_f32_16x16x32_bf16 v[92:95], a[116:119], v[180:183], v[92:95]
    v_mfma_f32_16x16x32_bf16 v[96:99], a[112:115], v[184:187], v[96:99]
    ds_read_b64_tr_b16 v[180:181], v19 offset:15616
    ds_read_b64_tr_b16 v[182:183], v19 offset:16896
    v_mfma_f32_16x16x32_bf16 v[100:103], a[116:119], v[184:187], v[100:103]
    buffer_load_dwordx4 v35, s[24:27], s83 offen offset:3072 lds
    v_mfma_f32_16x16x32_bf16 v[104:107], a[112:115], v[188:191], v[104:107]
    ds_read_b64_tr_b16 v[184:185], v18 offset:56320
    ds_read_b64_tr_b16 v[186:187], v18 offset:57600
    v_mfma_f32_16x16x32_bf16 v[108:111], a[116:119], v[188:191], v[108:111]
    s_add_u32 m0, s61, 12288
    s_add_u32 s6, s83, 128
    s_waitcnt lgkmcnt(6)
    v_mfma_f32_16x16x32_bf16 v[112:115], a[112:115], v[160:163], v[112:115]
    ds_read_b64_tr_b16 v[188:189], v19 offset:56320
    ds_read_b64_tr_b16 v[190:191], v19 offset:57600
    v_mfma_f32_16x16x32_bf16 v[116:119], a[116:119], v[160:163], v[116:119]
    buffer_load_dwordx4 v32, s[24:27], s6 offen offset:0 lds
    v_mfma_f32_16x16x32_bf16 v[120:123], a[112:115], v[164:167], v[120:123]
    ds_read_b64_tr_b16 v[160:161], v18 offset:56384
    ds_read_b64_tr_b16 v[162:163], v18 offset:57664
    v_mfma_f32_16x16x32_bf16 v[124:127], a[116:119], v[164:167], v[124:127]
    v_mfma_f32_16x16x32_bf16 v[128:131], a[112:115], v[168:171], v[128:131]
    ds_read_b64_tr_b16 v[164:165], v19 offset:56384
    ds_read_b64_tr_b16 v[166:167], v19 offset:57664
    v_mfma_f32_16x16x32_bf16 v[132:135], a[116:119], v[168:171], v[132:135]
    buffer_load_dwordx4 v33, s[24:27], s6 offen offset:1024 lds
    v_mfma_f32_16x16x32_bf16 v[136:139], a[112:115], v[172:175], v[136:139]
    ds_read_b64_tr_b16 v[168:169], v18 offset:56448
    ds_read_b64_tr_b16 v[170:171], v18 offset:57728
    v_mfma_f32_16x16x32_bf16 v[140:143], a[116:119], v[172:175], v[140:143]
    s_waitcnt lgkmcnt(6)
    v_mfma_f32_16x16x32_bf16 v[144:147], a[112:115], v[176:179], v[144:147]
    ds_read_b64_tr_b16 v[172:173], v19 offset:56448
    ds_read_b64_tr_b16 v[174:175], v19 offset:57728
    v_mfma_f32_16x16x32_bf16 v[148:151], a[116:119], v[176:179], v[148:151]
    buffer_load_dwordx4 v34, s[24:27], s6 offen offset:2048 lds
    v_mfma_f32_16x16x32_bf16 v[152:155], a[112:115], v[180:183], v[152:155]
    ds_read_b64_tr_b16 v[176:177], v18 offset:56512
    ds_read_b64_tr_b16 v[178:179], v18 offset:57792
    v_mfma_f32_16x16x32_bf16 v[156:159], a[116:119], v[180:183], v[156:159]
    v_mfma_f32_16x16x32_bf16 v[80:83], a[120:123], v[184:187], v[80:83]
    ds_read_b64_tr_b16 v[180:181], v19 offset:56512
    ds_read_b64_tr_b16 v[182:183], v19 offset:57792
    v_mfma_f32_16x16x32_bf16 v[84:87], a[124:127], v[184:187], v[84:87]
    buffer_load_dwordx4 v35, s[24:27], s6 offen offset:3072 lds
    v_mfma_f32_16x16x32_bf16 v[88:91], a[120:123], v[188:191], v[88:91]
    ds_read_b64_tr_b16 v[184:185], v18 offset:56576
    ds_read_b64_tr_b16 v[186:187], v18 offset:57856
    v_mfma_f32_16x16x32_bf16 v[92:95], a[124:127], v[188:191], v[92:95]
    s_add_u32 m0, s61, 0
    s_waitcnt lgkmcnt(6)
    v_mfma_f32_16x16x32_bf16 v[96:99], a[120:123], v[160:163], v[96:99]
    ds_read_b64_tr_b16 v[188:189], v19 offset:56576
    ds_read_b64_tr_b16 v[190:191], v19 offset:57856
    v_mfma_f32_16x16x32_bf16 v[100:103], a[124:127], v[160:163], v[100:103]
    buffer_load_dwordx4 v32, s[24:27], s84 offen offset:0 lds
    v_mfma_f32_16x16x32_bf16 v[104:107], a[120:123], v[164:167], v[104:107]
    v_mfma_f32_16x16x32_bf16 v[108:111], a[124:127], v[164:167], v[108:111]
    v_mfma_f32_16x16x32_bf16 v[112:115], a[120:123], v[168:171], v[112:115]
    v_mfma_f32_16x16x32_bf16 v[116:119], a[124:127], v[168:171], v[116:119]
    buffer_load_dwordx4 v33, s[24:27], s84 offen offset:1024 lds
    s_waitcnt vmcnt(15) lgkmcnt(0)
    s_barrier
    v_mfma_f32_16x16x32_bf16 v[120:123], a[120:123], v[172:175], v[120:123]
    ds_read_b64_tr_b16 v[160:161], v18 offset:0
    ds_read_b64_tr_b16 v[162:163], v18 offset:1280
    ds_read_b64_tr_b16 v[164:165], v19 offset:0
    ds_read_b64_tr_b16 v[166:167], v19 offset:1280
    v_mfma_f32_16x16x32_bf16 v[124:127], a[124:127], v[172:175], v[124:127]
    v_mfma_f32_16x16x32_bf16 v[128:131], a[120:123], v[176:179], v[128:131]
    ds_read_b64_tr_b16 v[168:169], v18 offset:64
    ds_read_b64_tr_b16 v[170:171], v18 offset:1344
    ds_read_b64_tr_b16 v[172:173], v19 offset:64
    ds_read_b64_tr_b16 v[174:175], v19 offset:1344
    v_mfma_f32_16x16x32_bf16 v[132:135], a[124:127], v[176:179], v[132:135]
    buffer_load_dwordx4 v34, s[24:27], s84 offen offset:2048 lds
    v_mfma_f32_16x16x32_bf16 v[136:139], a[120:123], v[180:183], v[136:139]
    ds_read_b64_tr_b16 v[176:177], v18 offset:128
    ds_read_b64_tr_b16 v[178:179], v18 offset:1408
    v_mfma_f32_16x16x32_bf16 v[140:143], a[124:127], v[180:183], v[140:143]
    v_mfma_f32_16x16x32_bf16 v[144:147], a[120:123], v[184:187], v[144:147]
    ds_read_b64_tr_b16 v[180:181], v19 offset:128
    ds_read_b64_tr_b16 v[182:183], v19 offset:1408
    v_mfma_f32_16x16x32_bf16 v[148:151], a[124:127], v[184:187], v[148:151]
    buffer_load_dwordx4 v35, s[24:27], s84 offen offset:3072 lds
    v_mfma_f32_16x16x32_bf16 v[152:155], a[120:123], v[188:191], v[152:155]
    ds_read_b64_tr_b16 v[184:185], v18 offset:192
    ds_read_b64_tr_b16 v[186:187], v18 offset:1472
    v_mfma_f32_16x16x32_bf16 v[156:159], a[124:127], v[188:191], v[156:159]
    s_add_u32 m0, s61, 4096
    s_add_u32 s6, s84, 128
    s_waitcnt lgkmcnt(6)
    v_mfma_f32_16x16x32_bf16 v[80:83], a[128:131], v[160:163], v[80:83]
    ds_read_b64_tr_b16 v[188:189], v19 offset:192
    ds_read_b64_tr_b16 v[190:191], v19 offset:1472
    v_mfma_f32_16x16x32_bf16 v[84:87], a[132:135], v[160:163], v[84:87]
    buffer_load_dwordx4 v32, s[24:27], s6 offen offset:0 lds
    s_waitcnt vmcnt(9)
    ds_read_b128 a[192:195], v4 offset:8192
    ds_read_b128 a[196:199], v4 offset:10240
    v_mfma_f32_16x16x32_bf16 v[88:91], a[128:131], v[164:167], v[88:91]
    ds_read_b64_tr_b16 v[160:161], v18 offset:256
    ds_read_b64_tr_b16 v[162:163], v18 offset:1536
    v_mfma_f32_16x16x32_bf16 v[92:95], a[132:135], v[164:167], v[92:95]
    ds_read_b128 a[200:203], v5 offset:8192
    ds_read_b128 a[204:207], v5 offset:10240
    v_mfma_f32_16x16x32_bf16 v[96:99], a[128:131], v[168:171], v[96:99]
    ds_read_b64_tr_b16 v[164:165], v19 offset:256
    ds_read_b64_tr_b16 v[166:167], v19 offset:1536
    v_mfma_f32_16x16x32_bf16 v[100:103], a[132:135], v[168:171], v[100:103]
    buffer_load_dwordx4 v33, s[24:27], s6 offen offset:1024 lds
    v_mfma_f32_16x16x32_bf16 v[104:107], a[128:131], v[172:175], v[104:107]
    ds_read_b64_tr_b16 v[168:169], v18 offset:40960
    ds_read_b64_tr_b16 v[170:171], v18 offset:42240
    v_mfma_f32_16x16x32_bf16 v[108:111], a[132:135], v[172:175], v[108:111]
    s_waitcnt lgkmcnt(10)
    v_mfma_f32_16x16x32_bf16 v[112:115], a[128:131], v[176:179], v[112:115]
    ds_read_b64_tr_b16 v[172:173], v19 offset:40960
    ds_read_b64_tr_b16 v[174:175], v19 offset:42240
    v_mfma_f32_16x16x32_bf16 v[116:119], a[132:135], v[176:179], v[116:119]
    buffer_load_dwordx4 v34, s[24:27], s6 offen offset:2048 lds
    v_mfma_f32_16x16x32_bf16 v[120:123], a[128:131], v[180:183], v[120:123]
    ds_read_b64_tr_b16 v[176:177], v18 offset:41024
    ds_read_b64_tr_b16 v[178:179], v18 offset:42304
    v_mfma_f32_16x16x32_bf16 v[124:127], a[132:135], v[180:183], v[124:127]
    v_mfma_f32_16x16x32_bf16 v[128:131], a[128:131], v[184:187], v[128:131]
    ds_read_b64_tr_b16 v[180:181], v19 offset:41024
    ds_read_b64_tr_b16 v[182:183], v19 offset:42304
    v_mfma_f32_16x16x32_bf16 v[132:135], a[132:135], v[184:187], v[132:135]
    buffer_load_dwordx4 v35, s[24:27], s6 offen offset:3072 lds
    v_mfma_f32_16x16x32_bf16 v[136:139], a[128:131], v[188:191], v[136:139]
    ds_read_b64_tr_b16 v[184:185], v18 offset:41088
    ds_read_b64_tr_b16 v[186:187], v18 offset:42368
    v_mfma_f32_16x16x32_bf16 v[140:143], a[132:135], v[188:191], v[140:143]
    s_waitcnt lgkmcnt(12)
    s_add_u32 m0, s61, 8192
    v_mfma_f32_16x16x32_bf16 v[144:147], a[128:131], v[160:163], v[144:147]
    ds_read_b64_tr_b16 v[188:189], v19 offset:41088
    ds_read_b64_tr_b16 v[190:191], v19 offset:42368
    v_mfma_f32_16x16x32_bf16 v[148:151], a[132:135], v[160:163], v[148:151]
    buffer_load_dwordx4 v32, s[24:27], s85 offen offset:0 lds
    s_waitcnt vmcnt(9)
    ds_read_b128 a[208:211], v4 offset:12288
    s_waitcnt lgkmcnt(7)
    v_mfma_f32_16x16x32_bf16 v[152:155], a[128:131], v[164:167], v[152:155]
    ds_read_b64_tr_b16 v[160:161], v18 offset:41152
    ds_read_b64_tr_b16 v[162:163], v18 offset:42432
    v_mfma_f32_16x16x32_bf16 v[156:159], a[132:135], v[164:167], v[156:159]
    ds_read_b128 a[212:215], v4 offset:14336
    ds_read_b128 a[216:219], v5 offset:12288
    v_mfma_f32_16x16x32_bf16 v[80:83], a[136:139], v[168:171], v[80:83]
    ds_read_b64_tr_b16 v[164:165], v19 offset:41152
    ds_read_b64_tr_b16 v[166:167], v19 offset:42432
    v_mfma_f32_16x16x32_bf16 v[84:87], a[140:143], v[168:171], v[84:87]
    buffer_load_dwordx4 v33, s[24:27], s85 offen offset:1024 lds
    ds_read_b128 a[220:223], v5 offset:14336
    v_mfma_f32_16x16x32_bf16 v[88:91], a[136:139], v[172:175], v[88:91]
    ds_read_b64_tr_b16 v[168:169], v18 offset:41216
    ds_read_b64_tr_b16 v[170:171], v18 offset:42496
    v_mfma_f32_16x16x32_bf16 v[92:95], a[140:143], v[172:175], v[92:95]
    v_mfma_f32_16x16x32_bf16 v[96:99], a[136:139], v[176:179], v[96:99]
    ds_read_b64_tr_b16 v[172:173], v19 offset:41216
    ds_read_b64_tr_b16 v[174:175], v19 offset:42496
    v_mfma_f32_16x16x32_bf16 v[100:103], a[140:143], v[176:179], v[100:103]
    buffer_load_dwordx4 v34, s[24:27], s85 offen offset:2048 lds
    s_waitcnt lgkmcnt(9)
    v_mfma_f32_16x16x32_bf16 v[104:107], a[136:139], v[180:183], v[104:107]
    v_mfma_f32_16x16x32_bf16 v[108:111], a[140:143], v[180:183], v[108:111]
    v_mfma_f32_16x16x32_bf16 v[112:115], a[136:139], v[184:187], v[112:115]
    v_mfma_f32_16x16x32_bf16 v[116:119], a[140:143], v[184:187], v[116:119]
    buffer_load_dwordx4 v35, s[24:27], s85 offen offset:3072 lds
    s_waitcnt lgkmcnt(0)
    s_barrier
    v_mfma_f32_16x16x32_bf16 v[120:123], a[136:139], v[188:191], v[120:123]
    ds_read_b64_tr_b16 v[176:177], v18 offset:5120
    ds_read_b64_tr_b16 v[178:179], v18 offset:6400
    ds_read_b64_tr_b16 v[180:181], v19 offset:5120
    ds_read_b64_tr_b16 v[182:183], v19 offset:6400
    v_mfma_f32_16x16x32_bf16 v[124:127], a[140:143], v[188:191], v[124:127]
    s_waitcnt vmcnt(8)
    ds_read_b128 a[224:227], v4 offset:0
    ds_read_b128 a[228:231], v4 offset:2048
    s_add_u32 m0, s61, 12288
    s_add_u32 s6, s85, 128
    v_mfma_f32_16x16x32_bf16 v[128:131], a[136:139], v[160:163], v[128:131]
    ds_read_b64_tr_b16 v[184:185], v18 offset:5184
    ds_read_b64_tr_b16 v[186:187], v18 offset:6464
    ds_read_b64_tr_b16 v[188:189], v19 offset:5184
    ds_read_b64_tr_b16 v[190:191], v19 offset:6464
    v_mfma_f32_16x16x32_bf16 v[132:135], a[140:143], v[160:163], v[132:135]
    buffer_load_dwordx4 v32, s[24:27], s6 offen offset:0 lds
    ds_read_b128 a[232:235], v5 offset:0
    ds_read_b128 a[236:239], v5 offset:2048
    v_mfma_f32_16x16x32_bf16 v[136:139], a[136:139], v[164:167], v[136:139]
    ds_read_b64_tr_b16 v[160:161], v18 offset:5248
    ds_read_b64_tr_b16 v[162:163], v18 offset:6528
    v_mfma_f32_16x16x32_bf16 v[140:143], a[140:143], v[164:167], v[140:143]
    v_mfma_f32_16x16x32_bf16 v[144:147], a[136:139], v[168:171], v[144:147]
    ds_read_b64_tr_b16 v[164:165], v19 offset:5248
    ds_read_b64_tr_b16 v[166:167], v19 offset:6528
    v_mfma_f32_16x16x32_bf16 v[148:151], a[140:143], v[168:171], v[148:151]
    buffer_load_dwordx4 v33, s[24:27], s6 offen offset:1024 lds
    v_mfma_f32_16x16x32_bf16 v[152:155], a[136:139], v[172:175], v[152:155]
    ds_read_b64_tr_b16 v[168:169], v18 offset:5312
    ds_read_b64_tr_b16 v[170:171], v18 offset:6592
    v_mfma_f32_16x16x32_bf16 v[156:159], a[140:143], v[172:175], v[156:159]
    s_waitcnt lgkmcnt(8)
    v_mfma_f32_16x16x32_bf16 v[80:83], a[144:147], v[176:179], v[80:83]
    ds_read_b64_tr_b16 v[172:173], v19 offset:5312
    ds_read_b64_tr_b16 v[174:175], v19 offset:6592
    v_mfma_f32_16x16x32_bf16 v[84:87], a[148:151], v[176:179], v[84:87]
    buffer_load_dwordx4 v34, s[24:27], s6 offen offset:2048 lds
    v_mfma_f32_16x16x32_bf16 v[88:91], a[144:147], v[180:183], v[88:91]
    ds_read_b64_tr_b16 v[176:177], v18 offset:5376
    ds_read_b64_tr_b16 v[178:179], v18 offset:6656
    v_mfma_f32_16x16x32_bf16 v[92:95], a[148:151], v[180:183], v[92:95]
    v_mfma_f32_16x16x32_bf16 v[96:99], a[144:147], v[184:187], v[96:99]
    ds_read_b64_tr_b16 v[180:181], v19 offset:5376
    ds_read_b64_tr_b16 v[182:183], v19 offset:6656
    v_mfma_f32_16x16x32_bf16 v[100:103], a[148:151], v[184:187], v[100:103]
    buffer_load_dwordx4 v35, s[24:27], s6 offen offset:3072 lds
    v_mfma_f32_16x16x32_bf16 v[104:107], a[144:147], v[188:191], v[104:107]
    ds_read_b64_tr_b16 v[184:185], v18 offset:46080
    ds_read_b64_tr_b16 v[186:187], v18 offset:47360
    v_mfma_f32_16x16x32_bf16 v[108:111], a[148:151], v[188:191], v[108:111]
    s_waitcnt vmcnt(8)
    ds_read_b128 a[240:243], v4 offset:4096
    ds_read_b128 a[244:247], v4 offset:6144
    s_waitcnt lgkmcnt(15)
    s_add_u32 m0, s61, 0
    s_waitcnt lgkmcnt(8)
    v_mfma_f32_16x16x32_bf16 v[112:115], a[144:147], v[160:163], v[112:115]
    ds_read_b64_tr_b16 v[188:189], v19 offset:46080
    ds_read_b64_tr_b16 v[190:191], v19 offset:47360
    v_mfma_f32_16x16x32_bf16 v[116:119], a[148:151], v[160:163], v[116:119]
    buffer_load_dwordx4 v32, s[24:27], s86 offen offset:0 lds
    ds_read_b128 a[248:251], v5 offset:4096
    ds_read_b128 a[252:255], v5 offset:6144
    v_mfma_f32_16x16x32_bf16 v[120:123], a[144:147], v[164:167], v[120:123]
    ds_read_b64_tr_b16 v[160:161], v18 offset:46144
    ds_read_b64_tr_b16 v[162:163], v18 offset:47424
    v_mfma_f32_16x16x32_bf16 v[124:127], a[148:151], v[164:167], v[124:127]
    v_mfma_f32_16x16x32_bf16 v[128:131], a[144:147], v[168:171], v[128:131]
    ds_read_b64_tr_b16 v[164:165], v19 offset:46144
    ds_read_b64_tr_b16 v[166:167], v19 offset:47424
    v_mfma_f32_16x16x32_bf16 v[132:135], a[148:151], v[168:171], v[132:135]
    buffer_load_dwordx4 v33, s[24:27], s86 offen offset:1024 lds
    v_mfma_f32_16x16x32_bf16 v[136:139], a[144:147], v[172:175], v[136:139]
    ds_read_b64_tr_b16 v[168:169], v18 offset:46208
    ds_read_b64_tr_b16 v[170:171], v18 offset:47488
    v_mfma_f32_16x16x32_bf16 v[140:143], a[148:151], v[172:175], v[140:143]
    s_waitcnt lgkmcnt(8)
    v_mfma_f32_16x16x32_bf16 v[144:147], a[144:147], v[176:179], v[144:147]
    ds_read_b64_tr_b16 v[172:173], v19 offset:46208
    ds_read_b64_tr_b16 v[174:175], v19 offset:47488
    v_mfma_f32_16x16x32_bf16 v[148:151], a[148:151], v[176:179], v[148:151]
    buffer_load_dwordx4 v34, s[24:27], s86 offen offset:2048 lds
    v_mfma_f32_16x16x32_bf16 v[152:155], a[144:147], v[180:183], v[152:155]
    ds_read_b64_tr_b16 v[176:177], v18 offset:46272
    ds_read_b64_tr_b16 v[178:179], v18 offset:47552
    v_mfma_f32_16x16x32_bf16 v[156:159], a[148:151], v[180:183], v[156:159]
    v_mfma_f32_16x16x32_bf16 v[80:83], a[152:155], v[184:187], v[80:83]
    ds_read_b64_tr_b16 v[180:181], v19 offset:46272
    ds_read_b64_tr_b16 v[182:183], v19 offset:47552
    v_mfma_f32_16x16x32_bf16 v[84:87], a[156:159], v[184:187], v[84:87]
    buffer_load_dwordx4 v35, s[24:27], s86 offen offset:3072 lds
    s_waitcnt vmcnt(8)
    ds_read_b128 v[192:195], v4 offset:8192
    ds_read_b128 v[196:199], v4 offset:10240
    v_mfma_f32_16x16x32_bf16 v[88:91], a[152:155], v[188:191], v[88:91]
    ds_read_b64_tr_b16 v[184:185], v18 offset:46336
    ds_read_b64_tr_b16 v[186:187], v18 offset:47616
    v_mfma_f32_16x16x32_bf16 v[92:95], a[156:159], v[188:191], v[92:95]
    ds_read_b128 v[200:203], v5 offset:8192
    ds_read_b128 v[204:207], v5 offset:10240
    s_waitcnt lgkmcnt(15)
    s_add_u32 m0, s61, 4096
    s_add_u32 s6, s86, 128
    v_mfma_f32_16x16x32_bf16 v[96:99], a[152:155], v[160:163], v[96:99]
    ds_read_b64_tr_b16 v[188:189], v19 offset:46336
    ds_read_b64_tr_b16 v[190:191], v19 offset:47616
    v_mfma_f32_16x16x32_bf16 v[100:103], a[156:159], v[160:163], v[100:103]
    buffer_load_dwordx4 v32, s[24:27], s6 offen offset:0 lds
    s_waitcnt lgkmcnt(10)
    v_mfma_f32_16x16x32_bf16 v[104:107], a[152:155], v[164:167], v[104:107]
    v_mfma_f32_16x16x32_bf16 v[108:111], a[156:159], v[164:167], v[108:111]
    v_mfma_f32_16x16x32_bf16 v[112:115], a[152:155], v[168:171], v[112:115]
    v_mfma_f32_16x16x32_bf16 v[116:119], a[156:159], v[168:171], v[116:119]
    buffer_load_dwordx4 v33, s[24:27], s6 offen offset:1024 lds
    v_mfma_f32_16x16x32_bf16 v[120:123], a[152:155], v[172:175], v[120:123]
    v_mfma_f32_16x16x32_bf16 v[124:127], a[156:159], v[172:175], v[124:127]
    v_mfma_f32_16x16x32_bf16 v[128:131], a[152:155], v[176:179], v[128:131]
    v_mfma_f32_16x16x32_bf16 v[132:135], a[156:159], v[176:179], v[132:135]
    buffer_load_dwordx4 v34, s[24:27], s6 offen offset:2048 lds
    s_waitcnt lgkmcnt(0)
    v_mfma_f32_16x16x32_bf16 v[136:139], a[152:155], v[180:183], v[136:139]
    v_mfma_f32_16x16x32_bf16 v[140:143], a[156:159], v[180:183], v[140:143]
    v_mfma_f32_16x16x32_bf16 v[144:147], a[152:155], v[184:187], v[144:147]
    v_mfma_f32_16x16x32_bf16 v[148:151], a[156:159], v[184:187], v[148:151]
    buffer_load_dwordx4 v35, s[24:27], s6 offen offset:3072 lds
    v_mfma_f32_16x16x32_bf16 v[152:155], a[152:155], v[188:191], v[152:155]
    v_mfma_f32_16x16x32_bf16 v[156:159], a[156:159], v[188:191], v[156:159]
    s_add_u32 m0, s61, 8192
L_tail_3:
    s_nop 0
    buffer_load_dwordx4 v32, s[24:27], s87 offen offset:0 lds
    buffer_load_dwordx4 v33, s[24:27], s87 offen offset:1024 lds
    buffer_load_dwordx4 v34, s[24:27], s87 offen offset:2048 lds
    buffer_load_dwordx4 v35, s[24:27], s87 offen offset:3072 lds
    s_barrier
    s_mov_b32 s100, 0x3fb8aa3b
    s_mov_b32 s101, 0x358637bd
    s_mov_b32 s7, s70
    v_cvt_pk_bf16_f32 v48, v120, v121
    v_cvt_pk_bf16_f32 v49, v122, v123
    v_cvt_pk_bf16_f32 v50, v124, v125
    v_cvt_pk_bf16_f32 v51, v126, v127
    v_pk_mul_f32 v[160:161], v[80:81], s[100:101] op_sel_hi:[1,0]
    v_pk_mul_f32 v[162:163], v[82:83], s[100:101] op_sel_hi:[1,0]
    v_pk_mul_f32 v[164:165], v[84:85], s[100:101] op_sel_hi:[1,0]
    v_pk_mul_f32 v[166:167], v[86:87], s[100:101] op_sel_hi:[1,0]
    v_exp_f32_e64 v160, v160 clamp
    v_exp_f32_e64 v161, v161 clamp
    v_exp_f32_e64 v162, v162 clamp
    v_exp_f32_e64 v163, v163 clamp
    v_exp_f32_e64 v164, v164 clamp
    v_exp_f32_e64 v165, v165 clamp
    v_exp_f32_e64 v166, v166 clamp
    v_exp_f32_e64 v167, v167 clamp
    ds_write_b128 v36, v[48:51] offset:21504
    v_max_f32 v80, s101, v80
    v_max_f32 v81, s101, v81
    v_max_f32 v82, s101, v82
    v_max_f32 v83, s101, v83
    v_max_f32 v84, s101, v84
    v_max_f32 v85, s101, v85
    v_max_f32 v86, s101, v86
    v_max_f32 v87, s101, v87
    v_pk_add_f32 v[80:81], v[80:81], v[160:161]
    v_pk_add_f32 v[82:83], v[82:83], v[162:163]
    v_pk_add_f32 v[84:85], v[84:85], v[164:165]
    v_pk_add_f32 v[86:87], v[86:87], v[166:167]
    buffer_load_ushort v46, v43, s[28:31], 0 offen offset:0
    buffer_load_ushort v47, v43, s[28:31], 0 offen offset:32
    buffer_load_dword v45, v44, s[48:51], 0 offen sc1
    v_cvt_pk_bf16_f32 v52, v80, v81
    v_cvt_pk_bf16_f32 v53, v82, v83
    v_cvt_pk_bf16_f32 v54, v84, v85
    v_cvt_pk_bf16_f32 v55, v86, v87
    ds_write_b128 v36, v[52:55] offset:16384
    v_cvt_pk_bf16_f32 v56, v128, v129
    v_cvt_pk_bf16_f32 v57, v130, v131
    v_cvt_pk_bf16_f32 v58, v132, v133
    v_cvt_pk_bf16_f32 v59, v134, v135
    v_pk_mul_f32 v[160:161], v[88:89], s[100:101] op_sel_hi:[1,0]
    v_pk_mul_f32 v[162:163], v[90:91], s[100:101] op_sel_hi:[1,0]
    v_pk_mul_f32 v[164:165], v[92:93], s[100:101] op_sel_hi:[1,0]
    v_pk_mul_f32 v[166:167], v[94:95], s[100:101] op_sel_hi:[1,0]
    v_exp_f32_e64 v160, v160 clamp
    v_exp_f32_e64 v161, v161 clamp
    v_exp_f32_e64 v162, v162 clamp
    v_exp_f32_e64 v163, v163 clamp
    v_exp_f32_e64 v164, v164 clamp
    v_exp_f32_e64 v165, v165 clamp
    v_exp_f32_e64 v166, v166 clamp
    v_exp_f32_e64 v167, v167 clamp
    ds_write_b128 v36, v[56:59] offset:22528
    v_max_f32 v88, s101, v88
    v_max_f32 v89, s101, v89
    v_max_f32 v90, s101, v90
    v_max_f32 v91, s101, v91
    v_max_f32 v92, s101, v92
    v_max_f32 v93, s101, v93
    v_max_f32 v94, s101, v94
    v_max_f32 v95, s101, v95
    v_pk_add_f32 v[88:89], v[88:89], v[160:161]
    v_pk_add_f32 v[90:91], v[90:91], v[162:163]
    v_pk_add_f32 v[92:93], v[92:93], v[164:165]
    v_pk_add_f32 v[94:95], v[94:95], v[166:167]
    v_cvt_pk_bf16_f32 v60, v88, v89
    v_cvt_pk_bf16_f32 v61, v90, v91
    v_cvt_pk_bf16_f32 v62, v92, v93
    v_cvt_pk_bf16_f32 v63, v94, v95
    ds_write_b128 v36, v[60:63] offset:17408
    v_cvt_pk_bf16_f32 v64, v136, v137
    v_cvt_pk_bf16_f32 v65, v138, v139
    v_cvt_pk_bf16_f32 v66, v140, v141
    v_cvt_pk_bf16_f32 v67, v142, v143
    v_pk_mul_f32 v[160:161], v[96:97], s[100:101] op_sel_hi:[1,0]
    v_pk_mul_f32 v[162:163], v[98:99], s[100:101] op_sel_hi:[1,0]
    v_pk_mul_f32 v[164:165], v[100:101], s[100:101] op_sel_hi:[1,0]
    v_pk_mul_f32 v[166:167], v[102:103], s[100:101] op_sel_hi:[1,0]
    v_exp_f32_e64 v160, v160 clamp
    v_exp_f32_e64 v161, v161 clamp
    v_exp_f32_e64 v162, v162 clamp
    v_exp_f32_e64 v163, v163 clamp
    v_exp_f32_e64 v164, v164 clamp
    v_exp_f32_e64 v165, v165 clamp
    v_exp_f32_e64 v166, v166 clamp
    v_exp_f32_e64 v167, v167 clamp
    ds_write_b128 v36, v[64:67] offset:23552
    v_max_f32 v96, s101, v96
    v_max_f32 v97, s101, v97
    v_max_f32 v98, s101, v98
    v_max_f32 v99, s101, v99
    v_max_f32 v100, s101, v100
    v_max_f32 v101, s101, v101
    v_max_f32 v102, s101, v102
    v_max_f32 v103, s101, v103
    v_pk_add_f32 v[96:97], v[96:97], v[160:161]
    v_pk_add_f32 v[98:99], v[98:99], v[162:163]
    v_pk_add_f32 v[100:101], v[100:101], v[164:165]
    v_pk_add_f32 v[102:103], v[102:103], v[166:167]
    v_cvt_pk_bf16_f32 v68, v96, v97
    v_cvt_pk_bf16_f32 v69, v98, v99
    v_cvt_pk_bf16_f32 v70, v100, v101
    v_cvt_pk_bf16_f32 v71, v102, v103
    ds_write_b128 v36, v[68:71] offset:18432
    v_cvt_pk_bf16_f32 v72, v144, v145
    v_cvt_pk_bf16_f32 v73, v146, v147
    v_cvt_pk_bf16_f32 v74, v148, v149
    v_cvt_pk_bf16_f32 v75, v150, v151
    v_pk_mul_f32 v[160:161], v[104:105], s[100:101] op_sel_hi:[1,0]
    v_pk_mul_f32 v[162:163], v[106:107], s[100:101] op_sel_hi:[1,0]
    v_pk_mul_f32 v[164:165], v[108:109], s[100:101] op_sel_hi:[1,0]
    v_pk_mul_f32 v[166:167], v[110:111], s[100:101] op_sel_hi:[1,0]
    v_exp_f32_e64 v160, v160 clamp
    v_exp_f32_e64 v161, v161 clamp
    v_exp_f32_e64 v162, v162 clamp
    v_exp_f32_e64 v163, v163 clamp
    v_exp_f32_e64 v164, v164 clamp
    v_exp_f32_e64 v165, v165 clamp
    v_exp_f32_e64 v166, v166 clamp
    v_exp_f32_e64 v167, v167 clamp
    ds_write_b128 v36, v[72:75] offset:24576
    v_max_f32 v104, s101, v104
    v_max_f32 v105, s101, v105
    v_max_f32 v106, s101, v106
    v_max_f32 v107, s101, v107
    v_max_f32 v108, s101, v108
    v_max_f32 v109, s101, v109
    v_max_f32 v110, s101, v110
    v_max_f32 v111, s101, v111
    v_pk_add_f32 v[104:105], v[104:105], v[160:161]
    v_pk_add_f32 v[106:107], v[106:107], v[162:163]
    v_pk_add_f32 v[108:109], v[108:109], v[164:165]
    v_pk_add_f32 v[110:111], v[110:111], v[166:167]
    s_waitcnt vmcnt(0)
    v_cmp_eq_u32 vcc, -1, v45
    s_nop 1
    s_cbranch_vccnz Lslow_6
Lback_7:
    v_cvt_pk_bf16_f32 v76, v104, v105
    s_add_u32 m0, s61, 28672
    s_nop 0
    buffer_load_dwordx4 v29, s[48:51], s90 offen offset:0 sc1 lds
    v_cvt_pk_bf16_f32 v77, v106, v107
    v_cvt_pk_bf16_f32 v78, v108, v109
    v_cvt_pk_bf16_f32 v79, v110, v111
    ds_write_b128 v36, v[76:79] offset:19456
    v_cvt_pk_bf16_f32 v48, v152, v153
    buffer_load_dwordx4 v29, s[48:51], s90 offen offset:1024 sc1 lds
    v_cvt_pk_bf16_f32 v49, v154, v155
    v_cvt_pk_bf16_f32 v50, v156, v157
    v_cvt_pk_bf16_f32 v51, v158, v159
    v_pk_mul_f32 v[160:161], v[112:113], s[100:101] op_sel_hi:[1,0]
    v_pk_mul_f32 v[162:163], v[114:115], s[100:101] op_sel_hi:[1,0]
    v_pk_mul_f32 v[164:165], v[116:117], s[100:101] op_sel_hi:[1,0]
    v_pk_mul_f32 v[166:167], v[118:119], s[100:101] op_sel_hi:[1,0]
    v_exp_f32_e64 v160, v160 clamp
    v_exp_f32_e64 v161, v161 clamp
    v_exp_f32_e64 v162, v162 clamp
    buffer_load_dwordx4 v29, s[48:51], s90 offen offset:2048 sc1 lds
    v_exp_f32_e64 v163, v163 clamp
    v_exp_f32_e64 v164, v164 clamp
    v_exp_f32_e64 v165, v165 clamp
    v_exp_f32_e64 v166, v166 clamp
    v_exp_f32_e64 v167, v167 clamp
    ds_write_b128 v36, v[48:51] offset:25600
    v_max_f32 v112, s101, v112
    buffer_load_dwordx4 v29, s[48:51], s90 offen offset:3072 sc1 lds
    v_max_f32 v113, s101, v113
    v_max_f32 v114, s101, v114
    v_max_f32 v115, s101, v115
    v_max_f32 v116, s101, v116
    v_max_f32 v117, s101, v117
    v_max_f32 v118, s101, v118
    v_max_f32 v119, s101, v119
    v_pk_add_f32 v[112:113], v[112:113], v[160:161]
    v_pk_add_f32 v[114:115], v[114:115], v[162:163]
    v_pk_add_f32 v[116:117], v[116:117], v[164:165]
    v_pk_add_f32 v[118:119], v[118:119], v[166:167]
    v_cvt_pk_bf16_f32 v52, v112, v113
    v_cvt_pk_bf16_f32 v53, v114, v115
    s_add_u32 m0, s61, 32768
    s_nop 0
    buffer_load_dwordx4 v29, s[48:51], s91 offen offset:0 sc1 lds
    v_cvt_pk_bf16_f32 v54, v116, v117
    v_cvt_pk_bf16_f32 v55, v118, v119
    ds_write_b128 v36, v[52:55] offset:20480
    s_waitcnt lgkmcnt(0)
    s_barrier
    ds_read_b128 a[0:3], v37 offset:16384
    ds_read_b128 a[4:7], v38 offset:21504
    ds_read_b128 a[8:11], v38 offset:22528
    ds_read_b128 a[12:15], v39 offset:16384
    ds_read_b128 a[16:19], v40 offset:21504
    ds_read_b128 a[20:23], v40 offset:22528
    ds_read_b128 a[24:27], v37 offset:57344
    ds_read_b128 a[28:31], v38 offset:62464
    ds_read_b128 a[32:35], v38 offset:63488
    ds_read_b128 a[36:39], v39 offset:57344
    ds_read_b128 a[40:43], v40 offset:62464
    ds_read_b128 a[44:47], v40 offset:63488
    v_add_u32 v37, 81920, v37
    v_add_u32 v38, 81920, v38
    v_add_u32 v39, 81920, v39
    v_add_u32 v40, 81920, v40
    s_waitcnt lgkmcnt(11)
    v_mfma_f32_16x16x32_bf16 v[96:99], v[12:15], a[0:3], 0
    ds_read_b128 a[48:51], v37 offset:16384
    s_waitcnt lgkmcnt(11)
    v_mfma_f32_16x16x32_bf16 v[80:83], a[4:7], a[0:3], 0
    ds_read_b128 a[52:55], v38 offset:21504
    s_waitcnt lgkmcnt(11)
    v_mfma_f32_16x16x32_bf16 v[84:87], a[8:11], a[0:3], 0
    ds_read_b128 a[56:59], v38 offset:22528
    buffer_load_dwordx4 v29, s[48:51], s91 offen offset:1024 sc1 lds
    s_waitcnt lgkmcnt(11)
    v_mfma_f32_16x16x32_bf16 v[100:103], v[12:15], a[12:15], 0
    ds_read_b128 a[60:63], v39 offset:16384
    s_waitcnt lgkmcnt(11)
    v_mfma_f32_16x16x32_bf16 v[88:91], a[16:19], a[12:15], 0
    ds_read_b128 a[64:67], v40 offset:21504
    s_waitcnt lgkmcnt(11)
    v_mfma_f32_16x16x32_bf16 v[92:95], a[20:23], a[12:15], 0
    ds_read_b128 a[68:71], v40 offset:22528
    buffer_load_dwordx4 v29, s[48:51], s91 offen offset:2048 sc1 lds
    s_waitcnt lgkmcnt(11)
    v_mfma_f32_16x16x32_bf16 v[96:99], v[12:15], a[24:27], v[96:99]
    ds_read_b128 a[72:75], v37 offset:57344
    s_waitcnt lgkmcnt(11)
    v_mfma_f32_16x16x32_bf16 v[80:83], a[28:31], a[24:27], v[80:83]
    ds_read_b128 a[76:79], v38 offset:62464
    s_waitcnt lgkmcnt(11)
    v_mfma_f32_16x16x32_bf16 v[84:87], a[32:35], a[24:27], v[84:87]
    ds_read_b128 a[80:83], v38 offset:63488
    buffer_load_dwordx4 v29, s[48:51], s91 offen offset:3072 sc1 lds
    s_waitcnt lgkmcnt(11)
    v_mfma_f32_16x16x32_bf16 v[100:103], v[12:15], a[36:39], v[100:103]
    ds_read_b128 a[84:87], v39 offset:57344
    s_waitcnt lgkmcnt(11)
    v_mfma_f32_16x16x32_bf16 v[88:91], a[40:43], a[36:39], v[88:91]
    ds_read_b128 a[88:91], v40 offset:62464
    s_waitcnt lgkmcnt(11)
    v_mfma_f32_16x16x32_bf16 v[92:95], a[44:47], a[36:39], v[92:95]
    ds_read_b128 a[92:95], v40 offset:63488
    s_add_u32 m0, s61, 36864
    s_nop 0
    buffer_load_dwordx4 v29, s[48:51], s92 offen offset:0 sc1 lds
    s_waitcnt lgkmcnt(11)
    v_mfma_f32_16x16x32_bf16 v[96:99], v[12:15], a[48:51], v[96:99]
    s_waitcnt lgkmcnt(10)
    v_mfma_f32_16x16x32_bf16 v[80:83], a[52:55], a[48:51], v[80:83]
    s_waitcnt lgkmcnt(9)
    v_mfma_f32_16x16x32_bf16 v[84:87], a[56:59], a[48:51], v[84:87]
    s_waitcnt lgkmcnt(8)
    v_mfma_f32_16x16x32_bf16 v[100:103], v[12:15], a[60:63], v[100:103]
    s_waitcnt lgkmcnt(7)
    v_mfma_f32_16x16x32_bf16 v[88:91], a[64:67], a[60:63], v[88:91]
    s_waitcnt lgkmcnt(6)
    v_mfma_f32_16x16x32_bf16 v[92:95], a[68:71], a[60:63], v[92:95]
    buffer_load_dwordx4 v29, s[48:51], s92 offen offset:1024 sc1 lds
    s_waitcnt lgkmcnt(5)
    v_mfma_f32_16x16x32_bf16 v[96:99], v[12:15], a[72:75], v[96:99]
    s_waitcnt lgkmcnt(4)
    v_mfma_f32_16x16x32_bf16 v[80:83], a[76:79], a[72:75], v[80:83]
    s_waitcnt lgkmcnt(3)
    v_mfma_f32_16x16x32_bf16 v[84:87], a[80:83], a[72:75], v[84:87]
    s_waitcnt lgkmcnt(2)
    v_mfma_f32_16x16x32_bf16 v[100:103], v[12:15], a[84:87], v[100:103]
    s_waitcnt lgkmcnt(1)
    v_mfma_f32_16x16x32_bf16 v[88:91], a[88:91], a[84:87], v[88:91]
    s_waitcnt lgkmcnt(0)
    v_mfma_f32_16x16x32_bf16 v[92:95], a[92:95], a[84:87], v[92:95]
    buffer_load_dwordx4 v29, s[48:51], s92 offen offset:2048 sc1 lds
    buffer_load_dwordx4 v29, s[48:51], s92 offen offset:3072 sc1 lds
    s_nop 5
L_p2:
    v_and_b32 v43, 0x7c, v31
    v_add_u32 v20, 16384, v29
    v_add_u32 v21, 98304, v29
    s_waitcnt vmcnt(8)
    s_barrier
    ds_read_b128 v[160:163], v20 offset:12288
    ds_read_b128 v[164:167], v20 offset:13312
    ds_read_b128 v[168:171], v20 offset:14336
    ds_read_b128 v[172:175], v20 offset:15360
    ds_read_b128 v[176:179], v20 offset:53248
    ds_read_b128 v[180:183], v20 offset:54272
    s_waitcnt lgkmcnt(5)
    v_mfma_f32_16x16x32_bf16 v[128:131], v[160:163], a[160:163], 0
    ds_read_b128 v[184:187], v20 offset:55296
    ds_read_b128 v[188:191], v20 offset:56320
    v_mfma_f32_16x16x32_bf16 v[136:139], v[160:163], a[164:167], 0
    buffer_store_dword v96, v43, s[48:51], s34 offen sc1
    s_add_u32 m0, s61, 16384
    s_waitcnt lgkmcnt(6)
    v_mfma_f32_16x16x32_bf16 v[132:135], v[164:167], a[160:163], 0
    ds_read_b128 v[160:163], v21 offset:12288
    ds_read_b128 v[208:211], v4 offset:12288
    v_mfma_f32_16x16x32_bf16 v[140:143], v[164:167], a[164:167], 0
    buffer_store_dword v100, v43, s[48:51], s35 offen sc1
    s_mul_i32 s75, s16, 14
    s_waitcnt lgkmcnt(4)
    v_mfma_f32_16x16x32_bf16 v[144:147], v[168:171], a[160:163], 0
    ds_read_b128 v[164:167], v21 offset:13312
    ds_read_b128 v[212:215], v4 offset:14336
    v_mfma_f32_16x16x32_bf16 v[152:155], v[168:171], a[164:167], 0
    buffer_store_dwordx4 v[80:83], v29, s[48:51], s32 offen offset:0 sc1
    s_add_u32 s75, s75, s17
    s_lshl2_add_u32 s81, s75, s56
    v_mfma_f32_16x16x32_bf16 v[148:151], v[172:175], a[160:163], 0
    ds_read_b128 v[168:171], v21 offset:14336
    ds_read_b128 v[216:219], v5 offset:12288
    v_mfma_f32_16x16x32_bf16 v[156:159], v[172:175], a[164:167], 0
    s_xor_b32 s75, s81, 4
    s_lshl_b32 s79, s75, 13
    s_add_u32 s79, s79, 18874368
    s_lshl_b32 s80, s75, 7
    v_mfma_f32_16x16x32_bf16 v[128:131], v[176:179], a[168:171], v[128:131]
    ds_read_b128 v[172:175], v21 offset:15360
    ds_read_b128 v[220:223], v5 offset:14336
    v_mfma_f32_16x16x32_bf16 v[136:139], v[176:179], a[172:175], v[136:139]
    buffer_store_dwordx4 v[84:87], v29, s[48:51], s32 offen offset:1024 sc1
    s_add_u32 s80, s80, 638976
    s_lshl2_add_u32 s67, s16, s56
    v_mfma_f32_16x16x32_bf16 v[132:135], v[180:183], a[168:171], v[132:135]
    ds_read_b128 v[176:179], v21 offset:53248
    ds_read_b128 v[224:227], v4 offset:0
    v_mfma_f32_16x16x32_bf16 v[140:143], v[180:183], a[172:175], v[140:143]
    s_lshl_b32 s70, s67, 7
    s_lshl_b32 s66, s67, 10
    s_add_u32 s66, s66, 344064
    s_waitcnt lgkmcnt(7)
    v_mfma_f32_16x16x32_bf16 v[144:147], v[184:187], a[168:171], v[144:147]
    ds_read_b128 v[180:183], v21 offset:54272
    ds_read_b128 v[228:231], v4 offset:2048
    v_mfma_f32_16x16x32_bf16 v[152:155], v[184:187], a[172:175], v[152:155]
    buffer_store_dwordx4 v[88:91], v29, s[48:51], s33 offen offset:0 sc1
    s_mul_i32 s67, s67, 14
    s_add_u32 s67, s67, s17
    v_mfma_f32_16x16x32_bf16 v[148:151], v[188:191], a[168:171], v[148:151]
    ds_read_b128 v[184:187], v21 offset:55296
    ds_read_b128 v[232:235], v5 offset:0
    v_mfma_f32_16x16x32_bf16 v[156:159], v[188:191], a[172:175], v[156:159]
    s_lshl_b32 s67, s67, 12
    s_add_u32 s67, s67, 6291456
    s_add_u32 s70, s70, 786432
    v_min_u32 v44, 640, v2
    v_mfma_f32_16x16x32_bf16 v[128:131], v[160:163], a[176:179], v[128:131]
    ds_read_b128 v[188:191], v21 offset:56320
    ds_read_b128 v[236:239], v5 offset:2048
    v_mfma_f32_16x16x32_bf16 v[136:139], v[160:163], a[180:183], v[136:139]
    buffer_store_dwordx4 v[92:95], v29, s[48:51], s62 offen offset:1024 sc1
    v_and_b32 v24, 60, v31
    v_mfma_f32_16x16x32_bf16 v[132:135], v[164:167], a[176:179], v[132:135]
    ds_read_b128 v[240:243], v4 offset:4096
    v_mfma_f32_16x16x32_bf16 v[140:143], v[164:167], a[180:183], v[140:143]
    s_cmp_eq_u32 s17, 0
    s_cselect_b32 s60, 0x80000000, s67
    s_add_u32 s75, s56, 1
    s_waitcnt lgkmcnt(6)
    v_mfma_f32_16x16x32_bf16 v[144:147], v[168:171], a[176:179], v[144:147]
    s_and_b32 s75, s75, 3
    s_lshl2_add_u32 s75, s4, s75
    v_mfma_f32_16x16x32_bf16 v[152:155], v[168:171], a[180:183], v[152:155]
    buffer_load_dwordx4 v29, s[48:51], s93 offen offset:0 sc1 lds
    s_waitcnt vmcnt(11) lgkmcnt(0)
    s_barrier
    v_mfma_f32_16x16x32_bf16 v[148:151], v[172:175], a[176:179], v[148:151]
    ds_read_b128 v[160:163], v20 offset:16384
    ds_read_b128 v[164:167], v20 offset:17408
    v_mfma_f32_16x16x32_bf16 v[156:159], v[172:175], a[180:183], v[156:159]
    buffer_load_dwordx4 v29, s[48:51], s93 offen offset:1024 sc1 lds
    s_mul_i32 s75, s75, 48
    s_mul_i32 s76, s56, 5
    v_mfma_f32_16x16x32_bf16 v[128:131], v[176:179], a[184:187], v[128:131]
    ds_read_b128 v[168:171], v20 offset:18432
    ds_read_b128 v[172:175], v20 offset:19456
    v_mfma_f32_16x16x32_bf16 v[136:139], v[176:179], a[188:191], v[136:139]
    buffer_load_dwordx4 v29, s[48:51], s93 offen offset:2048 sc1 lds
    s_add_u32 s75, s75, s76
    s_lshl_b32 s75, s75, 10
    v_mfma_f32_16x16x32_bf16 v[132:135], v[180:183], a[184:187], v[132:135]
    ds_read_b128 v[176:179], v20 offset:57344
    ds_read_b128 v[244:247], v4 offset:6144
    v_mfma_f32_16x16x32_bf16 v[140:143], v[180:183], a[188:191], v[140:143]
    buffer_load_dwordx4 v29, s[48:51], s93 offen offset:3072 sc1 lds
    s_add_u32 m0, s61, 20480
    s_add_u32 s63, s75, 10485760
    v_mfma_f32_16x16x32_bf16 v[144:147], v[184:187], a[184:187], v[144:147]
    ds_read_b128 v[180:183], v20 offset:58368
    ds_read_b128 v[248:251], v5 offset:4096
    v_mfma_f32_16x16x32_bf16 v[152:155], v[184:187], a[188:191], v[152:155]
    s_add_u32 s75, s56, 2
    s_and_b32 s75, s75, 3
    s_lshl2_add_u32 s75, s4, s75
    s_mul_i32 s75, s75, 48
    v_mfma_f32_16x16x32_bf16 v[148:151], v[188:191], a[184:187], v[148:151]
    ds_read_b128 v[184:187], v20 offset:59392
    ds_read_b128 v[252:255], v5 offset:6144
    v_mfma_f32_16x16x32_bf16 v[156:159], v[188:191], a[188:191], v[156:159]
    s_mul_i32 s76, s56, 5
    s_add_u32 s75, s75, s76
    s_lshl_b32 s75, s75, 10
    s_waitcnt lgkmcnt(6)
    v_mfma_f32_16x16x32_bf16 v[128:131], v[160:163], a[192:195], v[128:131]
    ds_read_b128 v[188:191], v20 offset:60416
    ds_read_b128 a[0:3], v4 offset:8192
    v_mfma_f32_16x16x32_bf16 v[136:139], v[160:163], a[196:199], v[136:139]
    s_add_u32 s64, s75, 10485760
    s_add_u32 s75, s56, 3
    s_and_b32 s75, s75, 3
    s_lshl2_add_u32 s75, s4, s75
    v_mfma_f32_16x16x32_bf16 v[132:135], v[164:167], a[192:195], v[132:135]
    ds_read_b128 v[160:163], v21 offset:16384
    ds_read_b128 a[4:7], v4 offset:10240
    v_mfma_f32_16x16x32_bf16 v[140:143], v[164:167], a[196:199], v[140:143]
    buffer_load_dwordx4 v29, s[48:51], s94 offen offset:0 sc1 lds
    s_mul_i32 s75, s75, 48
    s_mul_i32 s76, s56, 5
    v_mfma_f32_16x16x32_bf16 v[144:147], v[168:171], a[192:195], v[144:147]
    ds_read_b128 v[164:167], v21 offset:17408
    ds_read_b128 a[8:11], v5 offset:8192
    v_mfma_f32_16x16x32_bf16 v[152:155], v[168:171], a[196:199], v[152:155]
    s_add_u32 s75, s75, s76
    s_lshl_b32 s75, s75, 10
    s_add_u32 s65, s75, 10485760
    s_add_u32 s75, s56, 4
    v_mfma_f32_16x16x32_bf16 v[148:151], v[172:175], a[192:195], v[148:151]
    ds_read_b128 v[168:171], v21 offset:18432
    ds_read_b128 a[12:15], v5 offset:10240
    v_mfma_f32_16x16x32_bf16 v[156:159], v[172:175], a[196:199], v[156:159]
    buffer_load_dwordx4 v29, s[48:51], s94 offen offset:1024 sc1 lds
    s_and_b32 s75, s75, 3
    s_waitcnt lgkmcnt(7)
    v_mfma_f32_16x16x32_bf16 v[128:131], v[176:179], a[200:203], v[128:131]
    ds_read_b128 v[172:175], v21 offset:19456
    s_lshl2_add_u32 s75, s4, s75
    v_mfma_f32_16x16x32_bf16 v[136:139], v[176:179], a[204:207], v[136:139]
    s_mul_i32 s75, s75, 48
    s_mul_i32 s76, s56, 5
    s_add_u32 s75, s75, s76
    s_lshl_b32 s75, s75, 10
    v_mfma_f32_16x16x32_bf16 v[132:135], v[180:183], a[200:203], v[132:135]
    ds_read_b128 v[176:179], v21 offset:57344
    s_add_u32 s71, s75, 10485760
    v_mfma_f32_16x16x32_bf16 v[140:143], v[180:183], a[204:207], v[140:143]
    buffer_load_dwordx4 v29, s[48:51], s94 offen offset:2048 sc1 lds
    s_mul_i32 s75, s5, 48
    s_add_u32 s75, s75, s76
    v_mfma_f32_16x16x32_bf16 v[144:147], v[184:187], a[200:203], v[144:147]
    ds_read_b128 v[180:183], v21 offset:58368
    s_mul_i32 s75, s75, 5120
    v_mfma_f32_16x16x32_bf16 v[152:155], v[184:187], a[204:207], v[152:155]
    buffer_load_dwordx4 v29, s[48:51], s94 offen offset:3072 sc1 lds
    s_add_u32 m0, s61, 24576
    s_add_u32 s72, s75, 16777216
    v_mfma_f32_16x16x32_bf16 v[148:151], v[188:191], a[200:203], v[148:151]
    ds_read_b128 v[184:187], v21 offset:59392
    s_mul_i32 s75, s56, 10240
    v_mfma_f32_16x16x32_bf16 v[156:159], v[188:191], a[204:207], v[156:159]
    s_add_u32 s99, s72, s75
    s_add_u32 s99, s99, 102400
    s_lshr_b32 s75, s5, 1
    s_waitcnt lgkmcnt(3)
    v_mfma_f32_16x16x32_bf16 v[128:131], v[160:163], a[208:211], v[128:131]
    ds_read_b128 v[188:191], v21 offset:60416
    s_lshl_b32 s75, s75, 12
    v_mfma_f32_16x16x32_bf16 v[136:139], v[160:163], a[212:215], v[136:139]
    buffer_load_dwordx4 v29, s[48:51], s95 offen offset:0 sc1 lds
    s_waitcnt vmcnt(9)
    s_mov_b64 exec, 1
    buffer_store_dword v31, off, s[48:51], s7 sc1
    s_mov_b64 exec, -1
    v_mfma_f32_16x16x32_bf16 v[132:135], v[164:167], a[208:211], v[132:135]
    s_mul_i32 s76, s56, 896
    s_add_u32 s75, s75, s76
    v_mfma_f32_16x16x32_bf16 v[140:143], v[164:167], a[212:215], v[140:143]
    buffer_load_dwordx4 v29, s[48:51], s95 offen offset:1024 sc1 lds
    s_add_u32 s76, s75, 622592
    v_min_u32 v16, 768, v2
    v_mfma_f32_16x16x32_bf16 v[144:147], v[168:171], a[208:211], v[144:147]
    v_add_u32 v16, s76, v16
    s_lshl2_add_u32 s75, s5, s56
    v_mfma_f32_16x16x32_bf16 v[152:155], v[168:171], a[212:215], v[152:155]
    s_lshl_b32 s75, s75, 9
    s_add_u32 s75, s75, 606208
    s_waitcnt lgkmcnt(0)
    s_barrier
    v_mfma_f32_16x16x32_bf16 v[148:151], v[172:175], a[208:211], v[148:151]
    ds_read_b128 v[160:163], v20 offset:20480
    ds_read_b128 v[164:167], v20 offset:21504
    v_mfma_f32_16x16x32_bf16 v[156:159], v[172:175], a[212:215], v[156:159]
    buffer_load_dwordx4 v29, s[48:51], s95 offen offset:2048 sc1 lds
    v_min_u32 v17, 384, v2
    v_add_u32 v17, s75, v17
    v_mfma_f32_16x16x32_bf16 v[128:131], v[176:179], a[216:219], v[128:131]
    ds_read_b128 v[168:171], v20 offset:22528
    ds_read_b128 v[172:175], v20 offset:23552
    v_mfma_f32_16x16x32_bf16 v[136:139], v[176:179], a[220:223], v[136:139]
    s_lshl_b32 s73, s4, 12
    s_add_u32 s73, s73, 475136
    s_lshr_b32 s75, s56, 1
    s_lshl_b32 s75, s75, 8
    v_mfma_f32_16x16x32_bf16 v[132:135], v[180:183], a[216:219], v[132:135]
    ds_read_b128 v[176:179], v20 offset:61440
    s_add_u32 s75, s75, s73
    v_mfma_f32_16x16x32_bf16 v[140:143], v[180:183], a[220:223], v[140:143]
    buffer_load_dwordx4 v29, s[48:51], s95 offen offset:3072 sc1 lds
    s_add_u32 s75, s75, 3584
    v_and_b32 v18, 0x80, v2
    v_mfma_f32_16x16x32_bf16 v[144:147], v[184:187], a[216:219], v[144:147]
    ds_read_b128 v[180:183], v20 offset:62464
    s_add_u32 m0, s61, 12288
    s_add_u32 s6, s87, 128
    v_mfma_f32_16x16x32_bf16 v[152:155], v[184:187], a[220:223], v[152:155]
    v_add_u32 v28, s75, v18
    s_lshr_b32 s75, s56, 1
    s_lshl1_add_u32 s75, s4, s75
    s_lshl_b32 s75, s75, 8
    v_mfma_f32_16x16x32_bf16 v[148:151], v[188:191], a[216:219], v[148:151]
    ds_read_b128 v[184:187], v20 offset:63488
    s_add_u32 s75, s75, 753664
    v_mfma_f32_16x16x32_bf16 v[156:159], v[188:191], a[220:223], v[156:159]
    buffer_load_dwordx4 v32, s[24:27], s6 offen offset:0 lds
    v_add_u32 v26, s75, v18
    s_waitcnt lgkmcnt(3)
    v_mfma_f32_16x16x32_bf16 v[128:131], v[160:163], a[224:227], v[128:131]
    ds_read_b128 v[188:191], v20 offset:64512
    s_mul_i32 s75, s56, 7
    v_mfma_f32_16x16x32_bf16 v[136:139], v[160:163], a[228:231], v[136:139]
    s_add_u32 s75, s75, 1
    s_and_b32 s75, s75, 0xfe
    v_and_b32 v18, 7, v0
    v_add_u32 v18, s75, v18
    v_mfma_f32_16x16x32_bf16 v[132:135], v[164:167], a[224:227], v[132:135]
    ds_read_b128 v[160:163], v21 offset:20480
    v_min_u32 v18, 27, v18
    v_mfma_f32_16x16x32_bf16 v[140:143], v[164:167], a[228:231], v[140:143]
    buffer_load_dwordx4 v33, s[24:27], s6 offen offset:1024 lds
    v_lshlrev_b32 v18, 7, v18
    v_add_u32 v18, s73, v18
    v_mfma_f32_16x16x32_bf16 v[144:147], v[168:171], a[224:227], v[144:147]
    ds_read_b128 v[164:167], v21 offset:21504
    v_mfma_f32_16x16x32_bf16 v[152:155], v[168:171], a[228:231], v[152:155]
    s_cmp_eq_u32 s56, 3
    s_cselect_b32 s75, 0x80000000, 0
    v_add_u32 v22, s75, v29
    v_lshlrev_b32 v8, 16, v46
    v_mfma_f32_16x16x32_bf16 v[148:151], v[172:175], a[224:227], v[148:151]
    ds_read_b128 v[168:171], v21 offset:22528
    v_lshlrev_b32 v9, 16, v46
    v_mfma_f32_16x16x32_bf16 v[156:159], v[172:175], a[228:231], v[156:159]
    buffer_load_dwordx4 v34, s[24:27], s6 offen offset:2048 lds
    v_lshlrev_b32 v10, 16, v46
    s_waitcnt lgkmcnt(3)
    v_mfma_f32_16x16x32_bf16 v[128:131], v[176:179], a[232:235], v[128:131]
    ds_read_b128 v[172:175], v21 offset:23552
    v_lshlrev_b32 v11, 16, v46
    v_mfma_f32_16x16x32_bf16 v[136:139], v[176:179], a[236:239], v[136:139]
    v_lshlrev_b32 v12, 16, v47
    v_lshlrev_b32 v13, 16, v47
    v_lshlrev_b32 v14, 16, v47
    v_lshlrev_b32 v15, 16, v47
    v_mfma_f32_16x16x32_bf16 v[132:135], v[180:183], a[232:235], v[132:135]
    ds_read_b128 v[176:179], v21 offset:61440
    v_mfma_f32_16x16x32_bf16 v[140:143], v[180:183], a[236:239], v[140:143]
    buffer_load_dwordx4 v35, s[24:27], s6 offen offset:3072 lds
    s_cmp_eq_u32 s17, 0
    s_cselect_b32 s76, 0x80000000, 0
    v_mfma_f32_16x16x32_bf16 v[144:147], v[184:187], a[232:235], v[144:147]
    ds_read_b128 v[180:183], v21 offset:62464
    s_add_u32 m0, s61, 0
    v_mfma_f32_16x16x32_bf16 v[152:155], v[184:187], a[236:239], v[152:155]
    v_add_u32 v25, s76, v29
    s_lshl2_add_u32 s75, s16, s56
    s_mul_i32 s75, s75, 98304
    s_lshl_b32 s76, s17, 11
    v_mfma_f32_16x16x32_bf16 v[148:151], v[188:191], a[232:235], v[148:151]
    ds_read_b128 v[184:187], v21 offset:63488
    s_add_u32 s75, s75, s76
    v_mfma_f32_16x16x32_bf16 v[156:159], v[188:191], a[236:239], v[156:159]
    buffer_load_dwordx4 v32, s[24:27], s88 offen offset:0 lds
    s_add_u32 s18, s75, 10505216
    s_waitcnt lgkmcnt(3)
    v_mfma_f32_16x16x32_bf16 v[128:131], v[160:163], a[240:243], v[128:131]
    ds_read_b128 v[188:191], v21 offset:64512
    s_add_u32 s98, s18, 49152
    v_mfma_f32_16x16x32_bf16 v[136:139], v[160:163], a[244:247], v[136:139]
    s_lshr_b32 s75, s56, 1
    s_lshl1_add_u32 s75, s16, s75
    s_lshl_b32 s75, s75, 5
    s_and_b32 s76, s56, 1
    v_mfma_f32_16x16x32_bf16 v[132:135], v[164:167], a[240:243], v[132:135]
    s_lshl1_add_u32 s76, s17, s76
    s_add_u32 s75, s75, s76
    v_mfma_f32_16x16x32_bf16 v[140:143], v[164:167], a[244:247], v[140:143]
    buffer_load_dwordx4 v33, s[24:27], s88 offen offset:1024 lds
    s_lshl_b32 s75, s75, 7
    s_add_u32 s19, s75, 475136
    v_mfma_f32_16x16x32_bf16 v[144:147], v[168:171], a[240:243], v[144:147]
    v_mfma_f32_16x16x32_bf16 v[152:155], v[168:171], a[244:247], v[152:155]
    s_waitcnt vmcnt(15) lgkmcnt(0)
    s_barrier
    v_mfma_f32_16x16x32_bf16 v[148:151], v[172:175], a[240:243], v[148:151]
    ds_read_b128 v[160:163], v20 offset:0
    ds_read_b128 v[164:167], v20 offset:1024
    v_mfma_f32_16x16x32_bf16 v[156:159], v[172:175], a[244:247], v[156:159]
    buffer_load_dwordx4 v34, s[24:27], s88 offen offset:2048 lds
    v_mfma_f32_16x16x32_bf16 v[128:131], v[176:179], a[248:251], v[128:131]
    ds_read_b128 v[168:171], v20 offset:2048
    ds_read_b128 v[172:175], v20 offset:3072
    v_mfma_f32_16x16x32_bf16 v[136:139], v[176:179], a[252:255], v[136:139]
    v_mfma_f32_16x16x32_bf16 v[132:135], v[180:183], a[248:251], v[132:135]
    ds_read_b128 v[176:179], v20 offset:40960
    v_mfma_f32_16x16x32_bf16 v[140:143], v[180:183], a[252:255], v[140:143]
    buffer_load_dwordx4 v35, s[24:27], s88 offen offset:3072 lds
    v_mfma_f32_16x16x32_bf16 v[144:147], v[184:187], a[248:251], v[144:147]
    ds_read_b128 v[180:183], v20 offset:41984
    s_add_u32 m0, s61, 28672
    v_mfma_f32_16x16x32_bf16 v[152:155], v[184:187], a[252:255], v[152:155]
    v_mfma_f32_16x16x32_bf16 v[148:151], v[188:191], a[248:251], v[148:151]
    ds_read_b128 v[184:187], v20 offset:43008
    v_mfma_f32_16x16x32_bf16 v[156:159], v[188:191], a[252:255], v[156:159]
    buffer_load_dwordx4 v29, s[48:51], s96 offen offset:0 sc1 lds
    s_waitcnt lgkmcnt(3)
    v_mfma_f32_16x16x32_bf16 v[128:131], v[160:163], v[192:195], v[128:131]
    ds_read_b128 v[188:191], v20 offset:44032
    v_mfma_f32_16x16x32_bf16 v[136:139], v[160:163], v[196:199], v[136:139]
    v_mfma_f32_16x16x32_bf16 v[132:135], v[164:167], v[192:195], v[132:135]
    ds_read_b128 v[160:163], v21 offset:0
    v_mfma_f32_16x16x32_bf16 v[140:143], v[164:167], v[196:199], v[140:143]
    buffer_load_dwordx4 v29, s[48:51], s96 offen offset:1024 sc1 lds
    v_mfma_f32_16x16x32_bf16 v[144:147], v[168:171], v[192:195], v[144:147]
    ds_read_b128 v[164:167], v21 offset:1024
    v_mfma_f32_16x16x32_bf16 v[152:155], v[168:171], v[196:199], v[152:155]
    v_mfma_f32_16x16x32_bf16 v[148:151], v[172:175], v[192:195], v[148:151]
    ds_read_b128 v[168:171], v21 offset:2048
    v_mfma_f32_16x16x32_bf16 v[156:159], v[172:175], v[196:199], v[156:159]
    buffer_load_dwordx4 v29, s[48:51], s96 offen offset:2048 sc1 lds
    s_waitcnt lgkmcnt(3)
    v_mfma_f32_16x16x32_bf16 v[128:131], v[176:179], v[200:203], v[128:131]
    ds_read_b128 v[172:175], v21 offset:3072
    v_mfma_f32_16x16x32_bf16 v[136:139], v[176:179], v[204:207], v[136:139]
    v_mfma_f32_16x16x32_bf16 v[132:135], v[180:183], v[200:203], v[132:135]
    ds_read_b128 v[176:179], v21 offset:40960
    v_mfma_f32_16x16x32_bf16 v[140:143], v[180:183], v[204:207], v[140:143]
    buffer_load_dwordx4 v29, s[48:51], s96 offen offset:3072 sc1 lds
    v_mfma_f32_16x16x32_bf16 v[144:147], v[184:187], v[200:203], v[144:147]
    ds_read_b128 v[180:183], v21 offset:41984
    s_add_u32 m0, s61, 4096
    s_add_u32 s6, s88, 128
    v_mfma_f32_16x16x32_bf16 v[152:155], v[184:187], v[204:207], v[152:155]
    v_mfma_f32_16x16x32_bf16 v[148:151], v[188:191], v[200:203], v[148:151]
    ds_read_b128 v[184:187], v21 offset:43008
    v_mfma_f32_16x16x32_bf16 v[156:159], v[188:191], v[204:207], v[156:159]
    buffer_load_dwordx4 v32, s[24:27], s6 offen offset:0 lds
    s_waitcnt lgkmcnt(3)
    v_mfma_f32_16x16x32_bf16 v[128:131], v[160:163], v[208:211], v[128:131]
    ds_read_b128 v[188:191], v21 offset:44032
    v_mfma_f32_16x16x32_bf16 v[136:139], v[160:163], v[212:215], v[136:139]
    v_mfma_f32_16x16x32_bf16 v[132:135], v[164:167], v[208:211], v[132:135]
    s_waitcnt vmcnt(9)
    ds_read_b128 a[16:19], v4 offset:12288
    v_mfma_f32_16x16x32_bf16 v[140:143], v[164:167], v[212:215], v[140:143]
    buffer_load_dwordx4 v33, s[24:27], s6 offen offset:1024 lds
    v_mfma_f32_16x16x32_bf16 v[144:147], v[168:171], v[208:211], v[144:147]
    v_mfma_f32_16x16x32_bf16 v[152:155], v[168:171], v[212:215], v[152:155]
    s_waitcnt lgkmcnt(0)
    s_barrier
    v_mfma_f32_16x16x32_bf16 v[148:151], v[172:175], v[208:211], v[148:151]
    ds_read_b128 v[160:163], v20 offset:4096
    ds_read_b128 v[164:167], v20 offset:5120
    v_mfma_f32_16x16x32_bf16 v[156:159], v[172:175], v[212:215], v[156:159]
    buffer_load_dwordx4 v34, s[24:27], s6 offen offset:2048 lds
    v_mfma_f32_16x16x32_bf16 v[128:131], v[176:179], v[216:219], v[128:131]
    ds_read_b128 v[168:171], v20 offset:6144
    ds_read_b128 v[172:175], v20 offset:7168
    v_mfma_f32_16x16x32_bf16 v[136:139], v[176:179], v[220:223], v[136:139]
    buffer_load_dwordx4 v35, s[24:27], s6 offen offset:3072 lds
    s_add_u32 m0, s61, 8192
    v_mfma_f32_16x16x32_bf16 v[132:135], v[180:183], v[216:219], v[132:135]
    ds_read_b128 v[176:179], v20 offset:45056
    ds_read_b128 a[20:23], v4 offset:14336
    v_mfma_f32_16x16x32_bf16 v[140:143], v[180:183], v[220:223], v[140:143]
    v_mfma_f32_16x16x32_bf16 v[144:147], v[184:187], v[216:219], v[144:147]
    ds_read_b128 v[180:183], v20 offset:46080
    ds_read_b128 a[24:27], v5 offset:12288
    v_mfma_f32_16x16x32_bf16 v[152:155], v[184:187], v[220:223], v[152:155]
    v_mfma_f32_16x16x32_bf16 v[148:151], v[188:191], v[216:219], v[148:151]
    ds_read_b128 v[184:187], v20 offset:47104
    ds_read_b128 a[28:31], v5 offset:14336
    v_mfma_f32_16x16x32_bf16 v[156:159], v[188:191], v[220:223], v[156:159]
    buffer_load_dwordx4 v32, s[24:27], s89 offen offset:0 lds
    s_waitcnt lgkmcnt(6)
    v_mfma_f32_16x16x32_bf16 v[128:131], v[160:163], v[224:227], v[128:131]
    ds_read_b128 v[188:191], v20 offset:48128
    v_mfma_f32_16x16x32_bf16 v[136:139], v[160:163], v[228:231], v[136:139]
    v_mfma_f32_16x16x32_bf16 v[132:135], v[164:167], v[224:227], v[132:135]
    ds_read_b128 v[160:163], v21 offset:4096
    s_waitcnt vmcnt(9)
    ds_read_b128 a[32:35], v4 offset:0
    v_mfma_f32_16x16x32_bf16 v[140:143], v[164:167], v[228:231], v[140:143]
    buffer_load_dword v45, v44, s[48:51], s66 offen sc1
    v_mfma_f32_16x16x32_bf16 v[144:147], v[168:171], v[224:227], v[144:147]
    ds_read_b128 v[164:167], v21 offset:5120
    ds_read_b128 a[36:39], v4 offset:2048
    v_mfma_f32_16x16x32_bf16 v[152:155], v[168:171], v[228:231], v[152:155]
    buffer_load_dword v19, v16, s[48:51], 0 offen sc1
    v_mfma_f32_16x16x32_bf16 v[148:151], v[172:175], v[224:227], v[148:151]
    ds_read_b128 v[168:171], v21 offset:6144
    ds_read_b128 a[40:43], v5 offset:0
    v_mfma_f32_16x16x32_bf16 v[156:159], v[172:175], v[228:231], v[156:159]
    buffer_load_dwordx4 v33, s[24:27], s89 offen offset:1024 lds
    s_waitcnt lgkmcnt(6)
    v_mfma_f32_16x16x32_bf16 v[128:131], v[176:179], v[232:235], v[128:131]
    ds_read_b128 v[172:175], v21 offset:7168
    ds_read_b128 a[44:47], v5 offset:2048
    v_mfma_f32_16x16x32_bf16 v[136:139], v[176:179], v[236:239], v[136:139]
    buffer_load_dwordx4 v34, s[24:27], s89 offen offset:2048 lds
    v_mfma_f32_16x16x32_bf16 v[132:135], v[180:183], v[232:235], v[132:135]
    ds_read_b128 v[176:179], v21 offset:45056
    v_mfma_f32_16x16x32_bf16 v[140:143], v[180:183], v[236:239], v[140:143]
    buffer_load_dwordx4 v35, s[24:27], s89 offen offset:3072 lds
    s_add_u32 m0, s61, 32768
    v_mfma_f32_16x16x32_bf16 v[144:147], v[184:187], v[232:235], v[144:147]
    ds_read_b128 v[180:183], v21 offset:46080
    v_mfma_f32_16x16x32_bf16 v[152:155], v[184:187], v[236:239], v[152:155]
    buffer_load_dwordx4 v29, s[48:51], s97 offen offset:0 sc1 lds
    v_mfma_f32_16x16x32_bf16 v[148:151], v[188:191], v[232:235], v[148:151]
    ds_read_b128 v[184:187], v21 offset:47104
    v_mfma_f32_16x16x32_bf16 v[156:159], v[188:191], v[236:239], v[156:159]
    buffer_load_dwordx4 v29, s[48:51], s97 offen offset:1024 sc1 lds
    s_waitcnt lgkmcnt(4)
    v_mfma_f32_16x16x32_bf16 v[128:131], v[160:163], v[240:243], v[128:131]
    ds_read_b128 v[188:191], v21 offset:48128
    v_mfma_f32_16x16x32_bf16 v[136:139], v[160:163], v[244:247], v[136:139]
    buffer_load_dwordx4 v29, s[48:51], s97 offen offset:2048 sc1 lds
    v_mfma_f32_16x16x32_bf16 v[132:135], v[164:167], v[240:243], v[132:135]
    v_mfma_f32_16x16x32_bf16 v[140:143], v[164:167], v[244:247], v[140:143]
    buffer_load_dwordx4 v29, s[48:51], s97 offen offset:3072 sc1 lds
    s_add_u32 m0, s61, 12288
    s_add_u32 s6, s89, 128
    v_mfma_f32_16x16x32_bf16 v[144:147], v[168:171], v[240:243], v[144:147]
    v_mfma_f32_16x16x32_bf16 v[152:155], v[168:171], v[244:247], v[152:155]
    s_waitcnt lgkmcnt(0)
    s_barrier
    v_mfma_f32_16x16x32_bf16 v[148:151], v[172:175], v[240:243], v[148:151]
    ds_read_b128 v[160:163], v20 offset:8192
    ds_read_b128 v[164:167], v20 offset:9216
    v_mfma_f32_16x16x32_bf16 v[156:159], v[172:175], v[244:247], v[156:159]
    v_mfma_f32_16x16x32_bf16 v[128:131], v[176:179], v[248:251], v[128:131]
    ds_read_b128 v[168:171], v20 offset:10240
    ds_read_b128 v[172:175], v20 offset:11264
    v_mfma_f32_16x16x32_bf16 v[136:139], v[176:179], v[252:255], v[136:139]
    buffer_load_dwordx4 v32, s[24:27], s6 offen offset:0 lds
    v_mfma_f32_16x16x32_bf16 v[132:135], v[180:183], v[248:251], v[132:135]
    ds_read_b128 v[176:179], v20 offset:49152
    v_mfma_f32_16x16x32_bf16 v[140:143], v[180:183], v[252:255], v[140:143]
    buffer_load_dwordx4 v33, s[24:27], s6 offen offset:1024 lds
    v_mfma_f32_16x16x32_bf16 v[144:147], v[184:187], v[248:251], v[144:147]
    ds_read_b128 v[180:183], v20 offset:50176
    v_mfma_f32_16x16x32_bf16 v[152:155], v[184:187], v[252:255], v[152:155]
    buffer_load_dwordx4 v34, s[24:27], s6 offen offset:2048 lds
    v_mfma_f32_16x16x32_bf16 v[148:151], v[188:191], v[248:251], v[148:151]
    ds_read_b128 v[184:187], v20 offset:51200
    v_mfma_f32_16x16x32_bf16 v[156:159], v[188:191], v[252:255], v[156:159]
    buffer_load_dwordx4 v35, s[24:27], s6 offen offset:3072 lds
    s_add_u32 m0, s61, 36864
    s_add_u32 s6, s90, s78
    s_waitcnt lgkmcnt(3)
    v_mfma_f32_16x16x32_bf16 v[128:131], v[160:163], a[0:3], v[128:131]
    ds_read_b128 v[188:191], v20 offset:52224
    s_waitcnt vmcnt(14)
    ds_read_b128 a[48:51], v4 offset:4096
    v_mfma_f32_16x16x32_bf16 v[136:139], v[160:163], a[4:7], v[136:139]
    v_mfma_f32_16x16x32_bf16 v[132:135], v[164:167], a[0:3], v[132:135]
    ds_read_b128 v[160:163], v21 offset:8192
    ds_read_b128 a[52:55], v4 offset:6144
    v_mfma_f32_16x16x32_bf16 v[140:143], v[164:167], a[4:7], v[140:143]
    v_mfma_f32_16x16x32_bf16 v[144:147], v[168:171], a[0:3], v[144:147]
    ds_read_b128 v[164:167], v21 offset:9216
    ds_read_b128 a[56:59], v5 offset:4096
    v_mfma_f32_16x16x32_bf16 v[152:155], v[168:171], a[4:7], v[152:155]
    v_mfma_f32_16x16x32_bf16 v[148:151], v[172:175], a[0:3], v[148:151]
    ds_read_b128 v[168:171], v21 offset:10240
    ds_read_b128 a[60:63], v5 offset:6144
    v_mfma_f32_16x16x32_bf16 v[156:159], v[172:175], a[4:7], v[156:159]
    s_waitcnt vmcnt(12)
    v_cmp_eq_u32 vcc, -1, v45
    s_nop 1
    s_cbranch_vccnz Lslow_32
Lback_33:
    s_waitcnt lgkmcnt(7)
    v_mfma_f32_16x16x32_bf16 v[128:131], v[176:179], a[8:11], v[128:131]
    ds_read_b128 v[172:175], v21 offset:11264
    v_mfma_f32_16x16x32_bf16 v[136:139], v[176:179], a[12:15], v[136:139]
    buffer_load_dword v42, v24, s[48:51], s70 offen offset:0 sc1
    v_mfma_f32_16x16x32_bf16 v[132:135], v[180:183], a[8:11], v[132:135]
    ds_read_b128 v[176:179], v21 offset:49152
    v_mfma_f32_16x16x32_bf16 v[140:143], v[180:183], a[12:15], v[140:143]
    buffer_load_dword v40, v24, s[48:51], s70 offen offset:64 sc1
    v_mfma_f32_16x16x32_bf16 v[144:147], v[184:187], a[8:11], v[144:147]
    ds_read_b128 v[180:183], v21 offset:50176
    v_mfma_f32_16x16x32_bf16 v[152:155], v[184:187], a[12:15], v[152:155]
    buffer_load_dwordx4 v[112:115], v29, s[48:51], s60 offen offset:0 sc1
    v_mfma_f32_16x16x32_bf16 v[148:151], v[188:191], a[8:11], v[148:151]
    ds_read_b128 v[184:187], v21 offset:51200
    v_mfma_f32_16x16x32_bf16 v[156:159], v[188:191], a[12:15], v[156:159]
    buffer_load_dwordx4 v29, s[48:51], s6 offen offset:0 sc1 lds
    s_waitcnt lgkmcnt(3)
    v_mfma_f32_16x16x32_bf16 v[128:131], v[160:163], a[16:19], v[128:131]
    ds_read_b128 v[188:191], v21 offset:52224
    v_mfma_f32_16x16x32_bf16 v[136:139], v[160:163], a[20:23], v[136:139]
    buffer_load_dwordx4 v29, s[48:51], s6 offen offset:1024 sc1 lds
    v_mfma_f32_16x16x32_bf16 v[132:135], v[164:167], a[16:19], v[132:135]
    s_waitcnt vmcnt(13)
    ds_read_b128 a[64:67], v4 offset:8192
    v_mfma_f32_16x16x32_bf16 v[140:143], v[164:167], a[20:23], v[140:143]
    buffer_load_dwordx4 v29, s[48:51], s6 offen offset:2048 sc1 lds
    v_mfma_f32_16x16x32_bf16 v[144:147], v[168:171], a[16:19], v[144:147]
    v_mfma_f32_16x16x32_bf16 v[152:155], v[168:171], a[20:23], v[152:155]
    buffer_load_dwordx4 v29, s[48:51], s6 offen offset:3072 sc1 lds
    s_add_u32 m0, s61, 16384
    s_add_u32 s6, s91, s78
    s_waitcnt lgkmcnt(0)
    s_barrier
    v_mfma_f32_16x16x32_bf16 v[148:151], v[172:175], a[16:19], v[148:151]
    ds_read_b128 v[160:163], v20 offset:12288
    ds_read_b128 v[164:167], v20 offset:13312
    v_mfma_f32_16x16x32_bf16 v[156:159], v[172:175], a[20:23], v[156:159]
    v_mfma_f32_16x16x32_bf16 v[128:131], v[176:179], a[24:27], v[128:131]
    ds_read_b128 v[168:171], v20 offset:14336
    ds_read_b128 v[172:175], v20 offset:15360
    v_mfma_f32_16x16x32_bf16 v[136:139], v[176:179], a[28:31], v[136:139]
    buffer_load_dwordx4 v[116:119], v29, s[48:51], s60 offen offset:1024 sc1
    v_mfma_f32_16x16x32_bf16 v[132:135], v[180:183], a[24:27], v[132:135]
    ds_read_b128 v[176:179], v20 offset:53248
    ds_read_b128 a[68:71], v4 offset:10240
    v_mfma_f32_16x16x32_bf16 v[140:143], v[180:183], a[28:31], v[140:143]
    v_mfma_f32_16x16x32_bf16 v[144:147], v[184:187], a[24:27], v[144:147]
    ds_read_b128 v[180:183], v20 offset:54272
    ds_read_b128 a[72:75], v5 offset:8192
    v_mfma_f32_16x16x32_bf16 v[152:155], v[184:187], a[28:31], v[152:155]
    buffer_load_dwordx4 v[120:123], v29, s[48:51], s67 offen offset:2048 sc1
    v_mfma_f32_16x16x32_bf16 v[148:151], v[188:191], a[24:27], v[148:151]
    ds_read_b128 v[184:187], v20 offset:55296
    ds_read_b128 a[76:79], v5 offset:10240
    v_mfma_f32_16x16x32_bf16 v[156:159], v[188:191], a[28:31], v[156:159]
    s_waitcnt lgkmcnt(6)
    v_mfma_f32_16x16x32_bf16 v[128:131], v[160:163], a[32:35], v[128:131]
    ds_read_b128 v[188:191], v20 offset:56320
    v_mfma_f32_16x16x32_bf16 v[136:139], v[160:163], a[36:39], v[136:139]
    buffer_load_dwordx4 v[124:127], v29, s[48:51], s67 offen offset:3072 sc1
    v_cmp_eq_u32 vcc, -1, v19
    s_nop 1
    s_cbranch_vccnz Lslow_34
Lback_35:
    v_mfma_f32_16x16x32_bf16 v[132:135], v[164:167], a[32:35], v[132:135]
    ds_read_b128 v[160:163], v21 offset:12288
    v_mfma_f32_16x16x32_bf16 v[140:143], v[164:167], a[36:39], v[140:143]
    v_mfma_f32_16x16x32_bf16 v[144:147], v[168:171], a[32:35], v[144:147]
    ds_read_b128 v[164:167], v21 offset:13312
    v_mfma_f32_16x16x32_bf16 v[152:155], v[168:171], a[36:39], v[152:155]
    v_mfma_f32_16x16x32_bf16 v[148:151], v[172:175], a[32:35], v[148:151]
    ds_read_b128 v[168:171], v21 offset:14336
    v_mfma_f32_16x16x32_bf16 v[156:159], v[172:175], a[36:39], v[156:159]
    s_waitcnt lgkmcnt(3)
    v_mfma_f32_16x16x32_bf16 v[128:131], v[176:179], a[40:43], v[128:131]
    ds_read_b128 v[172:175], v21 offset:15360
    v_mfma_f32_16x16x32_bf16 v[136:139], v[176:179], a[44:47], v[136:139]
    v_mfma_f32_16x16x32_bf16 v[132:135], v[180:183], a[40:43], v[132:135]
    ds_read_b128 v[176:179], v21 offset:53248
    v_mfma_f32_16x16x32_bf16 v[140:143], v[180:183], a[44:47], v[140:143]
    v_mfma_f32_16x16x32_bf16 v[144:147], v[184:187], a[40:43], v[144:147]
    ds_read_b128 v[180:183], v21 offset:54272
    v_mfma_f32_16x16x32_bf16 v[152:155], v[184:187], a[44:47], v[152:155]
    buffer_load_dwordx4 v29, s[48:51], s6 offen offset:0 sc1 lds
    v_mfma_f32_16x16x32_bf16 v[148:151], v[188:191], a[40:43], v[148:151]
    ds_read_b128 v[184:187], v21 offset:55296
    v_mfma_f32_16x16x32_bf16 v[156:159], v[188:191], a[44:47], v[156:159]
    buffer_load_dwordx4 v29, s[48:51], s6 offen offset:1024 sc1 lds
    s_waitcnt lgkmcnt(3)
    v_mfma_f32_16x16x32_bf16 v[128:131], v[160:163], a[48:51], v[128:131]
    ds_read_b128 v[188:191], v21 offset:56320
    v_mfma_f32_16x16x32_bf16 v[136:139], v[160:163], a[52:55], v[136:139]
    buffer_load_dwordx4 v29, s[48:51], s6 offen offset:2048 sc1 lds
    v_mfma_f32_16x16x32_bf16 v[132:135], v[164:167], a[48:51], v[132:135]
    s_waitcnt vmcnt(13)
    ds_read_b128 a[80:83], v4 offset:12288
    v_mfma_f32_16x16x32_bf16 v[140:143], v[164:167], a[52:55], v[140:143]
    buffer_load_dwordx4 v29, s[48:51], s6 offen offset:3072 sc1 lds
    s_add_u32 m0, s61, 20480
    s_add_u32 s6, s92, s78
    v_mfma_f32_16x16x32_bf16 v[144:147], v[168:171], a[48:51], v[144:147]
    v_mfma_f32_16x16x32_bf16 v[152:155], v[168:171], a[52:55], v[152:155]
    s_waitcnt lgkmcnt(0)
    s_barrier
    v_mfma_f32_16x16x32_bf16 v[148:151], v[172:175], a[48:51], v[148:151]
    ds_read_b128 v[160:163], v20 offset:16384
    ds_read_b128 v[164:167], v20 offset:17408
    v_mfma_f32_16x16x32_bf16 v[156:159], v[172:175], a[52:55], v[156:159]
    v_mfma_f32_16x16x32_bf16 v[128:131], v[176:179], a[56:59], v[128:131]
    ds_read_b128 v[168:171], v20 offset:18432
    ds_read_b128 v[172:175], v20 offset:19456
    v_mfma_f32_16x16x32_bf16 v[136:139], v[176:179], a[60:63], v[136:139]
    v_mfma_f32_16x16x32_bf16 v[132:135], v[180:183], a[56:59], v[132:135]
    ds_read_b128 v[176:179], v20 offset:57344
    ds_read_b128 a[84:87], v4 offset:14336
    v_mfma_f32_16x16x32_bf16 v[140:143], v[180:183], a[60:63], v[140:143]
    v_mfma_f32_16x16x32_bf16 v[144:147], v[184:187], a[56:59], v[144:147]
    ds_read_b128 v[180:183], v20 offset:58368
    ds_read_b128 a[88:91], v5 offset:12288
    v_mfma_f32_16x16x32_bf16 v[152:155], v[184:187], a[60:63], v[152:155]
    v_mfma_f32_16x16x32_bf16 v[148:151], v[188:191], a[56:59], v[148:151]
    ds_read_b128 v[184:187], v20 offset:59392
    ds_read_b128 a[92:95], v5 offset:14336
    v_mfma_f32_16x16x32_bf16 v[156:159], v[188:191], a[60:63], v[156:159]
    buffer_load_dwordx4 v29, s[48:51], s6 offen offset:0 sc1 lds
    v_lshrrev_b32 v4, 5, v0
    s_waitcnt lgkmcnt(6)
    v_mfma_f32_16x16x32_bf16 v[128:131], v[160:163], a[64:67], v[128:131]
    ds_read_b128 v[188:191], v20 offset:60416
    v_add3_u32 v4, v4, s56, 1
    v_mfma_f32_16x16x32_bf16 v[136:139], v[160:163], a[68:71], v[136:139]
    v_and_b32 v5, 1, v4
    v_bfe_u32 v4, v4, 1, 1
    v_and_b32 v1, 0xf0, v29
    v_lshl_add_u32 v1, v5, 8, v1
    v_mfma_f32_16x16x32_bf16 v[132:135], v[164:167], a[64:67], v[132:135]
    ds_read_b128 v[160:163], v21 offset:16384
    v_bfe_u32 v5, v0, 4, 1
    v_mfma_f32_16x16x32_bf16 v[140:143], v[164:167], a[68:71], v[140:143]
    buffer_load_dwordx4 v29, s[48:51], s6 offen offset:1024 sc1 lds
    v_lshl_add_u32 v1, v5, 9, v1
    v_lshl_add_u32 v4, v4, 12, v1
    v_mfma_f32_16x16x32_bf16 v[144:147], v[168:171], a[64:67], v[144:147]
    ds_read_b128 v[164:167], v21 offset:17408
    v_xor_b32 v5, 0x1000, v4
    v_mfma_f32_16x16x32_bf16 v[152:155], v[168:171], a[68:71], v[152:155]
    s_lshl3_add_u32 s3, s4, s56
    s_lshl_b32 s3, s3, 10
    s_add_u32 s3, s3, 1048576
    v_mfma_f32_16x16x32_bf16 v[148:151], v[172:175], a[64:67], v[148:151]
    ds_read_b128 v[168:171], v21 offset:18432
    v_mfma_f32_16x16x32_bf16 v[156:159], v[172:175], a[68:71], v[156:159]
    buffer_load_dwordx4 v29, s[48:51], s6 offen offset:2048 sc1 lds
    s_waitcnt lgkmcnt(3)
    v_mfma_f32_16x16x32_bf16 v[128:131], v[176:179], a[72:75], v[128:131]
    ds_read_b128 v[172:175], v21 offset:19456
    v_mfma_f32_16x16x32_bf16 v[136:139], v[176:179], a[76:79], v[136:139]
    v_mfma_f32_16x16x32_bf16 v[132:135], v[180:183], a[72:75], v[132:135]
    ds_read_b128 v[176:179], v21 offset:57344
    v_mfma_f32_16x16x32_bf16 v[140:143], v[180:183], a[76:79], v[140:143]
    buffer_load_dwordx4 v29, s[48:51], s6 offen offset:3072 sc1 lds
    v_mfma_f32_16x16x32_bf16 v[144:147], v[184:187], a[72:75], v[144:147]
    ds_read_b128 v[180:183], v21 offset:58368
    s_add_u32 m0, s61, 24576
    s_add_u32 s6, s93, s78
    v_mfma_f32_16x16x32_bf16 v[152:155], v[184:187], a[76:79], v[152:155]
    v_mfma_f32_16x16x32_bf16 v[148:151], v[188:191], a[72:75], v[148:151]
    ds_read_b128 v[184:187], v21 offset:59392
    v_mfma_f32_16x16x32_bf16 v[156:159], v[188:191], a[76:79], v[156:159]
    buffer_load_dwordx4 v29, s[48:51], s6 offen offset:0 sc1 lds
    s_waitcnt lgkmcnt(3)
    v_mfma_f32_16x16x32_bf16 v[128:131], v[160:163], a[80:83], v[128:131]
    ds_read_b128 v[188:191], v21 offset:60416
    v_mfma_f32_16x16x32_bf16 v[136:139], v[160:163], a[84:87], v[136:139]
    v_mfma_f32_16x16x32_bf16 v[132:135], v[164:167], a[80:83], v[132:135]
    v_mfma_f32_16x16x32_bf16 v[140:143], v[164:167], a[84:87], v[140:143]
    buffer_load_dwordx4 v29, s[48:51], s6 offen offset:1024 sc1 lds
    v_mfma_f32_16x16x32_bf16 v[144:147], v[168:171], a[80:83], v[144:147]
    v_mfma_f32_16x16x32_bf16 v[152:155], v[168:171], a[84:87], v[152:155]
    s_waitcnt vmcnt(13) lgkmcnt(0)
    s_barrier
    v_mfma_f32_16x16x32_bf16 v[148:151], v[172:175], a[80:83], v[148:151]
    ds_read_b128 v[160:163], v20 offset:20480
    ds_read_b128 v[164:167], v20 offset:21504
    v_mfma_f32_16x16x32_bf16 v[156:159], v[172:175], a[84:87], v[156:159]
    buffer_load_dwordx4 v29, s[48:51], s6 offen offset:2048 sc1 lds
    v_mfma_f32_16x16x32_bf16 v[128:131], v[176:179], a[88:91], v[128:131]
    ds_read_b128 v[168:171], v20 offset:22528
    ds_read_b128 v[172:175], v20 offset:23552
    v_mfma_f32_16x16x32_bf16 v[136:139], v[176:179], a[92:95], v[136:139]
    v_mfma_f32_16x16x32_bf16 v[132:135], v[180:183], a[88:91], v[132:135]
    ds_read_b128 v[176:179], v20 offset:61440
    v_mfma_f32_16x16x32_bf16 v[140:143], v[180:183], a[92:95], v[140:143]
    buffer_load_dwordx4 v29, s[48:51], s6 offen offset:3072 sc1 lds
    v_mfma_f32_16x16x32_bf16 v[144:147], v[184:187], a[88:91], v[144:147]
    ds_read_b128 v[180:183], v20 offset:62464
    s_add_u32 m0, s61, 28672
    s_add_u32 s6, s94, s78
    v_mfma_f32_16x16x32_bf16 v[152:155], v[184:187], a[92:95], v[152:155]
    v_mfma_f32_16x16x32_bf16 v[148:151], v[188:191], a[88:91], v[148:151]
    ds_read_b128 v[184:187], v20 offset:63488
    v_mfma_f32_16x16x32_bf16 v[156:159], v[188:191], a[92:95], v[156:159]
    buffer_load_dwordx4 v29, s[48:51], s6 offen offset:0 sc1 lds
    s_waitcnt lgkmcnt(3)
    v_mfma_f32_16x16x32_bf16 v[48:51], v[160:163], a[160:163], v[8:11]
    ds_read_b128 v[188:191], v20 offset:64512
    v_mfma_f32_16x16x32_bf16 v[56:59], v[160:163], a[164:167], v[12:15]
    v_mfma_f32_16x16x32_bf16 v[52:55], v[164:167], a[160:163], v[8:11]
    ds_read_b128 v[160:163], v21 offset:20480
    v_mfma_f32_16x16x32_bf16 v[60:63], v[164:167], a[164:167], v[12:15]
    buffer_load_dwordx4 v29, s[48:51], s6 offen offset:1024 sc1 lds
    v_mfma_f32_16x16x32_bf16 v[64:67], v[168:171], a[160:163], v[8:11]
    ds_read_b128 v[164:167], v21 offset:21504
    v_mfma_f32_16x16x32_bf16 v[72:75], v[168:171], a[164:167], v[12:15]
    v_mfma_f32_16x16x32_bf16 v[68:71], v[172:175], a[160:163], v[8:11]
    ds_read_b128 v[168:171], v21 offset:22528
    v_cvt_pk_bf16_f32 v128, v128, v129
    v_mfma_f32_16x16x32_bf16 v[76:79], v[172:175], a[164:167], v[12:15]
    buffer_load_dwordx4 v29, s[48:51], s6 offen offset:2048 sc1 lds
    v_cvt_pk_bf16_f32 v129, v130, v131
    s_waitcnt lgkmcnt(3)
    v_mfma_f32_16x16x32_bf16 v[48:51], v[176:179], a[168:171], v[48:51]
    ds_read_b128 v[172:175], v21 offset:23552
    v_cvt_pk_bf16_f32 v130, v132, v133
    v_mfma_f32_16x16x32_bf16 v[56:59], v[176:179], a[172:175], v[56:59]
    v_cvt_pk_bf16_f32 v131, v134, v135
    v_mfma_f32_16x16x32_bf16 v[52:55], v[180:183], a[168:171], v[52:55]
    ds_read_b128 v[176:179], v21 offset:61440
    v_mfma_f32_16x16x32_bf16 v[60:63], v[180:183], a[172:175], v[60:63]
    buffer_store_dwordx4 v[128:131], v29, s[48:51], s79 offen offset:0 sc1
    v_mfma_f32_16x16x32_bf16 v[64:67], v[184:187], a[168:171], v[64:67]
    ds_read_b128 v[180:183], v21 offset:62464
    v_mfma_f32_16x16x32_bf16 v[72:75], v[184:187], a[172:175], v[72:75]
    v_mfma_f32_16x16x32_bf16 v[68:71], v[188:191], a[168:171], v[68:71]
    ds_read_b128 v[184:187], v21 offset:63488
    v_mfma_f32_16x16x32_bf16 v[76:79], v[188:191], a[172:175], v[76:79]
    s_waitcnt lgkmcnt(3)
    v_mfma_f32_16x16x32_bf16 v[48:51], v[160:163], a[176:179], v[48:51]
    ds_read_b128 v[188:191], v21 offset:64512
    v_cvt_pk_bf16_f32 v132, v136, v137
    v_mfma_f32_16x16x32_bf16 v[56:59], v[160:163], a[180:183], v[56:59]
    buffer_load_dwordx4 v29, s[48:51], s6 offen offset:3072 sc1 lds
    v_cvt_pk_bf16_f32 v133, v138, v139
    v_cvt_pk_bf16_f32 v134, v140, v141
    v_mfma_f32_16x16x32_bf16 v[52:55], v[164:167], a[176:179], v[52:55]
    v_cvt_pk_bf16_f32 v135, v142, v143
    v_mfma_f32_16x16x32_bf16 v[60:63], v[164:167], a[180:183], v[60:63]
    s_add_u32 m0, s61, 32768
    s_add_u32 s6, s95, s78
    v_mfma_f32_16x16x32_bf16 v[64:67], v[168:171], a[176:179], v[64:67]
    v_mfma_f32_16x16x32_bf16 v[72:75], v[168:171], a[180:183], v[72:75]
    buffer_store_dwordx4 v[132:135], v29, s[48:51], s79 offen offset:1024 sc1
    s_waitcnt vmcnt(14) lgkmcnt(0)
    s_barrier
    v_mfma_f32_16x16x32_bf16 v[68:71], v[172:175], a[176:179], v[68:71]
    ds_read_b128 v[160:163], v20 offset:0
    ds_read_b128 v[164:167], v20 offset:1024
    v_mfma_f32_16x16x32_bf16 v[76:79], v[172:175], a[180:183], v[76:79]
    v_mfma_f32_16x16x32_bf16 v[48:51], v[176:179], a[184:187], v[48:51]
    ds_read_b128 v[168:171], v20 offset:2048
    ds_read_b128 v[172:175], v20 offset:3072
    v_mfma_f32_16x16x32_bf16 v[56:59], v[176:179], a[188:191], v[56:59]
    v_mfma_f32_16x16x32_bf16 v[52:55], v[180:183], a[184:187], v[52:55]
    ds_read_b128 v[176:179], v20 offset:40960
    v_cvt_pk_bf16_f32 v136, v144, v145
    v_mfma_f32_16x16x32_bf16 v[60:63], v[180:183], a[188:191], v[60:63]
    buffer_load_dwordx4 v29, s[48:51], s6 offen offset:0 sc1 lds
    v_cvt_pk_bf16_f32 v137, v146, v147
    v_cvt_pk_bf16_f32 v138, v148, v149
    v_mfma_f32_16x16x32_bf16 v[64:67], v[184:187], a[184:187], v[64:67]
    ds_read_b128 v[180:183], v20 offset:41984
    v_cvt_pk_bf16_f32 v139, v150, v151
    v_mfma_f32_16x16x32_bf16 v[72:75], v[184:187], a[188:191], v[72:75]
    v_mfma_f32_16x16x32_bf16 v[68:71], v[188:191], a[184:187], v[68:71]
    ds_read_b128 v[184:187], v20 offset:43008
    v_mfma_f32_16x16x32_bf16 v[76:79], v[188:191], a[188:191], v[76:79]
    buffer_store_dwordx4 v[136:139], v29, s[48:51], s79 offen offset:2048 sc1
    s_waitcnt lgkmcnt(3)
    v_mfma_f32_16x16x32_bf16 v[48:51], v[160:163], a[192:195], v[48:51]
    ds_read_b128 v[188:191], v20 offset:44032
    v_mfma_f32_16x16x32_bf16 v[56:59], v[160:163], a[196:199], v[56:59]
    v_sub_f32 v42, 1.0, v42
    v_sub_f32 v40, 1.0, v40
    v_max_f32 v42, 0x0da24260, v42
    v_mfma_f32_16x16x32_bf16 v[52:55], v[164:167], a[192:195], v[52:55]
    ds_read_b128 v[160:163], v21 offset:0
    v_max_f32 v40, 0x0da24260, v40
    v_mfma_f32_16x16x32_bf16 v[60:63], v[164:167], a[196:199], v[60:63]
    v_rcp_f32 v42, v42
    v_rcp_f32 v40, v40
    v_mfma_f32_16x16x32_bf16 v[64:67], v[168:171], a[192:195], v[64:67]
    ds_read_b128 v[164:167], v21 offset:1024
    v_cvt_pk_bf16_f32 v140, v152, v153
    v_mfma_f32_16x16x32_bf16 v[72:75], v[168:171], a[196:199], v[72:75]
    buffer_load_dwordx4 v29, s[48:51], s6 offen offset:1024 sc1 lds
    v_cvt_pk_bf16_f32 v141, v154, v155
    v_cvt_pk_bf16_f32 v142, v156, v157
    v_mfma_f32_16x16x32_bf16 v[68:71], v[172:175], a[192:195], v[68:71]
    ds_read_b128 v[168:171], v21 offset:2048
    v_cvt_pk_bf16_f32 v143, v158, v159
    v_mfma_f32_16x16x32_bf16 v[76:79], v[172:175], a[196:199], v[76:79]
    v_mov_b32 v41, 0xbdd2d3e8
    v_lshlrev_b32 v80, 16, v112
    v_and_b32 v81, 0xffff0000, v112
    s_waitcnt lgkmcnt(3)
    v_mfma_f32_16x16x32_bf16 v[48:51], v[176:179], a[200:203], v[48:51]
    ds_read_b128 v[172:175], v21 offset:3072
    v_lshlrev_b32 v82, 16, v113
    v_mfma_f32_16x16x32_bf16 v[56:59], v[176:179], a[204:207], v[56:59]
    buffer_store_dwordx4 v[140:143], v29, s[48:51], s79 offen offset:3072 sc1
    v_and_b32 v83, 0xffff0000, v113
    v_mul_f32 v36, v80, v80
    v_mfma_f32_16x16x32_bf16 v[52:55], v[180:183], a[200:203], v[52:55]
    ds_read_b128 v[176:179], v21 offset:40960
    v_mul_f32 v37, v81, v81
    v_mfma_f32_16x16x32_bf16 v[60:63], v[180:183], a[204:207], v[60:63]
    v_mul_f32 v38, v82, v82
    v_mul_f32 v39, v83, v83
    v_fmaak_f32 v36, v41, v36, 0xc0135761
    v_fmaak_f32 v37, v41, v37, 0xc0135761
    v_mfma_f32_16x16x32_bf16 v[64:67], v[184:187], a[200:203], v[64:67]
    ds_read_b128 v[180:183], v21 offset:41984
    v_fmaak_f32 v38, v41, v38, 0xc0135761
    v_mfma_f32_16x16x32_bf16 v[72:75], v[184:187], a[204:207], v[72:75]
    v_fmaak_f32 v39, v41, v39, 0xc0135761
    v_mul_f32 v36, v36, v80
    v_mul_f32 v37, v37, v81
    v_mul_f32 v38, v38, v82
    v_mfma_f32_16x16x32_bf16 v[68:71], v[188:191], a[200:203], v[68:71]
    ds_read_b128 v[184:187], v21 offset:43008
    v_mul_f32 v39, v39, v83
    v_mfma_f32_16x16x32_bf16 v[76:79], v[188:191], a[204:207], v[76:79]
    buffer_load_dwordx4 v29, s[48:51], s6 offen offset:2048 sc1 lds
    s_waitcnt lgkmcnt(3)
    v_mfma_f32_16x16x32_bf16 v[48:51], v[160:163], a[208:211], v[48:51]
    ds_read_b128 v[188:191], v21 offset:44032
    v_mfma_f32_16x16x32_bf16 v[56:59], v[160:163], a[212:215], v[56:59]
    v_exp_f32 v36, v36
    v_exp_f32 v37, v37
    v_mfma_f32_16x16x32_bf16 v[52:55], v[164:167], a[208:211], v[52:55]
    v_exp_f32 v38, v38
    v_mfma_f32_16x16x32_bf16 v[60:63], v[164:167], a[212:215], v[60:63]
    buffer_load_dwordx4 v29, s[48:51], s6 offen offset:3072 sc1 lds
    v_exp_f32 v39, v39
    v_mfma_f32_16x16x32_bf16 v[64:67], v[168:171], a[208:211], v[64:67]
    s_add_u32 m0, s61, 36864
    s_add_u32 s6, s96, s78
    v_mfma_f32_16x16x32_bf16 v[72:75], v[168:171], a[212:215], v[72:75]
    v_fma_f32 v36, v36, v42, v42
    v_fma_f32 v37, v37, v42, v42
    s_waitcnt vmcnt(16) lgkmcnt(0)
    s_barrier
    v_mfma_f32_16x16x32_bf16 v[68:71], v[172:175], a[208:211], v[68:71]
    ds_read_b128 v[160:163], v20 offset:4096
    ds_read_b128 v[164:167], v20 offset:5120
    v_mfma_f32_16x16x32_bf16 v[76:79], v[172:175], a[212:215], v[76:79]
    buffer_load_dwordx4 v29, s[48:51], s6 offen offset:0 sc1 lds
    v_fma_f32 v38, v38, v42, v42
    v_fma_f32 v39, v39, v42, v42
    v_mfma_f32_16x16x32_bf16 v[48:51], v[176:179], a[216:219], v[48:51]
    ds_read_b128 v[168:171], v20 offset:6144
    ds_read_b128 v[172:175], v20 offset:7168
    v_mfma_f32_16x16x32_bf16 v[56:59], v[176:179], a[220:223], v[56:59]
    v_rcp_f32 v36, v36
    v_rcp_f32 v37, v37
    v_mfma_f32_16x16x32_bf16 v[52:55], v[180:183], a[216:219], v[52:55]
    ds_read_b128 v[176:179], v20 offset:45056
    v_mfma_f32_16x16x32_bf16 v[60:63], v[180:183], a[220:223], v[60:63]
    buffer_load_dwordx4 v29, s[48:51], s6 offen offset:1024 sc1 lds
    v_rcp_f32 v38, v38
    v_mfma_f32_16x16x32_bf16 v[64:67], v[184:187], a[216:219], v[64:67]
    ds_read_b128 v[180:183], v20 offset:46080
    v_mfma_f32_16x16x32_bf16 v[72:75], v[184:187], a[220:223], v[72:75]
    v_rcp_f32 v39, v39
    v_mul_f32 v80, v80, v36
    v_mul_f32 v81, v81, v37
    v_mfma_f32_16x16x32_bf16 v[68:71], v[188:191], a[216:219], v[68:71]
    ds_read_b128 v[184:187], v20 offset:47104
    v_mul_f32 v82, v82, v38
    v_mfma_f32_16x16x32_bf16 v[76:79], v[188:191], a[220:223], v[76:79]
    buffer_load_dwordx4 v29, s[48:51], s6 offen offset:2048 sc1 lds
    v_mul_f32 v83, v83, v39
    s_waitcnt lgkmcnt(3)
    v_mfma_f32_16x16x32_bf16 v[48:51], v[160:163], a[224:227], v[48:51]
    ds_read_b128 v[188:191], v20 offset:48128
    v_lshlrev_b32 v84, 16, v114
    v_mfma_f32_16x16x32_bf16 v[56:59], v[160:163], a[228:231], v[56:59]
    v_and_b32 v85, 0xffff0000, v114
    v_lshlrev_b32 v86, 16, v115
    v_and_b32 v87, 0xffff0000, v115
    v_mul_f32 v36, v84, v84
    v_mfma_f32_16x16x32_bf16 v[52:55], v[164:167], a[224:227], v[52:55]
    ds_read_b128 v[160:163], v21 offset:4096
    v_mul_f32 v37, v85, v85
    v_mfma_f32_16x16x32_bf16 v[60:63], v[164:167], a[228:231], v[60:63]
    buffer_load_dwordx4 v29, s[48:51], s6 offen offset:3072 sc1 lds
    v_mul_f32 v38, v86, v86
    v_mul_f32 v39, v87, v87
    v_mfma_f32_16x16x32_bf16 v[64:67], v[168:171], a[224:227], v[64:67]
    ds_read_b128 v[164:167], v21 offset:5120
    s_add_u32 m0, s61, 16384
    s_add_u32 s6, s97, s78
    v_mfma_f32_16x16x32_bf16 v[72:75], v[168:171], a[228:231], v[72:75]
    v_fmaak_f32 v36, v41, v36, 0xc0135761
    v_fmaak_f32 v37, v41, v37, 0xc0135761
    v_fmaak_f32 v38, v41, v38, 0xc0135761
    v_fmaak_f32 v39, v41, v39, 0xc0135761
    v_mfma_f32_16x16x32_bf16 v[68:71], v[172:175], a[224:227], v[68:71]
    ds_read_b128 v[168:171], v21 offset:6144
    v_mul_f32 v36, v36, v84
    v_mfma_f32_16x16x32_bf16 v[76:79], v[172:175], a[228:231], v[76:79]
    buffer_load_dwordx4 v29, s[48:51], s6 offen offset:0 sc1 lds
    v_mul_f32 v37, v37, v85
    s_waitcnt lgkmcnt(3)
    v_mfma_f32_16x16x32_bf16 v[48:51], v[176:179], a[232:235], v[48:51]
    ds_read_b128 v[172:175], v21 offset:7168
    v_mul_f32 v38, v38, v86
    v_mfma_f32_16x16x32_bf16 v[56:59], v[176:179], a[236:239], v[56:59]
    v_mul_f32 v39, v39, v87
    v_exp_f32 v36, v36
    v_mfma_f32_16x16x32_bf16 v[52:55], v[180:183], a[232:235], v[52:55]
    ds_read_b128 v[176:179], v21 offset:45056
    v_mfma_f32_16x16x32_bf16 v[60:63], v[180:183], a[236:239], v[60:63]
    buffer_load_dwordx4 v29, s[48:51], s6 offen offset:1024 sc1 lds
    v_exp_f32 v37, v37
    v_mfma_f32_16x16x32_bf16 v[64:67], v[184:187], a[232:235], v[64:67]
    ds_read_b128 v[180:183], v21 offset:46080
    v_mfma_f32_16x16x32_bf16 v[72:75], v[184:187], a[236:239], v[72:75]
    v_exp_f32 v38, v38
    v_exp_f32 v39, v39
    v_mfma_f32_16x16x32_bf16 v[68:71], v[188:191], a[232:235], v[68:71]
    ds_read_b128 v[184:187], v21 offset:47104
    v_fma_f32 v36, v36, v42, v42
    v_mfma_f32_16x16x32_bf16 v[76:79], v[188:191], a[236:239], v[76:79]
    buffer_load_dwordx4 v29, s[48:51], s6 offen offset:2048 sc1 lds
    v_fma_f32 v37, v37, v42, v42
    s_waitcnt lgkmcnt(3)
    v_mfma_f32_16x16x32_bf16 v[48:51], v[160:163], a[240:243], v[48:51]
    ds_read_b128 v[188:191], v21 offset:48128
    v_fma_f32 v38, v38, v42, v42
    v_mfma_f32_16x16x32_bf16 v[56:59], v[160:163], a[244:247], v[56:59]
    v_fma_f32 v39, v39, v42, v42
    v_rcp_f32 v36, v36
    v_mfma_f32_16x16x32_bf16 v[52:55], v[164:167], a[240:243], v[52:55]
    v_rcp_f32 v37, v37
    v_mfma_f32_16x16x32_bf16 v[60:63], v[164:167], a[244:247], v[60:63]
    buffer_load_dwordx4 v29, s[48:51], s6 offen offset:3072 sc1 lds
    v_rcp_f32 v38, v38
    v_mfma_f32_16x16x32_bf16 v[64:67], v[168:171], a[240:243], v[64:67]
    v_rcp_f32 v39, v39
    v_mfma_f32_16x16x32_bf16 v[72:75], v[168:171], a[244:247], v[72:75]
    v_mul_f32 v84, v84, v36
    v_mul_f32 v85, v85, v37
    s_waitcnt vmcnt(20) lgkmcnt(0)
    s_barrier
    v_mfma_f32_16x16x32_bf16 v[68:71], v[172:175], a[240:243], v[68:71]
    ds_read_b128 v[160:163], v20 offset:8192
    ds_read_b128 v[164:167], v20 offset:9216
    v_mfma_f32_16x16x32_bf16 v[76:79], v[172:175], a[244:247], v[76:79]
    buffer_load_dwordx4 a[96:99], v29, s[48:51], s99 offen offset:0 sc1
    v_mul_f32 v86, v86, v38
    v_mul_f32 v87, v87, v39
    v_mfma_f32_16x16x32_bf16 v[48:51], v[176:179], a[248:251], v[48:51]
    ds_read_b128 v[168:171], v20 offset:10240
    ds_read_b128 v[172:175], v20 offset:11264
    v_mfma_f32_16x16x32_bf16 v[56:59], v[176:179], a[252:255], v[56:59]
    v_lshlrev_b32 v88, 16, v116
    v_and_b32 v89, 0xffff0000, v116
    v_lshlrev_b32 v90, 16, v117
    v_and_b32 v91, 0xffff0000, v117
    v_mfma_f32_16x16x32_bf16 v[52:55], v[180:183], a[248:251], v[52:55]
    ds_read_b128 v[176:179], v20 offset:49152
    v_mul_f32 v36, v88, v88
    v_mfma_f32_16x16x32_bf16 v[60:63], v[180:183], a[252:255], v[60:63]
    buffer_load_dwordx4 a[100:103], v29, s[48:51], s99 offen offset:1024 sc1
    v_mul_f32 v37, v89, v89
    v_mul_f32 v38, v90, v90
    v_mfma_f32_16x16x32_bf16 v[64:67], v[184:187], a[248:251], v[64:67]
    ds_read_b128 v[180:183], v20 offset:50176
    v_mul_f32 v39, v91, v91
    v_mfma_f32_16x16x32_bf16 v[72:75], v[184:187], a[252:255], v[72:75]
    v_fmaak_f32 v36, v41, v36, 0xc0135761
    v_fmaak_f32 v37, v41, v37, 0xc0135761
    v_fmaak_f32 v38, v41, v38, 0xc0135761
    v_fmaak_f32 v39, v41, v39, 0xc0135761
    v_mfma_f32_16x16x32_bf16 v[68:71], v[188:191], a[248:251], v[68:71]
    ds_read_b128 v[184:187], v20 offset:51200
    v_mul_f32 v36, v36, v88
    v_mfma_f32_16x16x32_bf16 v[76:79], v[188:191], a[252:255], v[76:79]
    buffer_load_dwordx4 a[104:107], v29, s[48:51], s99 offen offset:2048 sc1
    v_mul_f32 v37, v37, v89
    s_waitcnt lgkmcnt(3)
    v_mfma_f32_16x16x32_bf16 v[48:51], v[160:163], v[192:195], v[48:51]
    ds_read_b128 v[188:191], v20 offset:52224
    v_mul_f32 v38, v38, v90
    v_mfma_f32_16x16x32_bf16 v[56:59], v[160:163], v[196:199], v[56:59]
    s_waitcnt vmcnt(13)
    s_mov_b64 exec, 1
    buffer_store_dword v31, off, s[48:51], s80 sc1
    s_mov_b64 exec, -1
    v_mfma_f32_16x16x32_bf16 v[52:55], v[164:167], v[192:195], v[52:55]
    ds_read_b128 v[160:163], v21 offset:8192
    v_mul_f32 v39, v39, v91
    v_mfma_f32_16x16x32_bf16 v[60:63], v[164:167], v[196:199], v[60:63]
    buffer_load_dwordx4 a[108:111], v29, s[48:51], s99 offen offset:3072 sc1
    v_exp_f32 v36, v36
    v_mfma_f32_16x16x32_bf16 v[64:67], v[168:171], v[192:195], v[64:67]
    ds_read_b128 v[164:167], v21 offset:9216
    s_add_u32 s99, s99, 4096
    v_mfma_f32_16x16x32_bf16 v[72:75], v[168:171], v[196:199], v[72:75]
    v_exp_f32 v37, v37
    v_exp_f32 v38, v38
    v_mfma_f32_16x16x32_bf16 v[68:71], v[172:175], v[192:195], v[68:71]
    ds_read_b128 v[168:171], v21 offset:10240
    v_mfma_f32_16x16x32_bf16 v[76:79], v[172:175], v[196:199], v[76:79]
    buffer_load_dwordx4 a[112:115], v29, s[48:51], s99 offen offset:0 sc1
    s_waitcnt lgkmcnt(3)
    v_mfma_f32_16x16x32_bf16 v[48:51], v[176:179], v[200:203], v[48:51]
    ds_read_b128 v[172:175], v21 offset:11264
    v_mfma_f32_16x16x32_bf16 v[56:59], v[176:179], v[204:207], v[56:59]
    v_exp_f32 v39, v39
    v_fma_f32 v36, v36, v40, v40
    v_fma_f32 v37, v37, v40, v40
    v_mfma_f32_16x16x32_bf16 v[52:55], v[180:183], v[200:203], v[52:55]
    ds_read_b128 v[176:179], v21 offset:49152
    v_fma_f32 v38, v38, v40, v40
    v_mfma_f32_16x16x32_bf16 v[60:63], v[180:183], v[204:207], v[60:63]
    buffer_load_dword v19, v28, s[48:51], 0 offen sc1
    v_fma_f32 v39, v39, v40, v40
    v_mfma_f32_16x16x32_bf16 v[64:67], v[184:187], v[200:203], v[64:67]
    ds_read_b128 v[180:183], v21 offset:50176
    v_mfma_f32_16x16x32_bf16 v[72:75], v[184:187], v[204:207], v[72:75]
    buffer_load_dwordx4 a[116:119], v29, s[48:51], s99 offen offset:1024 sc1
    v_rcp_f32 v36, v36
    v_mfma_f32_16x16x32_bf16 v[68:71], v[188:191], v[200:203], v[68:71]
    ds_read_b128 v[184:187], v21 offset:51200
    v_mfma_f32_16x16x32_bf16 v[76:79], v[188:191], v[204:207], v[76:79]
    v_rcp_f32 v37, v37
    s_waitcnt lgkmcnt(3)
    v_mfma_f32_16x16x32_bf16 v[48:51], v[160:163], v[208:211], v[48:51]
    ds_read_b128 v[188:191], v21 offset:52224
    v_mfma_f32_16x16x32_bf16 v[56:59], v[160:163], v[212:215], v[56:59]
    buffer_load_dwordx4 a[120:123], v29, s[48:51], s99 offen offset:2048 sc1
    v_rcp_f32 v38, v38
    v_mfma_f32_16x16x32_bf16 v[52:55], v[164:167], v[208:211], v[52:55]
    v_rcp_f32 v39, v39
    v_mfma_f32_16x16x32_bf16 v[60:63], v[164:167], v[212:215], v[60:63]
    v_mul_f32 v88, v88, v36
    v_mul_f32 v89, v89, v37
    v_mul_f32 v90, v90, v38
    v_mul_f32 v91, v91, v39
    v_mfma_f32_16x16x32_bf16 v[64:67], v[168:171], v[208:211], v[64:67]
    v_lshlrev_b32 v92, 16, v118
    v_and_b32 v93, 0xffff0000, v118
    v_mfma_f32_16x16x32_bf16 v[72:75], v[168:171], v[212:215], v[72:75]
    buffer_load_dwordx4 a[124:127], v29, s[48:51], s99 offen offset:3072 sc1
    s_waitcnt lgkmcnt(0)
    s_barrier
    v_mfma_f32_16x16x32_bf16 v[68:71], v[172:175], v[208:211], v[68:71]
    ds_read_b128 v[160:163], v20 offset:12288
    ds_read_b128 v[164:167], v20 offset:13312
    v_mfma_f32_16x16x32_bf16 v[76:79], v[172:175], v[212:215], v[76:79]
    s_add_u32 s99, s99, 4096
    v_lshlrev_b32 v94, 16, v119
    v_and_b32 v95, 0xffff0000, v119
    v_mul_f32 v36, v92, v92
    v_mfma_f32_16x16x32_bf16 v[48:51], v[176:179], v[216:219], v[48:51]
    ds_read_b128 v[168:171], v20 offset:14336
    ds_read_b128 v[172:175], v20 offset:15360
    v_mfma_f32_16x16x32_bf16 v[56:59], v[176:179], v[220:223], v[56:59]
    buffer_load_dwordx4 a[128:131], v29, s[48:51], s99 offen offset:0 sc1
    v_mul_f32 v37, v93, v93
    v_mul_f32 v38, v94, v94
    v_mfma_f32_16x16x32_bf16 v[52:55], v[180:183], v[216:219], v[52:55]
    ds_read_b128 v[176:179], v20 offset:53248
    v_mul_f32 v39, v95, v95
    v_mfma_f32_16x16x32_bf16 v[60:63], v[180:183], v[220:223], v[60:63]
    v_fmaak_f32 v36, v41, v36, 0xc0135761
    v_fmaak_f32 v37, v41, v37, 0xc0135761
    v_fmaak_f32 v38, v41, v38, 0xc0135761
    v_fmaak_f32 v39, v41, v39, 0xc0135761
    v_mfma_f32_16x16x32_bf16 v[64:67], v[184:187], v[216:219], v[64:67]
    ds_read_b128 v[180:183], v20 offset:54272
    v_mul_f32 v36, v36, v92
    v_mfma_f32_16x16x32_bf16 v[72:75], v[184:187], v[220:223], v[72:75]
    buffer_load_dwordx4 a[132:135], v29, s[48:51], s99 offen offset:1024 sc1
    v_mul_f32 v37, v37, v93
    v_mul_f32 v38, v38, v94
    v_mfma_f32_16x16x32_bf16 v[68:71], v[188:191], v[216:219], v[68:71]
    ds_read_b128 v[184:187], v20 offset:55296
    v_mul_f32 v39, v39, v95
    v_mfma_f32_16x16x32_bf16 v[76:79], v[188:191], v[220:223], v[76:79]
    v_exp_f32 v36, v36
    s_waitcnt lgkmcnt(3)
    v_mfma_f32_16x16x32_bf16 v[48:51], v[160:163], v[224:227], v[48:51]
    ds_read_b128 v[188:191], v20 offset:56320
    v_mfma_f32_16x16x32_bf16 v[56:59], v[160:163], v[228:231], v[56:59]
    buffer_load_dwordx4 a[136:139], v29, s[48:51], s99 offen offset:2048 sc1
    v_exp_f32 v37, v37
    v_mfma_f32_16x16x32_bf16 v[52:55], v[164:167], v[224:227], v[52:55]
    ds_read_b128 v[160:163], v21 offset:12288
    v_mfma_f32_16x16x32_bf16 v[60:63], v[164:167], v[228:231], v[60:63]
    v_exp_f32 v38, v38
    v_exp_f32 v39, v39
    v_mfma_f32_16x16x32_bf16 v[64:67], v[168:171], v[224:227], v[64:67]
    ds_read_b128 v[164:167], v21 offset:13312
    v_fma_f32 v36, v36, v40, v40
    v_mfma_f32_16x16x32_bf16 v[72:75], v[168:171], v[228:231], v[72:75]
    buffer_load_dwordx4 a[140:143], v29, s[48:51], s99 offen offset:3072 sc1
    v_fma_f32 v37, v37, v40, v40
    v_fma_f32 v38, v38, v40, v40
    v_mfma_f32_16x16x32_bf16 v[68:71], v[172:175], v[224:227], v[68:71]
    ds_read_b128 v[168:171], v21 offset:14336
    s_add_u32 s99, s99, 4096
    v_mfma_f32_16x16x32_bf16 v[76:79], v[172:175], v[228:231], v[76:79]
    v_fma_f32 v39, v39, v40, v40
    v_rcp_f32 v36, v36
    s_waitcnt lgkmcnt(3)
    v_mfma_f32_16x16x32_bf16 v[48:51], v[176:179], v[232:235], v[48:51]
    ds_read_b128 v[172:175], v21 offset:15360
    v_mfma_f32_16x16x32_bf16 v[56:59], v[176:179], v[236:239], v[56:59]
    buffer_load_dwordx4 a[144:147], v29, s[48:51], s99 offen offset:0 sc1
    v_rcp_f32 v37, v37
    v_mfma_f32_16x16x32_bf16 v[52:55], v[180:183], v[232:235], v[52:55]
    ds_read_b128 v[176:179], v21 offset:53248
    v_mfma_f32_16x16x32_bf16 v[60:63], v[180:183], v[236:239], v[60:63]
    v_rcp_f32 v38, v38
    v_rcp_f32 v39, v39
    v_mfma_f32_16x16x32_bf16 v[64:67], v[184:187], v[232:235], v[64:67]
    ds_read_b128 v[180:183], v21 offset:54272
    v_mul_f32 v92, v92, v36
    v_mfma_f32_16x16x32_bf16 v[72:75], v[184:187], v[236:239], v[72:75]
    buffer_load_dwordx4 a[148:151], v29, s[48:51], s99 offen offset:1024 sc1
    v_mul_f32 v93, v93, v37
    v_mul_f32 v94, v94, v38
    v_mfma_f32_16x16x32_bf16 v[68:71], v[188:191], v[232:235], v[68:71]
    ds_read_b128 v[184:187], v21 offset:55296
    v_mul_f32 v95, v95, v39
    v_mfma_f32_16x16x32_bf16 v[76:79], v[188:191], v[236:239], v[76:79]
    v_lshlrev_b32 v96, 16, v120
    v_and_b32 v97, 0xffff0000, v120
    v_lshlrev_b32 v98, 16, v121
    s_waitcnt lgkmcnt(3)
    v_mfma_f32_16x16x32_bf16 v[48:51], v[160:163], v[240:243], v[48:51]
    ds_read_b128 v[188:191], v21 offset:56320
    v_and_b32 v99, 0xffff0000, v121
    v_mfma_f32_16x16x32_bf16 v[56:59], v[160:163], v[244:247], v[56:59]
    buffer_load_dwordx4 a[152:155], v29, s[48:51], s99 offen offset:2048 sc1
    v_mul_f32 v36, v96, v96
    v_mul_f32 v37, v97, v97
    v_mfma_f32_16x16x32_bf16 v[52:55], v[164:167], v[240:243], v[52:55]
    v_mul_f32 v38, v98, v98
    v_mul_f32 v39, v99, v99
    v_mfma_f32_16x16x32_bf16 v[60:63], v[164:167], v[244:247], v[60:63]
    s_waitcnt vmcnt(10)
    v_cmp_eq_u32 vcc, -1, v19
    s_nop 1
    s_cbranch_vccnz Lslow_36
Lback_37:
    v_mfma_f32_16x16x32_bf16 v[64:67], v[168:171], v[240:243], v[64:67]
    v_fmaak_f32 v36, v41, v36, 0xc0135761
    v_fmaak_f32 v37, v41, v37, 0xc0135761
    v_mfma_f32_16x16x32_bf16 v[72:75], v[168:171], v[244:247], v[72:75]
    buffer_load_dwordx4 a[156:159], v29, s[48:51], s99 offen offset:3072 sc1
    s_waitcnt lgkmcnt(0)
    s_barrier
    v_mfma_f32_16x16x32_bf16 v[68:71], v[172:175], v[240:243], v[68:71]
    ds_read_b128 v[160:163], v20 offset:16384
    ds_read_b128 v[164:167], v20 offset:17408
    v_mfma_f32_16x16x32_bf16 v[76:79], v[172:175], v[244:247], v[76:79]
    s_add_u32 s99, s99, 4096
    v_fmaak_f32 v38, v41, v38, 0xc0135761
    v_fmaak_f32 v39, v41, v39, 0xc0135761
    v_mul_f32 v36, v36, v96
    v_mfma_f32_16x16x32_bf16 v[48:51], v[176:179], v[248:251], v[48:51]
    ds_read_b128 v[168:171], v20 offset:18432
    ds_read_b128 v[172:175], v20 offset:19456
    v_mfma_f32_16x16x32_bf16 v[56:59], v[176:179], v[252:255], v[56:59]
    buffer_load_dwordx4 a[160:163], v29, s[48:51], s99 offen offset:0 sc1
    v_mul_f32 v37, v37, v97
    v_mul_f32 v38, v38, v98
    v_mfma_f32_16x16x32_bf16 v[52:55], v[180:183], v[248:251], v[52:55]
    ds_read_b128 v[176:179], v20 offset:57344
    v_mul_f32 v39, v39, v99
    v_mfma_f32_16x16x32_bf16 v[60:63], v[180:183], v[252:255], v[60:63]
    v_exp_f32 v36, v36
    v_exp_f32 v37, v37
    v_mfma_f32_16x16x32_bf16 v[64:67], v[184:187], v[248:251], v[64:67]
    ds_read_b128 v[180:183], v20 offset:58368
    v_mfma_f32_16x16x32_bf16 v[72:75], v[184:187], v[252:255], v[72:75]
    buffer_load_dwordx4 a[164:167], v29, s[48:51], s99 offen offset:1024 sc1
    v_exp_f32 v38, v38
    v_mfma_f32_16x16x32_bf16 v[68:71], v[188:191], v[248:251], v[68:71]
    ds_read_b128 v[184:187], v20 offset:59392
    v_mfma_f32_16x16x32_bf16 v[76:79], v[188:191], v[252:255], v[76:79]
    v_exp_f32 v39, v39
    v_fma_f32 v36, v36, v42, v42
    s_waitcnt lgkmcnt(3)
    v_mfma_f32_16x16x32_bf16 v[48:51], v[160:163], a[0:3], v[48:51]
    ds_read_b128 v[188:191], v20 offset:60416
    s_lshl_b32 s80, s81, 7
    v_mfma_f32_16x16x32_bf16 v[56:59], v[160:163], a[4:7], v[56:59]
    buffer_load_dwordx4 a[168:171], v29, s[48:51], s99 offen offset:2048 sc1
    s_add_u32 s80, s80, 638976
    s_lshl_b32 s81, s81, 13
    v_mfma_f32_16x16x32_bf16 v[52:55], v[164:167], a[0:3], v[52:55]
    ds_read_b128 v[160:163], v21 offset:16384
    s_add_u32 s81, s81, 18874368
    v_mfma_f32_16x16x32_bf16 v[60:63], v[164:167], a[4:7], v[60:63]
    v_fma_f32 v37, v37, v42, v42
    v_fma_f32 v38, v38, v42, v42
    v_fma_f32 v39, v39, v42, v42
    v_mfma_f32_16x16x32_bf16 v[64:67], v[168:171], a[0:3], v[64:67]
    ds_read_b128 v[164:167], v21 offset:17408
    v_mfma_f32_16x16x32_bf16 v[72:75], v[168:171], a[4:7], v[72:75]
    buffer_load_dword v45, off, s[48:51], s80 sc1
    v_rcp_f32 v36, v36
    v_mfma_f32_16x16x32_bf16 v[68:71], v[172:175], a[0:3], v[68:71]
    ds_read_b128 v[168:171], v21 offset:18432
    v_mfma_f32_16x16x32_bf16 v[76:79], v[172:175], a[4:7], v[76:79]
    buffer_load_dwordx4 a[172:175], v29, s[48:51], s99 offen offset:3072 sc1
    s_waitcnt lgkmcnt(3)
    v_mfma_f32_16x16x32_bf16 v[48:51], v[176:179], a[8:11], v[48:51]
    ds_read_b128 v[172:175], v21 offset:19456
    v_mfma_f32_16x16x32_bf16 v[56:59], v[176:179], a[12:15], v[56:59]
    v_rcp_f32 v37, v37
    v_rcp_f32 v38, v38
    v_mfma_f32_16x16x32_bf16 v[52:55], v[180:183], a[8:11], v[52:55]
    ds_read_b128 v[176:179], v21 offset:57344
    v_mfma_f32_16x16x32_bf16 v[60:63], v[180:183], a[12:15], v[60:63]
    buffer_load_dwordx4 v[192:195], v29, s[48:51], s63 offen offset:0 sc1
    v_rcp_f32 v39, v39
    v_mfma_f32_16x16x32_bf16 v[64:67], v[184:187], a[8:11], v[64:67]
    ds_read_b128 v[180:183], v21 offset:58368
    v_mul_f32 v96, v96, v36
    v_mfma_f32_16x16x32_bf16 v[72:75], v[184:187], a[12:15], v[72:75]
    v_mul_f32 v97, v97, v37
    v_mul_f32 v98, v98, v38
    v_mul_f32 v99, v99, v39
    v_lshlrev_b32 v100, 16, v122
    v_mfma_f32_16x16x32_bf16 v[68:71], v[188:191], a[8:11], v[68:71]
    ds_read_b128 v[184:187], v21 offset:59392
    v_and_b32 v101, 0xffff0000, v122
    v_mfma_f32_16x16x32_bf16 v[76:79], v[188:191], a[12:15], v[76:79]
    buffer_load_dwordx4 v[196:199], v29, s[48:51], s64 offen offset:0 sc1
    v_lshlrev_b32 v102, 16, v123
    s_waitcnt lgkmcnt(3)
    v_mfma_f32_16x16x32_bf16 v[48:51], v[160:163], a[16:19], v[48:51]
    ds_read_b128 v[188:191], v21 offset:60416
    v_and_b32 v103, 0xffff0000, v123
    v_mfma_f32_16x16x32_bf16 v[56:59], v[160:163], a[20:23], v[56:59]
    v_mul_f32 v36, v100, v100
    v_mul_f32 v37, v101, v101
    v_mul_f32 v38, v102, v102
    v_mul_f32 v39, v103, v103
    v_mfma_f32_16x16x32_bf16 v[52:55], v[164:167], a[16:19], v[52:55]
    v_fmaak_f32 v36, v41, v36, 0xc0135761
    v_fmaak_f32 v37, v41, v37, 0xc0135761
    v_mfma_f32_16x16x32_bf16 v[60:63], v[164:167], a[20:23], v[60:63]
    buffer_load_dwordx4 v[200:203], v29, s[48:51], s65 offen offset:0 sc1
    v_fmaak_f32 v38, v41, v38, 0xc0135761
    v_fmaak_f32 v39, v41, v39, 0xc0135761
    v_mfma_f32_16x16x32_bf16 v[64:67], v[168:171], a[16:19], v[64:67]
    v_mul_f32 v36, v36, v100
    v_mul_f32 v37, v37, v101
    v_mfma_f32_16x16x32_bf16 v[72:75], v[168:171], a[20:23], v[72:75]
    v_mul_f32 v38, v38, v102
    v_mul_f32 v39, v39, v103
    s_waitcnt lgkmcnt(0)
    s_barrier
    v_mfma_f32_16x16x32_bf16 v[68:71], v[172:175], a[16:19], v[68:71]
    ds_read_b128 v[160:163], v20 offset:20480
    ds_read_b128 v[164:167], v20 offset:21504
    v_mfma_f32_16x16x32_bf16 v[76:79], v[172:175], a[20:23], v[76:79]
    buffer_load_dwordx4 v[204:207], v29, s[48:51], s71 offen offset:0 sc1
    v_exp_f32 v36, v36
    v_mfma_f32_16x16x32_bf16 v[48:51], v[176:179], a[24:27], v[48:51]
    ds_read_b128 v[168:171], v20 offset:22528
    ds_read_b128 v[172:175], v20 offset:23552
    v_mfma_f32_16x16x32_bf16 v[56:59], v[176:179], a[28:31], v[56:59]
    v_exp_f32 v37, v37
    v_exp_f32 v38, v38
    v_mfma_f32_16x16x32_bf16 v[52:55], v[180:183], a[24:27], v[52:55]
    ds_read_b128 v[176:179], v20 offset:61440
    v_mfma_f32_16x16x32_bf16 v[60:63], v[180:183], a[28:31], v[60:63]
    buffer_load_dwordx4 v[208:211], v29, s[48:51], s63 offen offset:1024 sc1
    v_exp_f32 v39, v39
    v_mfma_f32_16x16x32_bf16 v[64:67], v[184:187], a[24:27], v[64:67]
    ds_read_b128 v[180:183], v20 offset:62464
    v_fma_f32 v36, v36, v42, v42
    v_mfma_f32_16x16x32_bf16 v[72:75], v[184:187], a[28:31], v[72:75]
    v_fma_f32 v37, v37, v42, v42
    v_fma_f32 v38, v38, v42, v42
    v_fma_f32 v39, v39, v42, v42
    v_mfma_f32_16x16x32_bf16 v[68:71], v[188:191], a[24:27], v[68:71]
    ds_read_b128 v[184:187], v20 offset:63488
    v_mfma_f32_16x16x32_bf16 v[76:79], v[188:191], a[28:31], v[76:79]
    buffer_load_dwordx4 v[212:215], v29, s[48:51], s64 offen offset:1024 sc1
    s_waitcnt lgkmcnt(3)
    v_mfma_f32_16x16x32_bf16 v[48:51], v[160:163], a[32:35], v[48:51]
    ds_read_b128 v[188:191], v20 offset:64512
    v_mfma_f32_16x16x32_bf16 v[56:59], v[160:163], a[36:39], v[56:59]
    v_rcp_f32 v36, v36
    v_rcp_f32 v37, v37
    v_mfma_f32_16x16x32_bf16 v[52:55], v[164:167], a[32:35], v[52:55]
    ds_read_b128 v[160:163], v21 offset:20480
    v_mfma_f32_16x16x32_bf16 v[60:63], v[164:167], a[36:39], v[60:63]
    buffer_load_dwordx4 v[216:219], v29, s[48:51], s65 offen offset:1024 sc1
    v_rcp_f32 v38, v38
    v_mfma_f32_16x16x32_bf16 v[64:67], v[168:171], a[32:35], v[64:67]
    ds_read_b128 v[164:167], v21 offset:21504
    v_mfma_f32_16x16x32_bf16 v[72:75], v[168:171], a[36:39], v[72:75]
    v_rcp_f32 v39, v39
    v_mul_f32 v100, v100, v36
    v_mul_f32 v101, v101, v37
    v_mfma_f32_16x16x32_bf16 v[68:71], v[172:175], a[32:35], v[68:71]
    ds_read_b128 v[168:171], v21 offset:22528
    v_mul_f32 v102, v102, v38
    v_mfma_f32_16x16x32_bf16 v[76:79], v[172:175], a[36:39], v[76:79]
    buffer_load_dwordx4 v[220:223], v29, s[48:51], s71 offen offset:1024 sc1
    v_mul_f32 v103, v103, v39
    s_waitcnt lgkmcnt(3)
    v_mfma_f32_16x16x32_bf16 v[48:51], v[176:179], a[40:43], v[48:51]
    ds_read_b128 v[172:175], v21 offset:23552
    v_lshlrev_b32 v104, 16, v124
    v_mfma_f32_16x16x32_bf16 v[56:59], v[176:179], a[44:47], v[56:59]
    s_waitcnt vmcnt(9)
    v_cmp_eq_u32 vcc, -1, v45
    s_nop 1
    s_cbranch_vccnz Lslow_38
Lback_39:
    v_mfma_f32_16x16x32_bf16 v[52:55], v[180:183], a[40:43], v[52:55]
    ds_read_b128 v[176:179], v21 offset:61440
    v_and_b32 v105, 0xffff0000, v124
    v_mfma_f32_16x16x32_bf16 v[60:63], v[180:183], a[44:47], v[60:63]
    buffer_load_dwordx4 v[144:147], v29, s[48:51], s81 offen offset:0 sc1
    v_lshlrev_b32 v106, 16, v125
    v_and_b32 v107, 0xffff0000, v125
    v_mfma_f32_16x16x32_bf16 v[64:67], v[184:187], a[40:43], v[64:67]
    ds_read_b128 v[180:183], v21 offset:62464
    v_mul_f32 v36, v104, v104
    v_mfma_f32_16x16x32_bf16 v[72:75], v[184:187], a[44:47], v[72:75]
    v_mul_f32 v37, v105, v105
    v_mul_f32 v38, v106, v106
    v_mul_f32 v39, v107, v107
    v_fmaak_f32 v36, v41, v36, 0xc0135761
    v_mfma_f32_16x16x32_bf16 v[68:71], v[188:191], a[40:43], v[68:71]
    ds_read_b128 v[184:187], v21 offset:63488
    v_fmaak_f32 v37, v41, v37, 0xc0135761
    v_mfma_f32_16x16x32_bf16 v[76:79], v[188:191], a[44:47], v[76:79]
    buffer_load_dwordx4 v[148:151], v29, s[48:51], s81 offen offset:1024 sc1
    v_fmaak_f32 v38, v41, v38, 0xc0135761
    s_waitcnt lgkmcnt(3)
    v_mfma_f32_16x16x32_bf16 v[48:51], v[160:163], a[48:51], v[48:51]
    ds_read_b128 v[188:191], v21 offset:64512
    v_fmaak_f32 v39, v41, v39, 0xc0135761
    v_mfma_f32_16x16x32_bf16 v[56:59], v[160:163], a[52:55], v[56:59]
    v_mul_f32 v36, v36, v104
    v_mul_f32 v37, v37, v105
    v_mul_f32 v38, v38, v106
    v_mul_f32 v39, v39, v107
    v_mfma_f32_16x16x32_bf16 v[52:55], v[164:167], a[48:51], v[52:55]
    v_exp_f32 v36, v36
    v_mfma_f32_16x16x32_bf16 v[60:63], v[164:167], a[52:55], v[60:63]
    buffer_load_dwordx4 v[152:155], v29, s[48:51], s81 offen offset:2048 sc1
    v_exp_f32 v37, v37
    v_mfma_f32_16x16x32_bf16 v[64:67], v[168:171], a[48:51], v[64:67]
    v_exp_f32 v38, v38
    v_mfma_f32_16x16x32_bf16 v[72:75], v[168:171], a[52:55], v[72:75]
    v_exp_f32 v39, v39
    s_waitcnt lgkmcnt(0)
    s_barrier
    v_mfma_f32_16x16x32_bf16 v[68:71], v[172:175], a[48:51], v[68:71]
    ds_read_b128 v[160:163], v20 offset:0
    ds_read_b128 v[164:167], v20 offset:1024
    v_mfma_f32_16x16x32_bf16 v[76:79], v[172:175], a[52:55], v[76:79]
    buffer_load_dwordx4 v[156:159], v29, s[48:51], s81 offen offset:3072 sc1
    v_fma_f32 v36, v36, v40, v40
    v_fma_f32 v37, v37, v40, v40
    v_mfma_f32_16x16x32_bf16 v[48:51], v[176:179], a[56:59], v[48:51]
    ds_read_b128 v[168:171], v20 offset:2048
    ds_read_b128 v[172:175], v20 offset:3072
    v_mfma_f32_16x16x32_bf16 v[56:59], v[176:179], a[60:63], v[56:59]
    v_fma_f32 v38, v38, v40, v40
    v_fma_f32 v39, v39, v40, v40
    v_rcp_f32 v36, v36
    v_mfma_f32_16x16x32_bf16 v[52:55], v[180:183], a[56:59], v[52:55]
    ds_read_b128 v[176:179], v20 offset:40960
    v_mfma_f32_16x16x32_bf16 v[60:63], v[180:183], a[60:63], v[60:63]
    buffer_load_dwordx4 v[224:227], v29, s[48:51], s63 offen offset:2048 sc1
    v_rcp_f32 v37, v37
    v_mfma_f32_16x16x32_bf16 v[64:67], v[184:187], a[56:59], v[64:67]
    ds_read_b128 v[180:183], v20 offset:41984
    v_mfma_f32_16x16x32_bf16 v[72:75], v[184:187], a[60:63], v[72:75]
    v_rcp_f32 v38, v38
    v_rcp_f32 v39, v39
    v_mfma_f32_16x16x32_bf16 v[68:71], v[188:191], a[56:59], v[68:71]
    ds_read_b128 v[184:187], v20 offset:43008
    v_mul_f32 v104, v104, v36
    v_mfma_f32_16x16x32_bf16 v[76:79], v[188:191], a[60:63], v[76:79]
    buffer_load_dwordx4 v[228:231], v29, s[48:51], s64 offen offset:2048 sc1
    v_mul_f32 v105, v105, v37
    s_waitcnt lgkmcnt(3)
    v_mfma_f32_16x16x32_bf16 v[48:51], v[160:163], a[64:67], v[48:51]
    ds_read_b128 v[188:191], v20 offset:44032
    v_mul_f32 v106, v106, v38
    v_mfma_f32_16x16x32_bf16 v[56:59], v[160:163], a[68:71], v[56:59]
    v_mul_f32 v107, v107, v39
    v_lshlrev_b32 v108, 16, v126
    v_and_b32 v109, 0xffff0000, v126
    v_lshlrev_b32 v110, 16, v127
    v_mfma_f32_16x16x32_bf16 v[52:55], v[164:167], a[64:67], v[52:55]
    ds_read_b128 v[160:163], v21 offset:0
    v_and_b32 v111, 0xffff0000, v127
    v_mfma_f32_16x16x32_bf16 v[60:63], v[164:167], a[68:71], v[60:63]
    buffer_load_dword v19, v26, s[48:51], 0 offen sc1
    v_mul_f32 v36, v108, v108
    v_mul_f32 v37, v109, v109
    v_mfma_f32_16x16x32_bf16 v[64:67], v[168:171], a[64:67], v[64:67]
    ds_read_b128 v[164:167], v21 offset:1024
    v_mul_f32 v38, v110, v110
    v_mfma_f32_16x16x32_bf16 v[72:75], v[168:171], a[68:71], v[72:75]
    buffer_load_dwordx4 v[232:235], v29, s[48:51], s65 offen offset:2048 sc1
    v_mul_f32 v39, v111, v111
    v_fmaak_f32 v36, v41, v36, 0xc0135761
    v_mfma_f32_16x16x32_bf16 v[68:71], v[172:175], a[64:67], v[68:71]
    ds_read_b128 v[168:171], v21 offset:2048
    v_fmaak_f32 v37, v41, v37, 0xc0135761
    v_mfma_f32_16x16x32_bf16 v[76:79], v[172:175], a[68:71], v[76:79]
    v_fmaak_f32 v38, v41, v38, 0xc0135761
    v_fmaak_f32 v39, v41, v39, 0xc0135761
    v_mul_f32 v36, v36, v108
    s_waitcnt lgkmcnt(3)
    v_mfma_f32_16x16x32_bf16 v[48:51], v[176:179], a[72:75], v[48:51]
    ds_read_b128 v[172:175], v21 offset:3072
    v_mul_f32 v37, v37, v109
    v_mfma_f32_16x16x32_bf16 v[56:59], v[176:179], a[76:79], v[56:59]
    buffer_load_dwordx4 v[236:239], v29, s[48:51], s71 offen offset:2048 sc1
    v_mul_f32 v38, v38, v110
    v_mul_f32 v39, v39, v111
    v_mfma_f32_16x16x32_bf16 v[52:55], v[180:183], a[72:75], v[52:55]
    ds_read_b128 v[176:179], v21 offset:40960
    v_mfma_f32_16x16x32_bf16 v[60:63], v[180:183], a[76:79], v[60:63]
    v_exp_f32 v36, v36
    v_exp_f32 v37, v37
    v_mfma_f32_16x16x32_bf16 v[64:67], v[184:187], a[72:75], v[64:67]
    ds_read_b128 v[180:183], v21 offset:41984
    v_mfma_f32_16x16x32_bf16 v[72:75], v[184:187], a[76:79], v[72:75]
    buffer_load_dwordx4 v[240:243], v29, s[48:51], s63 offen offset:3072 sc1
    v_exp_f32 v38, v38
    v_mfma_f32_16x16x32_bf16 v[68:71], v[188:191], a[72:75], v[68:71]
    ds_read_b128 v[184:187], v21 offset:43008
    v_mfma_f32_16x16x32_bf16 v[76:79], v[188:191], a[76:79], v[76:79]
    v_exp_f32 v39, v39
    v_fma_f32 v36, v36, v40, v40
    s_waitcnt lgkmcnt(3)
    v_mfma_f32_16x16x32_bf16 v[48:51], v[160:163], a[80:83], v[48:51]
    ds_read_b128 v[188:191], v21 offset:44032
    v_fma_f32 v37, v37, v40, v40
    v_mfma_f32_16x16x32_bf16 v[56:59], v[160:163], a[84:87], v[56:59]
    buffer_load_dwordx4 v[244:247], v29, s[48:51], s64 offen offset:3072 sc1
    v_fma_f32 v38, v38, v40, v40
    v_fma_f32 v39, v39, v40, v40
    v_mfma_f32_16x16x32_bf16 v[52:55], v[164:167], a[80:83], v[52:55]
    v_rcp_f32 v36, v36
    v_mfma_f32_16x16x32_bf16 v[60:63], v[164:167], a[84:87], v[60:63]
    v_rcp_f32 v37, v37
    v_rcp_f32 v38, v38
    v_mfma_f32_16x16x32_bf16 v[64:67], v[168:171], a[80:83], v[64:67]
    v_rcp_f32 v39, v39
    v_mfma_f32_16x16x32_bf16 v[72:75], v[168:171], a[84:87], v[72:75]
    buffer_load_dwordx4 v[248:251], v29, s[48:51], s65 offen offset:3072 sc1
    v_mul_f32 v108, v108, v36
    v_mul_f32 v109, v109, v37
    v_mfma_f32_16x16x32_bf16 v[68:71], v[172:175], a[80:83], v[68:71]
    v_mul_f32 v110, v110, v38
    v_mul_f32 v111, v111, v39
    v_mfma_f32_16x16x32_bf16 v[76:79], v[172:175], a[84:87], v[76:79]
    s_waitcnt lgkmcnt(0)
    v_mfma_f32_16x16x32_bf16 v[48:51], v[176:179], a[88:91], v[48:51]
    v_mfma_f32_16x16x32_bf16 v[56:59], v[176:179], a[92:95], v[56:59]
    buffer_load_dwordx4 v[252:255], v29, s[48:51], s71 offen offset:3072 sc1
    s_waitcnt vmcnt(12)
    v_lshlrev_b32 v128, 16, v144
    v_and_b32 v129, 0xffff0000, v144
    v_mfma_f32_16x16x32_bf16 v[52:55], v[180:183], a[88:91], v[52:55]
    v_lshlrev_b32 v130, 16, v145
    v_and_b32 v131, 0xffff0000, v145
    v_mfma_f32_16x16x32_bf16 v[60:63], v[180:183], a[92:95], v[60:63]
    v_lshlrev_b32 v132, 16, v146
    v_and_b32 v133, 0xffff0000, v146
    v_lshlrev_b32 v134, 16, v147
    v_and_b32 v135, 0xffff0000, v147
    v_mfma_f32_16x16x32_bf16 v[64:67], v[184:187], a[88:91], v[64:67]
    s_waitcnt vmcnt(11)
    v_lshlrev_b32 v136, 16, v148
    v_and_b32 v137, 0xffff0000, v148
    v_mfma_f32_16x16x32_bf16 v[72:75], v[184:187], a[92:95], v[72:75]
    v_lshlrev_b32 v138, 16, v149
    v_and_b32 v139, 0xffff0000, v149
    v_lshlrev_b32 v140, 16, v150
    v_and_b32 v141, 0xffff0000, v150
    v_mfma_f32_16x16x32_bf16 v[68:71], v[188:191], a[88:91], v[68:71]
    v_lshlrev_b32 v142, 16, v151
    v_and_b32 v143, 0xffff0000, v151
    v_mfma_f32_16x16x32_bf16 v[76:79], v[188:191], a[92:95], v[76:79]
    s_waitcnt vmcnt(10)
    v_lshlrev_b32 v144, 16, v152
    v_and_b32 v145, 0xffff0000, v152
    v_lshlrev_b32 v146, 16, v153
    v_and_b32 v147, 0xffff0000, v153
    v_lshlrev_b32 v148, 16, v154
    v_and_b32 v149, 0xffff0000, v154
    v_lshlrev_b32 v150, 16, v155
    v_and_b32 v151, 0xffff0000, v155
    s_waitcnt vmcnt(9)
    v_lshlrev_b32 v152, 16, v156
    v_and_b32 v153, 0xffff0000, v156
    v_lshlrev_b32 v154, 16, v157
    v_and_b32 v155, 0xffff0000, v157
    v_lshlrev_b32 v156, 16, v158
    v_and_b32 v157, 0xffff0000, v158
    v_lshlrev_b32 v158, 16, v159
    v_and_b32 v159, 0xffff0000, v159
    s_waitcnt vmcnt(6)
    v_cmp_eq_u32 vcc, -1, v19
    s_nop 1
    s_cbranch_vccnz Lslow_40
Lback_41:
    s_add_u32 m0, s61, 0
    s_nop 0
    buffer_load_dwordx4 v4, s[48:51], s3 offen sc1 lds
    s_add_u32 m0, s61, 1024
    s_nop 0
    buffer_load_dwordx4 v5, s[48:51], s3 offen sc1 lds
    v_pk_add_f32 v[48:49], v[48:49], v[128:129]
    v_pk_add_f32 v[50:51], v[50:51], v[130:131]
    v_pk_mul_f32 v[48:49], v[48:49], v[80:81]
    v_pk_mul_f32 v[50:51], v[50:51], v[82:83]
    v_cvt_pk_bf16_f32 v80, v48, v49
    v_cvt_pk_bf16_f32 v81, v50, v51
    v_pk_add_f32 v[52:53], v[52:53], v[132:133]
    v_pk_add_f32 v[54:55], v[54:55], v[134:135]
    v_pk_mul_f32 v[52:53], v[52:53], v[84:85]
    v_pk_mul_f32 v[54:55], v[54:55], v[86:87]
    v_cvt_pk_bf16_f32 v82, v52, v53
    v_cvt_pk_bf16_f32 v83, v54, v55
    buffer_store_dwordx4 v[80:83], v25, s[48:51], s18 offen offset:0 sc1
    v_pk_add_f32 v[56:57], v[56:57], v[136:137]
    v_pk_add_f32 v[58:59], v[58:59], v[138:139]
    v_pk_mul_f32 v[56:57], v[56:57], v[88:89]
    v_pk_mul_f32 v[58:59], v[58:59], v[90:91]
    v_cvt_pk_bf16_f32 v84, v56, v57
    v_cvt_pk_bf16_f32 v85, v58, v59
    v_pk_add_f32 v[60:61], v[60:61], v[140:141]
    v_pk_add_f32 v[62:63], v[62:63], v[142:143]
    v_pk_mul_f32 v[60:61], v[60:61], v[92:93]
    v_pk_mul_f32 v[62:63], v[62:63], v[94:95]
    v_cvt_pk_bf16_f32 v86, v60, v61
    v_cvt_pk_bf16_f32 v87, v62, v63
    buffer_store_dwordx4 v[84:87], v25, s[48:51], s98 offen offset:0 sc1
    v_pk_add_f32 v[64:65], v[64:65], v[144:145]
    v_pk_add_f32 v[66:67], v[66:67], v[146:147]
    v_pk_mul_f32 v[64:65], v[64:65], v[96:97]
    v_pk_mul_f32 v[66:67], v[66:67], v[98:99]
    v_cvt_pk_bf16_f32 v88, v64, v65
    v_cvt_pk_bf16_f32 v89, v66, v67
    v_pk_add_f32 v[68:69], v[68:69], v[148:149]
    v_pk_add_f32 v[70:71], v[70:71], v[150:151]
    v_pk_mul_f32 v[68:69], v[68:69], v[100:101]
    v_pk_mul_f32 v[70:71], v[70:71], v[102:103]
    v_cvt_pk_bf16_f32 v90, v68, v69
    v_cvt_pk_bf16_f32 v91, v70, v71
    buffer_store_dwordx4 v[88:91], v29, s[48:51], s18 offen offset:1024 sc1
    v_pk_add_f32 v[72:73], v[72:73], v[152:153]
    v_pk_add_f32 v[74:75], v[74:75], v[154:155]
    v_pk_mul_f32 v[72:73], v[72:73], v[104:105]
    v_pk_mul_f32 v[74:75], v[74:75], v[106:107]
    v_cvt_pk_bf16_f32 v92, v72, v73
    v_cvt_pk_bf16_f32 v93, v74, v75
    v_pk_add_f32 v[76:77], v[76:77], v[156:157]
    v_pk_add_f32 v[78:79], v[78:79], v[158:159]
    v_pk_mul_f32 v[76:77], v[76:77], v[108:109]
    v_pk_mul_f32 v[78:79], v[78:79], v[110:111]
    v_cvt_pk_bf16_f32 v94, v76, v77
    v_cvt_pk_bf16_f32 v95, v78, v79
    buffer_store_dwordx4 v[92:95], v29, s[48:51], s98 offen offset:1024 sc1
    s_mov_b32 s7, s19
    s_nop 0
L_p3:
    buffer_load_dwordx4 v[160:163], v30, s[48:51], s63 offen offset:0 sc1
    buffer_load_dword v19, v17, s[48:51], 0 offen sc1
    v_lshrrev_b32 v28, 4, v0
    v_and_b32 v24, 15, v0
    v_lshl_add_u32 v25, v24, 4, s61
    v_lshlrev_b32 v33, 3, v28
    s_mov_b32 s75, 0x40000000
    v_bfe_u32 v32, s75, v33, 8
    v_lshl_add_u32 v8, v32, 2, v25
    s_mov_b32 s75, 0x40400000
    v_bfe_u32 v32, s75, v33, 8
    v_lshl_add_u32 v9, v32, 2, v25
    s_mov_b32 s75, 0x1010140
    v_bfe_u32 v32, s75, v33, 8
    v_lshl_add_u32 v10, v32, 2, v25
    s_mov_b32 s75, 0x41010140
    v_bfe_u32 v32, s75, v33, 8
    v_lshl_add_u32 v11, v32, 2, v25
    s_mov_b32 s75, 0x2024141
    v_bfe_u32 v32, s75, v33, 8
    v_lshl_add_u32 v12, v32, 2, v25
    s_mov_b32 s75, 0x2024141
    v_bfe_u32 v32, s75, v33, 8
    v_lshl_add_u32 v13, v32, 2, v25
    s_mov_b32 s75, 0x3424202
    v_bfe_u32 v32, s75, v33, 8
    v_lshl_add_u32 v14, v32, 2, v25
    s_mov_b32 s75, 0x3424242
    v_bfe_u32 v32, s75, v33, 8
    v_lshl_add_u32 v15, v32, 2, v25
    s_mov_b32 s75, 0x43430303
    v_bfe_u32 v32, s75, v33, 8
    v_lshl_add_u32 v1, v32, 2, v25
    s_mov_b32 s75, 0x43434303
    v_bfe_u32 v32, s75, v33, 8
    v_lshl_add_u32 v3, v32, 2, v25
    s_waitcnt vmcnt(6)
    ds_read_b32 v32, v8 offset:0
    ds_read_b32 v33, v9 offset:0
    ds_read_b32 v34, v8 offset:512
    ds_read_b32 v35, v9 offset:512
    ds_read_b32 v36, v8 offset:1024
    ds_read_b32 v37, v9 offset:1024
    ds_read_b32 v38, v8 offset:1536
    ds_read_b32 v39, v9 offset:1536
    ds_read_b32 v40, v10 offset:0
    ds_read_b32 v41, v11 offset:0
    ds_read_b32 v42, v10 offset:512
    ds_read_b32 v43, v11 offset:512
    ds_read_b32 v44, v10 offset:1024
    ds_read_b32 v45, v11 offset:1024
    ds_read_b32 v46, v10 offset:1536
    ds_read_b32 v47, v11 offset:1536
    v_add_u32 v20, s61, v29
    buffer_load_dwordx4 v[164:167], v30, s[48:51], s64 offen offset:0 sc1
    v_add_u32 v16, 0x1000, v22
    s_add_u32 s75, s56, 3
    s_and_b32 s75, s75, 3
    s_mul_i32 s75, s75, 40960
    v_add_u32 v21, s75, v29
    s_add_u32 s75, s56, 2
    s_and_b32 s75, s75, 3
    s_mul_i32 s75, s75, 40960
    v_add_u32 v23, s75, v29
    s_add_u32 s75, s56, 1
    s_and_b32 s75, s75, 3
    s_mul_i32 s75, s75, 40960
    v_add_u32 v27, s75, v29
    buffer_load_dwordx4 v[168:171], v30, s[48:51], s65 offen offset:0 sc1
    v_and_b32 v25, 7, v0
    v_xor_b32 v26, v25, v28
    v_lshlrev_b32 v26, 4, v26
    v_lshl_add_u32 v26, v24, 7, v26
    v_add_u32 v26, s61, v26
    v_lshlrev_b32 v5, 3, v28
    v_lshl_add_u32 v5, v24, 5, v5
    v_add_u32 v5, s61, v5
    v_lshrrev_b32 v28, 3, v0
    v_lshlrev_b32 v4, 4, v28
    v_xad_u32 v4, v4, v29, s61
    v_mul_u32_u24 v28, 1280, v28
    v_lshl_add_u32 v24, v25, 4, v28
    buffer_load_dwordx4 v[172:175], v30, s[48:51], s71 offen offset:0 sc1
    v_lshrrev_b32 v28, 1, v0
    v_mul_u32_u24 v28, 1280, v28
    v_and_b32 v25, 16, v29
    v_add_u32 v25, v25, v28
    s_lshl2_add_u32 s77, s4, s56
    s_mul_i32 s77, s77, 20480
    s_lshr_b32 s76, s5, 2
    s_mul_i32 s76, s76, 640
    s_add_u32 s77, s77, s76
    s_and_b32 s76, s5, 3
    s_lshl_b32 s76, s76, 5
    s_add_u32 s3, s77, s76
    s_lshl2_add_u32 s77, s76, s77
    s_add_u32 s76, s77, 10240
    s_lshl_b32 s6, s56, 11
    s_add_u32 s99, s99, 4096
    buffer_load_dwordx4 a[176:179], v29, s[48:51], s99 offen offset:0 sc1
    s_add_u32 s6, s6, 20480
    s_add_u32 s82, s72, 0
    s_add_u32 s83, s72, 5120
    s_add_u32 s84, s72, 10240
    s_add_u32 s85, s72, 15360
    s_add_u32 s86, s72, 20480
    v_lshlrev_b32 v64, 16, v192
    v_and_b32 v192, 0xffff0000, v192
    v_lshlrev_b32 v65, 16, v193
    v_and_b32 v193, 0xffff0000, v193
    v_lshlrev_b32 v66, 16, v194
    v_and_b32 v194, 0xffff0000, v194
    v_lshlrev_b32 v67, 16, v195
    v_and_b32 v195, 0xffff0000, v195
    buffer_load_dwordx4 a[180:183], v29, s[48:51], s99 offen offset:1024 sc1
    s_waitcnt lgkmcnt(14)
    v_pk_mul_f32 v[192:193], v[192:193], v[32:33] op_sel_hi:[1,0]
    v_pk_mul_f32 v[194:195], v[194:195], v[32:33] op_sel:[0,1] op_sel_hi:[1,1]
    v_pk_mul_f32 v[64:65], v[64:65], v[32:33] op_sel_hi:[1,0]
    v_pk_mul_f32 v[66:67], v[66:67], v[32:33] op_sel:[0,1] op_sel_hi:[1,1]
    v_cvt_pk_bf16_f32 v192, v64, v192
    v_cvt_pk_bf16_f32 v193, v65, v193
    v_cvt_pk_bf16_f32 v194, v66, v194
    v_cvt_pk_bf16_f32 v195, v67, v195
    v_lshlrev_b32 v68, 16, v196
    v_and_b32 v196, 0xffff0000, v196
    v_lshlrev_b32 v69, 16, v197
    v_and_b32 v197, 0xffff0000, v197
    v_lshlrev_b32 v70, 16, v198
    v_and_b32 v198, 0xffff0000, v198
    buffer_load_dwordx4 a[184:187], v29, s[48:51], s99 offen offset:2048 sc1
    v_lshlrev_b32 v71, 16, v199
    v_and_b32 v199, 0xffff0000, v199
    s_waitcnt lgkmcnt(12)
    v_pk_mul_f32 v[196:197], v[196:197], v[34:35] op_sel_hi:[1,0]
    v_pk_mul_f32 v[198:199], v[198:199], v[34:35] op_sel:[0,1] op_sel_hi:[1,1]
    v_pk_mul_f32 v[68:69], v[68:69], v[34:35] op_sel_hi:[1,0]
    v_pk_mul_f32 v[70:71], v[70:71], v[34:35] op_sel:[0,1] op_sel_hi:[1,1]
    v_cvt_pk_bf16_f32 v196, v68, v196
    v_cvt_pk_bf16_f32 v197, v69, v197
    v_cvt_pk_bf16_f32 v198, v70, v198
    v_cvt_pk_bf16_f32 v199, v71, v199
    v_lshlrev_b32 v72, 16, v200
    v_and_b32 v200, 0xffff0000, v200
    v_lshlrev_b32 v73, 16, v201
    v_and_b32 v201, 0xffff0000, v201
    buffer_load_dwordx4 a[188:191], v29, s[48:51], s99 offen offset:3072 sc1
    v_lshlrev_b32 v74, 16, v202
    v_and_b32 v202, 0xffff0000, v202
    v_lshlrev_b32 v75, 16, v203
    v_and_b32 v203, 0xffff0000, v203
    s_waitcnt lgkmcnt(10)
    v_pk_mul_f32 v[200:201], v[200:201], v[36:37] op_sel_hi:[1,0]
    v_pk_mul_f32 v[202:203], v[202:203], v[36:37] op_sel:[0,1] op_sel_hi:[1,1]
    v_pk_mul_f32 v[72:73], v[72:73], v[36:37] op_sel_hi:[1,0]
    v_pk_mul_f32 v[74:75], v[74:75], v[36:37] op_sel:[0,1] op_sel_hi:[1,1]
    v_cvt_pk_bf16_f32 v200, v72, v200
    v_cvt_pk_bf16_f32 v201, v73, v201
    v_cvt_pk_bf16_f32 v202, v74, v202
    v_cvt_pk_bf16_f32 v203, v75, v203
    v_lshlrev_b32 v76, 16, v204
    v_and_b32 v204, 0xffff0000, v204
    s_add_u32 s99, s99, 4096
    buffer_load_dwordx4 a[192:195], v29, s[48:51], s99 offen offset:0 sc1
    v_lshlrev_b32 v77, 16, v205
    v_and_b32 v205, 0xffff0000, v205
    v_lshlrev_b32 v78, 16, v206
    v_and_b32 v206, 0xffff0000, v206
    v_lshlrev_b32 v79, 16, v207
    v_and_b32 v207, 0xffff0000, v207
    s_waitcnt lgkmcnt(8)
    v_pk_mul_f32 v[204:205], v[204:205], v[38:39] op_sel_hi:[1,0]
    v_pk_mul_f32 v[206:207], v[206:207], v[38:39] op_sel:[0,1] op_sel_hi:[1,1]
    v_pk_mul_f32 v[76:77], v[76:77], v[38:39] op_sel_hi:[1,0]
    v_pk_mul_f32 v[78:79], v[78:79], v[38:39] op_sel:[0,1] op_sel_hi:[1,1]
    v_cvt_pk_bf16_f32 v204, v76, v204
    v_cvt_pk_bf16_f32 v205, v77, v205
    v_cvt_pk_bf16_f32 v206, v78, v206
    buffer_load_dwordx4 a[196:199], v29, s[48:51], s99 offen offset:1024 sc1
    v_cvt_pk_bf16_f32 v207, v79, v207
    ds_read_b32 v32, v12 offset:0
    ds_read_b32 v33, v13 offset:0
    ds_read_b32 v34, v12 offset:512
    ds_read_b32 v35, v13 offset:512
    ds_read_b32 v36, v12 offset:1024
    ds_read_b32 v37, v13 offset:1024
    ds_read_b32 v38, v12 offset:1536
    ds_read_b32 v39, v13 offset:1536
    s_waitcnt vmcnt(11)
    s_mov_b64 exec, 1
    buffer_store_dword v31, off, s[48:51], s7 sc1
    s_mov_b64 exec, -1
    v_lshlrev_b32 v64, 16, v208
    v_and_b32 v208, 0xffff0000, v208
    v_lshlrev_b32 v65, 16, v209
    v_and_b32 v209, 0xffff0000, v209
    v_lshlrev_b32 v66, 16, v210
    v_and_b32 v210, 0xffff0000, v210
    v_lshlrev_b32 v67, 16, v211
    s_waitcnt vmcnt(10)
    v_cmp_eq_u32 vcc, -1, v19
    s_nop 1
    s_cbranch_vccnz Lslow_42
Lback_43:
    buffer_load_dwordx4 a[236:239], v29, s[48:51], s82 offen offset:0 sc1
    v_and_b32 v211, 0xffff0000, v211
    s_waitcnt lgkmcnt(14)
    v_pk_mul_f32 v[208:209], v[208:209], v[40:41] op_sel_hi:[1,0]
    v_pk_mul_f32 v[210:211], v[210:211], v[40:41] op_sel:[0,1] op_sel_hi:[1,1]
    v_pk_mul_f32 v[64:65], v[64:65], v[40:41] op_sel_hi:[1,0]
    v_pk_mul_f32 v[66:67], v[66:67], v[40:41] op_sel:[0,1] op_sel_hi:[1,1]
    v_cvt_pk_bf16_f32 v208, v64, v208
    v_cvt_pk_bf16_f32 v209, v65, v209
    v_cvt_pk_bf16_f32 v210, v66, v210
    v_cvt_pk_bf16_f32 v211, v67, v211
    v_lshlrev_b32 v68, 16, v212
    v_and_b32 v212, 0xffff0000, v212
    v_lshlrev_b32 v69, 16, v213
    buffer_load_dwordx4 a[240:243], v29, s[48:51], s82 offen offset:1024 sc1
    v_and_b32 v213, 0xffff0000, v213
    v_lshlrev_b32 v70, 16, v214
    v_and_b32 v214, 0xffff0000, v214
    v_lshlrev_b32 v71, 16, v215
    v_and_b32 v215, 0xffff0000, v215
    s_waitcnt lgkmcnt(12)
    v_pk_mul_f32 v[212:213], v[212:213], v[42:43] op_sel_hi:[1,0]
    v_pk_mul_f32 v[214:215], v[214:215], v[42:43] op_sel:[0,1] op_sel_hi:[1,1]
    v_pk_mul_f32 v[68:69], v[68:69], v[42:43] op_sel_hi:[1,0]
    v_pk_mul_f32 v[70:71], v[70:71], v[42:43] op_sel:[0,1] op_sel_hi:[1,1]
    v_cvt_pk_bf16_f32 v212, v68, v212
    v_cvt_pk_bf16_f32 v213, v69, v213
    v_cvt_pk_bf16_f32 v214, v70, v214
    buffer_load_dwordx4 a[244:247], v29, s[48:51], s82 offen offset:2048 sc1
    v_cvt_pk_bf16_f32 v215, v71, v215
    v_lshlrev_b32 v72, 16, v216
    v_and_b32 v216, 0xffff0000, v216
    v_lshlrev_b32 v73, 16, v217
    v_and_b32 v217, 0xffff0000, v217
    v_lshlrev_b32 v74, 16, v218
    v_and_b32 v218, 0xffff0000, v218
    v_lshlrev_b32 v75, 16, v219
    v_and_b32 v219, 0xffff0000, v219
    s_waitcnt lgkmcnt(10)
    v_pk_mul_f32 v[216:217], v[216:217], v[44:45] op_sel_hi:[1,0]
    v_pk_mul_f32 v[218:219], v[218:219], v[44:45] op_sel:[0,1] op_sel_hi:[1,1]
    v_pk_mul_f32 v[72:73], v[72:73], v[44:45] op_sel_hi:[1,0]
    v_pk_mul_f32 v[74:75], v[74:75], v[44:45] op_sel:[0,1] op_sel_hi:[1,1]
    buffer_load_dwordx4 a[248:251], v29, s[48:51], s82 offen offset:3072 sc1
    v_cvt_pk_bf16_f32 v216, v72, v216
    v_cvt_pk_bf16_f32 v217, v73, v217
    v_cvt_pk_bf16_f32 v218, v74, v218
    v_cvt_pk_bf16_f32 v219, v75, v219
    v_lshlrev_b32 v76, 16, v220
    v_and_b32 v220, 0xffff0000, v220
    v_lshlrev_b32 v77, 16, v221
    v_and_b32 v221, 0xffff0000, v221
    v_lshlrev_b32 v78, 16, v222
    v_and_b32 v222, 0xffff0000, v222
    v_lshlrev_b32 v79, 16, v223
    v_and_b32 v223, 0xffff0000, v223
    s_waitcnt lgkmcnt(8)
    v_pk_mul_f32 v[220:221], v[220:221], v[46:47] op_sel_hi:[1,0]
    v_pk_mul_f32 v[222:223], v[222:223], v[46:47] op_sel:[0,1] op_sel_hi:[1,1]
    buffer_load_dwordx4 a[252:255], v30, s[48:51], s82 offen offset:0 sc1
    v_pk_mul_f32 v[76:77], v[76:77], v[46:47] op_sel_hi:[1,0]
    v_pk_mul_f32 v[78:79], v[78:79], v[46:47] op_sel:[0,1] op_sel_hi:[1,1]
    v_cvt_pk_bf16_f32 v220, v76, v220
    v_cvt_pk_bf16_f32 v221, v77, v221
    v_cvt_pk_bf16_f32 v222, v78, v222
    v_cvt_pk_bf16_f32 v223, v79, v223
    ds_read_b32 v40, v14 offset:0
    ds_read_b32 v41, v15 offset:0
    ds_read_b32 v42, v14 offset:512
    ds_read_b32 v43, v15 offset:512
    ds_read_b32 v44, v14 offset:1024
    ds_read_b32 v45, v15 offset:1024
    ds_read_b32 v46, v14 offset:1536
    ds_read_b32 v47, v15 offset:1536
    v_lshlrev_b32 v64, 16, v224
    buffer_load_dwordx4 a[0:3], v29, s[48:51], s83 offen offset:0 sc1
    v_and_b32 v224, 0xffff0000, v224
    v_lshlrev_b32 v65, 16, v225
    v_and_b32 v225, 0xffff0000, v225
    v_lshlrev_b32 v66, 16, v226
    v_and_b32 v226, 0xffff0000, v226
    v_lshlrev_b32 v67, 16, v227
    v_and_b32 v227, 0xffff0000, v227
    s_waitcnt lgkmcnt(14)
    v_pk_mul_f32 v[224:225], v[224:225], v[32:33] op_sel_hi:[1,0]
    v_pk_mul_f32 v[226:227], v[226:227], v[32:33] op_sel:[0,1] op_sel_hi:[1,1]
    v_pk_mul_f32 v[64:65], v[64:65], v[32:33] op_sel_hi:[1,0]
    v_pk_mul_f32 v[66:67], v[66:67], v[32:33] op_sel:[0,1] op_sel_hi:[1,1]
    v_cvt_pk_bf16_f32 v224, v64, v224
    buffer_load_dwordx4 a[4:7], v29, s[48:51], s83 offen offset:1024 sc1
    v_cvt_pk_bf16_f32 v225, v65, v225
    v_cvt_pk_bf16_f32 v226, v66, v226
    v_cvt_pk_bf16_f32 v227, v67, v227
    v_lshlrev_b32 v68, 16, v228
    v_and_b32 v228, 0xffff0000, v228
    v_lshlrev_b32 v69, 16, v229
    v_and_b32 v229, 0xffff0000, v229
    v_lshlrev_b32 v70, 16, v230
    v_and_b32 v230, 0xffff0000, v230
    v_lshlrev_b32 v71, 16, v231
    v_and_b32 v231, 0xffff0000, v231
    s_waitcnt lgkmcnt(12)
    v_pk_mul_f32 v[228:229], v[228:229], v[34:35] op_sel_hi:[1,0]
    buffer_load_dwordx4 a[8:11], v29, s[48:51], s83 offen offset:2048 sc1
    v_pk_mul_f32 v[230:231], v[230:231], v[34:35] op_sel:[0,1] op_sel_hi:[1,1]
    v_pk_mul_f32 v[68:69], v[68:69], v[34:35] op_sel_hi:[1,0]
    v_pk_mul_f32 v[70:71], v[70:71], v[34:35] op_sel:[0,1] op_sel_hi:[1,1]
    v_cvt_pk_bf16_f32 v228, v68, v228
    v_cvt_pk_bf16_f32 v229, v69, v229
    v_cvt_pk_bf16_f32 v230, v70, v230
    v_cvt_pk_bf16_f32 v231, v71, v231
    v_lshlrev_b32 v72, 16, v232
    v_and_b32 v232, 0xffff0000, v232
    v_lshlrev_b32 v73, 16, v233
    v_and_b32 v233, 0xffff0000, v233
    v_lshlrev_b32 v74, 16, v234
    v_and_b32 v234, 0xffff0000, v234
    v_lshlrev_b32 v75, 16, v235
    v_and_b32 v235, 0xffff0000, v235
    buffer_load_dwordx4 a[12:15], v29, s[48:51], s83 offen offset:3072 sc1
    s_waitcnt lgkmcnt(10)
    v_pk_mul_f32 v[232:233], v[232:233], v[36:37] op_sel_hi:[1,0]
    v_pk_mul_f32 v[234:235], v[234:235], v[36:37] op_sel:[0,1] op_sel_hi:[1,1]
    v_pk_mul_f32 v[72:73], v[72:73], v[36:37] op_sel_hi:[1,0]
    v_pk_mul_f32 v[74:75], v[74:75], v[36:37] op_sel:[0,1] op_sel_hi:[1,1]
    v_cvt_pk_bf16_f32 v232, v72, v232
    v_cvt_pk_bf16_f32 v233, v73, v233
    v_cvt_pk_bf16_f32 v234, v74, v234
    v_cvt_pk_bf16_f32 v235, v75, v235
    v_lshlrev_b32 v76, 16, v236
    v_and_b32 v236, 0xffff0000, v236
    v_lshlrev_b32 v77, 16, v237
    v_and_b32 v237, 0xffff0000, v237
    v_lshlrev_b32 v78, 16, v238
    v_and_b32 v238, 0xffff0000, v238
    buffer_load_dwordx4 a[16:19], v30, s[48:51], s83 offen offset:0 sc1
    v_lshlrev_b32 v79, 16, v239
    v_and_b32 v239, 0xffff0000, v239
    s_waitcnt lgkmcnt(8)
    v_pk_mul_f32 v[236:237], v[236:237], v[38:39] op_sel_hi:[1,0]
    v_pk_mul_f32 v[238:239], v[238:239], v[38:39] op_sel:[0,1] op_sel_hi:[1,1]
    v_pk_mul_f32 v[76:77], v[76:77], v[38:39] op_sel_hi:[1,0]
    v_pk_mul_f32 v[78:79], v[78:79], v[38:39] op_sel:[0,1] op_sel_hi:[1,1]
    v_cvt_pk_bf16_f32 v236, v76, v236
    v_cvt_pk_bf16_f32 v237, v77, v237
    v_cvt_pk_bf16_f32 v238, v78, v238
    v_cvt_pk_bf16_f32 v239, v79, v239
    ds_read_b32 v32, v1 offset:0
    ds_read_b32 v33, v3 offset:0
    ds_read_b32 v34, v1 offset:512
    ds_read_b32 v35, v3 offset:512
    ds_read_b32 v36, v1 offset:1024
    ds_read_b32 v37, v3 offset:1024
    ds_read_b32 v38, v1 offset:1536
    ds_read_b32 v39, v3 offset:1536
    s_waitcnt vmcnt(7)
    v_mfma_f32_16x16x32_bf16 v[80:83], a[236:239], v[192:195], 0
    buffer_load_dwordx4 a[20:23], v29, s[48:51], s84 offen offset:0 sc1
    v_mfma_f32_16x16x32_bf16 v[100:103], a[236:239], v[196:199], 0
    v_mfma_f32_16x16x32_bf16 v[120:123], a[236:239], v[200:203], 0
    v_mfma_f32_16x16x32_bf16 v[140:143], a[236:239], v[204:207], 0
    v_mfma_f32_16x16x32_bf16 v[84:87], a[240:243], v[192:195], 0
    buffer_load_dwordx4 a[24:27], v29, s[48:51], s84 offen offset:1024 sc1
    v_mfma_f32_16x16x32_bf16 v[104:107], a[240:243], v[196:199], 0
    v_mfma_f32_16x16x32_bf16 v[124:127], a[240:243], v[200:203], 0
    v_mfma_f32_16x16x32_bf16 v[144:147], a[240:243], v[204:207], 0
    v_mfma_f32_16x16x32_bf16 v[88:91], a[244:247], v[192:195], 0
    buffer_load_dwordx4 a[28:31], v29, s[48:51], s84 offen offset:2048 sc1
    v_mfma_f32_16x16x32_bf16 v[108:111], a[244:247], v[196:199], 0
    v_mfma_f32_16x16x32_bf16 v[128:131], a[244:247], v[200:203], 0
    v_mfma_f32_16x16x32_bf16 v[148:151], a[244:247], v[204:207], 0
    s_waitcnt vmcnt(8)
    v_mfma_f32_16x16x32_bf16 v[92:95], a[248:251], v[192:195], 0
    buffer_load_dwordx4 a[32:35], v29, s[48:51], s84 offen offset:3072 sc1
    v_mfma_f32_16x16x32_bf16 v[112:115], a[248:251], v[196:199], 0
    v_mfma_f32_16x16x32_bf16 v[132:135], a[248:251], v[200:203], 0
    v_mfma_f32_16x16x32_bf16 v[152:155], a[248:251], v[204:207], 0
    v_mfma_f32_16x16x32_bf16 v[96:99], a[252:255], v[192:195], 0
    buffer_load_dwordx4 a[36:39], v30, s[48:51], s84 offen offset:0 sc1
    v_mfma_f32_16x16x32_bf16 v[116:119], a[252:255], v[196:199], 0
    v_mfma_f32_16x16x32_bf16 v[136:139], a[252:255], v[200:203], 0
    v_mfma_f32_16x16x32_bf16 v[156:159], a[252:255], v[204:207], 0
    v_lshlrev_b32 v64, 16, v240
    v_and_b32 v240, 0xffff0000, v240
    v_lshlrev_b32 v65, 16, v241
    buffer_load_dwordx4 a[40:43], v29, s[48:51], s85 offen offset:0 sc1
    v_and_b32 v241, 0xffff0000, v241
    v_lshlrev_b32 v66, 16, v242
    v_and_b32 v242, 0xffff0000, v242
    v_lshlrev_b32 v67, 16, v243
    v_and_b32 v243, 0xffff0000, v243
    s_waitcnt lgkmcnt(14)
    v_pk_mul_f32 v[240:241], v[240:241], v[40:41] op_sel_hi:[1,0]
    v_pk_mul_f32 v[242:243], v[242:243], v[40:41] op_sel:[0,1] op_sel_hi:[1,1]
    v_pk_mul_f32 v[64:65], v[64:65], v[40:41] op_sel_hi:[1,0]
    v_pk_mul_f32 v[66:67], v[66:67], v[40:41] op_sel:[0,1] op_sel_hi:[1,1]
    v_cvt_pk_bf16_f32 v240, v64, v240
    v_cvt_pk_bf16_f32 v241, v65, v241
    v_cvt_pk_bf16_f32 v242, v66, v242
    v_cvt_pk_bf16_f32 v243, v67, v243
    v_lshlrev_b32 v68, 16, v244
    buffer_load_dwordx4 a[44:47], v29, s[48:51], s85 offen offset:1024 sc1
    v_and_b32 v244, 0xffff0000, v244
    v_lshlrev_b32 v69, 16, v245
    v_and_b32 v245, 0xffff0000, v245
    v_lshlrev_b32 v70, 16, v246
    v_and_b32 v246, 0xffff0000, v246
    v_lshlrev_b32 v71, 16, v247
    v_and_b32 v247, 0xffff0000, v247
    s_waitcnt lgkmcnt(12)
    v_pk_mul_f32 v[244:245], v[244:245], v[42:43] op_sel_hi:[1,0]
    v_pk_mul_f32 v[246:247], v[246:247], v[42:43] op_sel:[0,1] op_sel_hi:[1,1]
    v_pk_mul_f32 v[68:69], v[68:69], v[42:43] op_sel_hi:[1,0]
    v_pk_mul_f32 v[70:71], v[70:71], v[42:43] op_sel:[0,1] op_sel_hi:[1,1]
    v_cvt_pk_bf16_f32 v244, v68, v244
    v_cvt_pk_bf16_f32 v245, v69, v245
    v_cvt_pk_bf16_f32 v246, v70, v246
    buffer_load_dwordx4 a[48:51], v29, s[48:51], s85 offen offset:2048 sc1
    v_cvt_pk_bf16_f32 v247, v71, v247
    v_lshlrev_b32 v72, 16, v248
    v_and_b32 v248, 0xffff0000, v248
    v_lshlrev_b32 v73, 16, v249
    v_and_b32 v249, 0xffff0000, v249
    v_lshlrev_b32 v74, 16, v250
    v_and_b32 v250, 0xffff0000, v250
    v_lshlrev_b32 v75, 16, v251
    v_and_b32 v251, 0xffff0000, v251
    s_waitcnt lgkmcnt(10)
    v_pk_mul_f32 v[248:249], v[248:249], v[44:45] op_sel_hi:[1,0]
    v_pk_mul_f32 v[250:251], v[250:251], v[44:45] op_sel:[0,1] op_sel_hi:[1,1]
    v_pk_mul_f32 v[72:73], v[72:73], v[44:45] op_sel_hi:[1,0]
    v_pk_mul_f32 v[74:75], v[74:75], v[44:45] op_sel:[0,1] op_sel_hi:[1,1]
    v_cvt_pk_bf16_f32 v248, v72, v248
    buffer_load_dwordx4 a[52:55], v29, s[48:51], s85 offen offset:3072 sc1
    v_cvt_pk_bf16_f32 v249, v73, v249
    v_cvt_pk_bf16_f32 v250, v74, v250
    v_cvt_pk_bf16_f32 v251, v75, v251
    v_lshlrev_b32 v76, 16, v252
    v_and_b32 v252, 0xffff0000, v252
    v_lshlrev_b32 v77, 16, v253
    v_and_b32 v253, 0xffff0000, v253
    v_lshlrev_b32 v78, 16, v254
    v_and_b32 v254, 0xffff0000, v254
    v_lshlrev_b32 v79, 16, v255
    v_and_b32 v255, 0xffff0000, v255
    s_waitcnt lgkmcnt(8)
    v_pk_mul_f32 v[252:253], v[252:253], v[46:47] op_sel_hi:[1,0]
    v_pk_mul_f32 v[254:255], v[254:255], v[46:47] op_sel:[0,1] op_sel_hi:[1,1]
    v_pk_mul_f32 v[76:77], v[76:77], v[46:47] op_sel_hi:[1,0]
    buffer_load_dwordx4 a[56:59], v30, s[48:51], s85 offen offset:0 sc1
    v_pk_mul_f32 v[78:79], v[78:79], v[46:47] op_sel:[0,1] op_sel_hi:[1,1]
    v_cvt_pk_bf16_f32 v252, v76, v252
    v_cvt_pk_bf16_f32 v253, v77, v253
    v_cvt_pk_bf16_f32 v254, v78, v254
    v_cvt_pk_bf16_f32 v255, v79, v255
    s_waitcnt vmcnt(12)
    v_mfma_f32_16x16x32_bf16 v[80:83], a[0:3], v[208:211], v[80:83]
    v_mfma_f32_16x16x32_bf16 v[100:103], a[0:3], v[212:215], v[100:103]
    v_mfma_f32_16x16x32_bf16 v[120:123], a[0:3], v[216:219], v[120:123]
    buffer_load_dwordx4 a[60:63], v29, s[48:51], s86 offen offset:0 sc1
    v_mfma_f32_16x16x32_bf16 v[140:143], a[0:3], v[220:223], v[140:143]
    v_mfma_f32_16x16x32_bf16 v[84:87], a[4:7], v[208:211], v[84:87]
    v_mfma_f32_16x16x32_bf16 v[104:107], a[4:7], v[212:215], v[104:107]
    v_mfma_f32_16x16x32_bf16 v[124:127], a[4:7], v[216:219], v[124:127]
    buffer_load_dwordx4 a[64:67], v29, s[48:51], s86 offen offset:1024 sc1
    v_mfma_f32_16x16x32_bf16 v[144:147], a[4:7], v[220:223], v[144:147]
    v_mfma_f32_16x16x32_bf16 v[88:91], a[8:11], v[208:211], v[88:91]
    v_mfma_f32_16x16x32_bf16 v[108:111], a[8:11], v[212:215], v[108:111]
    v_mfma_f32_16x16x32_bf16 v[128:131], a[8:11], v[216:219], v[128:131]
    v_mfma_f32_16x16x32_bf16 v[148:151], a[8:11], v[220:223], v[148:151]
    buffer_load_dwordx4 a[68:71], v29, s[48:51], s86 offen offset:2048 sc1
    s_waitcnt vmcnt(13)
    v_mfma_f32_16x16x32_bf16 v[92:95], a[12:15], v[208:211], v[92:95]
    v_mfma_f32_16x16x32_bf16 v[112:115], a[12:15], v[212:215], v[112:115]
    v_mfma_f32_16x16x32_bf16 v[132:135], a[12:15], v[216:219], v[132:135]
    v_mfma_f32_16x16x32_bf16 v[152:155], a[12:15], v[220:223], v[152:155]
    buffer_load_dwordx4 a[72:75], v29, s[48:51], s86 offen offset:3072 sc1
    v_mfma_f32_16x16x32_bf16 v[96:99], a[16:19], v[208:211], v[96:99]
    v_mfma_f32_16x16x32_bf16 v[116:119], a[16:19], v[212:215], v[116:119]
    v_mfma_f32_16x16x32_bf16 v[136:139], a[16:19], v[216:219], v[136:139]
    v_mfma_f32_16x16x32_bf16 v[156:159], a[16:19], v[220:223], v[156:159]
    buffer_load_dword v19, v18, s[48:51], 0 offen sc1
    v_lshlrev_b32 v64, 16, v160
    v_and_b32 v160, 0xffff0000, v160
    v_lshlrev_b32 v65, 16, v161
    v_and_b32 v161, 0xffff0000, v161
    buffer_load_dwordx4 a[76:79], v30, s[48:51], s86 offen offset:0 sc1
    v_lshlrev_b32 v66, 16, v162
    v_and_b32 v162, 0xffff0000, v162
    v_lshlrev_b32 v67, 16, v163
    v_and_b32 v163, 0xffff0000, v163
    s_waitcnt lgkmcnt(6)
    v_pk_mul_f32 v[160:161], v[160:161], v[32:33] op_sel_hi:[1,0]
    v_pk_mul_f32 v[162:163], v[162:163], v[32:33] op_sel:[0,1] op_sel_hi:[1,1]
    v_pk_mul_f32 v[64:65], v[64:65], v[32:33] op_sel_hi:[1,0]
    v_pk_mul_f32 v[66:67], v[66:67], v[32:33] op_sel:[0,1] op_sel_hi:[1,1]
    v_cvt_pk_bf16_f32 v160, v64, v160
    v_cvt_pk_bf16_f32 v161, v65, v161
    v_cvt_pk_bf16_f32 v162, v66, v162
    v_cvt_pk_bf16_f32 v163, v67, v163
    buffer_load_dwordx4 a[200:203], v29, s[48:51], s99 offen offset:2048 sc1
    v_lshlrev_b32 v68, 16, v164
    v_and_b32 v164, 0xffff0000, v164
    v_lshlrev_b32 v69, 16, v165
    v_and_b32 v165, 0xffff0000, v165
    v_lshlrev_b32 v70, 16, v166
    v_and_b32 v166, 0xffff0000, v166
    v_lshlrev_b32 v71, 16, v167
    v_and_b32 v167, 0xffff0000, v167
    s_waitcnt lgkmcnt(4)
    v_pk_mul_f32 v[164:165], v[164:165], v[34:35] op_sel_hi:[1,0]
    v_pk_mul_f32 v[166:167], v[166:167], v[34:35] op_sel:[0,1] op_sel_hi:[1,1]
    v_pk_mul_f32 v[68:69], v[68:69], v[34:35] op_sel_hi:[1,0]
    v_pk_mul_f32 v[70:71], v[70:71], v[34:35] op_sel:[0,1] op_sel_hi:[1,1]
    v_cvt_pk_bf16_f32 v164, v68, v164
    v_cvt_pk_bf16_f32 v165, v69, v165
    buffer_load_dwordx4 a[204:207], v29, s[48:51], s99 offen offset:3072 sc1
    v_cvt_pk_bf16_f32 v166, v70, v166
    v_cvt_pk_bf16_f32 v167, v71, v167
    v_lshlrev_b32 v72, 16, v168
    v_and_b32 v168, 0xffff0000, v168
    v_lshlrev_b32 v73, 16, v169
    v_and_b32 v169, 0xffff0000, v169
    v_lshlrev_b32 v74, 16, v170
    v_and_b32 v170, 0xffff0000, v170
    v_lshlrev_b32 v75, 16, v171
    v_and_b32 v171, 0xffff0000, v171
    s_waitcnt lgkmcnt(2)
    v_pk_mul_f32 v[168:169], v[168:169], v[36:37] op_sel_hi:[1,0]
    v_pk_mul_f32 v[170:171], v[170:171], v[36:37] op_sel:[0,1] op_sel_hi:[1,1]
    v_pk_mul_f32 v[72:73], v[72:73], v[36:37] op_sel_hi:[1,0]
    v_pk_mul_f32 v[74:75], v[74:75], v[36:37] op_sel:[0,1] op_sel_hi:[1,1]
    s_add_u32 s99, s99, 4096
    buffer_load_dwordx4 a[208:211], v29, s[48:51], s99 offen offset:0 sc1
    v_cvt_pk_bf16_f32 v168, v72, v168
    v_cvt_pk_bf16_f32 v169, v73, v169
    v_cvt_pk_bf16_f32 v170, v74, v170
    v_cvt_pk_bf16_f32 v171, v75, v171
    v_lshlrev_b32 v76, 16, v172
    v_and_b32 v172, 0xffff0000, v172
    v_lshlrev_b32 v77, 16, v173
    v_and_b32 v173, 0xffff0000, v173
    v_lshlrev_b32 v78, 16, v174
    v_and_b32 v174, 0xffff0000, v174
    v_lshlrev_b32 v79, 16, v175
    v_and_b32 v175, 0xffff0000, v175
    s_waitcnt lgkmcnt(0)
    v_pk_mul_f32 v[172:173], v[172:173], v[38:39] op_sel_hi:[1,0]
    buffer_load_dwordx4 a[212:215], v29, s[48:51], s99 offen offset:1024 sc1
    v_pk_mul_f32 v[174:175], v[174:175], v[38:39] op_sel:[0,1] op_sel_hi:[1,1]
    v_pk_mul_f32 v[76:77], v[76:77], v[38:39] op_sel_hi:[1,0]
    v_pk_mul_f32 v[78:79], v[78:79], v[38:39] op_sel:[0,1] op_sel_hi:[1,1]
    v_cvt_pk_bf16_f32 v172, v76, v172
    v_cvt_pk_bf16_f32 v173, v77, v173
    v_cvt_pk_bf16_f32 v174, v78, v174
    v_cvt_pk_bf16_f32 v175, v79, v175
    s_waitcnt vmcnt(17)
    v_mfma_f32_16x16x32_bf16 v[80:83], a[20:23], v[224:227], v[80:83]
    v_mfma_f32_16x16x32_bf16 v[100:103], a[20:23], v[228:231], v[100:103]
    v_mfma_f32_16x16x32_bf16 v[120:123], a[20:23], v[232:235], v[120:123]
    buffer_load_dwordx4 a[216:219], v22, s[48:51], s99 offen offset:2048 sc1
    v_mfma_f32_16x16x32_bf16 v[140:143], a[20:23], v[236:239], v[140:143]
    v_mfma_f32_16x16x32_bf16 v[84:87], a[24:27], v[224:227], v[84:87]
    v_mfma_f32_16x16x32_bf16 v[104:107], a[24:27], v[228:231], v[104:107]
    v_mfma_f32_16x16x32_bf16 v[124:127], a[24:27], v[232:235], v[124:127]
    buffer_load_dwordx4 a[220:223], v22, s[48:51], s99 offen offset:3072 sc1
    v_mfma_f32_16x16x32_bf16 v[144:147], a[24:27], v[236:239], v[144:147]
    v_mfma_f32_16x16x32_bf16 v[88:91], a[28:31], v[224:227], v[88:91]
    v_mfma_f32_16x16x32_bf16 v[108:111], a[28:31], v[228:231], v[108:111]
    v_mfma_f32_16x16x32_bf16 v[128:131], a[28:31], v[232:235], v[128:131]
    s_add_u32 s99, s99, 4096
    buffer_load_dwordx4 a[224:227], v22, s[48:51], s99 offen offset:0 sc1
    v_mfma_f32_16x16x32_bf16 v[148:151], a[28:31], v[236:239], v[148:151]
    s_waitcnt vmcnt(18)
    v_mfma_f32_16x16x32_bf16 v[92:95], a[32:35], v[224:227], v[92:95]
    v_mfma_f32_16x16x32_bf16 v[112:115], a[32:35], v[228:231], v[112:115]
    v_mfma_f32_16x16x32_bf16 v[132:135], a[32:35], v[232:235], v[132:135]
    buffer_load_dwordx4 a[228:231], v22, s[48:51], s99 offen offset:1024 sc1
    v_mfma_f32_16x16x32_bf16 v[152:155], a[32:35], v[236:239], v[152:155]
    v_mfma_f32_16x16x32_bf16 v[96:99], a[36:39], v[224:227], v[96:99]
    v_mfma_f32_16x16x32_bf16 v[116:119], a[36:39], v[228:231], v[116:119]
    v_mfma_f32_16x16x32_bf16 v[136:139], a[36:39], v[232:235], v[136:139]
    buffer_load_dwordx4 a[232:235], v22, s[48:51], s99 offen offset:2048 sc1
    v_mfma_f32_16x16x32_bf16 v[156:159], a[36:39], v[236:239], v[156:159]
    s_waitcnt vmcnt(17)
    v_mfma_f32_16x16x32_bf16 v[80:83], a[40:43], v[240:243], v[80:83]
    v_mfma_f32_16x16x32_bf16 v[100:103], a[40:43], v[244:247], v[100:103]
    v_mfma_f32_16x16x32_bf16 v[120:123], a[40:43], v[248:251], v[120:123]
    v_mfma_f32_16x16x32_bf16 v[140:143], a[40:43], v[252:255], v[140:143]
    s_waitcnt vmcnt(10)
    v_cmp_eq_u32 vcc, -1, v19
    s_nop 1
    s_cbranch_vccnz Lslow_44
Lback_45:
    s_add_u32 s63, s63, s6
    buffer_load_dwordx4 a[80:83], v29, s[48:51], s63 offen offset:0 sc1
    v_mfma_f32_16x16x32_bf16 v[84:87], a[44:47], v[240:243], v[84:87]
    v_mfma_f32_16x16x32_bf16 v[104:107], a[44:47], v[244:247], v[104:107]
    v_mfma_f32_16x16x32_bf16 v[124:127], a[44:47], v[248:251], v[124:127]
    v_mfma_f32_16x16x32_bf16 v[144:147], a[44:47], v[252:255], v[144:147]
    buffer_load_dwordx4 a[84:87], v29, s[48:51], s63 offen offset:1024 sc1
    v_mfma_f32_16x16x32_bf16 v[88:91], a[48:51], v[240:243], v[88:91]
    v_mfma_f32_16x16x32_bf16 v[108:111], a[48:51], v[244:247], v[108:111]
    v_mfma_f32_16x16x32_bf16 v[128:131], a[48:51], v[248:251], v[128:131]
    v_mfma_f32_16x16x32_bf16 v[148:151], a[48:51], v[252:255], v[148:151]
    buffer_load_dwordx4 a[88:91], v29, s[48:51], s63 offen offset:2048 sc1
    v_mfma_f32_16x16x32_bf16 v[92:95], a[52:55], v[240:243], v[92:95]
    v_mfma_f32_16x16x32_bf16 v[112:115], a[52:55], v[244:247], v[112:115]
    v_mfma_f32_16x16x32_bf16 v[132:135], a[52:55], v[248:251], v[132:135]
    v_mfma_f32_16x16x32_bf16 v[152:155], a[52:55], v[252:255], v[152:155]
    buffer_load_dwordx4 a[92:95], v29, s[48:51], s63 offen offset:3072 sc1
    v_mfma_f32_16x16x32_bf16 v[96:99], a[56:59], v[240:243], v[96:99]
    v_mfma_f32_16x16x32_bf16 v[116:119], a[56:59], v[244:247], v[116:119]
    v_mfma_f32_16x16x32_bf16 v[136:139], a[56:59], v[248:251], v[136:139]
    v_mfma_f32_16x16x32_bf16 v[156:159], a[56:59], v[252:255], v[156:159]
    buffer_load_dwordx4 v[176:179], v30, s[48:51], s63 offen offset:0 sc1
    v_mfma_f32_16x16x32_bf16 v[80:83], a[60:63], v[160:163], v[80:83]
    v_mfma_f32_16x16x32_bf16 v[100:103], a[60:63], v[164:167], v[100:103]
    v_mfma_f32_16x16x32_bf16 v[120:123], a[60:63], v[168:171], v[120:123]
    v_mfma_f32_16x16x32_bf16 v[140:143], a[60:63], v[172:175], v[140:143]
    buffer_load_dwordx4 v[180:183], v30, s[48:51], s63 offen offset:1024 sc1
    v_mfma_f32_16x16x32_bf16 v[84:87], a[64:67], v[160:163], v[84:87]
    v_mfma_f32_16x16x32_bf16 v[104:107], a[64:67], v[164:167], v[104:107]
    v_mfma_f32_16x16x32_bf16 v[124:127], a[64:67], v[168:171], v[124:127]
    v_mfma_f32_16x16x32_bf16 v[144:147], a[64:67], v[172:175], v[144:147]
    buffer_load_dwordx4 v[184:187], v16, s[48:51], s63 offen offset:2048 sc1
    v_mfma_f32_16x16x32_bf16 v[88:91], a[68:71], v[160:163], v[88:91]
    v_mfma_f32_16x16x32_bf16 v[108:111], a[68:71], v[164:167], v[108:111]
    v_mfma_f32_16x16x32_bf16 v[128:131], a[68:71], v[168:171], v[128:131]
    v_mfma_f32_16x16x32_bf16 v[148:151], a[68:71], v[172:175], v[148:151]
    s_waitcnt vmcnt(16)
    v_mfma_f32_16x16x32_bf16 v[92:95], a[72:75], v[160:163], v[92:95]
    s_add_u32 s64, s64, s6
    buffer_load_dwordx4 v[188:191], v29, s[48:51], s64 offen offset:0 sc1
    v_mfma_f32_16x16x32_bf16 v[112:115], a[72:75], v[164:167], v[112:115]
    v_mfma_f32_16x16x32_bf16 v[132:135], a[72:75], v[168:171], v[132:135]
    v_mfma_f32_16x16x32_bf16 v[152:155], a[72:75], v[172:175], v[152:155]
    v_mfma_f32_16x16x32_bf16 v[96:99], a[76:79], v[160:163], v[96:99]
    buffer_load_dwordx4 v[48:51], v29, s[48:51], s64 offen offset:1024 sc1
    v_mfma_f32_16x16x32_bf16 v[116:119], a[76:79], v[164:167], v[116:119]
    v_mfma_f32_16x16x32_bf16 v[136:139], a[76:79], v[168:171], v[136:139]
    v_mfma_f32_16x16x32_bf16 v[156:159], a[76:79], v[172:175], v[156:159]
    s_waitcnt vmcnt(8)
    v_mfma_f32_16x16x32_bf16 v[96:99], a[112:115], a[80:83], v[96:99]
    buffer_load_dwordx4 v[52:55], v29, s[48:51], s64 offen offset:2048 sc1
    v_mfma_f32_16x16x32_bf16 v[80:83], a[96:99], a[80:83], v[80:83]
    v_mfma_f32_16x16x32_bf16 v[84:87], a[100:103], a[80:83], v[84:87]
    v_mfma_f32_16x16x32_bf16 v[88:91], a[104:107], a[80:83], v[88:91]
    v_mfma_f32_16x16x32_bf16 v[92:95], a[108:111], a[80:83], v[92:95]
    buffer_load_dwordx4 v[56:59], v29, s[48:51], s64 offen offset:3072 sc1
    s_waitcnt vmcnt(9)
    v_mfma_f32_16x16x32_bf16 v[96:99], a[132:135], a[84:87], v[96:99]
    v_mfma_f32_16x16x32_bf16 v[80:83], a[116:119], a[84:87], v[80:83]
    v_mfma_f32_16x16x32_bf16 v[84:87], a[120:123], a[84:87], v[84:87]
    v_mfma_f32_16x16x32_bf16 v[88:91], a[124:127], a[84:87], v[88:91]
    buffer_load_dwordx4 v[60:63], v30, s[48:51], s64 offen offset:0 sc1
    v_mfma_f32_16x16x32_bf16 v[92:95], a[128:131], a[84:87], v[92:95]
    s_waitcnt vmcnt(9)
    v_mfma_f32_16x16x32_bf16 v[96:99], a[152:155], a[88:91], v[96:99]
    v_mfma_f32_16x16x32_bf16 v[80:83], a[136:139], a[88:91], v[80:83]
    v_mfma_f32_16x16x32_bf16 v[84:87], a[140:143], a[88:91], v[84:87]
    buffer_load_dwordx4 v[64:67], v30, s[48:51], s64 offen offset:1024 sc1
    v_mfma_f32_16x16x32_bf16 v[88:91], a[144:147], a[88:91], v[88:91]
    v_mfma_f32_16x16x32_bf16 v[92:95], a[148:151], a[88:91], v[92:95]
    s_waitcnt vmcnt(9)
    v_mfma_f32_16x16x32_bf16 v[96:99], a[172:175], a[92:95], v[96:99]
    v_mfma_f32_16x16x32_bf16 v[80:83], a[156:159], a[92:95], v[80:83]
    v_mfma_f32_16x16x32_bf16 v[84:87], a[160:163], a[92:95], v[84:87]
    buffer_load_dwordx4 v[68:71], v16, s[48:51], s64 offen offset:2048 sc1
    v_mfma_f32_16x16x32_bf16 v[88:91], a[164:167], a[92:95], v[88:91]
    v_mfma_f32_16x16x32_bf16 v[92:95], a[168:171], a[92:95], v[92:95]
    s_waitcnt vmcnt(9)
    v_mfma_f32_16x16x32_bf16 v[96:99], a[192:195], v[176:179], v[96:99]
    v_mfma_f32_16x16x32_bf16 v[80:83], a[176:179], v[176:179], v[80:83]
    s_add_u32 s65, s65, s6
    buffer_load_dwordx4 v[72:75], v29, s[48:51], s65 offen offset:0 sc1
    v_mfma_f32_16x16x32_bf16 v[84:87], a[180:183], v[176:179], v[84:87]
    v_mfma_f32_16x16x32_bf16 v[88:91], a[184:187], v[176:179], v[88:91]
    v_mfma_f32_16x16x32_bf16 v[92:95], a[188:191], v[176:179], v[92:95]
    s_waitcnt vmcnt(9)
    v_mfma_f32_16x16x32_bf16 v[96:99], a[212:215], v[180:183], v[96:99]
    buffer_load_dwordx4 v[76:79], v29, s[48:51], s65 offen offset:1024 sc1
    v_mfma_f32_16x16x32_bf16 v[80:83], a[196:199], v[180:183], v[80:83]
    v_mfma_f32_16x16x32_bf16 v[84:87], a[200:203], v[180:183], v[84:87]
    v_mfma_f32_16x16x32_bf16 v[88:91], a[204:207], v[180:183], v[88:91]
    v_mfma_f32_16x16x32_bf16 v[92:95], a[208:211], v[180:183], v[92:95]
    buffer_load_dwordx4 a[80:83], v29, s[48:51], s65 offen offset:2048 sc1
    s_waitcnt vmcnt(10)
    v_mfma_f32_16x16x32_bf16 v[96:99], a[232:235], v[184:187], v[96:99]
    v_mfma_f32_16x16x32_bf16 v[80:83], a[216:219], v[184:187], v[80:83]
    v_mfma_f32_16x16x32_bf16 v[84:87], a[220:223], v[184:187], v[84:87]
    v_mfma_f32_16x16x32_bf16 v[88:91], a[224:227], v[184:187], v[88:91]
    buffer_load_dwordx4 a[84:87], v29, s[48:51], s65 offen offset:3072 sc1
    v_mfma_f32_16x16x32_bf16 v[92:95], a[228:231], v[184:187], v[92:95]
    s_waitcnt vmcnt(10)
    v_mfma_f32_16x16x32_bf16 v[116:119], a[112:115], v[188:191], v[116:119]
    v_mfma_f32_16x16x32_bf16 v[100:103], a[96:99], v[188:191], v[100:103]
    v_mfma_f32_16x16x32_bf16 v[104:107], a[100:103], v[188:191], v[104:107]
    buffer_load_dwordx4 a[88:91], v30, s[48:51], s65 offen offset:0 sc1
    v_mfma_f32_16x16x32_bf16 v[108:111], a[104:107], v[188:191], v[108:111]
    ds_write_b128 v20, v[96:99] offset:4096
    v_mfma_f32_16x16x32_bf16 v[112:115], a[108:111], v[188:191], v[112:115]
    s_waitcnt vmcnt(10)
    v_mfma_f32_16x16x32_bf16 v[116:119], a[132:135], v[48:51], v[116:119]
    buffer_load_dwordx4 a[92:95], v30, s[48:51], s65 offen offset:1024 sc1
    v_mfma_f32_16x16x32_bf16 v[100:103], a[116:119], v[48:51], v[100:103]
    v_mfma_f32_16x16x32_bf16 v[104:107], a[120:123], v[48:51], v[104:107]
    ds_write_b128 v20, v[80:83] offset:0
    v_mfma_f32_16x16x32_bf16 v[108:111], a[124:127], v[48:51], v[108:111]
    buffer_load_dwordx4 v[176:179], v16, s[48:51], s65 offen offset:2048 sc1
    v_mfma_f32_16x16x32_bf16 v[112:115], a[128:131], v[48:51], v[112:115]
    s_waitcnt vmcnt(11)
    v_mfma_f32_16x16x32_bf16 v[116:119], a[152:155], v[52:55], v[116:119]
    v_mfma_f32_16x16x32_bf16 v[100:103], a[136:139], v[52:55], v[100:103]
    ds_write_b128 v20, v[84:87] offset:1024
    v_mfma_f32_16x16x32_bf16 v[104:107], a[140:143], v[52:55], v[104:107]
    s_add_u32 s71, s71, s6
    buffer_load_dwordx4 v[180:183], v29, s[48:51], s71 offen offset:0 sc1
    v_mfma_f32_16x16x32_bf16 v[108:111], a[144:147], v[52:55], v[108:111]
    v_mfma_f32_16x16x32_bf16 v[112:115], a[148:151], v[52:55], v[112:115]
    s_waitcnt vmcnt(11)
    v_mfma_f32_16x16x32_bf16 v[116:119], a[172:175], v[56:59], v[116:119]
    ds_write_b128 v20, v[88:91] offset:2048
    v_mfma_f32_16x16x32_bf16 v[100:103], a[156:159], v[56:59], v[100:103]
    buffer_load_dwordx4 v[184:187], v29, s[48:51], s71 offen offset:1024 sc1
    v_mfma_f32_16x16x32_bf16 v[104:107], a[160:163], v[56:59], v[104:107]
    v_mfma_f32_16x16x32_bf16 v[108:111], a[164:167], v[56:59], v[108:111]
    v_mfma_f32_16x16x32_bf16 v[112:115], a[168:171], v[56:59], v[112:115]
    ds_write_b128 v20, v[92:95] offset:3072
    s_waitcnt vmcnt(11)
    v_mfma_f32_16x16x32_bf16 v[116:119], a[192:195], v[60:63], v[116:119]
    buffer_load_dwordx4 v[188:191], v29, s[48:51], s71 offen offset:2048 sc1
    v_mfma_f32_16x16x32_bf16 v[100:103], a[176:179], v[60:63], v[100:103]
    v_mfma_f32_16x16x32_bf16 v[104:107], a[180:183], v[60:63], v[104:107]
    v_mfma_f32_16x16x32_bf16 v[108:111], a[184:187], v[60:63], v[108:111]
    v_mfma_f32_16x16x32_bf16 v[112:115], a[188:191], v[60:63], v[112:115]
    buffer_load_dwordx4 v[48:51], v29, s[48:51], s71 offen offset:3072 sc1
    s_waitcnt vmcnt(12)
    v_mfma_f32_16x16x32_bf16 v[116:119], a[212:215], v[64:67], v[116:119]
    v_mfma_f32_16x16x32_bf16 v[100:103], a[196:199], v[64:67], v[100:103]
    v_mfma_f32_16x16x32_bf16 v[104:107], a[200:203], v[64:67], v[104:107]
    v_mfma_f32_16x16x32_bf16 v[108:111], a[204:207], v[64:67], v[108:111]
    buffer_load_dwordx4 v[52:55], v30, s[48:51], s71 offen offset:0 sc1
    v_mfma_f32_16x16x32_bf16 v[112:115], a[208:211], v[64:67], v[112:115]
    s_waitcnt vmcnt(12)
    v_mfma_f32_16x16x32_bf16 v[116:119], a[232:235], v[68:71], v[116:119]
    v_mfma_f32_16x16x32_bf16 v[100:103], a[216:219], v[68:71], v[100:103]
    v_mfma_f32_16x16x32_bf16 v[104:107], a[220:223], v[68:71], v[104:107]
    buffer_load_dwordx4 v[56:59], v30, s[48:51], s71 offen offset:1024 sc1
    v_mfma_f32_16x16x32_bf16 v[108:111], a[224:227], v[68:71], v[108:111]
    v_mfma_f32_16x16x32_bf16 v[112:115], a[228:231], v[68:71], v[112:115]
    s_waitcnt vmcnt(12)
    v_mfma_f32_16x16x32_bf16 v[136:139], a[112:115], v[72:75], v[136:139]
    v_mfma_f32_16x16x32_bf16 v[120:123], a[96:99], v[72:75], v[120:123]
    buffer_load_dwordx4 v[60:63], v16, s[48:51], s71 offen offset:2048 sc1
    v_mfma_f32_16x16x32_bf16 v[124:127], a[100:103], v[72:75], v[124:127]
    v_mfma_f32_16x16x32_bf16 v[128:131], a[104:107], v[72:75], v[128:131]
    ds_write_b128 v20, v[116:119] offset:9216
    v_mfma_f32_16x16x32_bf16 v[132:135], a[108:111], v[72:75], v[132:135]
    s_waitcnt vmcnt(12)
    v_mfma_f32_16x16x32_bf16 v[136:139], a[132:135], v[76:79], v[136:139]
    v_mfma_f32_16x16x32_bf16 v[120:123], a[116:119], v[76:79], v[120:123]
    v_mfma_f32_16x16x32_bf16 v[124:127], a[120:123], v[76:79], v[124:127]
    ds_write_b128 v20, v[100:103] offset:5120
    v_mfma_f32_16x16x32_bf16 v[128:131], a[124:127], v[76:79], v[128:131]
    v_mfma_f32_16x16x32_bf16 v[132:135], a[128:131], v[76:79], v[132:135]
    s_waitcnt vmcnt(11)
    v_mfma_f32_16x16x32_bf16 v[136:139], a[152:155], a[80:83], v[136:139]
    v_mfma_f32_16x16x32_bf16 v[120:123], a[136:139], a[80:83], v[120:123]
    ds_write_b128 v20, v[104:107] offset:6144
    v_mfma_f32_16x16x32_bf16 v[124:127], a[140:143], a[80:83], v[124:127]
    v_mfma_f32_16x16x32_bf16 v[128:131], a[144:147], a[80:83], v[128:131]
    v_mfma_f32_16x16x32_bf16 v[132:135], a[148:151], a[80:83], v[132:135]
    s_waitcnt vmcnt(10)
    v_mfma_f32_16x16x32_bf16 v[136:139], a[172:175], a[84:87], v[136:139]
    ds_write_b128 v20, v[108:111] offset:7168
    v_mfma_f32_16x16x32_bf16 v[120:123], a[156:159], a[84:87], v[120:123]
    v_mfma_f32_16x16x32_bf16 v[124:127], a[160:163], a[84:87], v[124:127]
    v_mfma_f32_16x16x32_bf16 v[128:131], a[164:167], a[84:87], v[128:131]
    v_mfma_f32_16x16x32_bf16 v[132:135], a[168:171], a[84:87], v[132:135]
    ds_write_b128 v20, v[112:115] offset:8192
    s_waitcnt vmcnt(9)
    v_mfma_f32_16x16x32_bf16 v[136:139], a[192:195], a[88:91], v[136:139]
    v_mfma_f32_16x16x32_bf16 v[120:123], a[176:179], a[88:91], v[120:123]
    v_mfma_f32_16x16x32_bf16 v[124:127], a[180:183], a[88:91], v[124:127]
    v_mfma_f32_16x16x32_bf16 v[128:131], a[184:187], a[88:91], v[128:131]
    v_mfma_f32_16x16x32_bf16 v[132:135], a[188:191], a[88:91], v[132:135]
    s_waitcnt vmcnt(8)
    v_mfma_f32_16x16x32_bf16 v[136:139], a[212:215], a[92:95], v[136:139]
    v_mfma_f32_16x16x32_bf16 v[120:123], a[196:199], a[92:95], v[120:123]
    v_mfma_f32_16x16x32_bf16 v[124:127], a[200:203], a[92:95], v[124:127]
    v_mfma_f32_16x16x32_bf16 v[128:131], a[204:207], a[92:95], v[128:131]
    v_mfma_f32_16x16x32_bf16 v[132:135], a[208:211], a[92:95], v[132:135]
    s_waitcnt vmcnt(7)
    v_mfma_f32_16x16x32_bf16 v[136:139], a[232:235], v[176:179], v[136:139]
    v_mfma_f32_16x16x32_bf16 v[120:123], a[216:219], v[176:179], v[120:123]
    v_mfma_f32_16x16x32_bf16 v[124:127], a[220:223], v[176:179], v[124:127]
    v_mfma_f32_16x16x32_bf16 v[128:131], a[224:227], v[176:179], v[128:131]
    v_mfma_f32_16x16x32_bf16 v[132:135], a[228:231], v[176:179], v[132:135]
    s_waitcnt vmcnt(6)
    v_mfma_f32_16x16x32_bf16 v[156:159], a[112:115], v[180:183], v[156:159]
    v_mfma_f32_16x16x32_bf16 v[140:143], a[96:99], v[180:183], v[140:143]
    v_mfma_f32_16x16x32_bf16 v[144:147], a[100:103], v[180:183], v[144:147]
    v_mfma_f32_16x16x32_bf16 v[148:151], a[104:107], v[180:183], v[148:151]
    ds_write_b128 v20, v[136:139] offset:14336
    v_mfma_f32_16x16x32_bf16 v[152:155], a[108:111], v[180:183], v[152:155]
    s_waitcnt vmcnt(5)
    v_mfma_f32_16x16x32_bf16 v[156:159], a[132:135], v[184:187], v[156:159]
    v_mfma_f32_16x16x32_bf16 v[140:143], a[116:119], v[184:187], v[140:143]
    v_mfma_f32_16x16x32_bf16 v[144:147], a[120:123], v[184:187], v[144:147]
    ds_write_b128 v20, v[120:123] offset:10240
    v_mfma_f32_16x16x32_bf16 v[148:151], a[124:127], v[184:187], v[148:151]
    v_mfma_f32_16x16x32_bf16 v[152:155], a[128:131], v[184:187], v[152:155]
    s_waitcnt vmcnt(4)
    v_mfma_f32_16x16x32_bf16 v[156:159], a[152:155], v[188:191], v[156:159]
    v_mfma_f32_16x16x32_bf16 v[140:143], a[136:139], v[188:191], v[140:143]
    ds_write_b128 v20, v[124:127] offset:11264
    v_mfma_f32_16x16x32_bf16 v[144:147], a[140:143], v[188:191], v[144:147]
    v_mfma_f32_16x16x32_bf16 v[148:151], a[144:147], v[188:191], v[148:151]
    v_mfma_f32_16x16x32_bf16 v[152:155], a[148:151], v[188:191], v[152:155]
    s_waitcnt vmcnt(3)
    v_mfma_f32_16x16x32_bf16 v[156:159], a[172:175], v[48:51], v[156:159]
    ds_write_b128 v20, v[128:131] offset:12288
    v_mfma_f32_16x16x32_bf16 v[140:143], a[156:159], v[48:51], v[140:143]
    v_mfma_f32_16x16x32_bf16 v[144:147], a[160:163], v[48:51], v[144:147]
    v_mfma_f32_16x16x32_bf16 v[148:151], a[164:167], v[48:51], v[148:151]
    v_mfma_f32_16x16x32_bf16 v[152:155], a[168:171], v[48:51], v[152:155]
    ds_write_b128 v20, v[132:135] offset:13312
    s_waitcnt vmcnt(2)
    v_mfma_f32_16x16x32_bf16 v[156:159], a[192:195], v[52:55], v[156:159]
    v_mfma_f32_16x16x32_bf16 v[140:143], a[176:179], v[52:55], v[140:143]
    v_mfma_f32_16x16x32_bf16 v[144:147], a[180:183], v[52:55], v[144:147]
    v_mfma_f32_16x16x32_bf16 v[148:151], a[184:187], v[52:55], v[148:151]
    v_mfma_f32_16x16x32_bf16 v[152:155], a[188:191], v[52:55], v[152:155]
    s_waitcnt lgkmcnt(0)
    s_barrier
    s_waitcnt vmcnt(1)
    v_mfma_f32_16x16x32_bf16 v[156:159], a[212:215], v[56:59], v[156:159]
    ds_read_b128 v[240:243], v21 offset:4096
    v_mfma_f32_16x16x32_bf16 v[140:143], a[196:199], v[56:59], v[140:143]
    ds_read_b128 v[244:247], v23 offset:9216
    v_mfma_f32_16x16x32_bf16 v[144:147], a[200:203], v[56:59], v[144:147]
    ds_read_b128 v[248:251], v27 offset:14336
    v_mfma_f32_16x16x32_bf16 v[148:151], a[204:207], v[56:59], v[148:151]
    ds_read_b128 v[192:195], v21 offset:0
    v_mfma_f32_16x16x32_bf16 v[152:155], a[208:211], v[56:59], v[152:155]
    ds_read_b128 v[196:199], v23 offset:5120
    s_waitcnt vmcnt(0)
    v_mfma_f32_16x16x32_bf16 v[156:159], a[232:235], v[60:63], v[156:159]
    ds_read_b128 v[200:203], v27 offset:10240
    v_mfma_f32_16x16x32_bf16 v[140:143], a[216:219], v[60:63], v[140:143]
    ds_read_b128 v[204:207], v21 offset:1024
    v_mfma_f32_16x16x32_bf16 v[144:147], a[220:223], v[60:63], v[144:147]
    ds_read_b128 v[208:211], v23 offset:6144
    v_mfma_f32_16x16x32_bf16 v[148:151], a[224:227], v[60:63], v[148:151]
    ds_read_b128 v[212:215], v27 offset:11264
    v_mfma_f32_16x16x32_bf16 v[152:155], a[228:231], v[60:63], v[152:155]
    ds_read_b128 v[216:219], v21 offset:2048
    ds_read_b128 v[220:223], v23 offset:7168
    ds_read_b128 v[224:227], v27 offset:12288
    ds_read_b128 v[228:231], v21 offset:3072
    ds_read_b128 v[232:235], v23 offset:8192
    ds_read_b128 v[236:239], v27 offset:13312
    s_waitcnt lgkmcnt(14)
    v_pk_add_f32 v[156:157], v[156:157], v[240:241]
    v_pk_add_f32 v[158:159], v[158:159], v[242:243]
    s_waitcnt lgkmcnt(13)
    v_pk_add_f32 v[156:157], v[156:157], v[244:245]
    v_pk_add_f32 v[158:159], v[158:159], v[246:247]
    s_waitcnt lgkmcnt(12)
    v_pk_add_f32 v[156:157], v[156:157], v[248:249]
    v_pk_add_f32 v[158:159], v[158:159], v[250:251]
    v_cvt_pk_bf16_f32 v40, v156, v157
    v_cvt_pk_bf16_f32 v41, v158, v159
    ds_write_b64 v5, v[40:41] offset:18432
    ds_read_b128 v[56:59], v20 offset:18432
    s_waitcnt lgkmcnt(13)
    v_pk_add_f32 v[140:141], v[140:141], v[192:193]
    v_pk_add_f32 v[142:143], v[142:143], v[194:195]
    s_waitcnt lgkmcnt(12)
    v_pk_add_f32 v[140:141], v[140:141], v[196:197]
    v_pk_add_f32 v[142:143], v[142:143], v[198:199]
    s_waitcnt lgkmcnt(11)
    v_pk_add_f32 v[140:141], v[140:141], v[200:201]
    v_pk_add_f32 v[142:143], v[142:143], v[202:203]
    v_cvt_pk_bf16_f32 v32, v140, v141
    v_cvt_pk_bf16_f32 v33, v142, v143
    s_waitcnt lgkmcnt(10)
    v_pk_add_f32 v[144:145], v[144:145], v[204:205]
    v_pk_add_f32 v[146:147], v[146:147], v[206:207]
    s_waitcnt lgkmcnt(9)
    v_pk_add_f32 v[144:145], v[144:145], v[208:209]
    v_pk_add_f32 v[146:147], v[146:147], v[210:211]
    s_waitcnt lgkmcnt(8)
    v_pk_add_f32 v[144:145], v[144:145], v[212:213]
    v_pk_add_f32 v[146:147], v[146:147], v[214:215]
    v_cvt_pk_bf16_f32 v34, v144, v145
    v_cvt_pk_bf16_f32 v35, v146, v147
    ds_write_b128 v26, v[32:35] offset:16384
    v_xor_b32 v26, 64, v26
    s_waitcnt lgkmcnt(8)
    v_pk_add_f32 v[148:149], v[148:149], v[216:217]
    v_pk_add_f32 v[150:151], v[150:151], v[218:219]
    s_waitcnt lgkmcnt(7)
    v_pk_add_f32 v[148:149], v[148:149], v[220:221]
    v_pk_add_f32 v[150:151], v[150:151], v[222:223]
    s_waitcnt lgkmcnt(6)
    v_pk_add_f32 v[148:149], v[148:149], v[224:225]
    v_pk_add_f32 v[150:151], v[150:151], v[226:227]
    v_cvt_pk_bf16_f32 v36, v148, v149
    v_cvt_pk_bf16_f32 v37, v150, v151
    s_waitcnt lgkmcnt(5)
    v_pk_add_f32 v[152:153], v[152:153], v[228:229]
    v_pk_add_f32 v[154:155], v[154:155], v[230:231]
    s_waitcnt lgkmcnt(4)
    v_pk_add_f32 v[152:153], v[152:153], v[232:233]
    v_pk_add_f32 v[154:155], v[154:155], v[234:235]
    s_waitcnt lgkmcnt(3)
    v_pk_add_f32 v[152:153], v[152:153], v[236:237]
    v_pk_add_f32 v[154:155], v[154:155], v[238:239]
    v_cvt_pk_bf16_f32 v38, v152, v153
    v_cvt_pk_bf16_f32 v39, v154, v155
    ds_write_b128 v26, v[36:39] offset:16384
    ds_read_b128 v[48:51], v4 offset:16384
    ds_read_b128 v[52:55], v4 offset:17408
    s_mov_b32 exec_hi, 0
    s_waitcnt lgkmcnt(4)
    buffer_store_dwordx4 v[56:59], v25, s[40:43], s3 offen offset:512 sc1
    s_mov_b64 exec, -1
    s_waitcnt lgkmcnt(1)
    buffer_store_dwordx4 v[48:51], v24, s[40:43], s77 offen sc1
    s_waitcnt lgkmcnt(0)
    buffer_store_dwordx4 v[52:55], v24, s[40:43], s76 offen sc1
L_end:
    s_endpgm
L_role_b:
    s_mul_i32 s98, s59, 3
    s_add_u32 s98, s98, s58
    s_sub_u32 s98, s98, 4
    s_mul_i32 s72, s98, 320
    s_bfe_u32 s71, s99, 0x40000
    s_mul_i32 s71, s71, 221184
    s_add_u32 s71, s71, s72
    s_mul_i32 s77, s62, 55296
    v_add_u32 v36, 0, v0
    v_mul_u32_u24 v37, 0xccd, v36
    v_lshrrev_b32 v37, 16, v37
    v_mul_u32_u24 v24, 3136, v37
    v_lshl_add_u32 v24, v36, 4, v24
    v_add_u32 v24, s77, v24
    v_add_u32 v36, 64, v0
    v_mul_u32_u24 v37, 0xccd, v36
    v_lshrrev_b32 v37, 16, v37
    v_mul_u32_u24 v25, 3136, v37
    v_lshl_add_u32 v25, v36, 4, v25
    v_add_u32 v25, s77, v25
    v_subrev_u32 v25, 1024, v25
    v_add_u32 v36, 128, v0
    v_mul_u32_u24 v37, 0xccd, v36
    v_lshrrev_b32 v37, 16, v37
    v_lshrrev_b32 v26, 5, v0
    v_mul_u32_u24 v26, 1, v26
    v_xor_b32 v36, v36, v26
    v_mul_u32_u24 v26, 3136, v37
    v_lshl_add_u32 v26, v36, 4, v26
    v_add_u32 v26, s77, v26
    v_subrev_u32 v26, 2048, v26
    v_add_u32 v36, 192, v0
    v_mul_u32_u24 v37, 0xccd, v36
    v_lshrrev_b32 v37, 16, v37
    v_xor_b32 v36, 1, v36
    v_mul_u32_u24 v27, 3136, v37
    v_lshl_add_u32 v27, v36, 4, v27
    v_add_u32 v27, s77, v27
    v_subrev_u32 v27, 3072, v27
    v_add_u32 v36, 256, v0
    v_mul_u32_u24 v37, 0xccd, v36
    v_lshrrev_b32 v37, 16, v37
    v_xor_b32 v36, 1, v36
    v_mul_u32_u24 v28, 3136, v37
    v_lshl_add_u32 v28, v36, 4, v28
    v_add_u32 v28, s77, v28
    v_mul_u32_u24 v18, 320, v12
    v_add3_u32 v18, v18, v13, v14
    v_xor_b32 v19, 16, v18
    s_lshl2_add_u32 s75, s16, s56
    s_lshl_b32 s75, s75, 17
    s_and_b32 s3, s17, 1
    s_lshl_b32 s76, s3, 11
    s_add_u32 s75, s75, s76
    s_xor_b32 s77, s17, 1
    s_lshl1_add_u32 s77, s77, s3
    s_lshl_b32 s77, s77, 17
    s_lshl_b32 s76, s56, 12
    s_add_u32 s77, s77, s76
    s_add_u32 m0, s61, 4096
    s_nop 0
    buffer_load_dwordx4 v8, s[8:11], s63 offen offset:0 lds
    buffer_load_dwordx4 v9, s[8:11], s63 offen offset:1024 lds
    buffer_load_dwordx4 v10, s[8:11], s63 offen offset:2048 lds
    buffer_load_dwordx4 v11, s[8:11], s63 offen offset:3072 lds
    s_bfe_u32 s63, s99, 0x40008
    s_mul_i32 s63, s63, 128
    s_add_u32 s63, s63, s64
    s_add_u32 m0, s61, 34816
    s_nop 0
    buffer_load_dwordx4 v16, s[20:23], s66 offen offset:0 lds
    buffer_load_dwordx4 v17, s[20:23], s66 offen offset:1024 lds
    s_add_u32 s77, s77, 2097152
    s_lshl_b32 s78, s3, 19
    s_sub_u32 s78, s78, 0x40000
    s_lshr_b32 s3, s17, 1
    s_mov_b32 s79, 0x76453201
    s_and_b32 s76, s16, 3
    s_cmp_eq_u32 s76, 1
    s_cselect_b32 s79, 0x75643120, s79
    s_cmp_eq_u32 s76, 2
    s_cselect_b32 s79, 0x67542310, s79
    s_cmp_eq_u32 s76, 3
    s_cselect_b32 s79, 0x76534210, s79
    s_and_b32 s3, s3, 7
    s_mul_i32 s3, s3, 0x11111111
    s_add_u32 s79, s79, s3
    s_bfe_u32 s76, s79, 0x30000
    s_lshl_b32 s76, s76, 8
    s_add_u32 s82, s76, s75
    s_lshl_b32 s76, s76, 6
    s_add_u32 s90, s76, s77
    s_bfe_u32 s76, s79, 0x30004
    s_lshl_b32 s76, s76, 8
    s_add_u32 s83, s76, s75
    s_lshl_b32 s76, s76, 6
    s_add_u32 s91, s76, s77
    s_bfe_u32 s76, s79, 0x30008
    s_lshl_b32 s76, s76, 8
    s_add_u32 s84, s76, s75
    s_lshl_b32 s76, s76, 6
    s_add_u32 s92, s76, s77
    s_bfe_u32 s76, s79, 0x3000c
    s_lshl_b32 s76, s76, 8
    s_add_u32 s85, s76, s75
    s_lshl_b32 s76, s76, 6
    s_add_u32 s93, s76, s77
    s_bfe_u32 s76, s79, 0x30010
    s_lshl_b32 s76, s76, 8
    s_add_u32 s86, s76, s75
    s_lshl_b32 s76, s76, 6
    s_add_u32 s94, s76, s77
    s_bfe_u32 s76, s79, 0x30014
    s_lshl_b32 s76, s76, 8
    s_add_u32 s87, s76, s75
    s_lshl_b32 s76, s76, 6
    s_add_u32 s95, s76, s77
    s_bfe_u32 s76, s79, 0x30018
    s_lshl_b32 s76, s76, 8
    s_add_u32 s88, s76, s75
    s_lshl_b32 s76, s76, 6
    s_add_u32 s96, s76, s77
    s_bfe_u32 s76, s79, 0x3001c
    s_lshl_b32 s76, s76, 8
    s_add_u32 s89, s76, s75
    s_lshl_b32 s76, s76, 6
    s_add_u32 s97, s76, s77
    s_and_b32 s77, s17, 1
    s_andn2_b32 s75, s17, 1
    s_lshl1_add_u32 s75, s75, s77
    s_lshl_b32 s75, s75, 5
    s_add_u32 s75, s75, s56
    s_lshl_b32 s75, s75, 7
    s_add_u32 s75, s75, 229376
    v_and_b32 v44, 7, v0
    v_bfe_u32 v43, v0, 3, 1
    v_lshl_add_u32 v44, v43, 4, v44
    v_lshl_add_u32 v44, v44, 9, s75
    s_lshl2_add_u32 s77, s16, s56
    s_lshl_b32 s77, s77, 6
    v_and_b32 v43, 15, v0
    v_lshl_add_u32 v43, v43, 1, s77
    v_bfe_u32 v240, v0, 1, 1
    v_bfe_u32 v241, v0, 2, 2
    v_and_b32 v242, 1, v0
    v_lshl_or_b32 v241, v241, 1, v242
    v_lshl_or_b32 v240, v240, 3, v241
    v_lshrrev_b32 v241, 5, v0
    v_lshl_or_b32 v241, v241, 2, v3
    v_xor_b32 v240, v240, v241
    v_lshlrev_b32 v240, 3, v240
    v_and_b32 v242, 15, v0
    v_lshl_add_u32 v240, v242, 7, v240
    v_add_u32 v240, s61, v240
    v_xor_b32 v241, 16, v240
    v_xor_b32 v242, 64, v240
    v_xor_b32 v243, 80, v240
    v_bfe_u32 v245, v0, 3, 1
    v_lshlrev_b32 v245, 3, v245
    v_bfe_u32 v246, v0, 4, 1
    v_bfe_u32 v247, v0, 1, 1
    v_xor_b32 v246, v246, v247
    v_lshl_or_b32 v245, v246, 2, v245
    v_lshrrev_b32 v246, 2, v0
    v_xor_b32 v247, v0, v246
    v_and_or_b32 v245, v247, 1, v245
    v_lshlrev_b32 v245, 3, v245
    v_and_b32 v246, 3, v246
    v_lshrrev_b32 v247, 4, v0
    v_lshl_add_u32 v246, v247, 3, v246
    v_lshl_add_u32 v245, v246, 7, v245
    v_add_u32 v245, s61, v245
    v_xor_b32 v246, 16, v245
    v_xor_b32 v247, 64, v245
    v_xor_b32 v248, 80, v245
    s_lshl2_add_u32 s75, s57, s56
    s_lshl_b32 s75, s75, 12
    s_lshl_b32 s76, s60, 18
    s_add_u32 s75, s75, s76
    s_add_u32 s80, s75, 2097152
    s_lshl4_add_u32 s76, s60, s57
    s_lshl2_add_u32 s76, s76, s56
    s_lshl_b32 s76, s76, 7
    s_add_u32 s81, s76, 229376
    s_waitcnt vmcnt(6)
    s_barrier
    ds_read_b128 a[0:3], v4 offset:0
    ds_read_b128 a[4:7], v4 offset:2048
    ds_read_b128 a[8:11], v5 offset:0
    ds_read_b128 a[12:15], v5 offset:2048
    ds_read_b64_tr_b16 v[160:161], v20 offset:16384
    ds_read_b64_tr_b16 v[162:163], v20 offset:16896
    ds_read_b64_tr_b16 v[164:165], v21 offset:16384
    ds_read_b64_tr_b16 v[166:167], v21 offset:16896
    ds_read_b64_tr_b16 v[168:169], v22 offset:16384
    ds_read_b64_tr_b16 v[170:171], v22 offset:16896
    ds_read_b64_tr_b16 v[172:173], v23 offset:16384
    ds_read_b64_tr_b16 v[174:175], v23 offset:16896
    ds_read_b64_tr_b16 v[176:177], v20 offset:57344
    ds_read_b64_tr_b16 v[178:179], v20 offset:57856
    ds_read_b64_tr_b16 v[180:181], v21 offset:57344
    ds_read_b64_tr_b16 v[182:183], v21 offset:57856
    s_waitcnt lgkmcnt(10)
    v_mfma_f32_16x16x32_bf16 v[48:51], v[160:163], a[0:3], 0
    ds_read_b64_tr_b16 v[184:185], v22 offset:57344
    ds_read_b64_tr_b16 v[186:187], v22 offset:57856
    ds_read_b64_tr_b16 v[188:189], v23 offset:57344
    ds_read_b64_tr_b16 v[190:191], v23 offset:57856
    v_mfma_f32_16x16x32_bf16 v[56:59], v[160:163], a[4:7], 0
    s_bfe_u32 s66, s99, 0x40008
    s_mul_i32 s66, s66, 221184
    s_add_u32 s66, s66, s67
    s_add_u32 m0, s61, 8192
    s_waitcnt lgkmcnt(12)
    v_mfma_f32_16x16x32_bf16 v[52:55], v[164:167], a[0:3], 0
    v_mfma_f32_16x16x32_bf16 v[60:63], v[164:167], a[4:7], 0
    buffer_load_dwordx4 v8, s[8:11], s63 offen offset:0 lds
    s_waitcnt lgkmcnt(4)
    v_mfma_f32_16x16x32_bf16 v[64:67], v[168:171], a[0:3], 0
    v_mfma_f32_16x16x32_bf16 v[72:75], v[168:171], a[4:7], 0
    buffer_load_dwordx4 v9, s[8:11], s63 offen offset:1024 lds
    s_waitcnt vmcnt(2) lgkmcnt(0)
    s_barrier
    ds_read_b128 a[16:19], v4 offset:4096
    ds_read_b128 a[20:23], v4 offset:6144
    ds_read_b128 a[24:27], v5 offset:4096
    ds_read_b128 a[28:31], v5 offset:6144
    v_mfma_f32_16x16x32_bf16 v[68:71], v[172:175], a[0:3], 0
    ds_read_b64_tr_b16 v[160:161], v20 offset:18432
    ds_read_b64_tr_b16 v[162:163], v20 offset:18944
    ds_read_b64_tr_b16 v[164:165], v21 offset:18432
    ds_read_b64_tr_b16 v[166:167], v21 offset:18944
    v_mfma_f32_16x16x32_bf16 v[76:79], v[172:175], a[4:7], 0
    buffer_load_dwordx4 v10, s[8:11], s63 offen offset:2048 lds
    v_mfma_f32_16x16x32_bf16 v[48:51], v[176:179], a[8:11], v[48:51]
    ds_read_b64_tr_b16 v[168:169], v22 offset:18432
    ds_read_b64_tr_b16 v[170:171], v22 offset:18944
    ds_read_b64_tr_b16 v[172:173], v23 offset:18432
    ds_read_b64_tr_b16 v[174:175], v23 offset:18944
    v_mfma_f32_16x16x32_bf16 v[56:59], v[176:179], a[12:15], v[56:59]
    buffer_load_dwordx4 v11, s[8:11], s63 offen offset:3072 lds
    s_bfe_u32 s63, s99, 0x4000c
    s_mul_i32 s63, s63, 128
    s_add_u32 s63, s63, s64
    s_add_u32 m0, s61, 36864
    v_mfma_f32_16x16x32_bf16 v[52:55], v[180:183], a[8:11], v[52:55]
    ds_read_b64_tr_b16 v[176:177], v20 offset:59392
    ds_read_b64_tr_b16 v[178:179], v20 offset:59904
    v_mfma_f32_16x16x32_bf16 v[60:63], v[180:183], a[12:15], v[60:63]
    buffer_load_dwordx4 v16, s[20:23], s66 offen offset:0 lds
    v_mfma_f32_16x16x32_bf16 v[64:67], v[184:187], a[8:11], v[64:67]
    ds_read_b64_tr_b16 v[180:181], v21 offset:59392
    ds_read_b64_tr_b16 v[182:183], v21 offset:59904
    v_mfma_f32_16x16x32_bf16 v[72:75], v[184:187], a[12:15], v[72:75]
    buffer_load_dwordx4 v17, s[20:23], s66 offen offset:1024 lds
    s_bfe_u32 s66, s99, 0x4000c
    s_mul_i32 s66, s66, 221184
    s_add_u32 s66, s66, s67
    s_add_u32 m0, s61, 12288
    v_mfma_f32_16x16x32_bf16 v[68:71], v[188:191], a[8:11], v[68:71]
    ds_read_b64_tr_b16 v[184:185], v22 offset:59392
    ds_read_b64_tr_b16 v[186:187], v22 offset:59904
    v_mfma_f32_16x16x32_bf16 v[76:79], v[188:191], a[12:15], v[76:79]
    buffer_load_dwordx4 v8, s[8:11], s63 offen offset:0 lds
    s_waitcnt lgkmcnt(6)
    v_mfma_f32_16x16x32_bf16 v[48:51], v[160:163], a[16:19], v[48:51]
    ds_read_b64_tr_b16 v[188:189], v23 offset:59392
    ds_read_b64_tr_b16 v[190:191], v23 offset:59904
    v_mfma_f32_16x16x32_bf16 v[56:59], v[160:163], a[20:23], v[56:59]
    buffer_load_dwordx4 v9, s[8:11], s63 offen offset:1024 lds
    v_mfma_f32_16x16x32_bf16 v[52:55], v[164:167], a[16:19], v[52:55]
    v_mfma_f32_16x16x32_bf16 v[60:63], v[164:167], a[20:23], v[60:63]
    buffer_load_dwordx4 v10, s[8:11], s63 offen offset:2048 lds
    v_mfma_f32_16x16x32_bf16 v[64:67], v[168:171], a[16:19], v[64:67]
    v_mfma_f32_16x16x32_bf16 v[72:75], v[168:171], a[20:23], v[72:75]
    buffer_load_dwordx4 v11, s[8:11], s63 offen offset:3072 lds
    s_bfe_u32 s63, s99, 0x40010
    s_mul_i32 s63, s63, 128
    s_add_u32 s63, s63, s64
    s_add_u32 m0, s61, 38912
    s_waitcnt vmcnt(4) lgkmcnt(0)
    s_barrier
    ds_read_b128 a[32:35], v4 offset:8192
    ds_read_b128 a[36:39], v4 offset:10240
    ds_read_b128 a[40:43], v5 offset:8192
    ds_read_b128 a[44:47], v5 offset:10240
    v_mfma_f32_16x16x32_bf16 v[68:71], v[172:175], a[16:19], v[68:71]
    ds_read_b64_tr_b16 v[160:161], v20 offset:20480
    ds_read_b64_tr_b16 v[162:163], v20 offset:20992
    ds_read_b64_tr_b16 v[164:165], v21 offset:20480
    ds_read_b64_tr_b16 v[166:167], v21 offset:20992
    v_mfma_f32_16x16x32_bf16 v[76:79], v[172:175], a[20:23], v[76:79]
    buffer_load_dwordx4 v16, s[20:23], s66 offen offset:0 lds
    v_mfma_f32_16x16x32_bf16 v[48:51], v[176:179], a[24:27], v[48:51]
    ds_read_b64_tr_b16 v[168:169], v22 offset:20480
    ds_read_b64_tr_b16 v[170:171], v22 offset:20992
    ds_read_b64_tr_b16 v[172:173], v23 offset:20480
    ds_read_b64_tr_b16 v[174:175], v23 offset:20992
    v_mfma_f32_16x16x32_bf16 v[56:59], v[176:179], a[28:31], v[56:59]
    buffer_load_dwordx4 v17, s[20:23], s66 offen offset:1024 lds
    s_bfe_u32 s66, s99, 0x40010
    s_mul_i32 s66, s66, 221184
    s_add_u32 s66, s66, s67
    s_add_u32 m0, s61, 0
    v_mfma_f32_16x16x32_bf16 v[52:55], v[180:183], a[24:27], v[52:55]
    ds_read_b64_tr_b16 v[176:177], v20 offset:61440
    ds_read_b64_tr_b16 v[178:179], v20 offset:61952
    v_mfma_f32_16x16x32_bf16 v[60:63], v[180:183], a[28:31], v[60:63]
    buffer_load_dwordx4 v8, s[8:11], s63 offen offset:0 lds
    v_mfma_f32_16x16x32_bf16 v[64:67], v[184:187], a[24:27], v[64:67]
    ds_read_b64_tr_b16 v[180:181], v21 offset:61440
    ds_read_b64_tr_b16 v[182:183], v21 offset:61952
    v_mfma_f32_16x16x32_bf16 v[72:75], v[184:187], a[28:31], v[72:75]
    buffer_load_dwordx4 v9, s[8:11], s63 offen offset:1024 lds
    v_mfma_f32_16x16x32_bf16 v[68:71], v[188:191], a[24:27], v[68:71]
    ds_read_b64_tr_b16 v[184:185], v22 offset:61440
    ds_read_b64_tr_b16 v[186:187], v22 offset:61952
    v_mfma_f32_16x16x32_bf16 v[76:79], v[188:191], a[28:31], v[76:79]
    buffer_load_dwordx4 v10, s[8:11], s63 offen offset:2048 lds
    s_waitcnt lgkmcnt(6)
    v_mfma_f32_16x16x32_bf16 v[48:51], v[160:163], a[32:35], v[48:51]
    ds_read_b64_tr_b16 v[188:189], v23 offset:61440
    ds_read_b64_tr_b16 v[190:191], v23 offset:61952
    v_mfma_f32_16x16x32_bf16 v[56:59], v[160:163], a[36:39], v[56:59]
    buffer_load_dwordx4 v11, s[8:11], s63 offen offset:3072 lds
    s_bfe_u32 s63, s99, 0x40014
    s_mul_i32 s63, s63, 128
    s_add_u32 s63, s63, s64
    s_add_u32 m0, s61, 32768
    v_mfma_f32_16x16x32_bf16 v[52:55], v[164:167], a[32:35], v[52:55]
    v_mfma_f32_16x16x32_bf16 v[60:63], v[164:167], a[36:39], v[60:63]
    buffer_load_dwordx4 v16, s[20:23], s66 offen offset:0 lds
    v_mfma_f32_16x16x32_bf16 v[64:67], v[168:171], a[32:35], v[64:67]
    v_mfma_f32_16x16x32_bf16 v[72:75], v[168:171], a[36:39], v[72:75]
    buffer_load_dwordx4 v17, s[20:23], s66 offen offset:1024 lds
    s_bfe_u32 s66, s99, 0x40014
    s_mul_i32 s66, s66, 221184
    s_add_u32 s66, s66, s67
    s_add_u32 m0, s61, 4096
    s_waitcnt vmcnt(6) lgkmcnt(0)
    s_barrier
    ds_read_b128 a[48:51], v4 offset:12288
    ds_read_b128 a[52:55], v4 offset:14336
    ds_read_b128 a[56:59], v5 offset:12288
    ds_read_b128 a[60:63], v5 offset:14336
    v_mfma_f32_16x16x32_bf16 v[68:71], v[172:175], a[32:35], v[68:71]
    ds_read_b64_tr_b16 v[160:161], v20 offset:22528
    ds_read_b64_tr_b16 v[162:163], v20 offset:23040
    ds_read_b64_tr_b16 v[164:165], v21 offset:22528
    ds_read_b64_tr_b16 v[166:167], v21 offset:23040
    v_mfma_f32_16x16x32_bf16 v[76:79], v[172:175], a[36:39], v[76:79]
    buffer_load_dwordx4 v8, s[8:11], s63 offen offset:0 lds
    v_mfma_f32_16x16x32_bf16 v[48:51], v[176:179], a[40:43], v[48:51]
    ds_read_b64_tr_b16 v[168:169], v22 offset:22528
    ds_read_b64_tr_b16 v[170:171], v22 offset:23040
    ds_read_b64_tr_b16 v[172:173], v23 offset:22528
    ds_read_b64_tr_b16 v[174:175], v23 offset:23040
    v_mfma_f32_16x16x32_bf16 v[56:59], v[176:179], a[44:47], v[56:59]
    buffer_load_dwordx4 v9, s[8:11], s63 offen offset:1024 lds
    v_mfma_f32_16x16x32_bf16 v[52:55], v[180:183], a[40:43], v[52:55]
    ds_read_b64_tr_b16 v[176:177], v20 offset:63488
    ds_read_b64_tr_b16 v[178:179], v20 offset:64000
    v_mfma_f32_16x16x32_bf16 v[60:63], v[180:183], a[44:47], v[60:63]
    buffer_load_dwordx4 v10, s[8:11], s63 offen offset:2048 lds
    v_mfma_f32_16x16x32_bf16 v[64:67], v[184:187], a[40:43], v[64:67]
    ds_read_b64_tr_b16 v[180:181], v21 offset:63488
    ds_read_b64_tr_b16 v[182:183], v21 offset:64000
    v_mfma_f32_16x16x32_bf16 v[72:75], v[184:187], a[44:47], v[72:75]
    buffer_load_dwordx4 v11, s[8:11], s63 offen offset:3072 lds
    s_bfe_u32 s63, s99, 0x40018
    s_mul_i32 s63, s63, 128
    s_add_u32 s63, s63, s64
    s_add_u32 m0, s61, 34816
    v_mfma_f32_16x16x32_bf16 v[68:71], v[188:191], a[40:43], v[68:71]
    ds_read_b64_tr_b16 v[184:185], v22 offset:63488
    ds_read_b64_tr_b16 v[186:187], v22 offset:64000
    v_mfma_f32_16x16x32_bf16 v[76:79], v[188:191], a[44:47], v[76:79]
    buffer_load_dwordx4 v16, s[20:23], s66 offen offset:0 lds
    s_waitcnt lgkmcnt(6)
    v_mfma_f32_16x16x32_bf16 v[48:51], v[160:163], a[48:51], v[48:51]
    ds_read_b64_tr_b16 v[188:189], v23 offset:63488
    ds_read_b64_tr_b16 v[190:191], v23 offset:64000
    v_mfma_f32_16x16x32_bf16 v[56:59], v[160:163], a[52:55], v[56:59]
    buffer_load_dwordx4 v17, s[20:23], s66 offen offset:1024 lds
    s_bfe_u32 s66, s99, 0x40018
    s_mul_i32 s66, s66, 221184
    s_add_u32 s66, s66, s67
    s_add_u32 m0, s61, 8192
    v_mfma_f32_16x16x32_bf16 v[52:55], v[164:167], a[48:51], v[52:55]
    v_mfma_f32_16x16x32_bf16 v[60:63], v[164:167], a[52:55], v[60:63]
    buffer_load_dwordx4 v8, s[8:11], s63 offen offset:0 lds
    v_mfma_f32_16x16x32_bf16 v[64:67], v[168:171], a[48:51], v[64:67]
    v_mfma_f32_16x16x32_bf16 v[72:75], v[168:171], a[52:55], v[72:75]
    buffer_load_dwordx4 v9, s[8:11], s63 offen offset:1024 lds
    s_waitcnt vmcnt(8) lgkmcnt(0)
    s_barrier
    ds_read_b128 a[64:67], v4 offset:0
    ds_read_b128 a[68:71], v4 offset:2048
    ds_read_b128 a[72:75], v5 offset:0
    ds_read_b128 a[76:79], v5 offset:2048
    v_mfma_f32_16x16x32_bf16 v[68:71], v[172:175], a[48:51], v[68:71]
    ds_read_b64_tr_b16 v[160:161], v20 offset:16384
    ds_read_b64_tr_b16 v[162:163], v20 offset:16896
    ds_read_b64_tr_b16 v[164:165], v21 offset:16384
    ds_read_b64_tr_b16 v[166:167], v21 offset:16896
    v_mfma_f32_16x16x32_bf16 v[76:79], v[172:175], a[52:55], v[76:79]
    buffer_load_dwordx4 v10, s[8:11], s63 offen offset:2048 lds
    v_mfma_f32_16x16x32_bf16 v[48:51], v[176:179], a[56:59], v[48:51]
    ds_read_b64_tr_b16 v[168:169], v22 offset:16384
    ds_read_b64_tr_b16 v[170:171], v22 offset:16896
    ds_read_b64_tr_b16 v[172:173], v23 offset:16384
    ds_read_b64_tr_b16 v[174:175], v23 offset:16896
    v_mfma_f32_16x16x32_bf16 v[56:59], v[176:179], a[60:63], v[56:59]
    buffer_load_dwordx4 v11, s[8:11], s63 offen offset:3072 lds
    s_bfe_u32 s63, s99, 0x4001c
    s_mul_i32 s63, s63, 128
    s_add_u32 s63, s63, s64
    s_add_u32 m0, s61, 36864
    v_mfma_f32_16x16x32_bf16 v[52:55], v[180:183], a[56:59], v[52:55]
    ds_read_b64_tr_b16 v[176:177], v20 offset:57344
    ds_read_b64_tr_b16 v[178:179], v20 offset:57856
    v_mfma_f32_16x16x32_bf16 v[60:63], v[180:183], a[60:63], v[60:63]
    buffer_load_dwordx4 v16, s[20:23], s66 offen offset:0 lds
    v_mfma_f32_16x16x32_bf16 v[64:67], v[184:187], a[56:59], v[64:67]
    ds_read_b64_tr_b16 v[180:181], v21 offset:57344
    ds_read_b64_tr_b16 v[182:183], v21 offset:57856
    v_mfma_f32_16x16x32_bf16 v[72:75], v[184:187], a[60:63], v[72:75]
    buffer_load_dwordx4 v17, s[20:23], s66 offen offset:1024 lds
    s_bfe_u32 s66, s99, 0x4001c
    s_mul_i32 s66, s66, 221184
    s_add_u32 s66, s66, s67
    s_add_u32 m0, s61, 12288
    v_mfma_f32_16x16x32_bf16 v[68:71], v[188:191], a[56:59], v[68:71]
    ds_read_b64_tr_b16 v[184:185], v22 offset:57344
    ds_read_b64_tr_b16 v[186:187], v22 offset:57856
    v_mfma_f32_16x16x32_bf16 v[76:79], v[188:191], a[60:63], v[76:79]
    buffer_load_dwordx4 v8, s[8:11], s63 offen offset:0 lds
    s_waitcnt lgkmcnt(6)
    v_mfma_f32_16x16x32_bf16 v[48:51], v[160:163], a[64:67], v[48:51]
    ds_read_b64_tr_b16 v[188:189], v23 offset:57344
    ds_read_b64_tr_b16 v[190:191], v23 offset:57856
    v_mfma_f32_16x16x32_bf16 v[56:59], v[160:163], a[68:71], v[56:59]
    buffer_load_dwordx4 v9, s[8:11], s63 offen offset:1024 lds
    v_mfma_f32_16x16x32_bf16 v[52:55], v[164:167], a[64:67], v[52:55]
    v_mfma_f32_16x16x32_bf16 v[60:63], v[164:167], a[68:71], v[60:63]
    buffer_load_dwordx4 v10, s[8:11], s63 offen offset:2048 lds
    v_mfma_f32_16x16x32_bf16 v[64:67], v[168:171], a[64:67], v[64:67]
    v_mfma_f32_16x16x32_bf16 v[72:75], v[168:171], a[68:71], v[72:75]
    buffer_load_dwordx4 v11, s[8:11], s63 offen offset:3072 lds
    s_bfe_u32 s63, s65, 0x40000
    s_mul_i32 s63, s63, 128
    s_add_u32 s63, s63, s64
    s_add_u32 m0, s61, 38912
    s_waitcnt vmcnt(10) lgkmcnt(0)
    s_barrier
    ds_read_b128 a[80:83], v4 offset:4096
    ds_read_b128 a[84:87], v4 offset:6144
    ds_read_b128 a[88:91], v5 offset:4096
    ds_read_b128 a[92:95], v5 offset:6144
    v_mfma_f32_16x16x32_bf16 v[68:71], v[172:175], a[64:67], v[68:71]
    ds_read_b64_tr_b16 v[160:161], v20 offset:18432
    ds_read_b64_tr_b16 v[162:163], v20 offset:18944
    ds_read_b64_tr_b16 v[164:165], v21 offset:18432
    ds_read_b64_tr_b16 v[166:167], v21 offset:18944
    v_mfma_f32_16x16x32_bf16 v[76:79], v[172:175], a[68:71], v[76:79]
    buffer_load_dwordx4 v16, s[20:23], s66 offen offset:0 lds
    v_mfma_f32_16x16x32_bf16 v[48:51], v[176:179], a[72:75], v[48:51]
    ds_read_b64_tr_b16 v[168:169], v22 offset:18432
    ds_read_b64_tr_b16 v[170:171], v22 offset:18944
    ds_read_b64_tr_b16 v[172:173], v23 offset:18432
    ds_read_b64_tr_b16 v[174:175], v23 offset:18944
    v_mfma_f32_16x16x32_bf16 v[56:59], v[176:179], a[76:79], v[56:59]
    buffer_load_dwordx4 v17, s[20:23], s66 offen offset:1024 lds
    s_bfe_u32 s66, s65, 0x40000
    s_mul_i32 s66, s66, 221184
    s_add_u32 s66, s66, s67
    s_add_u32 m0, s61, 0
    v_mfma_f32_16x16x32_bf16 v[52:55], v[180:183], a[72:75], v[52:55]
    ds_read_b64_tr_b16 v[176:177], v20 offset:59392
    ds_read_b64_tr_b16 v[178:179], v20 offset:59904
    v_mfma_f32_16x16x32_bf16 v[60:63], v[180:183], a[76:79], v[60:63]
    buffer_load_dwordx4 v8, s[8:11], s63 offen offset:0 lds
    v_mfma_f32_16x16x32_bf16 v[64:67], v[184:187], a[72:75], v[64:67]
    ds_read_b64_tr_b16 v[180:181], v21 offset:59392
    ds_read_b64_tr_b16 v[182:183], v21 offset:59904
    v_mfma_f32_16x16x32_bf16 v[72:75], v[184:187], a[76:79], v[72:75]
    buffer_load_dwordx4 v9, s[8:11], s63 offen offset:1024 lds
    v_mfma_f32_16x16x32_bf16 v[68:71], v[188:191], a[72:75], v[68:71]
    ds_read_b64_tr_b16 v[184:185], v22 offset:59392
    ds_read_b64_tr_b16 v[186:187], v22 offset:59904
    v_mfma_f32_16x16x32_bf16 v[76:79], v[188:191], a[76:79], v[76:79]
    buffer_load_dwordx4 v10, s[8:11], s63 offen offset:2048 lds
    s_waitcnt lgkmcnt(6)
    v_mfma_f32_16x16x32_bf16 v[48:51], v[160:163], a[80:83], v[48:51]
    ds_read_b64_tr_b16 v[188:189], v23 offset:59392
    ds_read_b64_tr_b16 v[190:191], v23 offset:59904
    v_mfma_f32_16x16x32_bf16 v[56:59], v[160:163], a[84:87], v[56:59]
    buffer_load_dwordx4 v11, s[8:11], s63 offen offset:3072 lds
    s_bfe_u32 s63, s65, 0x40004
    s_mul_i32 s63, s63, 128
    s_add_u32 s63, s63, s64
    s_add_u32 m0, s61, 32768
    v_mfma_f32_16x16x32_bf16 v[52:55], v[164:167], a[80:83], v[52:55]
    v_mfma_f32_16x16x32_bf16 v[60:63], v[164:167], a[84:87], v[60:63]
    buffer_load_dwordx4 v16, s[20:23], s66 offen offset:0 lds
    v_mfma_f32_16x16x32_bf16 v[64:67], v[168:171], a[80:83], v[64:67]
    v_mfma_f32_16x16x32_bf16 v[72:75], v[168:171], a[84:87], v[72:75]
    buffer_load_dwordx4 v17, s[20:23], s66 offen offset:1024 lds
    s_waitcnt vmcnt(12) lgkmcnt(0)
    s_barrier
    ds_read_b128 a[96:99], v4 offset:8192
    ds_read_b128 a[100:103], v4 offset:10240
    ds_read_b128 a[104:107], v5 offset:8192
    ds_read_b128 a[108:111], v5 offset:10240
    v_mfma_f32_16x16x32_bf16 v[68:71], v[172:175], a[80:83], v[68:71]
    ds_read_b64_tr_b16 v[160:161], v20 offset:20480
    ds_read_b64_tr_b16 v[162:163], v20 offset:20992
    ds_read_b64_tr_b16 v[164:165], v21 offset:20480
    ds_read_b64_tr_b16 v[166:167], v21 offset:20992
    v_mfma_f32_16x16x32_bf16 v[76:79], v[172:175], a[84:87], v[76:79]
    s_bfe_u32 s66, s65, 0x40004
    s_mul_i32 s66, s66, 221184
    s_add_u32 s66, s66, s67
    s_add_u32 m0, s61, 4096
    v_mfma_f32_16x16x32_bf16 v[48:51], v[176:179], a[88:91], v[48:51]
    ds_read_b64_tr_b16 v[168:169], v22 offset:20480
    ds_read_b64_tr_b16 v[170:171], v22 offset:20992
    ds_read_b64_tr_b16 v[172:173], v23 offset:20480
    ds_read_b64_tr_b16 v[174:175], v23 offset:20992
    v_mfma_f32_16x16x32_bf16 v[56:59], v[176:179], a[92:95], v[56:59]
    buffer_load_dwordx4 v8, s[8:11], s63 offen offset:0 lds
    v_mfma_f32_16x16x32_bf16 v[52:55], v[180:183], a[88:91], v[52:55]
    ds_read_b64_tr_b16 v[176:177], v20 offset:61440
    ds_read_b64_tr_b16 v[178:179], v20 offset:61952
    v_mfma_f32_16x16x32_bf16 v[60:63], v[180:183], a[92:95], v[60:63]
    buffer_load_dwordx4 v9, s[8:11], s63 offen offset:1024 lds
    v_mfma_f32_16x16x32_bf16 v[64:67], v[184:187], a[88:91], v[64:67]
    ds_read_b64_tr_b16 v[180:181], v21 offset:61440
    ds_read_b64_tr_b16 v[182:183], v21 offset:61952
    v_mfma_f32_16x16x32_bf16 v[72:75], v[184:187], a[92:95], v[72:75]
    buffer_load_dwordx4 v10, s[8:11], s63 offen offset:2048 lds
    v_mfma_f32_16x16x32_bf16 v[68:71], v[188:191], a[88:91], v[68:71]
    ds_read_b64_tr_b16 v[184:185], v22 offset:61440
    ds_read_b64_tr_b16 v[186:187], v22 offset:61952
    v_mfma_f32_16x16x32_bf16 v[76:79], v[188:191], a[92:95], v[76:79]
    buffer_load_dwordx4 v11, s[8:11], s63 offen offset:3072 lds
    s_add_u32 m0, s61, 34816
    s_waitcnt lgkmcnt(6)
    v_mfma_f32_16x16x32_bf16 v[48:51], v[160:163], a[96:99], v[48:51]
    ds_read_b64_tr_b16 v[188:189], v23 offset:61440
    ds_read_b64_tr_b16 v[190:191], v23 offset:61952
    v_mfma_f32_16x16x32_bf16 v[56:59], v[160:163], a[100:103], v[56:59]
    buffer_load_dwordx4 v16, s[20:23], s66 offen offset:0 lds
    v_mfma_f32_16x16x32_bf16 v[52:55], v[164:167], a[96:99], v[52:55]
    v_mfma_f32_16x16x32_bf16 v[60:63], v[164:167], a[100:103], v[60:63]
    buffer_load_dwordx4 v17, s[20:23], s66 offen offset:1024 lds
    s_add_u32 m0, s61, 16384
    v_mfma_f32_16x16x32_bf16 v[64:67], v[168:171], a[96:99], v[64:67]
    v_mfma_f32_16x16x32_bf16 v[72:75], v[168:171], a[100:103], v[72:75]
    buffer_load_dwordx4 v24, s[20:23], s71 offen offset:0 lds
    s_waitcnt vmcnt(13) lgkmcnt(0)
    s_barrier
    ds_read_b128 a[112:115], v4 offset:12288
    ds_read_b128 a[116:119], v4 offset:14336
    ds_read_b128 a[120:123], v5 offset:12288
    ds_read_b128 a[124:127], v5 offset:14336
    v_mfma_f32_16x16x32_bf16 v[68:71], v[172:175], a[96:99], v[68:71]
    ds_read_b64_tr_b16 v[160:161], v20 offset:22528
    ds_read_b64_tr_b16 v[162:163], v20 offset:23040
    ds_read_b64_tr_b16 v[164:165], v21 offset:22528
    ds_read_b64_tr_b16 v[166:167], v21 offset:23040
    v_mfma_f32_16x16x32_bf16 v[76:79], v[172:175], a[100:103], v[76:79]
    buffer_load_dwordx4 v25, s[20:23], s71 offen offset:1024 lds
    v_mfma_f32_16x16x32_bf16 v[48:51], v[176:179], a[104:107], v[48:51]
    ds_read_b64_tr_b16 v[168:169], v22 offset:22528
    ds_read_b64_tr_b16 v[170:171], v22 offset:23040
    ds_read_b64_tr_b16 v[172:173], v23 offset:22528
    ds_read_b64_tr_b16 v[174:175], v23 offset:23040
    v_mfma_f32_16x16x32_bf16 v[56:59], v[176:179], a[108:111], v[56:59]
    buffer_load_dwordx4 v26, s[20:23], s71 offen offset:2048 lds
    v_mfma_f32_16x16x32_bf16 v[52:55], v[180:183], a[104:107], v[52:55]
    ds_read_b64_tr_b16 v[176:177], v20 offset:63488
    ds_read_b64_tr_b16 v[178:179], v20 offset:64000
    v_mfma_f32_16x16x32_bf16 v[60:63], v[180:183], a[108:111], v[60:63]
    buffer_load_dwordx4 v27, s[20:23], s71 offen offset:3072 lds
    s_add_u32 m0, s61, 20480
    v_mfma_f32_16x16x32_bf16 v[64:67], v[184:187], a[104:107], v[64:67]
    ds_read_b64_tr_b16 v[180:181], v21 offset:63488
    ds_read_b64_tr_b16 v[182:183], v21 offset:64000
    v_mfma_f32_16x16x32_bf16 v[72:75], v[184:187], a[108:111], v[72:75]
    buffer_load_dwordx4 v28, s[20:23], s71 offen offset:0 lds
    v_mfma_f32_16x16x32_bf16 v[68:71], v[188:191], a[104:107], v[68:71]
    ds_read_b64_tr_b16 v[184:185], v22 offset:63488
    ds_read_b64_tr_b16 v[186:187], v22 offset:64000
    v_mfma_f32_16x16x32_bf16 v[76:79], v[188:191], a[108:111], v[76:79]
    buffer_load_dword v47, off, s[44:47], 0 sc1
    s_waitcnt lgkmcnt(6)
    v_mfma_f32_16x16x32_bf16 v[48:51], v[160:163], a[112:115], v[48:51]
    ds_read_b64_tr_b16 v[188:189], v23 offset:63488
    ds_read_b64_tr_b16 v[190:191], v23 offset:64000
    v_mfma_f32_16x16x32_bf16 v[56:59], v[160:163], a[116:119], v[56:59]
    v_mfma_f32_16x16x32_bf16 v[52:55], v[164:167], a[112:115], v[52:55]
    v_mfma_f32_16x16x32_bf16 v[60:63], v[164:167], a[116:119], v[60:63]
    v_mfma_f32_16x16x32_bf16 v[64:67], v[168:171], a[112:115], v[64:67]
    v_mfma_f32_16x16x32_bf16 v[72:75], v[168:171], a[116:119], v[72:75]
    s_waitcnt vmcnt(12) lgkmcnt(0)
    s_barrier
    ds_read_b128 a[128:131], v4 offset:0
    ds_read_b128 a[132:135], v4 offset:2048
    ds_read_b128 a[136:139], v5 offset:0
    ds_read_b128 a[140:143], v5 offset:2048
    v_mfma_f32_16x16x32_bf16 v[68:71], v[172:175], a[112:115], v[68:71]
    ds_read_b64_tr_b16 v[160:161], v20 offset:16384
    ds_read_b64_tr_b16 v[162:163], v20 offset:16896
    ds_read_b64_tr_b16 v[164:165], v21 offset:16384
    ds_read_b64_tr_b16 v[166:167], v21 offset:16896
    v_mfma_f32_16x16x32_bf16 v[76:79], v[172:175], a[116:119], v[76:79]
    v_mfma_f32_16x16x32_bf16 v[48:51], v[176:179], a[120:123], v[48:51]
    ds_read_b64_tr_b16 v[168:169], v22 offset:16384
    ds_read_b64_tr_b16 v[170:171], v22 offset:16896
    ds_read_b64_tr_b16 v[172:173], v23 offset:16384
    ds_read_b64_tr_b16 v[174:175], v23 offset:16896
    v_mfma_f32_16x16x32_bf16 v[56:59], v[176:179], a[124:127], v[56:59]
    v_mfma_f32_16x16x32_bf16 v[52:55], v[180:183], a[120:123], v[52:55]
    ds_read_b64_tr_b16 v[176:177], v20 offset:57344
    ds_read_b64_tr_b16 v[178:179], v20 offset:57856
    v_mfma_f32_16x16x32_bf16 v[60:63], v[180:183], a[124:127], v[60:63]
    v_mfma_f32_16x16x32_bf16 v[64:67], v[184:187], a[120:123], v[64:67]
    ds_read_b64_tr_b16 v[180:181], v21 offset:57344
    ds_read_b64_tr_b16 v[182:183], v21 offset:57856
    v_mfma_f32_16x16x32_bf16 v[72:75], v[184:187], a[124:127], v[72:75]
    v_mfma_f32_16x16x32_bf16 v[68:71], v[188:191], a[120:123], v[68:71]
    ds_read_b64_tr_b16 v[184:185], v22 offset:57344
    ds_read_b64_tr_b16 v[186:187], v22 offset:57856
    v_mfma_f32_16x16x32_bf16 v[76:79], v[188:191], a[124:127], v[76:79]
    s_waitcnt lgkmcnt(6)
    v_mfma_f32_16x16x32_bf16 v[48:51], v[160:163], a[128:131], v[48:51]
    ds_read_b64_tr_b16 v[188:189], v23 offset:57344
    ds_read_b64_tr_b16 v[190:191], v23 offset:57856
    v_mfma_f32_16x16x32_bf16 v[56:59], v[160:163], a[132:135], v[56:59]
    v_mfma_f32_16x16x32_bf16 v[52:55], v[164:167], a[128:131], v[52:55]
    v_mfma_f32_16x16x32_bf16 v[60:63], v[164:167], a[132:135], v[60:63]
    v_mfma_f32_16x16x32_bf16 v[64:67], v[168:171], a[128:131], v[64:67]
    v_mfma_f32_16x16x32_bf16 v[72:75], v[168:171], a[132:135], v[72:75]
    s_waitcnt vmcnt(6) lgkmcnt(0)
    s_barrier
    ds_read_b128 a[144:147], v4 offset:4096
    ds_read_b128 a[148:151], v4 offset:6144
    ds_read_b128 a[152:155], v5 offset:4096
    ds_read_b128 a[156:159], v5 offset:6144
    v_mfma_f32_16x16x32_bf16 v[68:71], v[172:175], a[128:131], v[68:71]
    ds_read_b64_tr_b16 v[160:161], v20 offset:18432
    ds_read_b64_tr_b16 v[162:163], v20 offset:18944
    ds_read_b64_tr_b16 v[164:165], v21 offset:18432
    ds_read_b64_tr_b16 v[166:167], v21 offset:18944
    v_mfma_f32_16x16x32_bf16 v[76:79], v[172:175], a[132:135], v[76:79]
    v_mfma_f32_16x16x32_bf16 v[48:51], v[176:179], a[136:139], v[48:51]
    ds_read_b64_tr_b16 v[168:169], v22 offset:18432
    ds_read_b64_tr_b16 v[170:171], v22 offset:18944
    ds_read_b64_tr_b16 v[172:173], v23 offset:18432
    ds_read_b64_tr_b16 v[174:175], v23 offset:18944
    v_mfma_f32_16x16x32_bf16 v[56:59], v[176:179], a[140:143], v[56:59]
    v_mfma_f32_16x16x32_bf16 v[52:55], v[180:183], a[136:139], v[52:55]
    ds_read_b64_tr_b16 v[176:177], v20 offset:59392
    ds_read_b64_tr_b16 v[178:179], v20 offset:59904
    v_mfma_f32_16x16x32_bf16 v[60:63], v[180:183], a[140:143], v[60:63]
    v_mfma_f32_16x16x32_bf16 v[64:67], v[184:187], a[136:139], v[64:67]
    ds_read_b64_tr_b16 v[180:181], v21 offset:59392
    ds_read_b64_tr_b16 v[182:183], v21 offset:59904
    v_mfma_f32_16x16x32_bf16 v[72:75], v[184:187], a[140:143], v[72:75]
    v_mfma_f32_16x16x32_bf16 v[68:71], v[188:191], a[136:139], v[68:71]
    ds_read_b64_tr_b16 v[184:185], v22 offset:59392
    ds_read_b64_tr_b16 v[186:187], v22 offset:59904
    v_mfma_f32_16x16x32_bf16 v[76:79], v[188:191], a[140:143], v[76:79]
    s_waitcnt lgkmcnt(6)
    v_mfma_f32_16x16x32_bf16 v[48:51], v[160:163], a[144:147], v[48:51]
    ds_read_b64_tr_b16 v[188:189], v23 offset:59392
    ds_read_b64_tr_b16 v[190:191], v23 offset:59904
    v_mfma_f32_16x16x32_bf16 v[56:59], v[160:163], a[148:151], v[56:59]
    v_mfma_f32_16x16x32_bf16 v[52:55], v[164:167], a[144:147], v[52:55]
    v_mfma_f32_16x16x32_bf16 v[60:63], v[164:167], a[148:151], v[60:63]
    v_mfma_f32_16x16x32_bf16 v[64:67], v[168:171], a[144:147], v[64:67]
    v_mfma_f32_16x16x32_bf16 v[72:75], v[168:171], a[148:151], v[72:75]
    v_mfma_f32_16x16x32_bf16 v[68:71], v[172:175], a[144:147], v[68:71]
    v_mfma_f32_16x16x32_bf16 v[76:79], v[172:175], a[148:151], v[76:79]
    s_waitcnt lgkmcnt(0)
    v_mfma_f32_16x16x32_bf16 v[48:51], v[176:179], a[152:155], v[48:51]
    v_mfma_f32_16x16x32_bf16 v[56:59], v[176:179], a[156:159], v[56:59]
    v_mfma_f32_16x16x32_bf16 v[52:55], v[180:183], a[152:155], v[52:55]
    v_mfma_f32_16x16x32_bf16 v[60:63], v[180:183], a[156:159], v[60:63]
    v_mfma_f32_16x16x32_bf16 v[64:67], v[184:187], a[152:155], v[64:67]
    v_mfma_f32_16x16x32_bf16 v[72:75], v[184:187], a[156:159], v[72:75]
    v_mfma_f32_16x16x32_bf16 v[68:71], v[188:191], a[152:155], v[68:71]
    v_mfma_f32_16x16x32_bf16 v[76:79], v[188:191], a[156:159], v[76:79]
    s_bfe_u32 s71, s99, 0x40004
    s_mul_i32 s71, s71, 221184
    s_add_u32 s71, s71, s72
    v_pk_mul_f32 v[80:81], v[48:49], v[48:49]
    s_add_u32 m0, s61, 21504
    s_nop 0
    buffer_load_dwordx4 v24, s[20:23], s71 offen offset:0 lds
    v_pk_mul_f32 v[82:83], v[50:51], v[50:51]
    v_pk_mul_f32 v[84:85], v[52:53], v[52:53]
    v_pk_mul_f32 v[86:87], v[54:55], v[54:55]
    v_pk_fma_f32 v[80:81], v[80:81], s[68:69], s[68:69] op_sel:[0,1,0] op_sel_hi:[1,1,0]
    v_pk_fma_f32 v[82:83], v[82:83], s[68:69], s[68:69] op_sel:[0,1,0] op_sel_hi:[1,1,0]
    v_pk_fma_f32 v[84:85], v[84:85], s[68:69], s[68:69] op_sel:[0,1,0] op_sel_hi:[1,1,0]
    v_pk_fma_f32 v[86:87], v[86:87], s[68:69], s[68:69] op_sel:[0,1,0] op_sel_hi:[1,1,0]
    v_pk_mul_f32 v[80:81], v[80:81], v[48:49]
    v_pk_mul_f32 v[82:83], v[82:83], v[50:51]
    v_pk_mul_f32 v[84:85], v[84:85], v[52:53]
    v_pk_mul_f32 v[86:87], v[86:87], v[54:55]
    v_exp_f32 v80, v80
    v_exp_f32 v81, v81
    buffer_load_dwordx4 v25, s[20:23], s71 offen offset:1024 lds
    v_exp_f32 v82, v82
    v_exp_f32 v83, v83
    v_exp_f32 v84, v84
    v_exp_f32 v85, v85
    v_exp_f32 v86, v86
    v_exp_f32 v87, v87
    v_pk_add_f32 v[80:81], v[80:81], 1.0 op_sel_hi:[1,0]
    v_pk_add_f32 v[82:83], v[82:83], 1.0 op_sel_hi:[1,0]
    v_pk_add_f32 v[84:85], v[84:85], 1.0 op_sel_hi:[1,0]
    v_pk_add_f32 v[86:87], v[86:87], 1.0 op_sel_hi:[1,0]
    v_rcp_f32 v80, v80
    buffer_load_dwordx4 v26, s[20:23], s71 offen offset:2048 lds
    v_rcp_f32 v81, v81
    v_rcp_f32 v82, v82
    v_rcp_f32 v83, v83
    v_rcp_f32 v84, v84
    v_rcp_f32 v85, v85
    v_rcp_f32 v86, v86
    v_rcp_f32 v87, v87
    v_pk_mul_f32 v[48:49], v[80:81], v[48:49]
    v_pk_mul_f32 v[50:51], v[82:83], v[50:51]
    buffer_load_dwordx4 v27, s[20:23], s71 offen offset:3072 lds
    v_pk_mul_f32 v[52:53], v[84:85], v[52:53]
    v_pk_mul_f32 v[54:55], v[86:87], v[54:55]
    v_pk_mul_f32 v[80:81], v[56:57], v[56:57]
    v_pk_mul_f32 v[82:83], v[58:59], v[58:59]
    v_pk_mul_f32 v[84:85], v[60:61], v[60:61]
    v_pk_mul_f32 v[86:87], v[62:63], v[62:63]
    v_pk_fma_f32 v[80:81], v[80:81], s[68:69], s[68:69] op_sel:[0,1,0] op_sel_hi:[1,1,0]
    v_pk_fma_f32 v[82:83], v[82:83], s[68:69], s[68:69] op_sel:[0,1,0] op_sel_hi:[1,1,0]
    v_pk_fma_f32 v[84:85], v[84:85], s[68:69], s[68:69] op_sel:[0,1,0] op_sel_hi:[1,1,0]
    v_pk_fma_f32 v[86:87], v[86:87], s[68:69], s[68:69] op_sel:[0,1,0] op_sel_hi:[1,1,0]
    v_pk_mul_f32 v[80:81], v[80:81], v[56:57]
    v_pk_mul_f32 v[82:83], v[82:83], v[58:59]
    v_pk_mul_f32 v[84:85], v[84:85], v[60:61]
    v_pk_mul_f32 v[86:87], v[86:87], v[62:63]
    v_exp_f32 v80, v80
    v_exp_f32 v81, v81
    s_add_u32 m0, s61, 25600
    s_nop 0
    buffer_load_dwordx4 v28, s[20:23], s71 offen offset:0 lds
    v_exp_f32 v82, v82
    v_exp_f32 v83, v83
    v_exp_f32 v84, v84
    v_exp_f32 v85, v85
    v_exp_f32 v86, v86
    v_exp_f32 v87, v87
    v_pk_add_f32 v[80:81], v[80:81], 1.0 op_sel_hi:[1,0]
    v_pk_add_f32 v[82:83], v[82:83], 1.0 op_sel_hi:[1,0]
    v_pk_add_f32 v[84:85], v[84:85], 1.0 op_sel_hi:[1,0]
    v_pk_add_f32 v[86:87], v[86:87], 1.0 op_sel_hi:[1,0]
    v_rcp_f32 v80, v80
    v_rcp_f32 v81, v81
    v_rcp_f32 v82, v82
    v_rcp_f32 v83, v83
    v_rcp_f32 v84, v84
    v_rcp_f32 v85, v85
    v_rcp_f32 v86, v86
    v_rcp_f32 v87, v87
    v_pk_mul_f32 v[56:57], v[80:81], v[56:57]
    v_pk_mul_f32 v[58:59], v[82:83], v[58:59]
    v_pk_mul_f32 v[60:61], v[84:85], v[60:61]
    v_pk_mul_f32 v[62:63], v[86:87], v[62:63]
    v_pk_mul_f32 v[80:81], v[64:65], v[64:65]
    v_pk_mul_f32 v[82:83], v[66:67], v[66:67]
    v_pk_mul_f32 v[84:85], v[68:69], v[68:69]
    v_pk_mul_f32 v[86:87], v[70:71], v[70:71]
    v_pk_fma_f32 v[80:81], v[80:81], s[68:69], s[68:69] op_sel:[0,1,0] op_sel_hi:[1,1,0]
    v_pk_fma_f32 v[82:83], v[82:83], s[68:69], s[68:69] op_sel:[0,1,0] op_sel_hi:[1,1,0]
    v_pk_fma_f32 v[84:85], v[84:85], s[68:69], s[68:69] op_sel:[0,1,0] op_sel_hi:[1,1,0]
    v_pk_fma_f32 v[86:87], v[86:87], s[68:69], s[68:69] op_sel:[0,1,0] op_sel_hi:[1,1,0]
    v_pk_mul_f32 v[80:81], v[80:81], v[64:65]
    v_pk_mul_f32 v[82:83], v[82:83], v[66:67]
    v_pk_mul_f32 v[84:85], v[84:85], v[68:69]
    v_pk_mul_f32 v[86:87], v[86:87], v[70:71]
    v_exp_f32 v80, v80
    v_exp_f32 v81, v81
    v_exp_f32 v82, v82
    v_exp_f32 v83, v83
    v_exp_f32 v84, v84
    v_exp_f32 v85, v85
    v_exp_f32 v86, v86
    v_exp_f32 v87, v87
    v_pk_add_f32 v[80:81], v[80:81], 1.0 op_sel_hi:[1,0]
    v_pk_add_f32 v[82:83], v[82:83], 1.0 op_sel_hi:[1,0]
    v_pk_add_f32 v[84:85], v[84:85], 1.0 op_sel_hi:[1,0]
    v_pk_add_f32 v[86:87], v[86:87], 1.0 op_sel_hi:[1,0]
    v_rcp_f32 v80, v80
    v_rcp_f32 v81, v81
    v_rcp_f32 v82, v82
    v_rcp_f32 v83, v83
    v_rcp_f32 v84, v84
    v_rcp_f32 v85, v85
    v_rcp_f32 v86, v86
    v_rcp_f32 v87, v87
    v_pk_mul_f32 v[64:65], v[80:81], v[64:65]
    v_pk_mul_f32 v[66:67], v[82:83], v[66:67]
    v_pk_mul_f32 v[68:69], v[84:85], v[68:69]
    v_pk_mul_f32 v[70:71], v[86:87], v[70:71]
    v_pk_mul_f32 v[80:81], v[72:73], v[72:73]
    v_pk_mul_f32 v[82:83], v[74:75], v[74:75]
    v_pk_mul_f32 v[84:85], v[76:77], v[76:77]
    v_pk_mul_f32 v[86:87], v[78:79], v[78:79]
    v_pk_fma_f32 v[80:81], v[80:81], s[68:69], s[68:69] op_sel:[0,1,0] op_sel_hi:[1,1,0]
    v_pk_fma_f32 v[82:83], v[82:83], s[68:69], s[68:69] op_sel:[0,1,0] op_sel_hi:[1,1,0]
    v_pk_fma_f32 v[84:85], v[84:85], s[68:69], s[68:69] op_sel:[0,1,0] op_sel_hi:[1,1,0]
    v_pk_fma_f32 v[86:87], v[86:87], s[68:69], s[68:69] op_sel:[0,1,0] op_sel_hi:[1,1,0]
    v_pk_mul_f32 v[80:81], v[80:81], v[72:73]
    v_pk_mul_f32 v[82:83], v[82:83], v[74:75]
    v_pk_mul_f32 v[84:85], v[84:85], v[76:77]
    v_pk_mul_f32 v[86:87], v[86:87], v[78:79]
    v_exp_f32 v80, v80
    v_exp_f32 v81, v81
    v_exp_f32 v82, v82
    v_exp_f32 v83, v83
    v_exp_f32 v84, v84
    v_exp_f32 v85, v85
    v_exp_f32 v86, v86
    v_exp_f32 v87, v87
    v_pk_add_f32 v[80:81], v[80:81], 1.0 op_sel_hi:[1,0]
    v_pk_add_f32 v[82:83], v[82:83], 1.0 op_sel_hi:[1,0]
    v_pk_add_f32 v[84:85], v[84:85], 1.0 op_sel_hi:[1,0]
    v_pk_add_f32 v[86:87], v[86:87], 1.0 op_sel_hi:[1,0]
    v_rcp_f32 v80, v80
    v_rcp_f32 v81, v81
    v_rcp_f32 v82, v82
    v_rcp_f32 v83, v83
    v_rcp_f32 v84, v84
    v_rcp_f32 v85, v85
    v_rcp_f32 v86, v86
    v_rcp_f32 v87, v87
    v_pk_mul_f32 v[72:73], v[80:81], v[72:73]
    v_pk_mul_f32 v[74:75], v[82:83], v[74:75]
    v_pk_mul_f32 v[76:77], v[84:85], v[76:77]
    v_pk_mul_f32 v[78:79], v[86:87], v[78:79]
    v_pk_add_f32 v[88:89], v[48:49], v[50:51]
    v_pk_mul_f32 v[96:97], v[48:49], v[48:49]
    v_pk_fma_f32 v[96:97], v[50:51], v[50:51], v[96:97]
    v_pk_add_f32 v[88:89], v[88:89], v[52:53]
    v_pk_fma_f32 v[96:97], v[52:53], v[52:53], v[96:97]
    v_pk_add_f32 v[88:89], v[88:89], v[54:55]
    v_pk_fma_f32 v[96:97], v[54:55], v[54:55], v[96:97]
    v_pk_add_f32 v[90:91], v[56:57], v[58:59]
    v_pk_mul_f32 v[98:99], v[56:57], v[56:57]
    v_pk_fma_f32 v[98:99], v[58:59], v[58:59], v[98:99]
    v_pk_add_f32 v[90:91], v[90:91], v[60:61]
    v_pk_fma_f32 v[98:99], v[60:61], v[60:61], v[98:99]
    v_pk_add_f32 v[90:91], v[90:91], v[62:63]
    v_pk_fma_f32 v[98:99], v[62:63], v[62:63], v[98:99]
    v_pk_add_f32 v[92:93], v[64:65], v[66:67]
    v_pk_mul_f32 v[100:101], v[64:65], v[64:65]
    v_pk_fma_f32 v[100:101], v[66:67], v[66:67], v[100:101]
    v_pk_add_f32 v[92:93], v[92:93], v[68:69]
    v_pk_fma_f32 v[100:101], v[68:69], v[68:69], v[100:101]
    v_pk_add_f32 v[92:93], v[92:93], v[70:71]
    v_pk_fma_f32 v[100:101], v[70:71], v[70:71], v[100:101]
    v_pk_add_f32 v[94:95], v[72:73], v[74:75]
    v_pk_mul_f32 v[102:103], v[72:73], v[72:73]
    v_pk_fma_f32 v[102:103], v[74:75], v[74:75], v[102:103]
    v_pk_add_f32 v[94:95], v[94:95], v[76:77]
    v_pk_fma_f32 v[102:103], v[76:77], v[76:77], v[102:103]
    v_pk_add_f32 v[94:95], v[94:95], v[78:79]
    v_pk_fma_f32 v[102:103], v[78:79], v[78:79], v[102:103]
    s_cmp_eq_u32 s60, 0
    s_cselect_b32 s100, 0, 1.0
    v_pk_fma_f32 v[88:89], v[88:89], s[100:101], v[92:93] op_sel_hi:[1,0,1]
    v_pk_fma_f32 v[90:91], v[90:91], s[100:101], v[94:95] op_sel_hi:[1,0,1]
    v_pk_fma_f32 v[96:97], v[96:97], s[100:101], v[100:101] op_sel_hi:[1,0,1]
    v_pk_fma_f32 v[98:99], v[98:99], s[100:101], v[102:103] op_sel_hi:[1,0,1]
    v_add_f32 v88, v88, v89
    v_add_f32 v90, v90, v91
    v_add_f32 v96, v96, v97
    v_add_f32 v98, v98, v99
    s_lshl2_add_u32 s76, s57, s56
    s_mul_i32 s7, s76, 3584
    v_permlane32_swap_b32 v88, v96
    v_permlane32_swap_b32 v90, v98
    v_add_f32 v88, v88, v96
    v_add_f32 v90, v90, v98
    s_lshl_b32 s76, s60, 8
    s_add_u32 s76, s76, s7
    v_permlane16_swap_b32 v88, v90
    v_add_f32 v90, v90, v88
    s_waitcnt vmcnt(5)
    v_cmp_gt_u32 vcc, 32, v47
    s_nop 1
    s_cbranch_vccnz Lslow_8
Lback_9:
    buffer_store_dword v90, v31, s[48:51], s76 offen sc1
    s_barrier
    ds_read_b64_tr_b16 v[160:161], v18 offset:0
    ds_read_b64_tr_b16 v[162:163], v18 offset:1280
    ds_read_b64_tr_b16 v[164:165], v19 offset:0
    ds_read_b64_tr_b16 v[166:167], v19 offset:1280
    ds_read_b64_tr_b16 v[168:169], v18 offset:64
    ds_read_b64_tr_b16 v[170:171], v18 offset:1344
    ds_read_b64_tr_b16 v[172:173], v19 offset:64
    ds_read_b64_tr_b16 v[174:175], v19 offset:1344
    ds_read_b64_tr_b16 v[176:177], v18 offset:128
    ds_read_b64_tr_b16 v[178:179], v18 offset:1408
    ds_read_b64_tr_b16 v[180:181], v19 offset:128
    ds_read_b64_tr_b16 v[182:183], v19 offset:1408
    s_waitcnt lgkmcnt(10)
    v_mfma_f32_16x16x32_bf16 v[80:83], v[160:163], a[0:3], 0
    ds_read_b64_tr_b16 v[184:185], v18 offset:192
    ds_read_b64_tr_b16 v[186:187], v18 offset:1472
    ds_read_b64_tr_b16 v[188:189], v19 offset:192
    ds_read_b64_tr_b16 v[190:191], v19 offset:1472
    v_mfma_f32_16x16x32_bf16 v[88:91], v[160:163], a[4:7], 0
    s_bfe_u32 s71, s99, 0x40008
    s_mul_i32 s71, s71, 221184
    s_add_u32 s71, s71, s72
    s_add_u32 m0, s61, 26624
    s_nop 0
    buffer_load_dwordx4 v24, s[20:23], s71 offen offset:0 lds
    s_waitcnt lgkmcnt(12)
    v_mfma_f32_16x16x32_bf16 v[84:87], v[164:167], a[0:3], 0
    ds_read_b64_tr_b16 v[160:161], v18 offset:256
    ds_read_b64_tr_b16 v[162:163], v18 offset:1536
    v_mfma_f32_16x16x32_bf16 v[92:95], v[164:167], a[4:7], 0
    buffer_load_dwordx4 v25, s[20:23], s71 offen offset:1024 lds
    s_waitcnt lgkmcnt(6)
    v_mfma_f32_16x16x32_bf16 v[96:99], v[168:171], a[0:3], 0
    ds_read_b64_tr_b16 v[164:165], v19 offset:256
    ds_read_b64_tr_b16 v[166:167], v19 offset:1536
    v_mfma_f32_16x16x32_bf16 v[104:107], v[168:171], a[4:7], 0
    buffer_load_dwordx4 v26, s[20:23], s71 offen offset:2048 lds
    v_mfma_f32_16x16x32_bf16 v[100:103], v[172:175], a[0:3], 0
    ds_read_b64_tr_b16 v[168:169], v18 offset:40960
    ds_read_b64_tr_b16 v[170:171], v18 offset:42240
    v_mfma_f32_16x16x32_bf16 v[108:111], v[172:175], a[4:7], 0
    buffer_load_dwordx4 v27, s[20:23], s71 offen offset:3072 lds
    s_add_u32 m0, s61, 30720
    v_mfma_f32_16x16x32_bf16 v[112:115], v[176:179], a[0:3], 0
    ds_read_b64_tr_b16 v[172:173], v19 offset:40960
    ds_read_b64_tr_b16 v[174:175], v19 offset:42240
    v_mfma_f32_16x16x32_bf16 v[120:123], v[176:179], a[4:7], 0
    buffer_load_dwordx4 v28, s[20:23], s71 offen offset:0 lds
    s_bfe_u32 s71, s99, 0x4000c
    s_mul_i32 s71, s71, 221184
    s_add_u32 s71, s71, s72
    s_add_u32 m0, s61, 31744
    v_mfma_f32_16x16x32_bf16 v[116:119], v[180:183], a[0:3], 0
    ds_read_b64_tr_b16 v[176:177], v18 offset:41024
    ds_read_b64_tr_b16 v[178:179], v18 offset:42304
    v_mfma_f32_16x16x32_bf16 v[124:127], v[180:183], a[4:7], 0
    s_waitcnt lgkmcnt(6)
    v_mfma_f32_16x16x32_bf16 v[128:131], v[184:187], a[0:3], 0
    ds_read_b64_tr_b16 v[180:181], v19 offset:41024
    ds_read_b64_tr_b16 v[182:183], v19 offset:42304
    v_mfma_f32_16x16x32_bf16 v[136:139], v[184:187], a[4:7], 0
    v_mfma_f32_16x16x32_bf16 v[132:135], v[188:191], a[0:3], 0
    ds_read_b64_tr_b16 v[184:185], v18 offset:41088
    ds_read_b64_tr_b16 v[186:187], v18 offset:42368
    v_mfma_f32_16x16x32_bf16 v[140:143], v[188:191], a[4:7], 0
    v_mfma_f32_16x16x32_bf16 v[144:147], v[160:163], a[0:3], 0
    ds_read_b64_tr_b16 v[188:189], v19 offset:41088
    ds_read_b64_tr_b16 v[190:191], v19 offset:42368
    v_mfma_f32_16x16x32_bf16 v[152:155], v[160:163], a[4:7], 0
    v_mfma_f32_16x16x32_bf16 v[148:151], v[164:167], a[0:3], 0
    ds_read_b64_tr_b16 v[160:161], v18 offset:41152
    ds_read_b64_tr_b16 v[162:163], v18 offset:42432
    v_mfma_f32_16x16x32_bf16 v[156:159], v[164:167], a[4:7], 0
    s_waitcnt lgkmcnt(6)
    v_mfma_f32_16x16x32_bf16 v[80:83], v[168:171], a[8:11], v[80:83]
    ds_read_b64_tr_b16 v[164:165], v19 offset:41152
    ds_read_b64_tr_b16 v[166:167], v19 offset:42432
    v_mfma_f32_16x16x32_bf16 v[88:91], v[168:171], a[12:15], v[88:91]
    buffer_load_dwordx4 v24, s[20:23], s71 offen offset:0 lds
    v_mfma_f32_16x16x32_bf16 v[84:87], v[172:175], a[8:11], v[84:87]
    ds_read_b64_tr_b16 v[168:169], v18 offset:41216
    ds_read_b64_tr_b16 v[170:171], v18 offset:42496
    v_mfma_f32_16x16x32_bf16 v[92:95], v[172:175], a[12:15], v[92:95]
    v_mfma_f32_16x16x32_bf16 v[96:99], v[176:179], a[8:11], v[96:99]
    ds_read_b64_tr_b16 v[172:173], v19 offset:41216
    ds_read_b64_tr_b16 v[174:175], v19 offset:42496
    v_mfma_f32_16x16x32_bf16 v[104:107], v[176:179], a[12:15], v[104:107]
    buffer_load_dwordx4 v25, s[20:23], s71 offen offset:1024 lds
    v_mfma_f32_16x16x32_bf16 v[100:103], v[180:183], a[8:11], v[100:103]
    v_mfma_f32_16x16x32_bf16 v[108:111], v[180:183], a[12:15], v[108:111]
    s_waitcnt lgkmcnt(4)
    v_mfma_f32_16x16x32_bf16 v[112:115], v[184:187], a[8:11], v[112:115]
    v_mfma_f32_16x16x32_bf16 v[120:123], v[184:187], a[12:15], v[120:123]
    buffer_load_dwordx4 v26, s[20:23], s71 offen offset:2048 lds
    s_waitcnt vmcnt(9) lgkmcnt(0)
    s_barrier
    v_mfma_f32_16x16x32_bf16 v[116:119], v[188:191], a[8:11], v[116:119]
    ds_read_b64_tr_b16 v[176:177], v18 offset:5120
    ds_read_b64_tr_b16 v[178:179], v18 offset:6400
    ds_read_b64_tr_b16 v[180:181], v19 offset:5120
    ds_read_b64_tr_b16 v[182:183], v19 offset:6400
    v_mfma_f32_16x16x32_bf16 v[124:127], v[188:191], a[12:15], v[124:127]
    v_mfma_f32_16x16x32_bf16 v[128:131], v[160:163], a[8:11], v[128:131]
    ds_read_b64_tr_b16 v[184:185], v18 offset:5184
    ds_read_b64_tr_b16 v[186:187], v18 offset:6464
    ds_read_b64_tr_b16 v[188:189], v19 offset:5184
    ds_read_b64_tr_b16 v[190:191], v19 offset:6464
    v_mfma_f32_16x16x32_bf16 v[136:139], v[160:163], a[12:15], v[136:139]
    buffer_load_dwordx4 v27, s[20:23], s71 offen offset:3072 lds
    v_mfma_f32_16x16x32_bf16 v[132:135], v[164:167], a[8:11], v[132:135]
    ds_read_b64_tr_b16 v[160:161], v18 offset:5248
    ds_read_b64_tr_b16 v[162:163], v18 offset:6528
    v_mfma_f32_16x16x32_bf16 v[140:143], v[164:167], a[12:15], v[140:143]
    s_add_u32 m0, s61, 35840
    v_mfma_f32_16x16x32_bf16 v[144:147], v[168:171], a[8:11], v[144:147]
    ds_read_b64_tr_b16 v[164:165], v19 offset:5248
    ds_read_b64_tr_b16 v[166:167], v19 offset:6528
    v_mfma_f32_16x16x32_bf16 v[152:155], v[168:171], a[12:15], v[152:155]
    buffer_load_dwordx4 v28, s[20:23], s71 offen offset:0 lds
    s_bfe_u32 s71, s99, 0x40010
    s_mul_i32 s71, s71, 221184
    s_add_u32 s71, s71, s72
    s_add_u32 m0, s61, 16384
    v_mfma_f32_16x16x32_bf16 v[148:151], v[172:175], a[8:11], v[148:151]
    ds_read_b64_tr_b16 v[168:169], v18 offset:5312
    ds_read_b64_tr_b16 v[170:171], v18 offset:6592
    v_mfma_f32_16x16x32_bf16 v[156:159], v[172:175], a[12:15], v[156:159]
    s_waitcnt lgkmcnt(6)
    v_mfma_f32_16x16x32_bf16 v[80:83], v[176:179], a[16:19], v[80:83]
    ds_read_b64_tr_b16 v[172:173], v19 offset:5312
    ds_read_b64_tr_b16 v[174:175], v19 offset:6592
    v_mfma_f32_16x16x32_bf16 v[88:91], v[176:179], a[20:23], v[88:91]
    buffer_load_dwordx4 v24, s[20:23], s71 offen offset:0 lds
    v_mfma_f32_16x16x32_bf16 v[84:87], v[180:183], a[16:19], v[84:87]
    ds_read_b64_tr_b16 v[176:177], v18 offset:5376
    ds_read_b64_tr_b16 v[178:179], v18 offset:6656
    v_mfma_f32_16x16x32_bf16 v[92:95], v[180:183], a[20:23], v[92:95]
    v_mfma_f32_16x16x32_bf16 v[96:99], v[184:187], a[16:19], v[96:99]
    ds_read_b64_tr_b16 v[180:181], v19 offset:5376
    ds_read_b64_tr_b16 v[182:183], v19 offset:6656
    v_mfma_f32_16x16x32_bf16 v[104:107], v[184:187], a[20:23], v[104:107]
    buffer_load_dwordx4 v25, s[20:23], s71 offen offset:1024 lds
    v_mfma_f32_16x16x32_bf16 v[100:103], v[188:191], a[16:19], v[100:103]
    ds_read_b64_tr_b16 v[184:185], v18 offset:46080
    ds_read_b64_tr_b16 v[186:187], v18 offset:47360
    v_mfma_f32_16x16x32_bf16 v[108:111], v[188:191], a[20:23], v[108:111]
    s_waitcnt lgkmcnt(6)
    v_mfma_f32_16x16x32_bf16 v[112:115], v[160:163], a[16:19], v[112:115]
    ds_read_b64_tr_b16 v[188:189], v19 offset:46080
    ds_read_b64_tr_b16 v[190:191], v19 offset:47360
    v_mfma_f32_16x16x32_bf16 v[120:123], v[160:163], a[20:23], v[120:123]
    buffer_load_dword v192, v31, s[48:51], s7 offen offset:0 sc1
    buffer_load_dword v193, v31, s[48:51], s7 offen offset:256 sc1
    v_mfma_f32_16x16x32_bf16 v[116:119], v[164:167], a[16:19], v[116:119]
    ds_read_b64_tr_b16 v[160:161], v18 offset:46144
    ds_read_b64_tr_b16 v[162:163], v18 offset:47424
    v_mfma_f32_16x16x32_bf16 v[124:127], v[164:167], a[20:23], v[124:127]
    buffer_load_dword v194, v31, s[48:51], s7 offen offset:512 sc1
    buffer_load_dword v195, v31, s[48:51], s7 offen offset:768 sc1
    v_mfma_f32_16x16x32_bf16 v[128:131], v[168:171], a[16:19], v[128:131]
    ds_read_b64_tr_b16 v[164:165], v19 offset:46144
    ds_read_b64_tr_b16 v[166:167], v19 offset:47424
    v_mfma_f32_16x16x32_bf16 v[136:139], v[168:171], a[20:23], v[136:139]
    buffer_load_dword v196, v31, s[48:51], s7 offen offset:1024 sc1
    buffer_load_dword v197, v31, s[48:51], s7 offen offset:1280 sc1
    v_mfma_f32_16x16x32_bf16 v[132:135], v[172:175], a[16:19], v[132:135]
    ds_read_b64_tr_b16 v[168:169], v18 offset:46208
    ds_read_b64_tr_b16 v[170:171], v18 offset:47488
    v_mfma_f32_16x16x32_bf16 v[140:143], v[172:175], a[20:23], v[140:143]
    buffer_load_dword v198, v31, s[48:51], s7 offen offset:1536 sc1
    s_waitcnt lgkmcnt(6)
    v_mfma_f32_16x16x32_bf16 v[144:147], v[176:179], a[16:19], v[144:147]
    ds_read_b64_tr_b16 v[172:173], v19 offset:46208
    ds_read_b64_tr_b16 v[174:175], v19 offset:47488
    v_mfma_f32_16x16x32_bf16 v[152:155], v[176:179], a[20:23], v[152:155]
    buffer_load_dword v199, v31, s[48:51], s7 offen offset:1792 sc1
    buffer_load_dword v200, v31, s[48:51], s7 offen offset:2048 sc1
    v_mfma_f32_16x16x32_bf16 v[148:151], v[180:183], a[16:19], v[148:151]
    ds_read_b64_tr_b16 v[176:177], v18 offset:46272
    ds_read_b64_tr_b16 v[178:179], v18 offset:47552
    v_mfma_f32_16x16x32_bf16 v[156:159], v[180:183], a[20:23], v[156:159]
    buffer_load_dword v201, v31, s[48:51], s7 offen offset:2304 sc1
    buffer_load_dword v202, v31, s[48:51], s7 offen offset:2560 sc1
    v_mfma_f32_16x16x32_bf16 v[80:83], v[184:187], a[24:27], v[80:83]
    ds_read_b64_tr_b16 v[180:181], v19 offset:46272
    ds_read_b64_tr_b16 v[182:183], v19 offset:47552
    v_mfma_f32_16x16x32_bf16 v[88:91], v[184:187], a[28:31], v[88:91]
    buffer_load_dword v203, v31, s[48:51], s7 offen offset:2816 sc1
    buffer_load_dword v204, v31, s[48:51], s7 offen offset:3072 sc1
    v_mfma_f32_16x16x32_bf16 v[84:87], v[188:191], a[24:27], v[84:87]
    ds_read_b64_tr_b16 v[184:185], v18 offset:46336
    ds_read_b64_tr_b16 v[186:187], v18 offset:47616
    v_mfma_f32_16x16x32_bf16 v[92:95], v[188:191], a[28:31], v[92:95]
    buffer_load_dword v205, v31, s[48:51], s7 offen offset:3328 sc1
    s_waitcnt lgkmcnt(6)
    v_mfma_f32_16x16x32_bf16 v[96:99], v[160:163], a[24:27], v[96:99]
    ds_read_b64_tr_b16 v[188:189], v19 offset:46336
    ds_read_b64_tr_b16 v[190:191], v19 offset:47616
    v_mfma_f32_16x16x32_bf16 v[104:107], v[160:163], a[28:31], v[104:107]
    buffer_load_dwordx4 v26, s[20:23], s71 offen offset:2048 lds
    v_mfma_f32_16x16x32_bf16 v[100:103], v[164:167], a[24:27], v[100:103]
    v_mfma_f32_16x16x32_bf16 v[108:111], v[164:167], a[28:31], v[108:111]
    v_mfma_f32_16x16x32_bf16 v[112:115], v[168:171], a[24:27], v[112:115]
    v_mfma_f32_16x16x32_bf16 v[120:123], v[168:171], a[28:31], v[120:123]
    buffer_load_dwordx4 v27, s[20:23], s71 offen offset:3072 lds
    s_waitcnt vmcnt(23) lgkmcnt(0)
    s_barrier
    v_mfma_f32_16x16x32_bf16 v[116:119], v[172:175], a[24:27], v[116:119]
    ds_read_b64_tr_b16 v[160:161], v18 offset:10240
    ds_read_b64_tr_b16 v[162:163], v18 offset:11520
    ds_read_b64_tr_b16 v[164:165], v19 offset:10240
    ds_read_b64_tr_b16 v[166:167], v19 offset:11520
    v_mfma_f32_16x16x32_bf16 v[124:127], v[172:175], a[28:31], v[124:127]
    s_add_u32 m0, s61, 20480
    v_mfma_f32_16x16x32_bf16 v[128:131], v[176:179], a[24:27], v[128:131]
    ds_read_b64_tr_b16 v[168:169], v18 offset:10304
    ds_read_b64_tr_b16 v[170:171], v18 offset:11584
    ds_read_b64_tr_b16 v[172:173], v19 offset:10304
    ds_read_b64_tr_b16 v[174:175], v19 offset:11584
    v_mfma_f32_16x16x32_bf16 v[136:139], v[176:179], a[28:31], v[136:139]
    buffer_load_dwordx4 v28, s[20:23], s71 offen offset:0 lds
    s_bfe_u32 s71, s99, 0x40014
    s_mul_i32 s71, s71, 221184
    v_mfma_f32_16x16x32_bf16 v[132:135], v[180:183], a[24:27], v[132:135]
    ds_read_b64_tr_b16 v[176:177], v18 offset:10368
    ds_read_b64_tr_b16 v[178:179], v18 offset:11648
    v_mfma_f32_16x16x32_bf16 v[140:143], v[180:183], a[28:31], v[140:143]
    s_add_u32 s71, s71, s72
    s_add_u32 m0, s61, 21504
    v_mfma_f32_16x16x32_bf16 v[144:147], v[184:187], a[24:27], v[144:147]
    ds_read_b64_tr_b16 v[180:181], v19 offset:10368
    ds_read_b64_tr_b16 v[182:183], v19 offset:11648
    v_mfma_f32_16x16x32_bf16 v[152:155], v[184:187], a[28:31], v[152:155]
    buffer_load_dwordx4 v24, s[20:23], s71 offen offset:0 lds
    v_mfma_f32_16x16x32_bf16 v[148:151], v[188:191], a[24:27], v[148:151]
    ds_read_b64_tr_b16 v[184:185], v18 offset:10432
    ds_read_b64_tr_b16 v[186:187], v18 offset:11712
    v_mfma_f32_16x16x32_bf16 v[156:159], v[188:191], a[28:31], v[156:159]
    s_waitcnt lgkmcnt(6)
    v_mfma_f32_16x16x32_bf16 v[80:83], v[160:163], a[32:35], v[80:83]
    ds_read_b64_tr_b16 v[188:189], v19 offset:10432
    ds_read_b64_tr_b16 v[190:191], v19 offset:11712
    v_mfma_f32_16x16x32_bf16 v[88:91], v[160:163], a[36:39], v[88:91]
    buffer_load_dwordx4 v25, s[20:23], s71 offen offset:1024 lds
    v_mfma_f32_16x16x32_bf16 v[84:87], v[164:167], a[32:35], v[84:87]
    ds_read_b64_tr_b16 v[160:161], v18 offset:10496
    ds_read_b64_tr_b16 v[162:163], v18 offset:11776
    v_mfma_f32_16x16x32_bf16 v[92:95], v[164:167], a[36:39], v[92:95]
    v_mfma_f32_16x16x32_bf16 v[96:99], v[168:171], a[32:35], v[96:99]
    ds_read_b64_tr_b16 v[164:165], v19 offset:10496
    ds_read_b64_tr_b16 v[166:167], v19 offset:11776
    v_mfma_f32_16x16x32_bf16 v[104:107], v[168:171], a[36:39], v[104:107]
    buffer_load_dwordx4 v26, s[20:23], s71 offen offset:2048 lds
    v_mfma_f32_16x16x32_bf16 v[100:103], v[172:175], a[32:35], v[100:103]
    ds_read_b64_tr_b16 v[168:169], v18 offset:51200
    ds_read_b64_tr_b16 v[170:171], v18 offset:52480
    v_mfma_f32_16x16x32_bf16 v[108:111], v[172:175], a[36:39], v[108:111]
    s_waitcnt lgkmcnt(6)
    v_mfma_f32_16x16x32_bf16 v[112:115], v[176:179], a[32:35], v[112:115]
    ds_read_b64_tr_b16 v[172:173], v19 offset:51200
    ds_read_b64_tr_b16 v[174:175], v19 offset:52480
    v_mfma_f32_16x16x32_bf16 v[120:123], v[176:179], a[36:39], v[120:123]
    buffer_load_dwordx4 v27, s[20:23], s71 offen offset:3072 lds
    v_mfma_f32_16x16x32_bf16 v[116:119], v[180:183], a[32:35], v[116:119]
    ds_read_b64_tr_b16 v[176:177], v18 offset:51264
    ds_read_b64_tr_b16 v[178:179], v18 offset:52544
    v_mfma_f32_16x16x32_bf16 v[124:127], v[180:183], a[36:39], v[124:127]
    s_add_u32 m0, s61, 25600
    v_mfma_f32_16x16x32_bf16 v[128:131], v[184:187], a[32:35], v[128:131]
    ds_read_b64_tr_b16 v[180:181], v19 offset:51264
    ds_read_b64_tr_b16 v[182:183], v19 offset:52544
    v_mfma_f32_16x16x32_bf16 v[136:139], v[184:187], a[36:39], v[136:139]
    buffer_load_dwordx4 v28, s[20:23], s71 offen offset:0 lds
    s_bfe_u32 s71, s99, 0x40018
    s_mul_i32 s71, s71, 221184
    v_mfma_f32_16x16x32_bf16 v[132:135], v[188:191], a[32:35], v[132:135]
    ds_read_b64_tr_b16 v[184:185], v18 offset:51328
    ds_read_b64_tr_b16 v[186:187], v18 offset:52608
    v_mfma_f32_16x16x32_bf16 v[140:143], v[188:191], a[36:39], v[140:143]
    s_add_u32 s71, s71, s72
    s_add_u32 m0, s61, 0
    s_waitcnt lgkmcnt(6)
    v_mfma_f32_16x16x32_bf16 v[144:147], v[160:163], a[32:35], v[144:147]
    ds_read_b64_tr_b16 v[188:189], v19 offset:51328
    ds_read_b64_tr_b16 v[190:191], v19 offset:52608
    v_mfma_f32_16x16x32_bf16 v[152:155], v[160:163], a[36:39], v[152:155]
    buffer_load_dwordx4 v32, s[24:27], s82 offen offset:0 lds
    s_waitcnt vmcnt(9)
    v_add_f32 v192, v192, v194
    v_mfma_f32_16x16x32_bf16 v[148:151], v[164:167], a[32:35], v[148:151]
    ds_read_b64_tr_b16 v[160:161], v18 offset:51392
    ds_read_b64_tr_b16 v[162:163], v18 offset:52672
    v_mfma_f32_16x16x32_bf16 v[156:159], v[164:167], a[36:39], v[156:159]
    v_add_f32 v193, v193, v195
    v_add_f32 v192, v192, v196
    v_add_f32 v193, v193, v197
    v_add_f32 v192, v192, v198
    v_add_f32 v193, v193, v199
    v_add_f32 v192, v192, v200
    v_add_f32 v193, v193, v201
    v_add_f32 v192, v192, v202
    v_mfma_f32_16x16x32_bf16 v[80:83], v[168:171], a[40:43], v[80:83]
    ds_read_b64_tr_b16 v[164:165], v19 offset:51392
    ds_read_b64_tr_b16 v[166:167], v19 offset:52672
    v_mfma_f32_16x16x32_bf16 v[88:91], v[168:171], a[44:47], v[88:91]
    buffer_load_dwordx4 v33, s[24:27], s82 offen offset:1024 lds
    v_add_f32 v193, v193, v203
    v_add_f32 v192, v192, v204
    v_add_f32 v193, v193, v205
    v_cmp_u_f32 vcc, v192, v193
    s_nop 1
    s_cbranch_vccnz Lslow_11
Lback_12:
    v_mfma_f32_16x16x32_bf16 v[84:87], v[172:175], a[40:43], v[84:87]
    ds_read_b64_tr_b16 v[168:169], v18 offset:51456
    ds_read_b64_tr_b16 v[170:171], v18 offset:52736
    v_mfma_f32_16x16x32_bf16 v[92:95], v[172:175], a[44:47], v[92:95]
    buffer_load_dwordx4 v34, s[24:27], s82 offen offset:2048 lds
    v_add_f32 v192, v192, v193
    v_mul_f32 v192, 0x3a97b426, v192
    v_mov_b32 v193, v192
    s_waitcnt lgkmcnt(6)
    v_mfma_f32_16x16x32_bf16 v[96:99], v[176:179], a[40:43], v[96:99]
    ds_read_b64_tr_b16 v[172:173], v19 offset:51456
    ds_read_b64_tr_b16 v[174:175], v19 offset:52736
    v_mfma_f32_16x16x32_bf16 v[104:107], v[176:179], a[44:47], v[104:107]
    v_permlane32_swap_b32 v192, v193
    v_fma_f32 v193, -v192, v192, v193
    v_max_f32 v193, 0, v193
    v_add_f32 v193, 0x3727c5ac, v193
    v_rsq_f32 v194, v193
    s_nop 0
    v_mfma_f32_16x16x32_bf16 v[100:103], v[180:183], a[40:43], v[100:103]
    v_mul_f32_e64 v195, -v192, v194
    v_mov_b32 v196, v194
    v_mfma_f32_16x16x32_bf16 v[108:111], v[180:183], a[44:47], v[108:111]
    buffer_load_dwordx4 v35, s[24:27], s82 offen offset:3072 lds
    v_mov_b32 v197, v195
    v_permlane16_swap_b32 v194, v196
    s_nop 0
    v_permlane16_swap_b32 v195, v197
    v_mfma_f32_16x16x32_bf16 v[112:115], v[184:187], a[40:43], v[112:115]
    s_add_u32 m0, s61, 4096
    s_add_u32 s6, s82, 128
    v_mfma_f32_16x16x32_bf16 v[120:123], v[184:187], a[44:47], v[120:123]
    v_fma_f32 v48, v48, v194, v195
    v_fma_f32 v49, v49, v194, v195
    v_fma_f32 v50, v50, v194, v195
    v_fma_f32 v51, v51, v194, v195
    v_cvt_pk_bf16_f32 v208, v48, v49
    v_cvt_pk_bf16_f32 v209, v50, v51
    s_waitcnt lgkmcnt(0)
    s_barrier
    v_mfma_f32_16x16x32_bf16 v[116:119], v[188:191], a[40:43], v[116:119]
    ds_read_b64_tr_b16 v[176:177], v18 offset:15360
    ds_read_b64_tr_b16 v[178:179], v18 offset:16640
    ds_read_b64_tr_b16 v[180:181], v19 offset:15360
    ds_read_b64_tr_b16 v[182:183], v19 offset:16640
    v_mfma_f32_16x16x32_bf16 v[124:127], v[188:191], a[44:47], v[124:127]
    ds_write_b64 v240, v[208:209] offset:12288
    buffer_load_dwordx4 v32, s[24:27], s6 offen offset:0 lds
    v_fma_f32 v52, v52, v194, v195
    v_fma_f32 v53, v53, v194, v195
    v_fma_f32 v54, v54, v194, v195
    v_fma_f32 v55, v55, v194, v195
    v_mfma_f32_16x16x32_bf16 v[128:131], v[160:163], a[40:43], v[128:131]
    ds_read_b64_tr_b16 v[184:185], v18 offset:15424
    ds_read_b64_tr_b16 v[186:187], v18 offset:16704
    ds_read_b64_tr_b16 v[188:189], v19 offset:15424
    ds_read_b64_tr_b16 v[190:191], v19 offset:16704
    v_mfma_f32_16x16x32_bf16 v[136:139], v[160:163], a[44:47], v[136:139]
    buffer_load_dwordx4 v33, s[24:27], s6 offen offset:1024 lds
    v_cvt_pk_bf16_f32 v210, v52, v53
    v_cvt_pk_bf16_f32 v211, v54, v55
    v_mfma_f32_16x16x32_bf16 v[132:135], v[164:167], a[40:43], v[132:135]
    ds_read_b64_tr_b16 v[160:161], v18 offset:15488
    ds_read_b64_tr_b16 v[162:163], v18 offset:16768
    v_mfma_f32_16x16x32_bf16 v[140:143], v[164:167], a[44:47], v[140:143]
    ds_write_b64 v241, v[210:211] offset:12288
    buffer_load_dwordx4 v34, s[24:27], s6 offen offset:2048 lds
    v_fma_f32 v56, v56, v196, v197
    v_fma_f32 v57, v57, v196, v197
    v_fma_f32 v58, v58, v196, v197
    v_fma_f32 v59, v59, v196, v197
    v_mfma_f32_16x16x32_bf16 v[144:147], v[168:171], a[40:43], v[144:147]
    ds_read_b64_tr_b16 v[164:165], v19 offset:15488
    ds_read_b64_tr_b16 v[166:167], v19 offset:16768
    v_mfma_f32_16x16x32_bf16 v[152:155], v[168:171], a[44:47], v[152:155]
    v_cvt_pk_bf16_f32 v212, v56, v57
    v_cvt_pk_bf16_f32 v213, v58, v59
    v_mfma_f32_16x16x32_bf16 v[148:151], v[172:175], a[40:43], v[148:151]
    ds_read_b64_tr_b16 v[168:169], v18 offset:15552
    ds_read_b64_tr_b16 v[170:171], v18 offset:16832
    v_mfma_f32_16x16x32_bf16 v[156:159], v[172:175], a[44:47], v[156:159]
    ds_write_b64 v240, v[212:213] offset:14336
    buffer_load_dwordx4 v35, s[24:27], s6 offen offset:3072 lds
    v_fma_f32 v60, v60, v196, v197
    v_fma_f32 v61, v61, v196, v197
    v_fma_f32 v62, v62, v196, v197
    s_waitcnt lgkmcnt(8)
    v_mfma_f32_16x16x32_bf16 v[80:83], v[176:179], a[48:51], v[80:83]
    ds_read_b64_tr_b16 v[172:173], v19 offset:15552
    ds_read_b64_tr_b16 v[174:175], v19 offset:16832
    v_mfma_f32_16x16x32_bf16 v[88:91], v[176:179], a[52:55], v[88:91]
    s_add_u32 m0, s61, 26624
    v_fma_f32 v63, v63, v196, v197
    v_cvt_pk_bf16_f32 v214, v60, v61
    v_cvt_pk_bf16_f32 v215, v62, v63
    v_mfma_f32_16x16x32_bf16 v[84:87], v[180:183], a[48:51], v[84:87]
    ds_read_b64_tr_b16 v[176:177], v18 offset:15616
    ds_read_b64_tr_b16 v[178:179], v18 offset:16896
    v_mfma_f32_16x16x32_bf16 v[92:95], v[180:183], a[52:55], v[92:95]
    ds_write_b64 v241, v[214:215] offset:14336
    buffer_load_dwordx4 v24, s[20:23], s71 offen offset:0 lds
    v_fma_f32 v64, v64, v194, v195
    v_fma_f32 v65, v65, v194, v195
    v_fma_f32 v66, v66, v194, v195
    v_fma_f32 v67, v67, v194, v195
    v_mfma_f32_16x16x32_bf16 v[96:99], v[184:187], a[48:51], v[96:99]
    ds_read_b64_tr_b16 v[180:181], v19 offset:15616
    ds_read_b64_tr_b16 v[182:183], v19 offset:16896
    v_mfma_f32_16x16x32_bf16 v[104:107], v[184:187], a[52:55], v[104:107]
    v_cvt_pk_bf16_f32 v216, v64, v65
    v_cvt_pk_bf16_f32 v217, v66, v67
    v_mfma_f32_16x16x32_bf16 v[100:103], v[188:191], a[48:51], v[100:103]
    ds_read_b64_tr_b16 v[184:185], v18 offset:56320
    ds_read_b64_tr_b16 v[186:187], v18 offset:57600
    v_mfma_f32_16x16x32_bf16 v[108:111], v[188:191], a[52:55], v[108:111]
    ds_write_b64 v242, v[216:217] offset:12288
    buffer_load_dwordx4 v25, s[20:23], s71 offen offset:1024 lds
    v_fma_f32 v68, v68, v194, v195
    v_fma_f32 v69, v69, v194, v195
    v_fma_f32 v70, v70, v194, v195
    s_waitcnt lgkmcnt(8)
    v_mfma_f32_16x16x32_bf16 v[112:115], v[160:163], a[48:51], v[112:115]
    ds_read_b64_tr_b16 v[188:189], v19 offset:56320
    ds_read_b64_tr_b16 v[190:191], v19 offset:57600
    v_mfma_f32_16x16x32_bf16 v[120:123], v[160:163], a[52:55], v[120:123]
    v_fma_f32 v71, v71, v194, v195
    v_cvt_pk_bf16_f32 v218, v68, v69
    v_cvt_pk_bf16_f32 v219, v70, v71
    v_mfma_f32_16x16x32_bf16 v[116:119], v[164:167], a[48:51], v[116:119]
    ds_read_b64_tr_b16 v[160:161], v18 offset:56384
    ds_read_b64_tr_b16 v[162:163], v18 offset:57664
    v_mfma_f32_16x16x32_bf16 v[124:127], v[164:167], a[52:55], v[124:127]
    ds_write_b64 v243, v[218:219] offset:12288
    buffer_load_dwordx4 v26, s[20:23], s71 offen offset:2048 lds
    s_waitcnt vmcnt(7)
    ds_read_b128 a[160:163], v4 offset:0
    v_fma_f32 v72, v72, v196, v197
    v_fma_f32 v73, v73, v196, v197
    v_fma_f32 v74, v74, v196, v197
    v_mfma_f32_16x16x32_bf16 v[128:131], v[168:171], a[48:51], v[128:131]
    ds_read_b64_tr_b16 v[164:165], v19 offset:56384
    ds_read_b64_tr_b16 v[166:167], v19 offset:57664
    v_mfma_f32_16x16x32_bf16 v[136:139], v[168:171], a[52:55], v[136:139]
    buffer_load_dwordx4 v27, s[20:23], s71 offen offset:3072 lds
    ds_read_b128 a[164:167], v4 offset:2048
    ds_read_b128 a[168:171], v5 offset:0
    v_fma_f32 v75, v75, v196, v197
    v_cvt_pk_bf16_f32 v220, v72, v73
    v_cvt_pk_bf16_f32 v221, v74, v75
    v_mfma_f32_16x16x32_bf16 v[132:135], v[172:175], a[48:51], v[132:135]
    ds_read_b64_tr_b16 v[168:169], v18 offset:56448
    ds_read_b64_tr_b16 v[170:171], v18 offset:57728
    v_mfma_f32_16x16x32_bf16 v[140:143], v[172:175], a[52:55], v[140:143]
    ds_write_b64 v242, v[220:221] offset:14336
    ds_read_b128 a[172:175], v5 offset:2048
    s_add_u32 m0, s61, 30720
    v_fma_f32 v76, v76, v196, v197
    v_fma_f32 v77, v77, v196, v197
    v_fma_f32 v78, v78, v196, v197
    s_waitcnt lgkmcnt(12)
    v_mfma_f32_16x16x32_bf16 v[144:147], v[176:179], a[48:51], v[144:147]
    ds_read_b64_tr_b16 v[172:173], v19 offset:56448
    ds_read_b64_tr_b16 v[174:175], v19 offset:57728
    v_mfma_f32_16x16x32_bf16 v[152:155], v[176:179], a[52:55], v[152:155]
    buffer_load_dwordx4 v28, s[20:23], s71 offen offset:0 lds
    s_bfe_u32 s71, s99, 0x4001c
    s_mul_i32 s71, s71, 221184
    s_add_u32 s71, s71, s72
    s_add_u32 m0, s61, 8192
    v_fma_f32 v79, v79, v196, v197
    v_mfma_f32_16x16x32_bf16 v[148:151], v[180:183], a[48:51], v[148:151]
    ds_read_b64_tr_b16 v[176:177], v18 offset:56512
    ds_read_b64_tr_b16 v[178:179], v18 offset:57792
    v_mfma_f32_16x16x32_bf16 v[156:159], v[180:183], a[52:55], v[156:159]
    v_cvt_pk_bf16_f32 v222, v76, v77
    v_cvt_pk_bf16_f32 v223, v78, v79
    v_mfma_f32_16x16x32_bf16 v[80:83], v[184:187], a[56:59], v[80:83]
    ds_read_b64_tr_b16 v[180:181], v19 offset:56512
    ds_read_b64_tr_b16 v[182:183], v19 offset:57792
    v_mfma_f32_16x16x32_bf16 v[88:91], v[184:187], a[60:63], v[88:91]
    ds_write_b64 v243, v[222:223] offset:14336
    ds_read_b64_tr_b16 v[224:225], v245 offset:12288
    ds_read_b64_tr_b16 v[226:227], v246 offset:12800
    ds_read_b64_tr_b16 v[228:229], v246 offset:12288
    buffer_load_dwordx4 v32, s[24:27], s83 offen offset:0 lds
    v_mfma_f32_16x16x32_bf16 v[84:87], v[188:191], a[56:59], v[84:87]
    ds_read_b64_tr_b16 v[184:185], v18 offset:56576
    ds_read_b64_tr_b16 v[186:187], v18 offset:57856
    v_mfma_f32_16x16x32_bf16 v[92:95], v[188:191], a[60:63], v[92:95]
    ds_read_b64_tr_b16 v[230:231], v245 offset:12800
    ds_read_b64_tr_b16 v[232:233], v247 offset:12288
    ds_read_b64_tr_b16 v[234:235], v248 offset:12800
    ds_read_b64_tr_b16 v[236:237], v248 offset:12288
    buffer_load_dwordx4 v33, s[24:27], s83 offen offset:1024 lds
    s_waitcnt lgkmcnt(14)
    v_mfma_f32_16x16x32_bf16 v[96:99], v[160:163], a[56:59], v[96:99]
    ds_read_b64_tr_b16 v[188:189], v19 offset:56576
    ds_read_b64_tr_b16 v[190:191], v19 offset:57856
    v_mfma_f32_16x16x32_bf16 v[104:107], v[160:163], a[60:63], v[104:107]
    ds_read_b64_tr_b16 v[238:239], v247 offset:12800
    s_waitcnt vmcnt(7)
    ds_read_b128 a[176:179], v4 offset:4096
    v_mfma_f32_16x16x32_bf16 v[100:103], v[164:167], a[56:59], v[100:103]
    ds_read_b128 a[180:183], v4 offset:6144
    v_mfma_f32_16x16x32_bf16 v[108:111], v[164:167], a[60:63], v[108:111]
    buffer_load_dwordx4 v34, s[24:27], s83 offen offset:2048 lds
    ds_read_b128 a[184:187], v5 offset:4096
    ds_read_b128 a[188:191], v5 offset:6144
    v_mfma_f32_16x16x32_bf16 v[112:115], v[168:171], a[56:59], v[112:115]
    v_mfma_f32_16x16x32_bf16 v[120:123], v[168:171], a[60:63], v[120:123]
    s_waitcnt lgkmcnt(0)
    s_barrier
    v_mfma_f32_16x16x32_bf16 v[116:119], v[172:175], a[56:59], v[116:119]
    ds_read_b64_tr_b16 v[160:161], v18 offset:0
    ds_read_b64_tr_b16 v[162:163], v18 offset:1280
    ds_read_b64_tr_b16 v[164:165], v19 offset:0
    ds_read_b64_tr_b16 v[166:167], v19 offset:1280
    v_mfma_f32_16x16x32_bf16 v[124:127], v[172:175], a[60:63], v[124:127]
    buffer_store_dwordx4 v[224:227], v29, s[48:51], s80 offen offset:0 sc1
    v_mfma_f32_16x16x32_bf16 v[128:131], v[176:179], a[56:59], v[128:131]
    ds_read_b64_tr_b16 v[168:169], v18 offset:64
    ds_read_b64_tr_b16 v[170:171], v18 offset:1344
    ds_read_b64_tr_b16 v[172:173], v19 offset:64
    ds_read_b64_tr_b16 v[174:175], v19 offset:1344
    v_mfma_f32_16x16x32_bf16 v[136:139], v[176:179], a[60:63], v[136:139]
    v_mfma_f32_16x16x32_bf16 v[132:135], v[180:183], a[56:59], v[132:135]
    ds_read_b64_tr_b16 v[176:177], v18 offset:128
    ds_read_b64_tr_b16 v[178:179], v18 offset:1408
    v_mfma_f32_16x16x32_bf16 v[140:143], v[180:183], a[60:63], v[140:143]
    v_mfma_f32_16x16x32_bf16 v[144:147], v[184:187], a[56:59], v[144:147]
    ds_read_b64_tr_b16 v[180:181], v19 offset:128
    ds_read_b64_tr_b16 v[182:183], v19 offset:1408
    v_mfma_f32_16x16x32_bf16 v[152:155], v[184:187], a[60:63], v[152:155]
    buffer_store_dwordx4 v[228:231], v29, s[48:51], s80 offen offset:1024 sc1
    v_mfma_f32_16x16x32_bf16 v[148:151], v[188:191], a[56:59], v[148:151]
    ds_read_b64_tr_b16 v[184:185], v18 offset:192
    ds_read_b64_tr_b16 v[186:187], v18 offset:1472
    v_mfma_f32_16x16x32_bf16 v[156:159], v[188:191], a[60:63], v[156:159]
    s_waitcnt lgkmcnt(6)
    v_mfma_f32_16x16x32_bf16 v[80:83], v[160:163], a[64:67], v[80:83]
    ds_read_b64_tr_b16 v[188:189], v19 offset:192
    ds_read_b64_tr_b16 v[190:191], v19 offset:1472
    v_mfma_f32_16x16x32_bf16 v[88:91], v[160:163], a[68:71], v[88:91]
    v_mfma_f32_16x16x32_bf16 v[84:87], v[164:167], a[64:67], v[84:87]
    ds_read_b64_tr_b16 v[160:161], v18 offset:256
    ds_read_b64_tr_b16 v[162:163], v18 offset:1536
    v_mfma_f32_16x16x32_bf16 v[92:95], v[164:167], a[68:71], v[92:95]
    buffer_store_dwordx4 v[232:235], v29, s[48:51], s80 offen offset:2048 sc1
    v_mfma_f32_16x16x32_bf16 v[96:99], v[168:171], a[64:67], v[96:99]
    ds_read_b64_tr_b16 v[164:165], v19 offset:256
    ds_read_b64_tr_b16 v[166:167], v19 offset:1536
    v_mfma_f32_16x16x32_bf16 v[104:107], v[168:171], a[68:71], v[104:107]
    v_mfma_f32_16x16x32_bf16 v[100:103], v[172:175], a[64:67], v[100:103]
    ds_read_b64_tr_b16 v[168:169], v18 offset:40960
    ds_read_b64_tr_b16 v[170:171], v18 offset:42240
    v_mfma_f32_16x16x32_bf16 v[108:111], v[172:175], a[68:71], v[108:111]
    s_waitcnt lgkmcnt(6)
    v_mfma_f32_16x16x32_bf16 v[112:115], v[176:179], a[64:67], v[112:115]
    ds_read_b64_tr_b16 v[172:173], v19 offset:40960
    ds_read_b64_tr_b16 v[174:175], v19 offset:42240
    v_mfma_f32_16x16x32_bf16 v[120:123], v[176:179], a[68:71], v[120:123]
    buffer_store_dwordx4 v[236:239], v29, s[48:51], s80 offen offset:3072 sc1
    v_mfma_f32_16x16x32_bf16 v[116:119], v[180:183], a[64:67], v[116:119]
    ds_read_b64_tr_b16 v[176:177], v18 offset:41024
    ds_read_b64_tr_b16 v[178:179], v18 offset:42304
    v_mfma_f32_16x16x32_bf16 v[124:127], v[180:183], a[68:71], v[124:127]
    v_mfma_f32_16x16x32_bf16 v[128:131], v[184:187], a[64:67], v[128:131]
    ds_read_b64_tr_b16 v[180:181], v19 offset:41024
    ds_read_b64_tr_b16 v[182:183], v19 offset:42304
    v_mfma_f32_16x16x32_bf16 v[136:139], v[184:187], a[68:71], v[136:139]
    v_mfma_f32_16x16x32_bf16 v[132:135], v[188:191], a[64:67], v[132:135]
    ds_read_b64_tr_b16 v[184:185], v18 offset:41088
    ds_read_b64_tr_b16 v[186:187], v18 offset:42368
    v_mfma_f32_16x16x32_bf16 v[140:143], v[188:191], a[68:71], v[140:143]
    buffer_load_dwordx4 v35, s[24:27], s83 offen offset:3072 lds
    s_waitcnt lgkmcnt(6)
    v_mfma_f32_16x16x32_bf16 v[144:147], v[160:163], a[64:67], v[144:147]
    ds_read_b64_tr_b16 v[188:189], v19 offset:41088
    ds_read_b64_tr_b16 v[190:191], v19 offset:42368
    v_mfma_f32_16x16x32_bf16 v[152:155], v[160:163], a[68:71], v[152:155]
    s_add_u32 m0, s61, 31744
    v_mfma_f32_16x16x32_bf16 v[148:151], v[164:167], a[64:67], v[148:151]
    ds_read_b64_tr_b16 v[160:161], v18 offset:41152
    ds_read_b64_tr_b16 v[162:163], v18 offset:42432
    v_mfma_f32_16x16x32_bf16 v[156:159], v[164:167], a[68:71], v[156:159]
    buffer_load_dwordx4 v24, s[20:23], s71 offen offset:0 lds
    v_mfma_f32_16x16x32_bf16 v[80:83], v[168:171], a[72:75], v[80:83]
    ds_read_b64_tr_b16 v[164:165], v19 offset:41152
    ds_read_b64_tr_b16 v[166:167], v19 offset:42432
    v_mfma_f32_16x16x32_bf16 v[88:91], v[168:171], a[76:79], v[88:91]
    v_mfma_f32_16x16x32_bf16 v[84:87], v[172:175], a[72:75], v[84:87]
    ds_read_b64_tr_b16 v[168:169], v18 offset:41216
    ds_read_b64_tr_b16 v[170:171], v18 offset:42496
    v_mfma_f32_16x16x32_bf16 v[92:95], v[172:175], a[76:79], v[92:95]
    buffer_load_dwordx4 v25, s[20:23], s71 offen offset:1024 lds
    s_waitcnt lgkmcnt(6)
    v_mfma_f32_16x16x32_bf16 v[96:99], v[176:179], a[72:75], v[96:99]
    ds_read_b64_tr_b16 v[172:173], v19 offset:41216
    ds_read_b64_tr_b16 v[174:175], v19 offset:42496
    v_mfma_f32_16x16x32_bf16 v[104:107], v[176:179], a[76:79], v[104:107]
    v_mfma_f32_16x16x32_bf16 v[100:103], v[180:183], a[72:75], v[100:103]
    v_mfma_f32_16x16x32_bf16 v[108:111], v[180:183], a[76:79], v[108:111]
    buffer_load_dwordx4 v26, s[20:23], s71 offen offset:2048 lds
    v_mfma_f32_16x16x32_bf16 v[112:115], v[184:187], a[72:75], v[112:115]
    v_mfma_f32_16x16x32_bf16 v[120:123], v[184:187], a[76:79], v[120:123]
    s_waitcnt lgkmcnt(0)
    s_barrier
    v_mfma_f32_16x16x32_bf16 v[116:119], v[188:191], a[72:75], v[116:119]
    ds_read_b64_tr_b16 v[176:177], v18 offset:5120
    ds_read_b64_tr_b16 v[178:179], v18 offset:6400
    ds_read_b64_tr_b16 v[180:181], v19 offset:5120
    ds_read_b64_tr_b16 v[182:183], v19 offset:6400
    v_mfma_f32_16x16x32_bf16 v[124:127], v[188:191], a[76:79], v[124:127]
    buffer_load_dwordx4 v27, s[20:23], s71 offen offset:3072 lds
    v_mfma_f32_16x16x32_bf16 v[128:131], v[160:163], a[72:75], v[128:131]
    ds_read_b64_tr_b16 v[184:185], v18 offset:5184
    ds_read_b64_tr_b16 v[186:187], v18 offset:6464
    ds_read_b64_tr_b16 v[188:189], v19 offset:5184
    ds_read_b64_tr_b16 v[190:191], v19 offset:6464
    v_mfma_f32_16x16x32_bf16 v[136:139], v[160:163], a[76:79], v[136:139]
    s_add_u32 m0, s61, 35840
    v_mfma_f32_16x16x32_bf16 v[132:135], v[164:167], a[72:75], v[132:135]
    ds_read_b64_tr_b16 v[160:161], v18 offset:5248
    ds_read_b64_tr_b16 v[162:163], v18 offset:6528
    v_mfma_f32_16x16x32_bf16 v[140:143], v[164:167], a[76:79], v[140:143]
    buffer_load_dwordx4 v28, s[20:23], s71 offen offset:0 lds
    s_bfe_u32 s71, s65, 0x40000
    s_mul_i32 s71, s71, 221184
    v_mfma_f32_16x16x32_bf16 v[144:147], v[168:171], a[72:75], v[144:147]
    ds_read_b64_tr_b16 v[164:165], v19 offset:5248
    ds_read_b64_tr_b16 v[166:167], v19 offset:6528
    v_mfma_f32_16x16x32_bf16 v[152:155], v[168:171], a[76:79], v[152:155]
    s_add_u32 s71, s71, s72
    s_add_u32 m0, s61, 16384
    v_mfma_f32_16x16x32_bf16 v[148:151], v[172:175], a[72:75], v[148:151]
    ds_read_b64_tr_b16 v[168:169], v18 offset:5312
    ds_read_b64_tr_b16 v[170:171], v18 offset:6592
    v_mfma_f32_16x16x32_bf16 v[156:159], v[172:175], a[76:79], v[156:159]
    buffer_load_dwordx4 v24, s[20:23], s71 offen offset:0 lds
    s_waitcnt lgkmcnt(6)
    v_mfma_f32_16x16x32_bf16 v[80:83], v[176:179], a[80:83], v[80:83]
    ds_read_b64_tr_b16 v[172:173], v19 offset:5312
    ds_read_b64_tr_b16 v[174:175], v19 offset:6592
    v_mfma_f32_16x16x32_bf16 v[88:91], v[176:179], a[84:87], v[88:91]
    v_mfma_f32_16x16x32_bf16 v[84:87], v[180:183], a[80:83], v[84:87]
    ds_read_b64_tr_b16 v[176:177], v18 offset:5376
    ds_read_b64_tr_b16 v[178:179], v18 offset:6656
    v_mfma_f32_16x16x32_bf16 v[92:95], v[180:183], a[84:87], v[92:95]
    buffer_load_dwordx4 v25, s[20:23], s71 offen offset:1024 lds
    v_mfma_f32_16x16x32_bf16 v[96:99], v[184:187], a[80:83], v[96:99]
    ds_read_b64_tr_b16 v[180:181], v19 offset:5376
    ds_read_b64_tr_b16 v[182:183], v19 offset:6656
    v_mfma_f32_16x16x32_bf16 v[104:107], v[184:187], a[84:87], v[104:107]
    v_mfma_f32_16x16x32_bf16 v[100:103], v[188:191], a[80:83], v[100:103]
    ds_read_b64_tr_b16 v[184:185], v18 offset:46080
    ds_read_b64_tr_b16 v[186:187], v18 offset:47360
    v_mfma_f32_16x16x32_bf16 v[108:111], v[188:191], a[84:87], v[108:111]
    buffer_load_dwordx4 v26, s[20:23], s71 offen offset:2048 lds
    s_waitcnt lgkmcnt(6)
    v_mfma_f32_16x16x32_bf16 v[112:115], v[160:163], a[80:83], v[112:115]
    ds_read_b64_tr_b16 v[188:189], v19 offset:46080
    ds_read_b64_tr_b16 v[190:191], v19 offset:47360
    v_mfma_f32_16x16x32_bf16 v[120:123], v[160:163], a[84:87], v[120:123]
    v_mfma_f32_16x16x32_bf16 v[116:119], v[164:167], a[80:83], v[116:119]
    ds_read_b64_tr_b16 v[160:161], v18 offset:46144
    ds_read_b64_tr_b16 v[162:163], v18 offset:47424
    v_mfma_f32_16x16x32_bf16 v[124:127], v[164:167], a[84:87], v[124:127]
    buffer_load_dwordx4 v27, s[20:23], s71 offen offset:3072 lds
    v_mfma_f32_16x16x32_bf16 v[128:131], v[168:171], a[80:83], v[128:131]
    ds_read_b64_tr_b16 v[164:165], v19 offset:46144
    ds_read_b64_tr_b16 v[166:167], v19 offset:47424
    v_mfma_f32_16x16x32_bf16 v[136:139], v[168:171], a[84:87], v[136:139]
    s_add_u32 m0, s61, 20480
    v_mfma_f32_16x16x32_bf16 v[132:135], v[172:175], a[80:83], v[132:135]
    ds_read_b64_tr_b16 v[168:169], v18 offset:46208
    ds_read_b64_tr_b16 v[170:171], v18 offset:47488
    v_mfma_f32_16x16x32_bf16 v[140:143], v[172:175], a[84:87], v[140:143]
    buffer_load_dwordx4 v28, s[20:23], s71 offen offset:0 lds
    s_bfe_u32 s71, s65, 0x40004
    s_waitcnt lgkmcnt(6)
    v_mfma_f32_16x16x32_bf16 v[144:147], v[176:179], a[80:83], v[144:147]
    ds_read_b64_tr_b16 v[172:173], v19 offset:46208
    ds_read_b64_tr_b16 v[174:175], v19 offset:47488
    v_mfma_f32_16x16x32_bf16 v[152:155], v[176:179], a[84:87], v[152:155]
    s_mul_i32 s71, s71, 221184
    s_add_u32 s71, s71, s72
    s_add_u32 m0, s61, 12288
    s_add_u32 s6, s83, 128
    v_mfma_f32_16x16x32_bf16 v[148:151], v[180:183], a[80:83], v[148:151]
    ds_read_b64_tr_b16 v[176:177], v18 offset:46272
    ds_read_b64_tr_b16 v[178:179], v18 offset:47552
    v_mfma_f32_16x16x32_bf16 v[156:159], v[180:183], a[84:87], v[156:159]
    buffer_load_dwordx4 v32, s[24:27], s6 offen offset:0 lds
    v_mfma_f32_16x16x32_bf16 v[80:83], v[184:187], a[88:91], v[80:83]
    ds_read_b64_tr_b16 v[180:181], v19 offset:46272
    ds_read_b64_tr_b16 v[182:183], v19 offset:47552
    v_mfma_f32_16x16x32_bf16 v[88:91], v[184:187], a[92:95], v[88:91]
    v_mfma_f32_16x16x32_bf16 v[84:87], v[188:191], a[88:91], v[84:87]
    ds_read_b64_tr_b16 v[184:185], v18 offset:46336
    ds_read_b64_tr_b16 v[186:187], v18 offset:47616
    v_mfma_f32_16x16x32_bf16 v[92:95], v[188:191], a[92:95], v[92:95]
    buffer_load_dwordx4 v33, s[24:27], s6 offen offset:1024 lds
    s_waitcnt lgkmcnt(6)
    v_mfma_f32_16x16x32_bf16 v[96:99], v[160:163], a[88:91], v[96:99]
    ds_read_b64_tr_b16 v[188:189], v19 offset:46336
    ds_read_b64_tr_b16 v[190:191], v19 offset:47616
    v_mfma_f32_16x16x32_bf16 v[104:107], v[160:163], a[92:95], v[104:107]
    s_waitcnt vmcnt(12)
    ds_read_b128 a[192:195], v4 offset:8192
    ds_read_b128 a[196:199], v4 offset:10240
    s_mov_b64 exec, 1
    buffer_store_dword v31, off, s[48:51], s81 sc1
    s_mov_b64 exec, -1
    v_mfma_f32_16x16x32_bf16 v[100:103], v[164:167], a[88:91], v[100:103]
    ds_read_b128 a[200:203], v5 offset:8192
    v_mfma_f32_16x16x32_bf16 v[108:111], v[164:167], a[92:95], v[108:111]
    buffer_load_dwordx4 v34, s[24:27], s6 offen offset:2048 lds
    ds_read_b128 a[204:207], v5 offset:10240
    v_mfma_f32_16x16x32_bf16 v[112:115], v[168:171], a[88:91], v[112:115]
    v_mfma_f32_16x16x32_bf16 v[120:123], v[168:171], a[92:95], v[120:123]
    s_waitcnt lgkmcnt(0)
    s_barrier
    v_mfma_f32_16x16x32_bf16 v[116:119], v[172:175], a[88:91], v[116:119]
    ds_read_b64_tr_b16 v[160:161], v18 offset:10240
    ds_read_b64_tr_b16 v[162:163], v18 offset:11520
    ds_read_b64_tr_b16 v[164:165], v19 offset:10240
    ds_read_b64_tr_b16 v[166:167], v19 offset:11520
    v_mfma_f32_16x16x32_bf16 v[124:127], v[172:175], a[92:95], v[124:127]
    buffer_load_dwordx4 v35, s[24:27], s6 offen offset:3072 lds
    v_mfma_f32_16x16x32_bf16 v[128:131], v[176:179], a[88:91], v[128:131]
    ds_read_b64_tr_b16 v[168:169], v18 offset:10304
    ds_read_b64_tr_b16 v[170:171], v18 offset:11584
    ds_read_b64_tr_b16 v[172:173], v19 offset:10304
    ds_read_b64_tr_b16 v[174:175], v19 offset:11584
    v_mfma_f32_16x16x32_bf16 v[136:139], v[176:179], a[92:95], v[136:139]
    s_add_u32 m0, s61, 21504
    v_mfma_f32_16x16x32_bf16 v[132:135], v[180:183], a[88:91], v[132:135]
    ds_read_b64_tr_b16 v[176:177], v18 offset:10368
    ds_read_b64_tr_b16 v[178:179], v18 offset:11648
    v_mfma_f32_16x16x32_bf16 v[140:143], v[180:183], a[92:95], v[140:143]
    buffer_load_dwordx4 v24, s[20:23], s71 offen offset:0 lds
    v_mfma_f32_16x16x32_bf16 v[144:147], v[184:187], a[88:91], v[144:147]
    ds_read_b64_tr_b16 v[180:181], v19 offset:10368
    ds_read_b64_tr_b16 v[182:183], v19 offset:11648
    v_mfma_f32_16x16x32_bf16 v[152:155], v[184:187], a[92:95], v[152:155]
    v_mfma_f32_16x16x32_bf16 v[148:151], v[188:191], a[88:91], v[148:151]
    ds_read_b64_tr_b16 v[184:185], v18 offset:10432
    ds_read_b64_tr_b16 v[186:187], v18 offset:11712
    v_mfma_f32_16x16x32_bf16 v[156:159], v[188:191], a[92:95], v[156:159]
    buffer_load_dwordx4 v25, s[20:23], s71 offen offset:1024 lds
    s_waitcnt lgkmcnt(6)
    v_mfma_f32_16x16x32_bf16 v[80:83], v[160:163], a[96:99], v[80:83]
    ds_read_b64_tr_b16 v[188:189], v19 offset:10432
    ds_read_b64_tr_b16 v[190:191], v19 offset:11712
    v_mfma_f32_16x16x32_bf16 v[88:91], v[160:163], a[100:103], v[88:91]
    v_mfma_f32_16x16x32_bf16 v[84:87], v[164:167], a[96:99], v[84:87]
    ds_read_b64_tr_b16 v[160:161], v18 offset:10496
    ds_read_b64_tr_b16 v[162:163], v18 offset:11776
    v_mfma_f32_16x16x32_bf16 v[92:95], v[164:167], a[100:103], v[92:95]
    buffer_load_dwordx4 v26, s[20:23], s71 offen offset:2048 lds
    v_mfma_f32_16x16x32_bf16 v[96:99], v[168:171], a[96:99], v[96:99]
    ds_read_b64_tr_b16 v[164:165], v19 offset:10496
    ds_read_b64_tr_b16 v[166:167], v19 offset:11776
    v_mfma_f32_16x16x32_bf16 v[104:107], v[168:171], a[100:103], v[104:107]
    v_mfma_f32_16x16x32_bf16 v[100:103], v[172:175], a[96:99], v[100:103]
    ds_read_b64_tr_b16 v[168:169], v18 offset:51200
    ds_read_b64_tr_b16 v[170:171], v18 offset:52480
    v_mfma_f32_16x16x32_bf16 v[108:111], v[172:175], a[100:103], v[108:111]
    buffer_load_dwordx4 v27, s[20:23], s71 offen offset:3072 lds
    s_waitcnt lgkmcnt(6)
    v_mfma_f32_16x16x32_bf16 v[112:115], v[176:179], a[96:99], v[112:115]
    ds_read_b64_tr_b16 v[172:173], v19 offset:51200
    ds_read_b64_tr_b16 v[174:175], v19 offset:52480
    v_mfma_f32_16x16x32_bf16 v[120:123], v[176:179], a[100:103], v[120:123]
    s_add_u32 m0, s61, 25600
    v_mfma_f32_16x16x32_bf16 v[116:119], v[180:183], a[96:99], v[116:119]
    ds_read_b64_tr_b16 v[176:177], v18 offset:51264
    ds_read_b64_tr_b16 v[178:179], v18 offset:52544
    v_mfma_f32_16x16x32_bf16 v[124:127], v[180:183], a[100:103], v[124:127]
    buffer_load_dwordx4 v28, s[20:23], s71 offen offset:0 lds
    v_mfma_f32_16x16x32_bf16 v[128:131], v[184:187], a[96:99], v[128:131]
    ds_read_b64_tr_b16 v[180:181], v19 offset:51264
    ds_read_b64_tr_b16 v[182:183], v19 offset:52544
    v_mfma_f32_16x16x32_bf16 v[136:139], v[184:187], a[100:103], v[136:139]
    s_add_u32 m0, s61, 0
    v_mfma_f32_16x16x32_bf16 v[132:135], v[188:191], a[96:99], v[132:135]
    ds_read_b64_tr_b16 v[184:185], v18 offset:51328
    ds_read_b64_tr_b16 v[186:187], v18 offset:52608
    v_mfma_f32_16x16x32_bf16 v[140:143], v[188:191], a[100:103], v[140:143]
    buffer_load_dwordx4 v32, s[24:27], s84 offen offset:0 lds
    s_waitcnt lgkmcnt(6)
    v_mfma_f32_16x16x32_bf16 v[144:147], v[160:163], a[96:99], v[144:147]
    ds_read_b64_tr_b16 v[188:189], v19 offset:51328
    ds_read_b64_tr_b16 v[190:191], v19 offset:52608
    v_mfma_f32_16x16x32_bf16 v[152:155], v[160:163], a[100:103], v[152:155]
    v_mfma_f32_16x16x32_bf16 v[148:151], v[164:167], a[96:99], v[148:151]
    ds_read_b64_tr_b16 v[160:161], v18 offset:51392
    ds_read_b64_tr_b16 v[162:163], v18 offset:52672
    v_mfma_f32_16x16x32_bf16 v[156:159], v[164:167], a[100:103], v[156:159]
    buffer_load_dwordx4 v33, s[24:27], s84 offen offset:1024 lds
    v_mfma_f32_16x16x32_bf16 v[80:83], v[168:171], a[104:107], v[80:83]
    ds_read_b64_tr_b16 v[164:165], v19 offset:51392
    ds_read_b64_tr_b16 v[166:167], v19 offset:52672
    v_mfma_f32_16x16x32_bf16 v[88:91], v[168:171], a[108:111], v[88:91]
    v_mfma_f32_16x16x32_bf16 v[84:87], v[172:175], a[104:107], v[84:87]
    ds_read_b64_tr_b16 v[168:169], v18 offset:51456
    ds_read_b64_tr_b16 v[170:171], v18 offset:52736
    v_mfma_f32_16x16x32_bf16 v[92:95], v[172:175], a[108:111], v[92:95]
    buffer_load_dwordx4 v34, s[24:27], s84 offen offset:2048 lds
    s_waitcnt lgkmcnt(6)
    v_mfma_f32_16x16x32_bf16 v[96:99], v[176:179], a[104:107], v[96:99]
    ds_read_b64_tr_b16 v[172:173], v19 offset:51456
    ds_read_b64_tr_b16 v[174:175], v19 offset:52736
    v_mfma_f32_16x16x32_bf16 v[104:107], v[176:179], a[108:111], v[104:107]
    v_mfma_f32_16x16x32_bf16 v[100:103], v[180:183], a[104:107], v[100:103]
    v_mfma_f32_16x16x32_bf16 v[108:111], v[180:183], a[108:111], v[108:111]
    buffer_load_dwordx4 v35, s[24:27], s84 offen offset:3072 lds
    v_mfma_f32_16x16x32_bf16 v[112:115], v[184:187], a[104:107], v[112:115]
    v_mfma_f32_16x16x32_bf16 v[120:123], v[184:187], a[108:111], v[120:123]
    s_add_u32 m0, s61, 4096
    s_add_u32 s6, s84, 128
    s_waitcnt vmcnt(19) lgkmcnt(0)
    s_barrier
    v_mfma_f32_16x16x32_bf16 v[116:119], v[188:191], a[104:107], v[116:119]
    ds_read_b64_tr_b16 v[176:177], v18 offset:15360
    ds_read_b64_tr_b16 v[178:179], v18 offset:16640
    ds_read_b64_tr_b16 v[180:181], v19 offset:15360
    ds_read_b64_tr_b16 v[182:183], v19 offset:16640
    v_mfma_f32_16x16x32_bf16 v[124:127], v[188:191], a[108:111], v[124:127]
    buffer_load_dwordx4 v32, s[24:27], s6 offen offset:0 lds
    v_mfma_f32_16x16x32_bf16 v[128:131], v[160:163], a[104:107], v[128:131]
    ds_read_b64_tr_b16 v[184:185], v18 offset:15424
    ds_read_b64_tr_b16 v[186:187], v18 offset:16704
    ds_read_b64_tr_b16 v[188:189], v19 offset:15424
    ds_read_b64_tr_b16 v[190:191], v19 offset:16704
    v_mfma_f32_16x16x32_bf16 v[136:139], v[160:163], a[108:111], v[136:139]
    v_mfma_f32_16x16x32_bf16 v[132:135], v[164:167], a[104:107], v[132:135]
    ds_read_b64_tr_b16 v[160:161], v18 offset:15488
    ds_read_b64_tr_b16 v[162:163], v18 offset:16768
    v_mfma_f32_16x16x32_bf16 v[140:143], v[164:167], a[108:111], v[140:143]
    buffer_load_dwordx4 v33, s[24:27], s6 offen offset:1024 lds
    v_mfma_f32_16x16x32_bf16 v[144:147], v[168:171], a[104:107], v[144:147]
    ds_read_b64_tr_b16 v[164:165], v19 offset:15488
    ds_read_b64_tr_b16 v[166:167], v19 offset:16768
    v_mfma_f32_16x16x32_bf16 v[152:155], v[168:171], a[108:111], v[152:155]
    s_waitcnt vmcnt(11)
    ds_read_b128 a[208:211], v4 offset:12288
    ds_read_b128 a[212:215], v4 offset:14336
    v_mfma_f32_16x16x32_bf16 v[148:151], v[172:175], a[104:107], v[148:151]
    ds_read_b64_tr_b16 v[168:169], v18 offset:15552
    ds_read_b64_tr_b16 v[170:171], v18 offset:16832
    v_mfma_f32_16x16x32_bf16 v[156:159], v[172:175], a[108:111], v[156:159]
    buffer_load_dwordx4 v34, s[24:27], s6 offen offset:2048 lds
    ds_read_b128 a[216:219], v5 offset:12288
    s_waitcnt lgkmcnt(9)
    v_mfma_f32_16x16x32_bf16 v[80:83], v[176:179], a[112:115], v[80:83]
    ds_read_b64_tr_b16 v[172:173], v19 offset:15552
    ds_read_b64_tr_b16 v[174:175], v19 offset:16832
    v_mfma_f32_16x16x32_bf16 v[88:91], v[176:179], a[116:119], v[88:91]
    ds_read_b128 a[220:223], v5 offset:14336
    v_mfma_f32_16x16x32_bf16 v[84:87], v[180:183], a[112:115], v[84:87]
    ds_read_b64_tr_b16 v[176:177], v18 offset:15616
    ds_read_b64_tr_b16 v[178:179], v18 offset:16896
    v_mfma_f32_16x16x32_bf16 v[92:95], v[180:183], a[116:119], v[92:95]
    buffer_load_dwordx4 v35, s[24:27], s6 offen offset:3072 lds
    v_mfma_f32_16x16x32_bf16 v[96:99], v[184:187], a[112:115], v[96:99]
    ds_read_b64_tr_b16 v[180:181], v19 offset:15616
    ds_read_b64_tr_b16 v[182:183], v19 offset:16896
    v_mfma_f32_16x16x32_bf16 v[104:107], v[184:187], a[116:119], v[104:107]
    s_add_u32 m0, s61, 8192
    v_mfma_f32_16x16x32_bf16 v[100:103], v[188:191], a[112:115], v[100:103]
    ds_read_b64_tr_b16 v[184:185], v18 offset:56320
    ds_read_b64_tr_b16 v[186:187], v18 offset:57600
    v_mfma_f32_16x16x32_bf16 v[108:111], v[188:191], a[116:119], v[108:111]
    buffer_load_dwordx4 v32, s[24:27], s85 offen offset:0 lds
    s_waitcnt lgkmcnt(7)
    v_mfma_f32_16x16x32_bf16 v[112:115], v[160:163], a[112:115], v[112:115]
    ds_read_b64_tr_b16 v[188:189], v19 offset:56320
    ds_read_b64_tr_b16 v[190:191], v19 offset:57600
    v_mfma_f32_16x16x32_bf16 v[120:123], v[160:163], a[116:119], v[120:123]
    v_mfma_f32_16x16x32_bf16 v[116:119], v[164:167], a[112:115], v[116:119]
    ds_read_b64_tr_b16 v[160:161], v18 offset:56384
    ds_read_b64_tr_b16 v[162:163], v18 offset:57664
    v_mfma_f32_16x16x32_bf16 v[124:127], v[164:167], a[116:119], v[124:127]
    buffer_load_dwordx4 v33, s[24:27], s85 offen offset:1024 lds
    v_mfma_f32_16x16x32_bf16 v[128:131], v[168:171], a[112:115], v[128:131]
    ds_read_b64_tr_b16 v[164:165], v19 offset:56384
    ds_read_b64_tr_b16 v[166:167], v19 offset:57664
    v_mfma_f32_16x16x32_bf16 v[136:139], v[168:171], a[116:119], v[136:139]
    v_mfma_f32_16x16x32_bf16 v[132:135], v[172:175], a[112:115], v[132:135]
    ds_read_b64_tr_b16 v[168:169], v18 offset:56448
    ds_read_b64_tr_b16 v[170:171], v18 offset:57728
    v_mfma_f32_16x16x32_bf16 v[140:143], v[172:175], a[116:119], v[140:143]
    buffer_load_dwordx4 v34, s[24:27], s85 offen offset:2048 lds
    s_waitcnt lgkmcnt(6)
    v_mfma_f32_16x16x32_bf16 v[144:147], v[176:179], a[112:115], v[144:147]
    ds_read_b64_tr_b16 v[172:173], v19 offset:56448
    ds_read_b64_tr_b16 v[174:175], v19 offset:57728
    v_mfma_f32_16x16x32_bf16 v[152:155], v[176:179], a[116:119], v[152:155]
    v_mfma_f32_16x16x32_bf16 v[148:151], v[180:183], a[112:115], v[148:151]
    ds_read_b64_tr_b16 v[176:177], v18 offset:56512
    ds_read_b64_tr_b16 v[178:179], v18 offset:57792
    v_mfma_f32_16x16x32_bf16 v[156:159], v[180:183], a[116:119], v[156:159]
    buffer_load_dwordx4 v35, s[24:27], s85 offen offset:3072 lds
    v_mfma_f32_16x16x32_bf16 v[80:83], v[184:187], a[120:123], v[80:83]
    ds_read_b64_tr_b16 v[180:181], v19 offset:56512
    ds_read_b64_tr_b16 v[182:183], v19 offset:57792
    v_mfma_f32_16x16x32_bf16 v[88:91], v[184:187], a[124:127], v[88:91]
    s_add_u32 m0, s61, 12288
    s_add_u32 s6, s85, 128
    v_mfma_f32_16x16x32_bf16 v[84:87], v[188:191], a[120:123], v[84:87]
    ds_read_b64_tr_b16 v[184:185], v18 offset:56576
    ds_read_b64_tr_b16 v[186:187], v18 offset:57856
    v_mfma_f32_16x16x32_bf16 v[92:95], v[188:191], a[124:127], v[92:95]
    buffer_load_dwordx4 v32, s[24:27], s6 offen offset:0 lds
    s_waitcnt vmcnt(9)
    ds_read_b128 a[224:227], v4 offset:0
    s_waitcnt lgkmcnt(7)
    v_mfma_f32_16x16x32_bf16 v[96:99], v[160:163], a[120:123], v[96:99]
    ds_read_b64_tr_b16 v[188:189], v19 offset:56576
    ds_read_b64_tr_b16 v[190:191], v19 offset:57856
    v_mfma_f32_16x16x32_bf16 v[104:107], v[160:163], a[124:127], v[104:107]
    ds_read_b128 a[228:231], v4 offset:2048
    ds_read_b128 a[232:235], v5 offset:0
    v_mfma_f32_16x16x32_bf16 v[100:103], v[164:167], a[120:123], v[100:103]
    ds_read_b128 a[236:239], v5 offset:2048
    v_mfma_f32_16x16x32_bf16 v[108:111], v[164:167], a[124:127], v[108:111]
    buffer_load_dwordx4 v33, s[24:27], s6 offen offset:1024 lds
    v_mfma_f32_16x16x32_bf16 v[112:115], v[168:171], a[120:123], v[112:115]
    v_mfma_f32_16x16x32_bf16 v[120:123], v[168:171], a[124:127], v[120:123]
    s_waitcnt lgkmcnt(0)
    s_barrier
    v_mfma_f32_16x16x32_bf16 v[116:119], v[172:175], a[120:123], v[116:119]
    ds_read_b64_tr_b16 v[160:161], v18 offset:0
    ds_read_b64_tr_b16 v[162:163], v18 offset:1280
    ds_read_b64_tr_b16 v[164:165], v19 offset:0
    ds_read_b64_tr_b16 v[166:167], v19 offset:1280
    v_mfma_f32_16x16x32_bf16 v[124:127], v[172:175], a[124:127], v[124:127]
    buffer_load_dwordx4 v34, s[24:27], s6 offen offset:2048 lds
    v_mfma_f32_16x16x32_bf16 v[128:131], v[176:179], a[120:123], v[128:131]
    ds_read_b64_tr_b16 v[168:169], v18 offset:64
    ds_read_b64_tr_b16 v[170:171], v18 offset:1344
    ds_read_b64_tr_b16 v[172:173], v19 offset:64
    ds_read_b64_tr_b16 v[174:175], v19 offset:1344
    v_mfma_f32_16x16x32_bf16 v[136:139], v[176:179], a[124:127], v[136:139]
    v_mfma_f32_16x16x32_bf16 v[132:135], v[180:183], a[120:123], v[132:135]
    ds_read_b64_tr_b16 v[176:177], v18 offset:128
    ds_read_b64_tr_b16 v[178:179], v18 offset:1408
    v_mfma_f32_16x16x32_bf16 v[140:143], v[180:183], a[124:127], v[140:143]
    buffer_load_dwordx4 v35, s[24:27], s6 offen offset:3072 lds
    v_mfma_f32_16x16x32_bf16 v[144:147], v[184:187], a[120:123], v[144:147]
    ds_read_b64_tr_b16 v[180:181], v19 offset:128
    ds_read_b64_tr_b16 v[182:183], v19 offset:1408
    v_mfma_f32_16x16x32_bf16 v[152:155], v[184:187], a[124:127], v[152:155]
    s_add_u32 m0, s61, 0
    v_mfma_f32_16x16x32_bf16 v[148:151], v[188:191], a[120:123], v[148:151]
    ds_read_b64_tr_b16 v[184:185], v18 offset:192
    ds_read_b64_tr_b16 v[186:187], v18 offset:1472
    v_mfma_f32_16x16x32_bf16 v[156:159], v[188:191], a[124:127], v[156:159]
    buffer_load_dwordx4 v32, s[24:27], s86 offen offset:0 lds
    s_waitcnt vmcnt(9)
    ds_read_b128 a[240:243], v4 offset:4096
    s_waitcnt lgkmcnt(7)
    v_mfma_f32_16x16x32_bf16 v[80:83], v[160:163], a[128:131], v[80:83]
    ds_read_b64_tr_b16 v[188:189], v19 offset:192
    ds_read_b64_tr_b16 v[190:191], v19 offset:1472
    v_mfma_f32_16x16x32_bf16 v[88:91], v[160:163], a[132:135], v[88:91]
    ds_read_b128 a[244:247], v4 offset:6144
    ds_read_b128 a[248:251], v5 offset:4096
    v_mfma_f32_16x16x32_bf16 v[84:87], v[164:167], a[128:131], v[84:87]
    ds_read_b64_tr_b16 v[160:161], v18 offset:256
    ds_read_b64_tr_b16 v[162:163], v18 offset:1536
    v_mfma_f32_16x16x32_bf16 v[92:95], v[164:167], a[132:135], v[92:95]
    buffer_load_dwordx4 v33, s[24:27], s86 offen offset:1024 lds
    ds_read_b128 a[252:255], v5 offset:6144
    v_mfma_f32_16x16x32_bf16 v[96:99], v[168:171], a[128:131], v[96:99]
    ds_read_b64_tr_b16 v[164:165], v19 offset:256
    ds_read_b64_tr_b16 v[166:167], v19 offset:1536
    v_mfma_f32_16x16x32_bf16 v[104:107], v[168:171], a[132:135], v[104:107]
    v_mfma_f32_16x16x32_bf16 v[100:103], v[172:175], a[128:131], v[100:103]
    ds_read_b64_tr_b16 v[168:169], v18 offset:40960
    ds_read_b64_tr_b16 v[170:171], v18 offset:42240
    v_mfma_f32_16x16x32_bf16 v[108:111], v[172:175], a[132:135], v[108:111]
    buffer_load_dwordx4 v34, s[24:27], s86 offen offset:2048 lds
    s_waitcnt lgkmcnt(9)
    v_mfma_f32_16x16x32_bf16 v[112:115], v[176:179], a[128:131], v[112:115]
    ds_read_b64_tr_b16 v[172:173], v19 offset:40960
    ds_read_b64_tr_b16 v[174:175], v19 offset:42240
    v_mfma_f32_16x16x32_bf16 v[120:123], v[176:179], a[132:135], v[120:123]
    v_mfma_f32_16x16x32_bf16 v[116:119], v[180:183], a[128:131], v[116:119]
    ds_read_b64_tr_b16 v[176:177], v18 offset:41024
    ds_read_b64_tr_b16 v[178:179], v18 offset:42304
    v_mfma_f32_16x16x32_bf16 v[124:127], v[180:183], a[132:135], v[124:127]
    buffer_load_dwordx4 v35, s[24:27], s86 offen offset:3072 lds
    v_mfma_f32_16x16x32_bf16 v[128:131], v[184:187], a[128:131], v[128:131]
    ds_read_b64_tr_b16 v[180:181], v19 offset:41024
    ds_read_b64_tr_b16 v[182:183], v19 offset:42304
    v_mfma_f32_16x16x32_bf16 v[136:139], v[184:187], a[132:135], v[136:139]
    s_waitcnt vmcnt(8)
    ds_read_b128 v[192:195], v4 offset:8192
    ds_read_b128 v[196:199], v4 offset:10240
    s_waitcnt lgkmcnt(12)
    s_add_u32 m0, s61, 4096
    s_add_u32 s6, s86, 128
    v_mfma_f32_16x16x32_bf16 v[132:135], v[188:191], a[128:131], v[132:135]
    ds_read_b64_tr_b16 v[184:185], v18 offset:41088
    ds_read_b64_tr_b16 v[186:187], v18 offset:42368
    v_mfma_f32_16x16x32_bf16 v[140:143], v[188:191], a[132:135], v[140:143]
    buffer_load_dwordx4 v32, s[24:27], s6 offen offset:0 lds
    ds_read_b128 v[200:203], v5 offset:8192
    ds_read_b128 v[204:207], v5 offset:10240
    v_mfma_f32_16x16x32_bf16 v[144:147], v[160:163], a[128:131], v[144:147]
    ds_read_b64_tr_b16 v[188:189], v19 offset:41088
    ds_read_b64_tr_b16 v[190:191], v19 offset:42368
    v_mfma_f32_16x16x32_bf16 v[152:155], v[160:163], a[132:135], v[152:155]
    s_waitcnt lgkmcnt(10)
    v_mfma_f32_16x16x32_bf16 v[148:151], v[164:167], a[128:131], v[148:151]
    ds_read_b64_tr_b16 v[160:161], v18 offset:41152
    ds_read_b64_tr_b16 v[162:163], v18 offset:42432
    v_mfma_f32_16x16x32_bf16 v[156:159], v[164:167], a[132:135], v[156:159]
    buffer_load_dwordx4 v33, s[24:27], s6 offen offset:1024 lds
    v_mfma_f32_16x16x32_bf16 v[80:83], v[168:171], a[136:139], v[80:83]
    ds_read_b64_tr_b16 v[164:165], v19 offset:41152
    ds_read_b64_tr_b16 v[166:167], v19 offset:42432
    v_mfma_f32_16x16x32_bf16 v[88:91], v[168:171], a[140:143], v[88:91]
    v_mfma_f32_16x16x32_bf16 v[84:87], v[172:175], a[136:139], v[84:87]
    ds_read_b64_tr_b16 v[168:169], v18 offset:41216
    ds_read_b64_tr_b16 v[170:171], v18 offset:42496
    v_mfma_f32_16x16x32_bf16 v[92:95], v[172:175], a[140:143], v[92:95]
    buffer_load_dwordx4 v34, s[24:27], s6 offen offset:2048 lds
    v_mfma_f32_16x16x32_bf16 v[96:99], v[176:179], a[136:139], v[96:99]
    ds_read_b64_tr_b16 v[172:173], v19 offset:41216
    ds_read_b64_tr_b16 v[174:175], v19 offset:42496
    v_mfma_f32_16x16x32_bf16 v[104:107], v[176:179], a[140:143], v[104:107]
    s_waitcnt lgkmcnt(6)
    v_mfma_f32_16x16x32_bf16 v[100:103], v[180:183], a[136:139], v[100:103]
    v_mfma_f32_16x16x32_bf16 v[108:111], v[180:183], a[140:143], v[108:111]
    buffer_load_dwordx4 v35, s[24:27], s6 offen offset:3072 lds
    v_mfma_f32_16x16x32_bf16 v[112:115], v[184:187], a[136:139], v[112:115]
    v_mfma_f32_16x16x32_bf16 v[120:123], v[184:187], a[140:143], v[120:123]
    s_add_u32 m0, s61, 8192
    s_waitcnt lgkmcnt(0)
    s_barrier
    v_mfma_f32_16x16x32_bf16 v[116:119], v[188:191], a[136:139], v[116:119]
    ds_read_b64_tr_b16 v[176:177], v18 offset:5120
    ds_read_b64_tr_b16 v[178:179], v18 offset:6400
    ds_read_b64_tr_b16 v[180:181], v19 offset:5120
    ds_read_b64_tr_b16 v[182:183], v19 offset:6400
    v_mfma_f32_16x16x32_bf16 v[124:127], v[188:191], a[140:143], v[124:127]
    buffer_load_dwordx4 v32, s[24:27], s87 offen offset:0 lds
    v_mfma_f32_16x16x32_bf16 v[128:131], v[160:163], a[136:139], v[128:131]
    ds_read_b64_tr_b16 v[184:185], v18 offset:5184
    ds_read_b64_tr_b16 v[186:187], v18 offset:6464
    ds_read_b64_tr_b16 v[188:189], v19 offset:5184
    ds_read_b64_tr_b16 v[190:191], v19 offset:6464
    v_mfma_f32_16x16x32_bf16 v[136:139], v[160:163], a[140:143], v[136:139]
    v_mfma_f32_16x16x32_bf16 v[132:135], v[164:167], a[136:139], v[132:135]
    ds_read_b64_tr_b16 v[160:161], v18 offset:5248
    ds_read_b64_tr_b16 v[162:163], v18 offset:6528
    v_mfma_f32_16x16x32_bf16 v[140:143], v[164:167], a[140:143], v[140:143]
    buffer_load_ushort v46, v43, s[28:31], 0 offen offset:0
    v_mfma_f32_16x16x32_bf16 v[144:147], v[168:171], a[136:139], v[144:147]
    ds_read_b64_tr_b16 v[164:165], v19 offset:5248
    ds_read_b64_tr_b16 v[166:167], v19 offset:6528
    v_mfma_f32_16x16x32_bf16 v[152:155], v[168:171], a[140:143], v[152:155]
    buffer_load_ushort v47, v43, s[28:31], 0 offen offset:32
    v_mfma_f32_16x16x32_bf16 v[148:151], v[172:175], a[136:139], v[148:151]
    ds_read_b64_tr_b16 v[168:169], v18 offset:5312
    ds_read_b64_tr_b16 v[170:171], v18 offset:6592
    v_mfma_f32_16x16x32_bf16 v[156:159], v[172:175], a[140:143], v[156:159]
    buffer_load_dword v45, v44, s[48:51], 0 offen sc1
    s_waitcnt lgkmcnt(6)
    v_mfma_f32_16x16x32_bf16 v[80:83], v[176:179], a[144:147], v[80:83]
    ds_read_b64_tr_b16 v[172:173], v19 offset:5312
    ds_read_b64_tr_b16 v[174:175], v19 offset:6592
    v_mfma_f32_16x16x32_bf16 v[88:91], v[176:179], a[148:151], v[88:91]
    buffer_load_dwordx4 v33, s[24:27], s87 offen offset:1024 lds
    v_mfma_f32_16x16x32_bf16 v[84:87], v[180:183], a[144:147], v[84:87]
    ds_read_b64_tr_b16 v[176:177], v18 offset:5376
    ds_read_b64_tr_b16 v[178:179], v18 offset:6656
    v_mfma_f32_16x16x32_bf16 v[92:95], v[180:183], a[148:151], v[92:95]
    v_mfma_f32_16x16x32_bf16 v[96:99], v[184:187], a[144:147], v[96:99]
    ds_read_b64_tr_b16 v[180:181], v19 offset:5376
    ds_read_b64_tr_b16 v[182:183], v19 offset:6656
    v_mfma_f32_16x16x32_bf16 v[104:107], v[184:187], a[148:151], v[104:107]
    buffer_load_dwordx4 v34, s[24:27], s87 offen offset:2048 lds
    v_mfma_f32_16x16x32_bf16 v[100:103], v[188:191], a[144:147], v[100:103]
    ds_read_b64_tr_b16 v[184:185], v18 offset:46080
    ds_read_b64_tr_b16 v[186:187], v18 offset:47360
    v_mfma_f32_16x16x32_bf16 v[108:111], v[188:191], a[148:151], v[108:111]
    s_waitcnt lgkmcnt(6)
    v_mfma_f32_16x16x32_bf16 v[112:115], v[160:163], a[144:147], v[112:115]
    ds_read_b64_tr_b16 v[188:189], v19 offset:46080
    ds_read_b64_tr_b16 v[190:191], v19 offset:47360
    v_mfma_f32_16x16x32_bf16 v[120:123], v[160:163], a[148:151], v[120:123]
    buffer_load_dwordx4 v35, s[24:27], s87 offen offset:3072 lds
    v_mfma_f32_16x16x32_bf16 v[116:119], v[164:167], a[144:147], v[116:119]
    ds_read_b64_tr_b16 v[160:161], v18 offset:46144
    ds_read_b64_tr_b16 v[162:163], v18 offset:47424
    v_mfma_f32_16x16x32_bf16 v[124:127], v[164:167], a[148:151], v[124:127]
    v_mfma_f32_16x16x32_bf16 v[128:131], v[168:171], a[144:147], v[128:131]
    ds_read_b64_tr_b16 v[164:165], v19 offset:46144
    ds_read_b64_tr_b16 v[166:167], v19 offset:47424
    v_mfma_f32_16x16x32_bf16 v[136:139], v[168:171], a[148:151], v[136:139]
    v_mfma_f32_16x16x32_bf16 v[132:135], v[172:175], a[144:147], v[132:135]
    ds_read_b64_tr_b16 v[168:169], v18 offset:46208
    ds_read_b64_tr_b16 v[170:171], v18 offset:47488
    v_mfma_f32_16x16x32_bf16 v[140:143], v[172:175], a[148:151], v[140:143]
    s_waitcnt lgkmcnt(6)
    v_mfma_f32_16x16x32_bf16 v[144:147], v[176:179], a[144:147], v[144:147]
    ds_read_b64_tr_b16 v[172:173], v19 offset:46208
    ds_read_b64_tr_b16 v[174:175], v19 offset:47488
    v_mfma_f32_16x16x32_bf16 v[152:155], v[176:179], a[148:151], v[152:155]
    v_mfma_f32_16x16x32_bf16 v[148:151], v[180:183], a[144:147], v[148:151]
    ds_read_b64_tr_b16 v[176:177], v18 offset:46272
    ds_read_b64_tr_b16 v[178:179], v18 offset:47552
    v_mfma_f32_16x16x32_bf16 v[156:159], v[180:183], a[148:151], v[156:159]
    v_mfma_f32_16x16x32_bf16 v[80:83], v[184:187], a[152:155], v[80:83]
    ds_read_b64_tr_b16 v[180:181], v19 offset:46272
    ds_read_b64_tr_b16 v[182:183], v19 offset:47552
    v_mfma_f32_16x16x32_bf16 v[88:91], v[184:187], a[156:159], v[88:91]
    v_mfma_f32_16x16x32_bf16 v[84:87], v[188:191], a[152:155], v[84:87]
    ds_read_b64_tr_b16 v[184:185], v18 offset:46336
    ds_read_b64_tr_b16 v[186:187], v18 offset:47616
    v_mfma_f32_16x16x32_bf16 v[92:95], v[188:191], a[156:159], v[92:95]
    s_waitcnt lgkmcnt(6)
    v_mfma_f32_16x16x32_bf16 v[96:99], v[160:163], a[152:155], v[96:99]
    ds_read_b64_tr_b16 v[188:189], v19 offset:46336
    ds_read_b64_tr_b16 v[190:191], v19 offset:47616
    v_mfma_f32_16x16x32_bf16 v[104:107], v[160:163], a[156:159], v[104:107]
    v_mfma_f32_16x16x32_bf16 v[100:103], v[164:167], a[152:155], v[100:103]
    v_mfma_f32_16x16x32_bf16 v[108:111], v[164:167], a[156:159], v[108:111]
    v_mfma_f32_16x16x32_bf16 v[112:115], v[168:171], a[152:155], v[112:115]
    v_mfma_f32_16x16x32_bf16 v[120:123], v[168:171], a[156:159], v[120:123]
    v_mfma_f32_16x16x32_bf16 v[116:119], v[172:175], a[152:155], v[116:119]
    v_mfma_f32_16x16x32_bf16 v[124:127], v[172:175], a[156:159], v[124:127]
    s_waitcnt lgkmcnt(0)
    v_mfma_f32_16x16x32_bf16 v[128:131], v[176:179], a[152:155], v[128:131]
    v_mfma_f32_16x16x32_bf16 v[136:139], v[176:179], a[156:159], v[136:139]
    v_mfma_f32_16x16x32_bf16 v[132:135], v[180:183], a[152:155], v[132:135]
    v_mfma_f32_16x16x32_bf16 v[140:143], v[180:183], a[156:159], v[140:143]
    v_mfma_f32_16x16x32_bf16 v[144:147], v[184:187], a[152:155], v[144:147]
    v_mfma_f32_16x16x32_bf16 v[152:155], v[184:187], a[156:159], v[152:155]
    v_mfma_f32_16x16x32_bf16 v[148:151], v[188:191], a[152:155], v[148:151]
    v_mfma_f32_16x16x32_bf16 v[156:159], v[188:191], a[156:159], v[156:159]
L_tail_10:
    s_barrier
    s_lshl2_add_u32 s75, s57, s56
    s_mul_i32 s75, s75, 28
    s_mul_i32 s76, s98, 5
    s_add_u32 s76, s76, 1
    s_add_u32 s75, s75, s76
    s_lshl_b32 s75, s75, 11
    s_add_u32 s75, s75, 6291456
    v_cvt_pk_bf16_f32 v80, v80, v81
    v_cvt_pk_bf16_f32 v81, v82, v83
    v_cvt_pk_bf16_f32 v82, v84, v85
    v_cvt_pk_bf16_f32 v83, v86, v87
    v_cvt_pk_bf16_f32 v84, v88, v89
    v_cvt_pk_bf16_f32 v85, v90, v91
    v_cvt_pk_bf16_f32 v86, v92, v93
    v_cvt_pk_bf16_f32 v87, v94, v95
    buffer_store_dwordx4 v[80:83], v29, s[48:51], s75 offen offset:0 sc1
    buffer_store_dwordx4 v[84:87], v29, s[48:51], s75 offen offset:1024 sc1
    v_cvt_pk_bf16_f32 v88, v96, v97
    v_cvt_pk_bf16_f32 v89, v98, v99
    v_cvt_pk_bf16_f32 v90, v100, v101
    v_cvt_pk_bf16_f32 v91, v102, v103
    v_cvt_pk_bf16_f32 v92, v104, v105
    v_cvt_pk_bf16_f32 v93, v106, v107
    v_cvt_pk_bf16_f32 v94, v108, v109
    v_cvt_pk_bf16_f32 v95, v110, v111
    buffer_store_dwordx4 v[88:91], v29, s[48:51], s75 offen offset:2048 sc1
    buffer_store_dwordx4 v[92:95], v29, s[48:51], s75 offen offset:3072 sc1
    v_cvt_pk_bf16_f32 v96, v112, v113
    v_cvt_pk_bf16_f32 v97, v114, v115
    v_cvt_pk_bf16_f32 v98, v116, v117
    v_cvt_pk_bf16_f32 v99, v118, v119
    v_cvt_pk_bf16_f32 v100, v120, v121
    v_cvt_pk_bf16_f32 v101, v122, v123
    v_cvt_pk_bf16_f32 v102, v124, v125
    v_cvt_pk_bf16_f32 v103, v126, v127
    buffer_store_dwordx4 v[96:99], v30, s[48:51], s75 offen offset:0 sc1
    buffer_store_dwordx4 v[100:103], v30, s[48:51], s75 offen offset:1024 sc1
    v_cvt_pk_bf16_f32 v104, v128, v129
    v_cvt_pk_bf16_f32 v105, v130, v131
    v_cvt_pk_bf16_f32 v106, v132, v133
    v_cvt_pk_bf16_f32 v107, v134, v135
    v_cvt_pk_bf16_f32 v108, v136, v137
    v_cvt_pk_bf16_f32 v109, v138, v139
    v_cvt_pk_bf16_f32 v110, v140, v141
    v_cvt_pk_bf16_f32 v111, v142, v143
    buffer_store_dwordx4 v[104:107], v30, s[48:51], s75 offen offset:2048 sc1
    buffer_store_dwordx4 v[108:111], v30, s[48:51], s75 offen offset:3072 sc1
    v_cvt_pk_bf16_f32 v112, v144, v145
    v_cvt_pk_bf16_f32 v113, v146, v147
    v_cvt_pk_bf16_f32 v114, v148, v149
    v_cvt_pk_bf16_f32 v115, v150, v151
    v_cvt_pk_bf16_f32 v116, v152, v153
    v_cvt_pk_bf16_f32 v117, v154, v155
    v_cvt_pk_bf16_f32 v118, v156, v157
    v_cvt_pk_bf16_f32 v119, v158, v159
    s_add_u32 s75, s75, 8192
    buffer_store_dwordx4 v[112:115], v29, s[48:51], s75 offen offset:0 sc1
    buffer_store_dwordx4 v[116:119], v29, s[48:51], s75 offen offset:1024 sc1
    s_lshl2_add_u32 s7, s57, s56
    s_lshl3_add_u32 s7, s7, s98
    s_lshl_b32 s7, s7, 7
    s_add_u32 s7, s7, 344064
    s_waitcnt vmcnt(13)
    v_cmp_eq_u32 vcc, -1, v45
    s_nop 1
    s_cbranch_vccnz Lslow_13
Lback_14:
    s_add_u32 m0, s61, 28672
    s_nop 0
    buffer_load_dwordx4 v29, s[48:51], s90 offen offset:0 sc1 lds
    buffer_load_dwordx4 v29, s[48:51], s90 offen offset:1024 sc1 lds
    buffer_load_dwordx4 v29, s[48:51], s90 offen offset:2048 sc1 lds
    buffer_load_dwordx4 v29, s[48:51], s90 offen offset:3072 sc1 lds
    s_add_u32 m0, s61, 32768
    s_nop 0
    buffer_load_dwordx4 v29, s[48:51], s91 offen offset:0 sc1 lds
    buffer_load_dwordx4 v29, s[48:51], s91 offen offset:1024 sc1 lds
    buffer_load_dwordx4 v29, s[48:51], s91 offen offset:2048 sc1 lds
    buffer_load_dwordx4 v29, s[48:51], s91 offen offset:3072 sc1 lds
    s_waitcnt vmcnt(8)
    s_mov_b64 exec, 1
    buffer_store_dword v31, off, s[48:51], s7 sc1
    s_mov_b64 exec, -1
    s_mov_b32 s7, 0x80000000
    s_mov_b32 s32, 0x80000000
    s_mov_b32 s33, 0x80000000
    s_mov_b32 s62, 0x80000000
    s_mov_b32 s34, 0x80000000
    s_mov_b32 s35, 0x80000000
    s_add_u32 m0, s61, 36864
    s_nop 0
    buffer_load_dwordx4 v29, s[48:51], s92 offen offset:0 sc1 lds
    buffer_load_dwordx4 v29, s[48:51], s92 offen offset:1024 sc1 lds
    buffer_load_dwordx4 v29, s[48:51], s92 offen offset:2048 sc1 lds
    buffer_load_dwordx4 v29, s[48:51], s92 offen offset:3072 sc1 lds
    s_branch L_p2
L_role_l:
    s_mov_b32 s98, 5
    s_mov_b32 s72, 1600
    s_bfe_u32 s71, s99, 0x40000
    s_mul_i32 s71, s71, 221184
    s_add_u32 s71, s71, s72
    v_lshrrev_b32 v36, 3, v0
    v_lshlrev_b32 v36, 2, v36
    v_and_b32 v37, 0x70, v29
    v_bfe_u32 v38, s99, v36, 4
    v_lshl_add_u32 v38, v38, 7, v37
    v_bfe_u32 v39, s65, v36, 4
    v_lshl_add_u32 v39, v39, 7, v37
    v_lshrrev_b32 v18, 4, v0
    v_lshl_add_u32 v18, v18, 4, s61
    s_lshl2_add_u32 s75, s16, s56
    s_lshl_b32 s75, s75, 17
    s_and_b32 s3, s17, 1
    s_lshl_b32 s76, s3, 11
    s_add_u32 s75, s75, s76
    s_xor_b32 s77, s17, 1
    s_lshl1_add_u32 s77, s77, s3
    s_lshl_b32 s77, s77, 17
    s_lshl_b32 s76, s56, 12
    s_add_u32 s77, s77, s76
    s_add_u32 s77, s77, 2097152
    s_lshl_b32 s78, s3, 19
    s_sub_u32 s78, s78, 0x40000
    s_lshr_b32 s3, s17, 1
    s_mov_b32 s79, 0x76453201
    s_and_b32 s76, s16, 3
    s_cmp_eq_u32 s76, 1
    s_cselect_b32 s79, 0x75643120, s79
    s_cmp_eq_u32 s76, 2
    s_cselect_b32 s79, 0x67542310, s79
    s_cmp_eq_u32 s76, 3
    s_cselect_b32 s79, 0x76534210, s79
    s_and_b32 s3, s3, 7
    s_mul_i32 s3, s3, 0x11111111
    s_add_u32 s79, s79, s3
    s_bfe_u32 s76, s79, 0x30000
    s_lshl_b32 s76, s76, 8
    s_add_u32 s82, s76, s75
    s_lshl_b32 s76, s76, 6
    s_add_u32 s90, s76, s77
    s_bfe_u32 s76, s79, 0x30004
    s_lshl_b32 s76, s76, 8
    s_add_u32 s83, s76, s75
    s_lshl_b32 s76, s76, 6
    s_add_u32 s91, s76, s77
    s_bfe_u32 s76, s79, 0x30008
    s_lshl_b32 s76, s76, 8
    s_add_u32 s84, s76, s75
    s_lshl_b32 s76, s76, 6
    s_add_u32 s92, s76, s77
    s_bfe_u32 s76, s79, 0x3000c
    s_lshl_b32 s76, s76, 8
    s_add_u32 s85, s76, s75
    s_lshl_b32 s76, s76, 6
    s_add_u32 s93, s76, s77
    s_bfe_u32 s76, s79, 0x30010
    s_lshl_b32 s76, s76, 8
    s_add_u32 s86, s76, s75
    s_add_u32 m0, s61, 4096
    s_nop 0
    buffer_load_dwordx4 v8, s[8:11], s63 offen offset:0 lds
    buffer_load_dwordx4 v9, s[8:11], s63 offen offset:1024 lds
    buffer_load_dwordx4 v10, s[8:11], s63 offen offset:2048 lds
    buffer_load_dwordx4 v11, s[8:11], s63 offen offset:3072 lds
    s_bfe_u32 s63, s99, 0x40008
    s_mul_i32 s63, s63, 128
    s_add_u32 s63, s63, s64
    s_add_u32 m0, s61, 34816
    s_nop 0
    buffer_load_dwordx4 v16, s[20:23], s66 offen offset:0 lds
    buffer_load_dwordx4 v17, s[20:23], s66 offen offset:1024 lds
    s_lshl_b32 s76, s76, 6
    s_add_u32 s94, s76, s77
    s_bfe_u32 s76, s79, 0x30014
    s_lshl_b32 s76, s76, 8
    s_add_u32 s87, s76, s75
    s_lshl_b32 s76, s76, 6
    s_add_u32 s95, s76, s77
    s_bfe_u32 s76, s79, 0x30018
    s_lshl_b32 s76, s76, 8
    s_add_u32 s88, s76, s75
    s_lshl_b32 s76, s76, 6
    s_add_u32 s96, s76, s77
    s_bfe_u32 s76, s79, 0x3001c
    s_lshl_b32 s76, s76, 8
    s_add_u32 s89, s76, s75
    s_lshl_b32 s76, s76, 6
    s_add_u32 s97, s76, s77
    s_and_b32 s77, s17, 1
    s_andn2_b32 s75, s17, 1
    s_lshl1_add_u32 s75, s75, s77
    s_lshl_b32 s75, s75, 5
    s_add_u32 s75, s75, s56
    s_lshl_b32 s75, s75, 7
    s_add_u32 s75, s75, 229376
    v_and_b32 v44, 7, v0
    v_bfe_u32 v43, v0, 3, 1
    v_lshl_add_u32 v44, v43, 4, v44
    v_lshl_add_u32 v44, v44, 9, s75
    s_lshl2_add_u32 s77, s16, s56
    s_lshl_b32 s77, s77, 6
    v_and_b32 v43, 15, v0
    v_lshl_add_u32 v43, v43, 1, s77
    v_bfe_u32 v240, v0, 1, 1
    v_bfe_u32 v241, v0, 2, 2
    v_and_b32 v242, 1, v0
    v_lshl_or_b32 v241, v241, 1, v242
    v_lshl_or_b32 v240, v240, 3, v241
    v_lshrrev_b32 v241, 5, v0
    v_lshl_or_b32 v241, v241, 2, v3
    v_xor_b32 v240, v240, v241
    v_lshlrev_b32 v240, 3, v240
    v_and_b32 v242, 15, v0
    v_lshl_add_u32 v240, v242, 7, v240
    v_add_u32 v240, s61, v240
    v_xor_b32 v241, 16, v240
    v_xor_b32 v242, 64, v240
    v_xor_b32 v243, 80, v240
    v_bfe_u32 v245, v0, 3, 1
    v_lshlrev_b32 v245, 3, v245
    v_bfe_u32 v246, v0, 4, 1
    v_bfe_u32 v247, v0, 1, 1
    v_xor_b32 v246, v246, v247
    v_lshl_or_b32 v245, v246, 2, v245
    v_lshrrev_b32 v246, 2, v0
    v_xor_b32 v247, v0, v246
    v_and_or_b32 v245, v247, 1, v245
    v_lshlrev_b32 v245, 3, v245
    v_and_b32 v246, 3, v246
    v_lshrrev_b32 v247, 4, v0
    v_lshl_add_u32 v246, v247, 3, v246
    v_lshl_add_u32 v245, v246, 7, v245
    v_add_u32 v245, s61, v245
    v_xor_b32 v246, 16, v245
    v_xor_b32 v247, 64, v245
    v_xor_b32 v248, 80, v245
    s_lshl2_add_u32 s75, s57, s56
    s_lshl_b32 s75, s75, 12
    s_lshl_b32 s76, s60, 18
    s_add_u32 s75, s75, s76
    s_add_u32 s80, s75, 2097152
    s_lshl4_add_u32 s76, s60, s57
    s_lshl2_add_u32 s76, s76, s56
    s_lshl_b32 s76, s76, 7
    s_add_u32 s81, s76, 229376
    s_waitcnt vmcnt(6)
    s_barrier
    ds_read_b128 a[0:3], v4 offset:0
    ds_read_b128 a[4:7], v4 offset:2048
    ds_read_b128 a[8:11], v5 offset:0
    ds_read_b128 a[12:15], v5 offset:2048
    ds_read_b64_tr_b16 v[160:161], v20 offset:16384
    ds_read_b64_tr_b16 v[162:163], v20 offset:16896
    ds_read_b64_tr_b16 v[164:165], v21 offset:16384
    ds_read_b64_tr_b16 v[166:167], v21 offset:16896
    ds_read_b64_tr_b16 v[168:169], v22 offset:16384
    ds_read_b64_tr_b16 v[170:171], v22 offset:16896
    ds_read_b64_tr_b16 v[172:173], v23 offset:16384
    ds_read_b64_tr_b16 v[174:175], v23 offset:16896
    ds_read_b64_tr_b16 v[176:177], v20 offset:57344
    ds_read_b64_tr_b16 v[178:179], v20 offset:57856
    ds_read_b64_tr_b16 v[180:181], v21 offset:57344
    ds_read_b64_tr_b16 v[182:183], v21 offset:57856
    s_waitcnt lgkmcnt(10)
    v_mfma_f32_16x16x32_bf16 v[48:51], v[160:163], a[0:3], 0
    ds_read_b64_tr_b16 v[184:185], v22 offset:57344
    ds_read_b64_tr_b16 v[186:187], v22 offset:57856
    ds_read_b64_tr_b16 v[188:189], v23 offset:57344
    ds_read_b64_tr_b16 v[190:191], v23 offset:57856
    v_mfma_f32_16x16x32_bf16 v[56:59], v[160:163], a[4:7], 0
    s_bfe_u32 s66, s99, 0x40008
    s_mul_i32 s66, s66, 221184
    s_add_u32 s66, s66, s67
    s_add_u32 m0, s61, 8192
    s_waitcnt lgkmcnt(12)
    v_mfma_f32_16x16x32_bf16 v[52:55], v[164:167], a[0:3], 0
    v_mfma_f32_16x16x32_bf16 v[60:63], v[164:167], a[4:7], 0
    buffer_load_dwordx4 v8, s[8:11], s63 offen offset:0 lds
    s_waitcnt lgkmcnt(4)
    v_mfma_f32_16x16x32_bf16 v[64:67], v[168:171], a[0:3], 0
    v_mfma_f32_16x16x32_bf16 v[72:75], v[168:171], a[4:7], 0
    buffer_load_dwordx4 v9, s[8:11], s63 offen offset:1024 lds
    s_waitcnt vmcnt(2) lgkmcnt(0)
    s_barrier
    ds_read_b128 a[16:19], v4 offset:4096
    ds_read_b128 a[20:23], v4 offset:6144
    ds_read_b128 a[24:27], v5 offset:4096
    ds_read_b128 a[28:31], v5 offset:6144
    v_mfma_f32_16x16x32_bf16 v[68:71], v[172:175], a[0:3], 0
    ds_read_b64_tr_b16 v[160:161], v20 offset:18432
    ds_read_b64_tr_b16 v[162:163], v20 offset:18944
    ds_read_b64_tr_b16 v[164:165], v21 offset:18432
    ds_read_b64_tr_b16 v[166:167], v21 offset:18944
    v_mfma_f32_16x16x32_bf16 v[76:79], v[172:175], a[4:7], 0
    buffer_load_dwordx4 v10, s[8:11], s63 offen offset:2048 lds
    v_mfma_f32_16x16x32_bf16 v[48:51], v[176:179], a[8:11], v[48:51]
    ds_read_b64_tr_b16 v[168:169], v22 offset:18432
    ds_read_b64_tr_b16 v[170:171], v22 offset:18944
    ds_read_b64_tr_b16 v[172:173], v23 offset:18432
    ds_read_b64_tr_b16 v[174:175], v23 offset:18944
    v_mfma_f32_16x16x32_bf16 v[56:59], v[176:179], a[12:15], v[56:59]
    buffer_load_dwordx4 v11, s[8:11], s63 offen offset:3072 lds
    s_bfe_u32 s63, s99, 0x4000c
    s_mul_i32 s63, s63, 128
    s_add_u32 s63, s63, s64
    s_add_u32 m0, s61, 36864
    v_mfma_f32_16x16x32_bf16 v[52:55], v[180:183], a[8:11], v[52:55]
    ds_read_b64_tr_b16 v[176:177], v20 offset:59392
    ds_read_b64_tr_b16 v[178:179], v20 offset:59904
    v_mfma_f32_16x16x32_bf16 v[60:63], v[180:183], a[12:15], v[60:63]
    buffer_load_dwordx4 v16, s[20:23], s66 offen offset:0 lds
    v_mfma_f32_16x16x32_bf16 v[64:67], v[184:187], a[8:11], v[64:67]
    ds_read_b64_tr_b16 v[180:181], v21 offset:59392
    ds_read_b64_tr_b16 v[182:183], v21 offset:59904
    v_mfma_f32_16x16x32_bf16 v[72:75], v[184:187], a[12:15], v[72:75]
    buffer_load_dwordx4 v17, s[20:23], s66 offen offset:1024 lds
    s_bfe_u32 s66, s99, 0x4000c
    s_mul_i32 s66, s66, 221184
    s_add_u32 s66, s66, s67
    s_add_u32 m0, s61, 12288
    v_mfma_f32_16x16x32_bf16 v[68:71], v[188:191], a[8:11], v[68:71]
    ds_read_b64_tr_b16 v[184:185], v22 offset:59392
    ds_read_b64_tr_b16 v[186:187], v22 offset:59904
    v_mfma_f32_16x16x32_bf16 v[76:79], v[188:191], a[12:15], v[76:79]
    buffer_load_dwordx4 v8, s[8:11], s63 offen offset:0 lds
    s_waitcnt lgkmcnt(6)
    v_mfma_f32_16x16x32_bf16 v[48:51], v[160:163], a[16:19], v[48:51]
    ds_read_b64_tr_b16 v[188:189], v23 offset:59392
    ds_read_b64_tr_b16 v[190:191], v23 offset:59904
    v_mfma_f32_16x16x32_bf16 v[56:59], v[160:163], a[20:23], v[56:59]
    buffer_load_dwordx4 v9, s[8:11], s63 offen offset:1024 lds
    v_mfma_f32_16x16x32_bf16 v[52:55], v[164:167], a[16:19], v[52:55]
    v_mfma_f32_16x16x32_bf16 v[60:63], v[164:167], a[20:23], v[60:63]
    buffer_load_dwordx4 v10, s[8:11], s63 offen offset:2048 lds
    v_mfma_f32_16x16x32_bf16 v[64:67], v[168:171], a[16:19], v[64:67]
    v_mfma_f32_16x16x32_bf16 v[72:75], v[168:171], a[20:23], v[72:75]
    buffer_load_dwordx4 v11, s[8:11], s63 offen offset:3072 lds
    s_bfe_u32 s63, s99, 0x40010
    s_mul_i32 s63, s63, 128
    s_add_u32 s63, s63, s64
    s_add_u32 m0, s61, 38912
    s_waitcnt vmcnt(4) lgkmcnt(0)
    s_barrier
    ds_read_b128 a[32:35], v4 offset:8192
    ds_read_b128 a[36:39], v4 offset:10240
    ds_read_b128 a[40:43], v5 offset:8192
    ds_read_b128 a[44:47], v5 offset:10240
    v_mfma_f32_16x16x32_bf16 v[68:71], v[172:175], a[16:19], v[68:71]
    ds_read_b64_tr_b16 v[160:161], v20 offset:20480
    ds_read_b64_tr_b16 v[162:163], v20 offset:20992
    ds_read_b64_tr_b16 v[164:165], v21 offset:20480
    ds_read_b64_tr_b16 v[166:167], v21 offset:20992
    v_mfma_f32_16x16x32_bf16 v[76:79], v[172:175], a[20:23], v[76:79]
    buffer_load_dwordx4 v16, s[20:23], s66 offen offset:0 lds
    v_mfma_f32_16x16x32_bf16 v[48:51], v[176:179], a[24:27], v[48:51]
    ds_read_b64_tr_b16 v[168:169], v22 offset:20480
    ds_read_b64_tr_b16 v[170:171], v22 offset:20992
    ds_read_b64_tr_b16 v[172:173], v23 offset:20480
    ds_read_b64_tr_b16 v[174:175], v23 offset:20992
    v_mfma_f32_16x16x32_bf16 v[56:59], v[176:179], a[28:31], v[56:59]
    buffer_load_dwordx4 v17, s[20:23], s66 offen offset:1024 lds
    s_bfe_u32 s66, s99, 0x40010
    s_mul_i32 s66, s66, 221184
    s_add_u32 s66, s66, s67
    s_add_u32 m0, s61, 0
    v_mfma_f32_16x16x32_bf16 v[52:55], v[180:183], a[24:27], v[52:55]
    ds_read_b64_tr_b16 v[176:177], v20 offset:61440
    ds_read_b64_tr_b16 v[178:179], v20 offset:61952
    v_mfma_f32_16x16x32_bf16 v[60:63], v[180:183], a[28:31], v[60:63]
    buffer_load_dwordx4 v8, s[8:11], s63 offen offset:0 lds
    v_mfma_f32_16x16x32_bf16 v[64:67], v[184:187], a[24:27], v[64:67]
    ds_read_b64_tr_b16 v[180:181], v21 offset:61440
    ds_read_b64_tr_b16 v[182:183], v21 offset:61952
    v_mfma_f32_16x16x32_bf16 v[72:75], v[184:187], a[28:31], v[72:75]
    buffer_load_dwordx4 v9, s[8:11], s63 offen offset:1024 lds
    v_mfma_f32_16x16x32_bf16 v[68:71], v[188:191], a[24:27], v[68:71]
    ds_read_b64_tr_b16 v[184:185], v22 offset:61440
    ds_read_b64_tr_b16 v[186:187], v22 offset:61952
    v_mfma_f32_16x16x32_bf16 v[76:79], v[188:191], a[28:31], v[76:79]
    buffer_load_dwordx4 v10, s[8:11], s63 offen offset:2048 lds
    s_waitcnt lgkmcnt(6)
    v_mfma_f32_16x16x32_bf16 v[48:51], v[160:163], a[32:35], v[48:51]
    ds_read_b64_tr_b16 v[188:189], v23 offset:61440
    ds_read_b64_tr_b16 v[190:191], v23 offset:61952
    v_mfma_f32_16x16x32_bf16 v[56:59], v[160:163], a[36:39], v[56:59]
    buffer_load_dwordx4 v11, s[8:11], s63 offen offset:3072 lds
    s_bfe_u32 s63, s99, 0x40014
    s_mul_i32 s63, s63, 128
    s_add_u32 s63, s63, s64
    s_add_u32 m0, s61, 32768
    v_mfma_f32_16x16x32_bf16 v[52:55], v[164:167], a[32:35], v[52:55]
    v_mfma_f32_16x16x32_bf16 v[60:63], v[164:167], a[36:39], v[60:63]
    buffer_load_dwordx4 v16, s[20:23], s66 offen offset:0 lds
    v_mfma_f32_16x16x32_bf16 v[64:67], v[168:171], a[32:35], v[64:67]
    v_mfma_f32_16x16x32_bf16 v[72:75], v[168:171], a[36:39], v[72:75]
    buffer_load_dwordx4 v17, s[20:23], s66 offen offset:1024 lds
    s_bfe_u32 s66, s99, 0x40014
    s_mul_i32 s66, s66, 221184
    s_add_u32 s66, s66, s67
    s_add_u32 m0, s61, 4096
    s_waitcnt vmcnt(6) lgkmcnt(0)
    s_barrier
    ds_read_b128 a[48:51], v4 offset:12288
    ds_read_b128 a[52:55], v4 offset:14336
    ds_read_b128 a[56:59], v5 offset:12288
    ds_read_b128 a[60:63], v5 offset:14336
    v_mfma_f32_16x16x32_bf16 v[68:71], v[172:175], a[32:35], v[68:71]
    ds_read_b64_tr_b16 v[160:161], v20 offset:22528
    ds_read_b64_tr_b16 v[162:163], v20 offset:23040
    ds_read_b64_tr_b16 v[164:165], v21 offset:22528
    ds_read_b64_tr_b16 v[166:167], v21 offset:23040
    v_mfma_f32_16x16x32_bf16 v[76:79], v[172:175], a[36:39], v[76:79]
    buffer_load_dwordx4 v8, s[8:11], s63 offen offset:0 lds
    v_mfma_f32_16x16x32_bf16 v[48:51], v[176:179], a[40:43], v[48:51]
    ds_read_b64_tr_b16 v[168:169], v22 offset:22528
    ds_read_b64_tr_b16 v[170:171], v22 offset:23040
    ds_read_b64_tr_b16 v[172:173], v23 offset:22528
    ds_read_b64_tr_b16 v[174:175], v23 offset:23040
    v_mfma_f32_16x16x32_bf16 v[56:59], v[176:179], a[44:47], v[56:59]
    buffer_load_dwordx4 v9, s[8:11], s63 offen offset:1024 lds
    v_mfma_f32_16x16x32_bf16 v[52:55], v[180:183], a[40:43], v[52:55]
    ds_read_b64_tr_b16 v[176:177], v20 offset:63488
    ds_read_b64_tr_b16 v[178:179], v20 offset:64000
    v_mfma_f32_16x16x32_bf16 v[60:63], v[180:183], a[44:47], v[60:63]
    buffer_load_dwordx4 v10, s[8:11], s63 offen offset:2048 lds
    v_mfma_f32_16x16x32_bf16 v[64:67], v[184:187], a[40:43], v[64:67]
    ds_read_b64_tr_b16 v[180:181], v21 offset:63488
    ds_read_b64_tr_b16 v[182:183], v21 offset:64000
    v_mfma_f32_16x16x32_bf16 v[72:75], v[184:187], a[44:47], v[72:75]
    buffer_load_dwordx4 v11, s[8:11], s63 offen offset:3072 lds
    s_bfe_u32 s63, s99, 0x40018
    s_mul_i32 s63, s63, 128
    s_add_u32 s63, s63, s64
    s_add_u32 m0, s61, 34816
    v_mfma_f32_16x16x32_bf16 v[68:71], v[188:191], a[40:43], v[68:71]
    ds_read_b64_tr_b16 v[184:185], v22 offset:63488
    ds_read_b64_tr_b16 v[186:187], v22 offset:64000
    v_mfma_f32_16x16x32_bf16 v[76:79], v[188:191], a[44:47], v[76:79]
    buffer_load_dwordx4 v16, s[20:23], s66 offen offset:0 lds
    s_waitcnt lgkmcnt(6)
    v_mfma_f32_16x16x32_bf16 v[48:51], v[160:163], a[48:51], v[48:51]
    ds_read_b64_tr_b16 v[188:189], v23 offset:63488
    ds_read_b64_tr_b16 v[190:191], v23 offset:64000
    v_mfma_f32_16x16x32_bf16 v[56:59], v[160:163], a[52:55], v[56:59]
    buffer_load_dwordx4 v17, s[20:23], s66 offen offset:1024 lds
    s_bfe_u32 s66, s99, 0x40018
    s_mul_i32 s66, s66, 221184
    s_add_u32 s66, s66, s67
    s_add_u32 m0, s61, 8192
    v_mfma_f32_16x16x32_bf16 v[52:55], v[164:167], a[48:51], v[52:55]
    v_mfma_f32_16x16x32_bf16 v[60:63], v[164:167], a[52:55], v[60:63]
    buffer_load_dwordx4 v8, s[8:11], s63 offen offset:0 lds
    v_mfma_f32_16x16x32_bf16 v[64:67], v[168:171], a[48:51], v[64:67]
    v_mfma_f32_16x16x32_bf16 v[72:75], v[168:171], a[52:55], v[72:75]
    buffer_load_dwordx4 v9, s[8:11], s63 offen offset:1024 lds
    s_waitcnt vmcnt(8) lgkmcnt(0)
    s_barrier
    ds_read_b128 a[64:67], v4 offset:0
    ds_read_b128 a[68:71], v4 offset:2048
    ds_read_b128 a[72:75], v5 offset:0
    ds_read_b128 a[76:79], v5 offset:2048
    v_mfma_f32_16x16x32_bf16 v[68:71], v[172:175], a[48:51], v[68:71]
    ds_read_b64_tr_b16 v[160:161], v20 offset:16384
    ds_read_b64_tr_b16 v[162:163], v20 offset:16896
    ds_read_b64_tr_b16 v[164:165], v21 offset:16384
    ds_read_b64_tr_b16 v[166:167], v21 offset:16896
    v_mfma_f32_16x16x32_bf16 v[76:79], v[172:175], a[52:55], v[76:79]
    buffer_load_dwordx4 v10, s[8:11], s63 offen offset:2048 lds
    v_mfma_f32_16x16x32_bf16 v[48:51], v[176:179], a[56:59], v[48:51]
    ds_read_b64_tr_b16 v[168:169], v22 offset:16384
    ds_read_b64_tr_b16 v[170:171], v22 offset:16896
    ds_read_b64_tr_b16 v[172:173], v23 offset:16384
    ds_read_b64_tr_b16 v[174:175], v23 offset:16896
    v_mfma_f32_16x16x32_bf16 v[56:59], v[176:179], a[60:63], v[56:59]
    buffer_load_dwordx4 v11, s[8:11], s63 offen offset:3072 lds
    s_bfe_u32 s63, s99, 0x4001c
    s_mul_i32 s63, s63, 128
    s_add_u32 s63, s63, s64
    s_add_u32 m0, s61, 36864
    v_mfma_f32_16x16x32_bf16 v[52:55], v[180:183], a[56:59], v[52:55]
    ds_read_b64_tr_b16 v[176:177], v20 offset:57344
    ds_read_b64_tr_b16 v[178:179], v20 offset:57856
    v_mfma_f32_16x16x32_bf16 v[60:63], v[180:183], a[60:63], v[60:63]
    buffer_load_dwordx4 v16, s[20:23], s66 offen offset:0 lds
    v_mfma_f32_16x16x32_bf16 v[64:67], v[184:187], a[56:59], v[64:67]
    ds_read_b64_tr_b16 v[180:181], v21 offset:57344
    ds_read_b64_tr_b16 v[182:183], v21 offset:57856
    v_mfma_f32_16x16x32_bf16 v[72:75], v[184:187], a[60:63], v[72:75]
    buffer_load_dwordx4 v17, s[20:23], s66 offen offset:1024 lds
    s_bfe_u32 s66, s99, 0x4001c
    s_mul_i32 s66, s66, 221184
    s_add_u32 s66, s66, s67
    s_add_u32 m0, s61, 12288
    v_mfma_f32_16x16x32_bf16 v[68:71], v[188:191], a[56:59], v[68:71]
    ds_read_b64_tr_b16 v[184:185], v22 offset:57344
    ds_read_b64_tr_b16 v[186:187], v22 offset:57856
    v_mfma_f32_16x16x32_bf16 v[76:79], v[188:191], a[60:63], v[76:79]
    buffer_load_dwordx4 v8, s[8:11], s63 offen offset:0 lds
    s_waitcnt lgkmcnt(6)
    v_mfma_f32_16x16x32_bf16 v[48:51], v[160:163], a[64:67], v[48:51]
    ds_read_b64_tr_b16 v[188:189], v23 offset:57344
    ds_read_b64_tr_b16 v[190:191], v23 offset:57856
    v_mfma_f32_16x16x32_bf16 v[56:59], v[160:163], a[68:71], v[56:59]
    buffer_load_dwordx4 v9, s[8:11], s63 offen offset:1024 lds
    v_mfma_f32_16x16x32_bf16 v[52:55], v[164:167], a[64:67], v[52:55]
    v_mfma_f32_16x16x32_bf16 v[60:63], v[164:167], a[68:71], v[60:63]
    buffer_load_dwordx4 v10, s[8:11], s63 offen offset:2048 lds
    v_mfma_f32_16x16x32_bf16 v[64:67], v[168:171], a[64:67], v[64:67]
    v_mfma_f32_16x16x32_bf16 v[72:75], v[168:171], a[68:71], v[72:75]
    buffer_load_dwordx4 v11, s[8:11], s63 offen offset:3072 lds
    s_bfe_u32 s63, s65, 0x40000
    s_mul_i32 s63, s63, 128
    s_add_u32 s63, s63, s64
    s_add_u32 m0, s61, 38912
    s_waitcnt vmcnt(10) lgkmcnt(0)
    s_barrier
    ds_read_b128 a[80:83], v4 offset:4096
    ds_read_b128 a[84:87], v4 offset:6144
    ds_read_b128 a[88:91], v5 offset:4096
    ds_read_b128 a[92:95], v5 offset:6144
    v_mfma_f32_16x16x32_bf16 v[68:71], v[172:175], a[64:67], v[68:71]
    ds_read_b64_tr_b16 v[160:161], v20 offset:18432
    ds_read_b64_tr_b16 v[162:163], v20 offset:18944
    ds_read_b64_tr_b16 v[164:165], v21 offset:18432
    ds_read_b64_tr_b16 v[166:167], v21 offset:18944
    v_mfma_f32_16x16x32_bf16 v[76:79], v[172:175], a[68:71], v[76:79]
    buffer_load_dwordx4 v16, s[20:23], s66 offen offset:0 lds
    v_mfma_f32_16x16x32_bf16 v[48:51], v[176:179], a[72:75], v[48:51]
    ds_read_b64_tr_b16 v[168:169], v22 offset:18432
    ds_read_b64_tr_b16 v[170:171], v22 offset:18944
    ds_read_b64_tr_b16 v[172:173], v23 offset:18432
    ds_read_b64_tr_b16 v[174:175], v23 offset:18944
    v_mfma_f32_16x16x32_bf16 v[56:59], v[176:179], a[76:79], v[56:59]
    buffer_load_dwordx4 v17, s[20:23], s66 offen offset:1024 lds
    s_bfe_u32 s66, s65, 0x40000
    s_mul_i32 s66, s66, 221184
    s_add_u32 s66, s66, s67
    s_add_u32 m0, s61, 0
    v_mfma_f32_16x16x32_bf16 v[52:55], v[180:183], a[72:75], v[52:55]
    ds_read_b64_tr_b16 v[176:177], v20 offset:59392
    ds_read_b64_tr_b16 v[178:179], v20 offset:59904
    v_mfma_f32_16x16x32_bf16 v[60:63], v[180:183], a[76:79], v[60:63]
    buffer_load_dwordx4 v8, s[8:11], s63 offen offset:0 lds
    v_mfma_f32_16x16x32_bf16 v[64:67], v[184:187], a[72:75], v[64:67]
    ds_read_b64_tr_b16 v[180:181], v21 offset:59392
    ds_read_b64_tr_b16 v[182:183], v21 offset:59904
    v_mfma_f32_16x16x32_bf16 v[72:75], v[184:187], a[76:79], v[72:75]
    buffer_load_dwordx4 v9, s[8:11], s63 offen offset:1024 lds
    v_mfma_f32_16x16x32_bf16 v[68:71], v[188:191], a[72:75], v[68:71]
    ds_read_b64_tr_b16 v[184:185], v22 offset:59392
    ds_read_b64_tr_b16 v[186:187], v22 offset:59904
    v_mfma_f32_16x16x32_bf16 v[76:79], v[188:191], a[76:79], v[76:79]
    buffer_load_dwordx4 v10, s[8:11], s63 offen offset:2048 lds
    s_waitcnt lgkmcnt(6)
    v_mfma_f32_16x16x32_bf16 v[48:51], v[160:163], a[80:83], v[48:51]
    ds_read_b64_tr_b16 v[188:189], v23 offset:59392
    ds_read_b64_tr_b16 v[190:191], v23 offset:59904
    v_mfma_f32_16x16x32_bf16 v[56:59], v[160:163], a[84:87], v[56:59]
    buffer_load_dwordx4 v11, s[8:11], s63 offen offset:3072 lds
    s_bfe_u32 s63, s65, 0x40004
    s_mul_i32 s63, s63, 128
    s_add_u32 s63, s63, s64
    s_add_u32 m0, s61, 32768
    v_mfma_f32_16x16x32_bf16 v[52:55], v[164:167], a[80:83], v[52:55]
    v_mfma_f32_16x16x32_bf16 v[60:63], v[164:167], a[84:87], v[60:63]
    buffer_load_dwordx4 v16, s[20:23], s66 offen offset:0 lds
    v_mfma_f32_16x16x32_bf16 v[64:67], v[168:171], a[80:83], v[64:67]
    v_mfma_f32_16x16x32_bf16 v[72:75], v[168:171], a[84:87], v[72:75]
    buffer_load_dwordx4 v17, s[20:23], s66 offen offset:1024 lds
    s_waitcnt vmcnt(12) lgkmcnt(0)
    s_barrier
    ds_read_b128 a[96:99], v4 offset:8192
    ds_read_b128 a[100:103], v4 offset:10240
    ds_read_b128 a[104:107], v5 offset:8192
    ds_read_b128 a[108:111], v5 offset:10240
    v_mfma_f32_16x16x32_bf16 v[68:71], v[172:175], a[80:83], v[68:71]
    ds_read_b64_tr_b16 v[160:161], v20 offset:20480
    ds_read_b64_tr_b16 v[162:163], v20 offset:20992
    ds_read_b64_tr_b16 v[164:165], v21 offset:20480
    ds_read_b64_tr_b16 v[166:167], v21 offset:20992
    v_mfma_f32_16x16x32_bf16 v[76:79], v[172:175], a[84:87], v[76:79]
    s_bfe_u32 s66, s65, 0x40004
    s_mul_i32 s66, s66, 221184
    s_add_u32 s66, s66, s67
    s_add_u32 m0, s61, 4096
    v_mfma_f32_16x16x32_bf16 v[48:51], v[176:179], a[88:91], v[48:51]
    ds_read_b64_tr_b16 v[168:169], v22 offset:20480
    ds_read_b64_tr_b16 v[170:171], v22 offset:20992
    ds_read_b64_tr_b16 v[172:173], v23 offset:20480
    ds_read_b64_tr_b16 v[174:175], v23 offset:20992
    v_mfma_f32_16x16x32_bf16 v[56:59], v[176:179], a[92:95], v[56:59]
    buffer_load_dwordx4 v8, s[8:11], s63 offen offset:0 lds
    v_mfma_f32_16x16x32_bf16 v[52:55], v[180:183], a[88:91], v[52:55]
    ds_read_b64_tr_b16 v[176:177], v20 offset:61440
    ds_read_b64_tr_b16 v[178:179], v20 offset:61952
    v_mfma_f32_16x16x32_bf16 v[60:63], v[180:183], a[92:95], v[60:63]
    buffer_load_dwordx4 v9, s[8:11], s63 offen offset:1024 lds
    v_mfma_f32_16x16x32_bf16 v[64:67], v[184:187], a[88:91], v[64:67]
    ds_read_b64_tr_b16 v[180:181], v21 offset:61440
    ds_read_b64_tr_b16 v[182:183], v21 offset:61952
    v_mfma_f32_16x16x32_bf16 v[72:75], v[184:187], a[92:95], v[72:75]
    buffer_load_dwordx4 v10, s[8:11], s63 offen offset:2048 lds
    v_mfma_f32_16x16x32_bf16 v[68:71], v[188:191], a[88:91], v[68:71]
    ds_read_b64_tr_b16 v[184:185], v22 offset:61440
    ds_read_b64_tr_b16 v[186:187], v22 offset:61952
    v_mfma_f32_16x16x32_bf16 v[76:79], v[188:191], a[92:95], v[76:79]
    buffer_load_dwordx4 v11, s[8:11], s63 offen offset:3072 lds
    s_add_u32 m0, s61, 34816
    s_waitcnt lgkmcnt(6)
    v_mfma_f32_16x16x32_bf16 v[48:51], v[160:163], a[96:99], v[48:51]
    ds_read_b64_tr_b16 v[188:189], v23 offset:61440
    ds_read_b64_tr_b16 v[190:191], v23 offset:61952
    v_mfma_f32_16x16x32_bf16 v[56:59], v[160:163], a[100:103], v[56:59]
    buffer_load_dwordx4 v16, s[20:23], s66 offen offset:0 lds
    v_mfma_f32_16x16x32_bf16 v[52:55], v[164:167], a[96:99], v[52:55]
    v_mfma_f32_16x16x32_bf16 v[60:63], v[164:167], a[100:103], v[60:63]
    buffer_load_dwordx4 v17, s[20:23], s66 offen offset:1024 lds
    s_add_u32 m0, s61, 30720
    v_mfma_f32_16x16x32_bf16 v[64:67], v[168:171], a[96:99], v[64:67]
    v_mfma_f32_16x16x32_bf16 v[72:75], v[168:171], a[100:103], v[72:75]
    buffer_load_dwordx4 v38, s[36:39], 0 offen lds
    s_add_u32 m0, s61, 31744
    s_waitcnt vmcnt(13) lgkmcnt(0)
    s_barrier
    ds_read_b128 a[112:115], v4 offset:12288
    ds_read_b128 a[116:119], v4 offset:14336
    ds_read_b128 a[120:123], v5 offset:12288
    ds_read_b128 a[124:127], v5 offset:14336
    v_mfma_f32_16x16x32_bf16 v[68:71], v[172:175], a[96:99], v[68:71]
    ds_read_b64_tr_b16 v[160:161], v20 offset:22528
    ds_read_b64_tr_b16 v[162:163], v20 offset:23040
    ds_read_b64_tr_b16 v[164:165], v21 offset:22528
    ds_read_b64_tr_b16 v[166:167], v21 offset:23040
    v_mfma_f32_16x16x32_bf16 v[76:79], v[172:175], a[100:103], v[76:79]
    buffer_load_dwordx4 v39, s[36:39], 0 offen lds
    s_add_u32 m0, s61, 16384
    v_mfma_f32_16x16x32_bf16 v[48:51], v[176:179], a[104:107], v[48:51]
    ds_read_b64_tr_b16 v[168:169], v22 offset:22528
    ds_read_b64_tr_b16 v[170:171], v22 offset:23040
    ds_read_b64_tr_b16 v[172:173], v23 offset:22528
    ds_read_b64_tr_b16 v[174:175], v23 offset:23040
    v_mfma_f32_16x16x32_bf16 v[56:59], v[176:179], a[108:111], v[56:59]
    buffer_load_dwordx4 v16, s[20:23], s71 offen offset:0 lds
    v_mfma_f32_16x16x32_bf16 v[52:55], v[180:183], a[104:107], v[52:55]
    ds_read_b64_tr_b16 v[176:177], v20 offset:63488
    ds_read_b64_tr_b16 v[178:179], v20 offset:64000
    v_mfma_f32_16x16x32_bf16 v[60:63], v[180:183], a[108:111], v[60:63]
    buffer_load_dwordx4 v17, s[20:23], s71 offen offset:1024 lds
    v_mfma_f32_16x16x32_bf16 v[64:67], v[184:187], a[104:107], v[64:67]
    ds_read_b64_tr_b16 v[180:181], v21 offset:63488
    ds_read_b64_tr_b16 v[182:183], v21 offset:64000
    v_mfma_f32_16x16x32_bf16 v[72:75], v[184:187], a[108:111], v[72:75]
    v_mfma_f32_16x16x32_bf16 v[68:71], v[188:191], a[104:107], v[68:71]
    ds_read_b64_tr_b16 v[184:185], v22 offset:63488
    ds_read_b64_tr_b16 v[186:187], v22 offset:64000
    v_mfma_f32_16x16x32_bf16 v[76:79], v[188:191], a[108:111], v[76:79]
    buffer_load_dword v47, off, s[44:47], 0 sc1
    s_waitcnt lgkmcnt(6)
    v_mfma_f32_16x16x32_bf16 v[48:51], v[160:163], a[112:115], v[48:51]
    ds_read_b64_tr_b16 v[188:189], v23 offset:63488
    ds_read_b64_tr_b16 v[190:191], v23 offset:64000
    v_mfma_f32_16x16x32_bf16 v[56:59], v[160:163], a[116:119], v[56:59]
    v_mfma_f32_16x16x32_bf16 v[52:55], v[164:167], a[112:115], v[52:55]
    v_mfma_f32_16x16x32_bf16 v[60:63], v[164:167], a[116:119], v[60:63]
    v_mfma_f32_16x16x32_bf16 v[64:67], v[168:171], a[112:115], v[64:67]
    v_mfma_f32_16x16x32_bf16 v[72:75], v[168:171], a[116:119], v[72:75]
    s_waitcnt vmcnt(11) lgkmcnt(0)
    s_barrier
    ds_read_b128 a[128:131], v4 offset:0
    ds_read_b128 a[132:135], v4 offset:2048
    ds_read_b128 a[136:139], v5 offset:0
    ds_read_b128 a[140:143], v5 offset:2048
    v_mfma_f32_16x16x32_bf16 v[68:71], v[172:175], a[112:115], v[68:71]
    ds_read_b64_tr_b16 v[160:161], v20 offset:16384
    ds_read_b64_tr_b16 v[162:163], v20 offset:16896
    ds_read_b64_tr_b16 v[164:165], v21 offset:16384
    ds_read_b64_tr_b16 v[166:167], v21 offset:16896
    v_mfma_f32_16x16x32_bf16 v[76:79], v[172:175], a[116:119], v[76:79]
    v_mfma_f32_16x16x32_bf16 v[48:51], v[176:179], a[120:123], v[48:51]
    ds_read_b64_tr_b16 v[168:169], v22 offset:16384
    ds_read_b64_tr_b16 v[170:171], v22 offset:16896
    ds_read_b64_tr_b16 v[172:173], v23 offset:16384
    ds_read_b64_tr_b16 v[174:175], v23 offset:16896
    v_mfma_f32_16x16x32_bf16 v[56:59], v[176:179], a[124:127], v[56:59]
    v_mfma_f32_16x16x32_bf16 v[52:55], v[180:183], a[120:123], v[52:55]
    ds_read_b64_tr_b16 v[176:177], v20 offset:57344
    ds_read_b64_tr_b16 v[178:179], v20 offset:57856
    v_mfma_f32_16x16x32_bf16 v[60:63], v[180:183], a[124:127], v[60:63]
    v_mfma_f32_16x16x32_bf16 v[64:67], v[184:187], a[120:123], v[64:67]
    ds_read_b64_tr_b16 v[180:181], v21 offset:57344
    ds_read_b64_tr_b16 v[182:183], v21 offset:57856
    v_mfma_f32_16x16x32_bf16 v[72:75], v[184:187], a[124:127], v[72:75]
    v_mfma_f32_16x16x32_bf16 v[68:71], v[188:191], a[120:123], v[68:71]
    ds_read_b64_tr_b16 v[184:185], v22 offset:57344
    ds_read_b64_tr_b16 v[186:187], v22 offset:57856
    v_mfma_f32_16x16x32_bf16 v[76:79], v[188:191], a[124:127], v[76:79]
    s_waitcnt lgkmcnt(6)
    v_mfma_f32_16x16x32_bf16 v[48:51], v[160:163], a[128:131], v[48:51]
    ds_read_b64_tr_b16 v[188:189], v23 offset:57344
    ds_read_b64_tr_b16 v[190:191], v23 offset:57856
    v_mfma_f32_16x16x32_bf16 v[56:59], v[160:163], a[132:135], v[56:59]
    v_mfma_f32_16x16x32_bf16 v[52:55], v[164:167], a[128:131], v[52:55]
    v_mfma_f32_16x16x32_bf16 v[60:63], v[164:167], a[132:135], v[60:63]
    v_mfma_f32_16x16x32_bf16 v[64:67], v[168:171], a[128:131], v[64:67]
    v_mfma_f32_16x16x32_bf16 v[72:75], v[168:171], a[132:135], v[72:75]
    s_waitcnt vmcnt(5) lgkmcnt(0)
    s_barrier
    ds_read_b128 a[144:147], v4 offset:4096
    ds_read_b128 a[148:151], v4 offset:6144
    ds_read_b128 a[152:155], v5 offset:4096
    ds_read_b128 a[156:159], v5 offset:6144
    v_mfma_f32_16x16x32_bf16 v[68:71], v[172:175], a[128:131], v[68:71]
    ds_read_b64_tr_b16 v[160:161], v20 offset:18432
    ds_read_b64_tr_b16 v[162:163], v20 offset:18944
    ds_read_b64_tr_b16 v[164:165], v21 offset:18432
    ds_read_b64_tr_b16 v[166:167], v21 offset:18944
    v_mfma_f32_16x16x32_bf16 v[76:79], v[172:175], a[132:135], v[76:79]
    v_mfma_f32_16x16x32_bf16 v[48:51], v[176:179], a[136:139], v[48:51]
    ds_read_b64_tr_b16 v[168:169], v22 offset:18432
    ds_read_b64_tr_b16 v[170:171], v22 offset:18944
    ds_read_b64_tr_b16 v[172:173], v23 offset:18432
    ds_read_b64_tr_b16 v[174:175], v23 offset:18944
    v_mfma_f32_16x16x32_bf16 v[56:59], v[176:179], a[140:143], v[56:59]
    v_mfma_f32_16x16x32_bf16 v[52:55], v[180:183], a[136:139], v[52:55]
    ds_read_b64_tr_b16 v[176:177], v20 offset:59392
    ds_read_b64_tr_b16 v[178:179], v20 offset:59904
    v_mfma_f32_16x16x32_bf16 v[60:63], v[180:183], a[140:143], v[60:63]
    v_mfma_f32_16x16x32_bf16 v[64:67], v[184:187], a[136:139], v[64:67]
    ds_read_b64_tr_b16 v[180:181], v21 offset:59392
    ds_read_b64_tr_b16 v[182:183], v21 offset:59904
    v_mfma_f32_16x16x32_bf16 v[72:75], v[184:187], a[140:143], v[72:75]
    v_mfma_f32_16x16x32_bf16 v[68:71], v[188:191], a[136:139], v[68:71]
    ds_read_b64_tr_b16 v[184:185], v22 offset:59392
    ds_read_b64_tr_b16 v[186:187], v22 offset:59904
    v_mfma_f32_16x16x32_bf16 v[76:79], v[188:191], a[140:143], v[76:79]
    s_waitcnt lgkmcnt(6)
    v_mfma_f32_16x16x32_bf16 v[48:51], v[160:163], a[144:147], v[48:51]
    ds_read_b64_tr_b16 v[188:189], v23 offset:59392
    ds_read_b64_tr_b16 v[190:191], v23 offset:59904
    v_mfma_f32_16x16x32_bf16 v[56:59], v[160:163], a[148:151], v[56:59]
    v_mfma_f32_16x16x32_bf16 v[52:55], v[164:167], a[144:147], v[52:55]
    v_mfma_f32_16x16x32_bf16 v[60:63], v[164:167], a[148:151], v[60:63]
    v_mfma_f32_16x16x32_bf16 v[64:67], v[168:171], a[144:147], v[64:67]
    v_mfma_f32_16x16x32_bf16 v[72:75], v[168:171], a[148:151], v[72:75]
    v_mfma_f32_16x16x32_bf16 v[68:71], v[172:175], a[144:147], v[68:71]
    v_mfma_f32_16x16x32_bf16 v[76:79], v[172:175], a[148:151], v[76:79]
    s_waitcnt lgkmcnt(0)
    v_mfma_f32_16x16x32_bf16 v[48:51], v[176:179], a[152:155], v[48:51]
    v_mfma_f32_16x16x32_bf16 v[56:59], v[176:179], a[156:159], v[56:59]
    v_mfma_f32_16x16x32_bf16 v[52:55], v[180:183], a[152:155], v[52:55]
    v_mfma_f32_16x16x32_bf16 v[60:63], v[180:183], a[156:159], v[60:63]
    v_mfma_f32_16x16x32_bf16 v[64:67], v[184:187], a[152:155], v[64:67]
    v_mfma_f32_16x16x32_bf16 v[72:75], v[184:187], a[156:159], v[72:75]
    v_mfma_f32_16x16x32_bf16 v[68:71], v[188:191], a[152:155], v[68:71]
    v_mfma_f32_16x16x32_bf16 v[76:79], v[188:191], a[156:159], v[76:79]
    s_bfe_u32 s71, s99, 0x40004
    s_mul_i32 s71, s71, 221184
    s_add_u32 s71, s71, s72
    v_pk_mul_f32 v[80:81], v[48:49], v[48:49]
    s_add_u32 m0, s61, 18432
    s_nop 0
    buffer_load_dwordx4 v16, s[20:23], s71 offen offset:0 lds
    v_pk_mul_f32 v[82:83], v[50:51], v[50:51]
    v_pk_mul_f32 v[84:85], v[52:53], v[52:53]
    v_pk_mul_f32 v[86:87], v[54:55], v[54:55]
    v_pk_fma_f32 v[80:81], v[80:81], s[68:69], s[68:69] op_sel:[0,1,0] op_sel_hi:[1,1,0]
    v_pk_fma_f32 v[82:83], v[82:83], s[68:69], s[68:69] op_sel:[0,1,0] op_sel_hi:[1,1,0]
    v_pk_fma_f32 v[84:85], v[84:85], s[68:69], s[68:69] op_sel:[0,1,0] op_sel_hi:[1,1,0]
    v_pk_fma_f32 v[86:87], v[86:87], s[68:69], s[68:69] op_sel:[0,1,0] op_sel_hi:[1,1,0]
    v_pk_mul_f32 v[80:81], v[80:81], v[48:49]
    v_pk_mul_f32 v[82:83], v[82:83], v[50:51]
    v_pk_mul_f32 v[84:85], v[84:85], v[52:53]
    v_pk_mul_f32 v[86:87], v[86:87], v[54:55]
    v_exp_f32 v80, v80
    v_exp_f32 v81, v81
    v_exp_f32 v82, v82
    v_exp_f32 v83, v83
    v_exp_f32 v84, v84
    v_exp_f32 v85, v85
    v_exp_f32 v86, v86
    v_exp_f32 v87, v87
    v_pk_add_f32 v[80:81], v[80:81], 1.0 op_sel_hi:[1,0]
    buffer_load_dwordx4 v17, s[20:23], s71 offen offset:1024 lds
    v_pk_add_f32 v[82:83], v[82:83], 1.0 op_sel_hi:[1,0]
    v_pk_add_f32 v[84:85], v[84:85], 1.0 op_sel_hi:[1,0]
    v_pk_add_f32 v[86:87], v[86:87], 1.0 op_sel_hi:[1,0]
    v_rcp_f32 v80, v80
    v_rcp_f32 v81, v81
    v_rcp_f32 v82, v82
    v_rcp_f32 v83, v83
    v_rcp_f32 v84, v84
    v_rcp_f32 v85, v85
    v_rcp_f32 v86, v86
    v_rcp_f32 v87, v87
    v_pk_mul_f32 v[48:49], v[80:81], v[48:49]
    v_pk_mul_f32 v[50:51], v[82:83], v[50:51]
    v_pk_mul_f32 v[52:53], v[84:85], v[52:53]
    v_pk_mul_f32 v[54:55], v[86:87], v[54:55]
    v_pk_mul_f32 v[80:81], v[56:57], v[56:57]
    v_pk_mul_f32 v[82:83], v[58:59], v[58:59]
    v_pk_mul_f32 v[84:85], v[60:61], v[60:61]
    v_pk_mul_f32 v[86:87], v[62:63], v[62:63]
    v_pk_fma_f32 v[80:81], v[80:81], s[68:69], s[68:69] op_sel:[0,1,0] op_sel_hi:[1,1,0]
    v_pk_fma_f32 v[82:83], v[82:83], s[68:69], s[68:69] op_sel:[0,1,0] op_sel_hi:[1,1,0]
    v_pk_fma_f32 v[84:85], v[84:85], s[68:69], s[68:69] op_sel:[0,1,0] op_sel_hi:[1,1,0]
    v_pk_fma_f32 v[86:87], v[86:87], s[68:69], s[68:69] op_sel:[0,1,0] op_sel_hi:[1,1,0]
    v_pk_mul_f32 v[80:81], v[80:81], v[56:57]
    v_pk_mul_f32 v[82:83], v[82:83], v[58:59]
    v_pk_mul_f32 v[84:85], v[84:85], v[60:61]
    v_pk_mul_f32 v[86:87], v[86:87], v[62:63]
    v_exp_f32 v80, v80
    v_exp_f32 v81, v81
    v_exp_f32 v82, v82
    v_exp_f32 v83, v83
    v_exp_f32 v84, v84
    v_exp_f32 v85, v85
    v_exp_f32 v86, v86
    v_exp_f32 v87, v87
    v_pk_add_f32 v[80:81], v[80:81], 1.0 op_sel_hi:[1,0]
    v_pk_add_f32 v[82:83], v[82:83], 1.0 op_sel_hi:[1,0]
    v_pk_add_f32 v[84:85], v[84:85], 1.0 op_sel_hi:[1,0]
    v_pk_add_f32 v[86:87], v[86:87], 1.0 op_sel_hi:[1,0]
    v_rcp_f32 v80, v80
    v_rcp_f32 v81, v81
    v_rcp_f32 v82, v82
    v_rcp_f32 v83, v83
    v_rcp_f32 v84, v84
    v_rcp_f32 v85, v85
    v_rcp_f32 v86, v86
    v_rcp_f32 v87, v87
    v_pk_mul_f32 v[56:57], v[80:81], v[56:57]
    v_pk_mul_f32 v[58:59], v[82:83], v[58:59]
    v_pk_mul_f32 v[60:61], v[84:85], v[60:61]
    v_pk_mul_f32 v[62:63], v[86:87], v[62:63]
    v_pk_mul_f32 v[80:81], v[64:65], v[64:65]
    v_pk_mul_f32 v[82:83], v[66:67], v[66:67]
    v_pk_mul_f32 v[84:85], v[68:69], v[68:69]
    v_pk_mul_f32 v[86:87], v[70:71], v[70:71]
    v_pk_fma_f32 v[80:81], v[80:81], s[68:69], s[68:69] op_sel:[0,1,0] op_sel_hi:[1,1,0]
    v_pk_fma_f32 v[82:83], v[82:83], s[68:69], s[68:69] op_sel:[0,1,0] op_sel_hi:[1,1,0]
    v_pk_fma_f32 v[84:85], v[84:85], s[68:69], s[68:69] op_sel:[0,1,0] op_sel_hi:[1,1,0]
    v_pk_fma_f32 v[86:87], v[86:87], s[68:69], s[68:69] op_sel:[0,1,0] op_sel_hi:[1,1,0]
    v_pk_mul_f32 v[80:81], v[80:81], v[64:65]
    v_pk_mul_f32 v[82:83], v[82:83], v[66:67]
    v_pk_mul_f32 v[84:85], v[84:85], v[68:69]
    v_pk_mul_f32 v[86:87], v[86:87], v[70:71]
    v_exp_f32 v80, v80
    v_exp_f32 v81, v81
    v_exp_f32 v82, v82
    v_exp_f32 v83, v83
    v_exp_f32 v84, v84
    v_exp_f32 v85, v85
    v_exp_f32 v86, v86
    v_exp_f32 v87, v87
    v_pk_add_f32 v[80:81], v[80:81], 1.0 op_sel_hi:[1,0]
    v_pk_add_f32 v[82:83], v[82:83], 1.0 op_sel_hi:[1,0]
    v_pk_add_f32 v[84:85], v[84:85], 1.0 op_sel_hi:[1,0]
    v_pk_add_f32 v[86:87], v[86:87], 1.0 op_sel_hi:[1,0]
    v_rcp_f32 v80, v80
    v_rcp_f32 v81, v81
    v_rcp_f32 v82, v82
    v_rcp_f32 v83, v83
    v_rcp_f32 v84, v84
    v_rcp_f32 v85, v85
    v_rcp_f32 v86, v86
    v_rcp_f32 v87, v87
    v_pk_mul_f32 v[64:65], v[80:81], v[64:65]
    v_pk_mul_f32 v[66:67], v[82:83], v[66:67]
    v_pk_mul_f32 v[68:69], v[84:85], v[68:69]
    v_pk_mul_f32 v[70:71], v[86:87], v[70:71]
    v_pk_mul_f32 v[80:81], v[72:73], v[72:73]
    v_pk_mul_f32 v[82:83], v[74:75], v[74:75]
    v_pk_mul_f32 v[84:85], v[76:77], v[76:77]
    v_pk_mul_f32 v[86:87], v[78:79], v[78:79]
    v_pk_fma_f32 v[80:81], v[80:81], s[68:69], s[68:69] op_sel:[0,1,0] op_sel_hi:[1,1,0]
    v_pk_fma_f32 v[82:83], v[82:83], s[68:69], s[68:69] op_sel:[0,1,0] op_sel_hi:[1,1,0]
    v_pk_fma_f32 v[84:85], v[84:85], s[68:69], s[68:69] op_sel:[0,1,0] op_sel_hi:[1,1,0]
    v_pk_fma_f32 v[86:87], v[86:87], s[68:69], s[68:69] op_sel:[0,1,0] op_sel_hi:[1,1,0]
    v_pk_mul_f32 v[80:81], v[80:81], v[72:73]
    v_pk_mul_f32 v[82:83], v[82:83], v[74:75]
    v_pk_mul_f32 v[84:85], v[84:85], v[76:77]
    v_pk_mul_f32 v[86:87], v[86:87], v[78:79]
    v_exp_f32 v80, v80
    v_exp_f32 v81, v81
    v_exp_f32 v82, v82
    v_exp_f32 v83, v83
    v_exp_f32 v84, v84
    v_exp_f32 v85, v85
    v_exp_f32 v86, v86
    v_exp_f32 v87, v87
    v_pk_add_f32 v[80:81], v[80:81], 1.0 op_sel_hi:[1,0]
    v_pk_add_f32 v[82:83], v[82:83], 1.0 op_sel_hi:[1,0]
    v_pk_add_f32 v[84:85], v[84:85], 1.0 op_sel_hi:[1,0]
    v_pk_add_f32 v[86:87], v[86:87], 1.0 op_sel_hi:[1,0]
    v_rcp_f32 v80, v80
    v_rcp_f32 v81, v81
    v_rcp_f32 v82, v82
    v_rcp_f32 v83, v83
    v_rcp_f32 v84, v84
    v_rcp_f32 v85, v85
    v_rcp_f32 v86, v86
    v_rcp_f32 v87, v87
    v_pk_mul_f32 v[72:73], v[80:81], v[72:73]
    v_pk_mul_f32 v[74:75], v[82:83], v[74:75]
    v_pk_mul_f32 v[76:77], v[84:85], v[76:77]
    v_pk_mul_f32 v[78:79], v[86:87], v[78:79]
    v_pk_add_f32 v[88:89], v[48:49], v[50:51]
    v_pk_mul_f32 v[96:97], v[48:49], v[48:49]
    v_pk_fma_f32 v[96:97], v[50:51], v[50:51], v[96:97]
    v_pk_add_f32 v[88:89], v[88:89], v[52:53]
    v_pk_fma_f32 v[96:97], v[52:53], v[52:53], v[96:97]
    v_pk_add_f32 v[88:89], v[88:89], v[54:55]
    v_pk_fma_f32 v[96:97], v[54:55], v[54:55], v[96:97]
    v_pk_add_f32 v[90:91], v[56:57], v[58:59]
    v_pk_mul_f32 v[98:99], v[56:57], v[56:57]
    v_pk_fma_f32 v[98:99], v[58:59], v[58:59], v[98:99]
    v_pk_add_f32 v[90:91], v[90:91], v[60:61]
    v_pk_fma_f32 v[98:99], v[60:61], v[60:61], v[98:99]
    v_pk_add_f32 v[90:91], v[90:91], v[62:63]
    v_pk_fma_f32 v[98:99], v[62:63], v[62:63], v[98:99]
    v_pk_add_f32 v[92:93], v[64:65], v[66:67]
    v_pk_mul_f32 v[100:101], v[64:65], v[64:65]
    v_pk_fma_f32 v[100:101], v[66:67], v[66:67], v[100:101]
    v_pk_add_f32 v[92:93], v[92:93], v[68:69]
    v_pk_fma_f32 v[100:101], v[68:69], v[68:69], v[100:101]
    v_pk_add_f32 v[92:93], v[92:93], v[70:71]
    v_pk_fma_f32 v[100:101], v[70:71], v[70:71], v[100:101]
    v_pk_add_f32 v[94:95], v[72:73], v[74:75]
    v_pk_mul_f32 v[102:103], v[72:73], v[72:73]
    v_pk_fma_f32 v[102:103], v[74:75], v[74:75], v[102:103]
    v_pk_add_f32 v[94:95], v[94:95], v[76:77]
    v_pk_fma_f32 v[102:103], v[76:77], v[76:77], v[102:103]
    v_pk_add_f32 v[94:95], v[94:95], v[78:79]
    v_pk_fma_f32 v[102:103], v[78:79], v[78:79], v[102:103]
    s_cmp_eq_u32 s60, 0
    s_cselect_b32 s100, 0, 1.0
    v_pk_fma_f32 v[88:89], v[88:89], s[100:101], v[92:93] op_sel_hi:[1,0,1]
    v_pk_fma_f32 v[90:91], v[90:91], s[100:101], v[94:95] op_sel_hi:[1,0,1]
    v_pk_fma_f32 v[96:97], v[96:97], s[100:101], v[100:101] op_sel_hi:[1,0,1]
    v_pk_fma_f32 v[98:99], v[98:99], s[100:101], v[102:103] op_sel_hi:[1,0,1]
    v_add_f32 v88, v88, v89
    v_add_f32 v90, v90, v91
    v_add_f32 v96, v96, v97
    v_add_f32 v98, v98, v99
    s_lshl2_add_u32 s76, s57, s56
    s_mul_i32 s7, s76, 3584
    v_permlane32_swap_b32 v88, v96
    v_permlane32_swap_b32 v90, v98
    v_add_f32 v88, v88, v96
    v_add_f32 v90, v90, v98
    s_lshl_b32 s76, s60, 8
    s_add_u32 s76, s76, s7
    v_permlane16_swap_b32 v88, v90
    v_add_f32 v90, v90, v88
    s_waitcnt vmcnt(2)
    v_cmp_gt_u32 vcc, 32, v47
    s_nop 1
    s_cbranch_vccnz Lslow_15
Lback_16:
    buffer_store_dword v90, v31, s[48:51], s76 offen sc1
    s_barrier
    ds_read_b64_tr_b16 v[160:161], v20 offset:0
    ds_read_b64_tr_b16 v[162:163], v20 offset:512
    ds_read_b64_tr_b16 v[164:165], v21 offset:0
    ds_read_b64_tr_b16 v[166:167], v21 offset:512
    ds_read_b64_tr_b16 v[168:169], v22 offset:0
    ds_read_b64_tr_b16 v[170:171], v22 offset:512
    ds_read_b64_tr_b16 v[172:173], v23 offset:0
    ds_read_b64_tr_b16 v[174:175], v23 offset:512
    ds_read_b128 v[176:179], v18 offset:30720
    ds_read_b64_tr_b16 v[180:181], v20 offset:40960
    ds_read_b64_tr_b16 v[182:183], v20 offset:41472
    s_waitcnt lgkmcnt(9)
    v_mfma_f32_16x16x32_bf16 v[80:83], v[160:163], a[0:3], 0
    ds_read_b64_tr_b16 v[184:185], v21 offset:40960
    ds_read_b64_tr_b16 v[186:187], v21 offset:41472
    ds_read_b64_tr_b16 v[188:189], v22 offset:40960
    ds_read_b64_tr_b16 v[190:191], v22 offset:41472
    v_mfma_f32_16x16x32_bf16 v[88:91], v[160:163], a[4:7], 0
    s_bfe_u32 s71, s99, 0x40008
    s_mul_i32 s71, s71, 221184
    s_add_u32 s71, s71, s72
    s_add_u32 m0, s61, 20480
    s_nop 0
    buffer_load_dwordx4 v16, s[20:23], s71 offen offset:0 lds
    s_waitcnt lgkmcnt(11)
    v_mfma_f32_16x16x32_bf16 v[84:87], v[164:167], a[0:3], 0
    ds_read_b64_tr_b16 v[160:161], v23 offset:40960
    ds_read_b64_tr_b16 v[162:163], v23 offset:41472
    v_mfma_f32_16x16x32_bf16 v[92:95], v[164:167], a[4:7], 0
    buffer_load_dwordx4 v17, s[20:23], s71 offen offset:1024 lds
    s_bfe_u32 s71, s99, 0x4000c
    s_mul_i32 s71, s71, 221184
    s_add_u32 s71, s71, s72
    s_add_u32 m0, s61, 22528
    s_waitcnt lgkmcnt(6)
    v_mfma_f32_16x16x32_bf16 v[96:99], v[168:171], a[0:3], 0
    ds_read_b128 v[164:167], v18 offset:30784
    v_mfma_f32_16x16x32_bf16 v[104:107], v[168:171], a[4:7], 0
    buffer_load_dwordx4 v16, s[20:23], s71 offen offset:0 lds
    v_mfma_f32_16x16x32_bf16 v[100:103], v[172:175], a[0:3], 0
    v_mfma_f32_16x16x32_bf16 v[108:111], v[172:175], a[4:7], 0
    buffer_load_dwordx4 v17, s[20:23], s71 offen offset:1024 lds
    s_bfe_u32 s71, s99, 0x40010
    s_mul_i32 s71, s71, 221184
    s_add_u32 s71, s71, s72
    s_add_u32 m0, s61, 24576
    v_mfma_f32_16x16x32_bf16 v[112:115], v[176:179], a[0:3], 0
    v_mfma_f32_16x16x32_bf16 v[116:119], v[176:179], a[4:7], 0
    buffer_load_dwordx4 v16, s[20:23], s71 offen offset:0 lds
    s_waitcnt vmcnt(6) lgkmcnt(0)
    s_barrier
    v_mfma_f32_16x16x32_bf16 v[80:83], v[180:183], a[8:11], v[80:83]
    ds_read_b64_tr_b16 v[168:169], v20 offset:2048
    ds_read_b64_tr_b16 v[170:171], v20 offset:2560
    ds_read_b64_tr_b16 v[172:173], v21 offset:2048
    ds_read_b64_tr_b16 v[174:175], v21 offset:2560
    v_mfma_f32_16x16x32_bf16 v[88:91], v[180:183], a[12:15], v[88:91]
    buffer_load_dwordx4 v17, s[20:23], s71 offen offset:1024 lds
    s_bfe_u32 s71, s99, 0x40014
    s_mul_i32 s71, s71, 221184
    s_add_u32 s71, s71, s72
    s_add_u32 m0, s61, 26624
    v_mfma_f32_16x16x32_bf16 v[84:87], v[184:187], a[8:11], v[84:87]
    ds_read_b64_tr_b16 v[176:177], v22 offset:2048
    ds_read_b64_tr_b16 v[178:179], v22 offset:2560
    ds_read_b64_tr_b16 v[180:181], v23 offset:2048
    ds_read_b64_tr_b16 v[182:183], v23 offset:2560
    v_mfma_f32_16x16x32_bf16 v[92:95], v[184:187], a[12:15], v[92:95]
    v_mfma_f32_16x16x32_bf16 v[96:99], v[188:191], a[8:11], v[96:99]
    ds_read_b128 v[184:187], v18 offset:30848
    v_mfma_f32_16x16x32_bf16 v[104:107], v[188:191], a[12:15], v[104:107]
    v_mfma_f32_16x16x32_bf16 v[100:103], v[160:163], a[8:11], v[100:103]
    ds_read_b64_tr_b16 v[188:189], v20 offset:43008
    ds_read_b64_tr_b16 v[190:191], v20 offset:43520
    v_mfma_f32_16x16x32_bf16 v[108:111], v[160:163], a[12:15], v[108:111]
    buffer_load_dwordx4 v16, s[20:23], s71 offen offset:0 lds
    v_mfma_f32_16x16x32_bf16 v[112:115], v[164:167], a[8:11], v[112:115]
    ds_read_b64_tr_b16 v[160:161], v21 offset:43008
    ds_read_b64_tr_b16 v[162:163], v21 offset:43520
    v_mfma_f32_16x16x32_bf16 v[116:119], v[164:167], a[12:15], v[116:119]
    buffer_load_dwordx4 v17, s[20:23], s71 offen offset:1024 lds
    s_bfe_u32 s71, s99, 0x40018
    s_mul_i32 s71, s71, 221184
    s_add_u32 s71, s71, s72
    s_add_u32 m0, s61, 28672
    s_waitcnt lgkmcnt(5)
    v_mfma_f32_16x16x32_bf16 v[80:83], v[168:171], a[16:19], v[80:83]
    ds_read_b64_tr_b16 v[164:165], v22 offset:43008
    ds_read_b64_tr_b16 v[166:167], v22 offset:43520
    v_mfma_f32_16x16x32_bf16 v[88:91], v[168:171], a[20:23], v[88:91]
    v_mfma_f32_16x16x32_bf16 v[84:87], v[172:175], a[16:19], v[84:87]
    ds_read_b64_tr_b16 v[168:169], v23 offset:43008
    ds_read_b64_tr_b16 v[170:171], v23 offset:43520
    v_mfma_f32_16x16x32_bf16 v[92:95], v[172:175], a[20:23], v[92:95]
    v_mfma_f32_16x16x32_bf16 v[96:99], v[176:179], a[16:19], v[96:99]
    ds_read_b128 v[172:175], v18 offset:30912
    v_mfma_f32_16x16x32_bf16 v[104:107], v[176:179], a[20:23], v[104:107]
    v_mfma_f32_16x16x32_bf16 v[100:103], v[180:183], a[16:19], v[100:103]
    v_mfma_f32_16x16x32_bf16 v[108:111], v[180:183], a[20:23], v[108:111]
    s_waitcnt lgkmcnt(3)
    v_mfma_f32_16x16x32_bf16 v[112:115], v[184:187], a[16:19], v[112:115]
    v_mfma_f32_16x16x32_bf16 v[116:119], v[184:187], a[20:23], v[116:119]
    s_waitcnt vmcnt(6) lgkmcnt(0)
    s_barrier
    v_mfma_f32_16x16x32_bf16 v[80:83], v[188:191], a[24:27], v[80:83]
    ds_read_b64_tr_b16 v[176:177], v20 offset:4096
    ds_read_b64_tr_b16 v[178:179], v20 offset:4608
    ds_read_b64_tr_b16 v[180:181], v21 offset:4096
    ds_read_b64_tr_b16 v[182:183], v21 offset:4608
    v_mfma_f32_16x16x32_bf16 v[88:91], v[188:191], a[28:31], v[88:91]
    v_mfma_f32_16x16x32_bf16 v[84:87], v[160:163], a[24:27], v[84:87]
    ds_read_b64_tr_b16 v[184:185], v22 offset:4096
    ds_read_b64_tr_b16 v[186:187], v22 offset:4608
    ds_read_b64_tr_b16 v[188:189], v23 offset:4096
    ds_read_b64_tr_b16 v[190:191], v23 offset:4608
    v_mfma_f32_16x16x32_bf16 v[92:95], v[160:163], a[28:31], v[92:95]
    v_mfma_f32_16x16x32_bf16 v[96:99], v[164:167], a[24:27], v[96:99]
    ds_read_b128 v[160:163], v18 offset:30976
    v_mfma_f32_16x16x32_bf16 v[104:107], v[164:167], a[28:31], v[104:107]
    v_mfma_f32_16x16x32_bf16 v[100:103], v[168:171], a[24:27], v[100:103]
    ds_read_b64_tr_b16 v[164:165], v20 offset:45056
    ds_read_b64_tr_b16 v[166:167], v20 offset:45568
    v_mfma_f32_16x16x32_bf16 v[108:111], v[168:171], a[28:31], v[108:111]
    buffer_load_dwordx4 v16, s[20:23], s71 offen offset:0 lds
    v_mfma_f32_16x16x32_bf16 v[112:115], v[172:175], a[24:27], v[112:115]
    ds_read_b64_tr_b16 v[168:169], v21 offset:45056
    ds_read_b64_tr_b16 v[170:171], v21 offset:45568
    v_mfma_f32_16x16x32_bf16 v[116:119], v[172:175], a[28:31], v[116:119]
    buffer_load_dwordx4 v17, s[20:23], s71 offen offset:1024 lds
    s_bfe_u32 s71, s99, 0x4001c
    s_mul_i32 s71, s71, 221184
    s_add_u32 s71, s71, s72
    s_add_u32 m0, s61, 16384
    s_waitcnt lgkmcnt(5)
    v_mfma_f32_16x16x32_bf16 v[80:83], v[176:179], a[32:35], v[80:83]
    ds_read_b64_tr_b16 v[172:173], v22 offset:45056
    ds_read_b64_tr_b16 v[174:175], v22 offset:45568
    v_mfma_f32_16x16x32_bf16 v[88:91], v[176:179], a[36:39], v[88:91]
    v_mfma_f32_16x16x32_bf16 v[84:87], v[180:183], a[32:35], v[84:87]
    ds_read_b64_tr_b16 v[176:177], v23 offset:45056
    ds_read_b64_tr_b16 v[178:179], v23 offset:45568
    v_mfma_f32_16x16x32_bf16 v[92:95], v[180:183], a[36:39], v[92:95]
    v_mfma_f32_16x16x32_bf16 v[96:99], v[184:187], a[32:35], v[96:99]
    ds_read_b128 v[180:183], v18 offset:31040
    v_mfma_f32_16x16x32_bf16 v[104:107], v[184:187], a[36:39], v[104:107]
    v_mfma_f32_16x16x32_bf16 v[100:103], v[188:191], a[32:35], v[100:103]
    v_mfma_f32_16x16x32_bf16 v[108:111], v[188:191], a[36:39], v[108:111]
    s_waitcnt lgkmcnt(3)
    v_mfma_f32_16x16x32_bf16 v[112:115], v[160:163], a[32:35], v[112:115]
    v_mfma_f32_16x16x32_bf16 v[116:119], v[160:163], a[36:39], v[116:119]
    buffer_load_dword v192, v31, s[48:51], s7 offen offset:0 sc1
    s_waitcnt vmcnt(7) lgkmcnt(0)
    s_barrier
    v_mfma_f32_16x16x32_bf16 v[80:83], v[164:167], a[40:43], v[80:83]
    ds_read_b64_tr_b16 v[184:185], v20 offset:6144
    ds_read_b64_tr_b16 v[186:187], v20 offset:6656
    ds_read_b64_tr_b16 v[188:189], v21 offset:6144
    ds_read_b64_tr_b16 v[190:191], v21 offset:6656
    v_mfma_f32_16x16x32_bf16 v[88:91], v[164:167], a[44:47], v[88:91]
    buffer_load_dword v193, v31, s[48:51], s7 offen offset:256 sc1
    buffer_load_dword v194, v31, s[48:51], s7 offen offset:512 sc1
    v_mfma_f32_16x16x32_bf16 v[84:87], v[168:171], a[40:43], v[84:87]
    ds_read_b64_tr_b16 v[160:161], v22 offset:6144
    ds_read_b64_tr_b16 v[162:163], v22 offset:6656
    ds_read_b64_tr_b16 v[164:165], v23 offset:6144
    ds_read_b64_tr_b16 v[166:167], v23 offset:6656
    v_mfma_f32_16x16x32_bf16 v[92:95], v[168:171], a[44:47], v[92:95]
    buffer_load_dword v195, v31, s[48:51], s7 offen offset:768 sc1
    buffer_load_dword v196, v31, s[48:51], s7 offen offset:1024 sc1
    v_mfma_f32_16x16x32_bf16 v[96:99], v[172:175], a[40:43], v[96:99]
    ds_read_b128 v[168:171], v18 offset:31104
    v_mfma_f32_16x16x32_bf16 v[104:107], v[172:175], a[44:47], v[104:107]
    buffer_load_dword v197, v31, s[48:51], s7 offen offset:1280 sc1
    buffer_load_dword v198, v31, s[48:51], s7 offen offset:1536 sc1
    v_mfma_f32_16x16x32_bf16 v[100:103], v[176:179], a[40:43], v[100:103]
    ds_read_b64_tr_b16 v[172:173], v20 offset:47104
    ds_read_b64_tr_b16 v[174:175], v20 offset:47616
    v_mfma_f32_16x16x32_bf16 v[108:111], v[176:179], a[44:47], v[108:111]
    buffer_load_dwordx4 v16, s[20:23], s71 offen offset:0 lds
    v_mfma_f32_16x16x32_bf16 v[112:115], v[180:183], a[40:43], v[112:115]
    ds_read_b64_tr_b16 v[176:177], v21 offset:47104
    ds_read_b64_tr_b16 v[178:179], v21 offset:47616
    v_mfma_f32_16x16x32_bf16 v[116:119], v[180:183], a[44:47], v[116:119]
    buffer_load_dwordx4 v17, s[20:23], s71 offen offset:1024 lds
    s_bfe_u32 s71, s65, 0x40000
    s_mul_i32 s71, s71, 221184
    s_add_u32 s71, s71, s72
    s_add_u32 m0, s61, 18432
    s_waitcnt lgkmcnt(5)
    v_mfma_f32_16x16x32_bf16 v[80:83], v[184:187], a[48:51], v[80:83]
    ds_read_b64_tr_b16 v[180:181], v22 offset:47104
    ds_read_b64_tr_b16 v[182:183], v22 offset:47616
    v_mfma_f32_16x16x32_bf16 v[88:91], v[184:187], a[52:55], v[88:91]
    v_mfma_f32_16x16x32_bf16 v[84:87], v[188:191], a[48:51], v[84:87]
    ds_read_b64_tr_b16 v[184:185], v23 offset:47104
    ds_read_b64_tr_b16 v[186:187], v23 offset:47616
    v_mfma_f32_16x16x32_bf16 v[92:95], v[188:191], a[52:55], v[92:95]
    v_mfma_f32_16x16x32_bf16 v[96:99], v[160:163], a[48:51], v[96:99]
    ds_read_b128 v[188:191], v18 offset:31168
    v_mfma_f32_16x16x32_bf16 v[104:107], v[160:163], a[52:55], v[104:107]
    v_mfma_f32_16x16x32_bf16 v[100:103], v[164:167], a[48:51], v[100:103]
    v_mfma_f32_16x16x32_bf16 v[108:111], v[164:167], a[52:55], v[108:111]
    s_waitcnt lgkmcnt(3)
    v_mfma_f32_16x16x32_bf16 v[112:115], v[168:171], a[48:51], v[112:115]
    v_mfma_f32_16x16x32_bf16 v[116:119], v[168:171], a[52:55], v[116:119]
    buffer_load_dword v199, v31, s[48:51], s7 offen offset:1792 sc1
    s_waitcnt vmcnt(14) lgkmcnt(0)
    s_barrier
    v_mfma_f32_16x16x32_bf16 v[80:83], v[172:175], a[56:59], v[80:83]
    ds_read_b64_tr_b16 v[160:161], v20 offset:8192
    ds_read_b64_tr_b16 v[162:163], v20 offset:8704
    ds_read_b64_tr_b16 v[164:165], v21 offset:8192
    ds_read_b64_tr_b16 v[166:167], v21 offset:8704
    v_mfma_f32_16x16x32_bf16 v[88:91], v[172:175], a[60:63], v[88:91]
    buffer_load_dword v200, v31, s[48:51], s7 offen offset:2048 sc1
    buffer_load_dword v201, v31, s[48:51], s7 offen offset:2304 sc1
    v_mfma_f32_16x16x32_bf16 v[84:87], v[176:179], a[56:59], v[84:87]
    ds_read_b64_tr_b16 v[168:169], v22 offset:8192
    ds_read_b64_tr_b16 v[170:171], v22 offset:8704
    ds_read_b64_tr_b16 v[172:173], v23 offset:8192
    ds_read_b64_tr_b16 v[174:175], v23 offset:8704
    v_mfma_f32_16x16x32_bf16 v[92:95], v[176:179], a[60:63], v[92:95]
    buffer_load_dword v202, v31, s[48:51], s7 offen offset:2560 sc1
    buffer_load_dword v203, v31, s[48:51], s7 offen offset:2816 sc1
    v_mfma_f32_16x16x32_bf16 v[96:99], v[180:183], a[56:59], v[96:99]
    ds_read_b128 v[176:179], v18 offset:31232
    v_mfma_f32_16x16x32_bf16 v[104:107], v[180:183], a[60:63], v[104:107]
    buffer_load_dword v204, v31, s[48:51], s7 offen offset:3072 sc1
    buffer_load_dword v205, v31, s[48:51], s7 offen offset:3328 sc1
    v_mfma_f32_16x16x32_bf16 v[100:103], v[184:187], a[56:59], v[100:103]
    ds_read_b64_tr_b16 v[180:181], v20 offset:49152
    ds_read_b64_tr_b16 v[182:183], v20 offset:49664
    v_mfma_f32_16x16x32_bf16 v[108:111], v[184:187], a[60:63], v[108:111]
    buffer_load_dwordx4 v16, s[20:23], s71 offen offset:0 lds
    v_mfma_f32_16x16x32_bf16 v[112:115], v[188:191], a[56:59], v[112:115]
    ds_read_b64_tr_b16 v[184:185], v21 offset:49152
    ds_read_b64_tr_b16 v[186:187], v21 offset:49664
    v_mfma_f32_16x16x32_bf16 v[116:119], v[188:191], a[60:63], v[116:119]
    buffer_load_dwordx4 v17, s[20:23], s71 offen offset:1024 lds
    s_bfe_u32 s71, s65, 0x40004
    s_mul_i32 s71, s71, 221184
    s_add_u32 s71, s71, s72
    s_add_u32 m0, s61, 20480
    s_waitcnt lgkmcnt(5)
    v_mfma_f32_16x16x32_bf16 v[80:83], v[160:163], a[64:67], v[80:83]
    ds_read_b64_tr_b16 v[188:189], v22 offset:49152
    ds_read_b64_tr_b16 v[190:191], v22 offset:49664
    v_mfma_f32_16x16x32_bf16 v[88:91], v[160:163], a[68:71], v[88:91]
    v_mfma_f32_16x16x32_bf16 v[84:87], v[164:167], a[64:67], v[84:87]
    ds_read_b64_tr_b16 v[160:161], v23 offset:49152
    ds_read_b64_tr_b16 v[162:163], v23 offset:49664
    v_mfma_f32_16x16x32_bf16 v[92:95], v[164:167], a[68:71], v[92:95]
    v_mfma_f32_16x16x32_bf16 v[96:99], v[168:171], a[64:67], v[96:99]
    ds_read_b128 v[164:167], v18 offset:31296
    v_mfma_f32_16x16x32_bf16 v[104:107], v[168:171], a[68:71], v[104:107]
    v_mfma_f32_16x16x32_bf16 v[100:103], v[172:175], a[64:67], v[100:103]
    v_mfma_f32_16x16x32_bf16 v[108:111], v[172:175], a[68:71], v[108:111]
    s_waitcnt lgkmcnt(3)
    v_mfma_f32_16x16x32_bf16 v[112:115], v[176:179], a[64:67], v[112:115]
    v_mfma_f32_16x16x32_bf16 v[116:119], v[176:179], a[68:71], v[116:119]
    s_waitcnt vmcnt(20) lgkmcnt(0)
    s_barrier
    v_mfma_f32_16x16x32_bf16 v[80:83], v[180:183], a[72:75], v[80:83]
    ds_read_b64_tr_b16 v[168:169], v20 offset:10240
    ds_read_b64_tr_b16 v[170:171], v20 offset:10752
    ds_read_b64_tr_b16 v[172:173], v21 offset:10240
    ds_read_b64_tr_b16 v[174:175], v21 offset:10752
    v_mfma_f32_16x16x32_bf16 v[88:91], v[180:183], a[76:79], v[88:91]
    buffer_load_dwordx4 v16, s[20:23], s71 offen offset:0 lds
    v_mfma_f32_16x16x32_bf16 v[84:87], v[184:187], a[72:75], v[84:87]
    ds_read_b64_tr_b16 v[176:177], v22 offset:10240
    ds_read_b64_tr_b16 v[178:179], v22 offset:10752
    ds_read_b64_tr_b16 v[180:181], v23 offset:10240
    ds_read_b64_tr_b16 v[182:183], v23 offset:10752
    v_mfma_f32_16x16x32_bf16 v[92:95], v[184:187], a[76:79], v[92:95]
    v_mfma_f32_16x16x32_bf16 v[96:99], v[188:191], a[72:75], v[96:99]
    ds_read_b128 v[184:187], v18 offset:31360
    v_mfma_f32_16x16x32_bf16 v[104:107], v[188:191], a[76:79], v[104:107]
    v_mfma_f32_16x16x32_bf16 v[100:103], v[160:163], a[72:75], v[100:103]
    ds_read_b64_tr_b16 v[188:189], v20 offset:51200
    ds_read_b64_tr_b16 v[190:191], v20 offset:51712
    v_mfma_f32_16x16x32_bf16 v[108:111], v[160:163], a[76:79], v[108:111]
    buffer_load_dwordx4 v17, s[20:23], s71 offen offset:1024 lds
    v_mfma_f32_16x16x32_bf16 v[112:115], v[164:167], a[72:75], v[112:115]
    ds_read_b64_tr_b16 v[160:161], v21 offset:51200
    ds_read_b64_tr_b16 v[162:163], v21 offset:51712
    v_mfma_f32_16x16x32_bf16 v[116:119], v[164:167], a[76:79], v[116:119]
    s_waitcnt lgkmcnt(5)
    v_mfma_f32_16x16x32_bf16 v[80:83], v[168:171], a[80:83], v[80:83]
    ds_read_b64_tr_b16 v[164:165], v22 offset:51200
    ds_read_b64_tr_b16 v[166:167], v22 offset:51712
    v_mfma_f32_16x16x32_bf16 v[88:91], v[168:171], a[84:87], v[88:91]
    v_mfma_f32_16x16x32_bf16 v[84:87], v[172:175], a[80:83], v[84:87]
    ds_read_b64_tr_b16 v[168:169], v23 offset:51200
    ds_read_b64_tr_b16 v[170:171], v23 offset:51712
    v_mfma_f32_16x16x32_bf16 v[92:95], v[172:175], a[84:87], v[92:95]
    s_add_u32 m0, s61, 0
    v_mfma_f32_16x16x32_bf16 v[96:99], v[176:179], a[80:83], v[96:99]
    ds_read_b128 v[172:175], v18 offset:31424
    v_mfma_f32_16x16x32_bf16 v[104:107], v[176:179], a[84:87], v[104:107]
    buffer_load_dwordx4 v32, s[24:27], s82 offen offset:0 lds
    v_mfma_f32_16x16x32_bf16 v[100:103], v[180:183], a[80:83], v[100:103]
    v_mfma_f32_16x16x32_bf16 v[108:111], v[180:183], a[84:87], v[108:111]
    s_waitcnt lgkmcnt(3)
    v_mfma_f32_16x16x32_bf16 v[112:115], v[184:187], a[80:83], v[112:115]
    v_mfma_f32_16x16x32_bf16 v[116:119], v[184:187], a[84:87], v[116:119]
    buffer_load_dwordx4 v33, s[24:27], s82 offen offset:1024 lds
    s_waitcnt vmcnt(22) lgkmcnt(0)
    s_barrier
    v_mfma_f32_16x16x32_bf16 v[80:83], v[188:191], a[88:91], v[80:83]
    ds_read_b64_tr_b16 v[176:177], v20 offset:12288
    ds_read_b64_tr_b16 v[178:179], v20 offset:12800
    ds_read_b64_tr_b16 v[180:181], v21 offset:12288
    ds_read_b64_tr_b16 v[182:183], v21 offset:12800
    v_mfma_f32_16x16x32_bf16 v[88:91], v[188:191], a[92:95], v[88:91]
    s_waitcnt vmcnt(6)
    v_add_f32 v192, v192, v194
    v_add_f32 v193, v193, v195
    v_add_f32 v192, v192, v196
    v_mfma_f32_16x16x32_bf16 v[84:87], v[160:163], a[88:91], v[84:87]
    ds_read_b64_tr_b16 v[184:185], v22 offset:12288
    ds_read_b64_tr_b16 v[186:187], v22 offset:12800
    ds_read_b64_tr_b16 v[188:189], v23 offset:12288
    ds_read_b64_tr_b16 v[190:191], v23 offset:12800
    v_mfma_f32_16x16x32_bf16 v[92:95], v[160:163], a[92:95], v[92:95]
    buffer_load_dwordx4 v34, s[24:27], s82 offen offset:2048 lds
    v_add_f32 v193, v193, v197
    v_add_f32 v192, v192, v198
    v_add_f32 v193, v193, v199
    v_add_f32 v192, v192, v200
    v_add_f32 v193, v193, v201
    v_mfma_f32_16x16x32_bf16 v[96:99], v[164:167], a[88:91], v[96:99]
    ds_read_b128 v[160:163], v18 offset:31488
    v_add_f32 v192, v192, v202
    v_mfma_f32_16x16x32_bf16 v[104:107], v[164:167], a[92:95], v[104:107]
    v_add_f32 v193, v193, v203
    v_add_f32 v192, v192, v204
    v_add_f32 v193, v193, v205
    v_cmp_u_f32 vcc, v192, v193
    s_nop 1
    s_cbranch_vccnz Lslow_18
Lback_19:
    v_add_f32 v192, v192, v193
    v_mfma_f32_16x16x32_bf16 v[100:103], v[168:171], a[88:91], v[100:103]
    ds_read_b64_tr_b16 v[164:165], v20 offset:53248
    ds_read_b64_tr_b16 v[166:167], v20 offset:53760
    v_mfma_f32_16x16x32_bf16 v[108:111], v[168:171], a[92:95], v[108:111]
    buffer_load_dwordx4 v35, s[24:27], s82 offen offset:3072 lds
    v_mul_f32 v192, 0x3a97b426, v192
    v_mov_b32 v193, v192
    v_mfma_f32_16x16x32_bf16 v[112:115], v[172:175], a[88:91], v[112:115]
    ds_read_b64_tr_b16 v[168:169], v21 offset:53248
    ds_read_b64_tr_b16 v[170:171], v21 offset:53760
    v_mfma_f32_16x16x32_bf16 v[116:119], v[172:175], a[92:95], v[116:119]
    s_add_u32 m0, s61, 4096
    s_add_u32 s6, s82, 128
    v_permlane32_swap_b32 v192, v193
    v_fma_f32 v193, -v192, v192, v193
    v_max_f32 v193, 0, v193
    v_add_f32 v193, 0x3727c5ac, v193
    s_waitcnt lgkmcnt(5)
    v_mfma_f32_16x16x32_bf16 v[80:83], v[176:179], a[96:99], v[80:83]
    ds_read_b64_tr_b16 v[172:173], v22 offset:53248
    ds_read_b64_tr_b16 v[174:175], v22 offset:53760
    v_mfma_f32_16x16x32_bf16 v[88:91], v[176:179], a[100:103], v[88:91]
    buffer_load_dwordx4 v32, s[24:27], s6 offen offset:0 lds
    v_rsq_f32 v194, v193
    s_nop 0
    v_mul_f32_e64 v195, -v192, v194
    v_mov_b32 v196, v194
    v_mfma_f32_16x16x32_bf16 v[84:87], v[180:183], a[96:99], v[84:87]
    ds_read_b64_tr_b16 v[176:177], v23 offset:53248
    ds_read_b64_tr_b16 v[178:179], v23 offset:53760
    v_mfma_f32_16x16x32_bf16 v[92:95], v[180:183], a[100:103], v[92:95]
    v_mov_b32 v197, v195
    v_permlane16_swap_b32 v194, v196
    s_nop 0
    v_permlane16_swap_b32 v195, v197
    v_fma_f32 v48, v48, v194, v195
    v_fma_f32 v49, v49, v194, v195
    v_fma_f32 v50, v50, v194, v195
    v_mfma_f32_16x16x32_bf16 v[96:99], v[184:187], a[96:99], v[96:99]
    ds_read_b128 v[180:183], v18 offset:31552
    v_fma_f32 v51, v51, v194, v195
    v_mfma_f32_16x16x32_bf16 v[104:107], v[184:187], a[100:103], v[104:107]
    buffer_load_dwordx4 v33, s[24:27], s6 offen offset:1024 lds
    v_cvt_pk_bf16_f32 v208, v48, v49
    v_cvt_pk_bf16_f32 v209, v50, v51
    v_mfma_f32_16x16x32_bf16 v[100:103], v[188:191], a[96:99], v[100:103]
    v_mfma_f32_16x16x32_bf16 v[108:111], v[188:191], a[100:103], v[108:111]
    ds_write_b64 v240, v[208:209] offset:12288
    buffer_load_dwordx4 v34, s[24:27], s6 offen offset:2048 lds
    v_fma_f32 v52, v52, v194, v195
    v_fma_f32 v53, v53, v194, v195
    v_fma_f32 v54, v54, v194, v195
    s_waitcnt lgkmcnt(4)
    v_mfma_f32_16x16x32_bf16 v[112:115], v[160:163], a[96:99], v[112:115]
    v_fma_f32 v55, v55, v194, v195
    v_cvt_pk_bf16_f32 v210, v52, v53
    v_mfma_f32_16x16x32_bf16 v[116:119], v[160:163], a[100:103], v[116:119]
    v_cvt_pk_bf16_f32 v211, v54, v55
    s_waitcnt lgkmcnt(0)
    s_barrier
    v_mfma_f32_16x16x32_bf16 v[80:83], v[164:167], a[104:107], v[80:83]
    ds_read_b64_tr_b16 v[184:185], v20 offset:0
    ds_read_b64_tr_b16 v[186:187], v20 offset:512
    ds_read_b64_tr_b16 v[188:189], v21 offset:0
    ds_read_b64_tr_b16 v[190:191], v21 offset:512
    v_mfma_f32_16x16x32_bf16 v[88:91], v[164:167], a[108:111], v[88:91]
    ds_write_b64 v241, v[210:211] offset:12288
    buffer_load_dwordx4 v35, s[24:27], s6 offen offset:3072 lds
    v_fma_f32 v56, v56, v196, v197
    v_fma_f32 v57, v57, v196, v197
    v_fma_f32 v58, v58, v196, v197
    v_fma_f32 v59, v59, v196, v197
    v_mfma_f32_16x16x32_bf16 v[84:87], v[168:171], a[104:107], v[84:87]
    ds_read_b64_tr_b16 v[160:161], v22 offset:0
    ds_read_b64_tr_b16 v[162:163], v22 offset:512
    ds_read_b64_tr_b16 v[164:165], v23 offset:0
    ds_read_b64_tr_b16 v[166:167], v23 offset:512
    v_mfma_f32_16x16x32_bf16 v[92:95], v[168:171], a[108:111], v[92:95]
    s_add_u32 m0, s61, 8192
    v_cvt_pk_bf16_f32 v212, v56, v57
    v_cvt_pk_bf16_f32 v213, v58, v59
    v_mfma_f32_16x16x32_bf16 v[96:99], v[172:175], a[104:107], v[96:99]
    ds_read_b128 v[168:171], v18 offset:31616
    v_mfma_f32_16x16x32_bf16 v[104:107], v[172:175], a[108:111], v[104:107]
    ds_write_b64 v240, v[212:213] offset:14336
    buffer_load_dwordx4 v32, s[24:27], s83 offen offset:0 lds
    v_fma_f32 v60, v60, v196, v197
    v_fma_f32 v61, v61, v196, v197
    v_fma_f32 v62, v62, v196, v197
    v_fma_f32 v63, v63, v196, v197
    v_mfma_f32_16x16x32_bf16 v[100:103], v[176:179], a[104:107], v[100:103]
    ds_read_b64_tr_b16 v[172:173], v20 offset:40960
    ds_read_b64_tr_b16 v[174:175], v20 offset:41472
    v_mfma_f32_16x16x32_bf16 v[108:111], v[176:179], a[108:111], v[108:111]
    v_cvt_pk_bf16_f32 v214, v60, v61
    v_cvt_pk_bf16_f32 v215, v62, v63
    v_mfma_f32_16x16x32_bf16 v[112:115], v[180:183], a[104:107], v[112:115]
    ds_read_b64_tr_b16 v[176:177], v21 offset:40960
    ds_read_b64_tr_b16 v[178:179], v21 offset:41472
    v_mfma_f32_16x16x32_bf16 v[116:119], v[180:183], a[108:111], v[116:119]
    ds_write_b64 v241, v[214:215] offset:14336
    buffer_load_dwordx4 v33, s[24:27], s83 offen offset:1024 lds
    v_fma_f32 v64, v64, v194, v195
    v_fma_f32 v65, v65, v194, v195
    v_fma_f32 v66, v66, v194, v195
    s_waitcnt lgkmcnt(7)
    v_mfma_f32_16x16x32_bf16 v[80:83], v[184:187], a[112:115], v[80:83]
    ds_read_b64_tr_b16 v[180:181], v22 offset:40960
    ds_read_b64_tr_b16 v[182:183], v22 offset:41472
    v_mfma_f32_16x16x32_bf16 v[88:91], v[184:187], a[116:119], v[88:91]
    s_waitcnt vmcnt(6)
    ds_read_b128 a[160:163], v4 offset:0
    ds_read_b128 a[164:167], v4 offset:2048
    v_fma_f32 v67, v67, v194, v195
    v_cvt_pk_bf16_f32 v216, v64, v65
    v_cvt_pk_bf16_f32 v217, v66, v67
    v_mfma_f32_16x16x32_bf16 v[84:87], v[188:191], a[112:115], v[84:87]
    ds_read_b64_tr_b16 v[184:185], v23 offset:40960
    ds_read_b64_tr_b16 v[186:187], v23 offset:41472
    v_mfma_f32_16x16x32_bf16 v[92:95], v[188:191], a[116:119], v[92:95]
    ds_write_b64 v242, v[216:217] offset:12288
    buffer_load_dwordx4 v34, s[24:27], s83 offen offset:2048 lds
    ds_read_b128 a[168:171], v5 offset:0
    v_fma_f32 v68, v68, v194, v195
    v_fma_f32 v69, v69, v194, v195
    v_fma_f32 v70, v70, v194, v195
    v_mfma_f32_16x16x32_bf16 v[96:99], v[160:163], a[112:115], v[96:99]
    ds_read_b128 v[188:191], v18 offset:31680
    ds_read_b128 a[172:175], v5 offset:2048
    v_mfma_f32_16x16x32_bf16 v[104:107], v[160:163], a[116:119], v[104:107]
    v_fma_f32 v71, v71, v194, v195
    v_cvt_pk_bf16_f32 v218, v68, v69
    v_cvt_pk_bf16_f32 v219, v70, v71
    v_mfma_f32_16x16x32_bf16 v[100:103], v[164:167], a[112:115], v[100:103]
    v_mfma_f32_16x16x32_bf16 v[108:111], v[164:167], a[116:119], v[108:111]
    ds_write_b64 v243, v[218:219] offset:12288
    buffer_load_dwordx4 v35, s[24:27], s83 offen offset:3072 lds
    v_fma_f32 v72, v72, v196, v197
    v_fma_f32 v73, v73, v196, v197
    v_fma_f32 v74, v74, v196, v197
    s_waitcnt lgkmcnt(9)
    v_mfma_f32_16x16x32_bf16 v[112:115], v[168:171], a[112:115], v[112:115]
    v_fma_f32 v75, v75, v196, v197
    v_cvt_pk_bf16_f32 v220, v72, v73
    v_mfma_f32_16x16x32_bf16 v[116:119], v[168:171], a[116:119], v[116:119]
    v_cvt_pk_bf16_f32 v221, v74, v75
    s_waitcnt lgkmcnt(0)
    s_barrier
    v_mfma_f32_16x16x32_bf16 v[80:83], v[172:175], a[120:123], v[80:83]
    ds_read_b64_tr_b16 v[160:161], v20 offset:2048
    ds_read_b64_tr_b16 v[162:163], v20 offset:2560
    ds_read_b64_tr_b16 v[164:165], v21 offset:2048
    ds_read_b64_tr_b16 v[166:167], v21 offset:2560
    v_mfma_f32_16x16x32_bf16 v[88:91], v[172:175], a[124:127], v[88:91]
    ds_write_b64 v242, v[220:221] offset:14336
    v_fma_f32 v76, v76, v196, v197
    v_fma_f32 v77, v77, v196, v197
    v_fma_f32 v78, v78, v196, v197
    v_fma_f32 v79, v79, v196, v197
    v_cvt_pk_bf16_f32 v222, v76, v77
    v_mfma_f32_16x16x32_bf16 v[84:87], v[176:179], a[120:123], v[84:87]
    ds_read_b64_tr_b16 v[168:169], v22 offset:2048
    ds_read_b64_tr_b16 v[170:171], v22 offset:2560
    ds_read_b64_tr_b16 v[172:173], v23 offset:2048
    ds_read_b64_tr_b16 v[174:175], v23 offset:2560
    v_mfma_f32_16x16x32_bf16 v[92:95], v[176:179], a[124:127], v[92:95]
    v_cvt_pk_bf16_f32 v223, v78, v79
    v_mfma_f32_16x16x32_bf16 v[96:99], v[180:183], a[120:123], v[96:99]
    ds_read_b128 v[176:179], v18 offset:31744
    v_mfma_f32_16x16x32_bf16 v[104:107], v[180:183], a[124:127], v[104:107]
    ds_write_b64 v243, v[222:223] offset:14336
    ds_read_b64_tr_b16 v[224:225], v245 offset:12288
    ds_read_b64_tr_b16 v[226:227], v246 offset:12800
    ds_read_b64_tr_b16 v[228:229], v246 offset:12288
    v_mfma_f32_16x16x32_bf16 v[100:103], v[184:187], a[120:123], v[100:103]
    ds_read_b64_tr_b16 v[180:181], v20 offset:43008
    ds_read_b64_tr_b16 v[182:183], v20 offset:43520
    v_mfma_f32_16x16x32_bf16 v[108:111], v[184:187], a[124:127], v[108:111]
    ds_read_b64_tr_b16 v[230:231], v245 offset:12800
    ds_read_b64_tr_b16 v[232:233], v247 offset:12288
    ds_read_b64_tr_b16 v[234:235], v248 offset:12800
    ds_read_b64_tr_b16 v[236:237], v248 offset:12288
    v_mfma_f32_16x16x32_bf16 v[112:115], v[188:191], a[120:123], v[112:115]
    ds_read_b64_tr_b16 v[184:185], v21 offset:43008
    ds_read_b64_tr_b16 v[186:187], v21 offset:43520
    v_mfma_f32_16x16x32_bf16 v[116:119], v[188:191], a[124:127], v[116:119]
    ds_read_b64_tr_b16 v[238:239], v247 offset:12800
    s_waitcnt vmcnt(4)
    ds_read_b128 a[176:179], v4 offset:4096
    s_waitcnt lgkmcnt(15)
    v_mfma_f32_16x16x32_bf16 v[80:83], v[160:163], a[128:131], v[80:83]
    ds_read_b64_tr_b16 v[188:189], v22 offset:43008
    ds_read_b64_tr_b16 v[190:191], v22 offset:43520
    v_mfma_f32_16x16x32_bf16 v[88:91], v[160:163], a[132:135], v[88:91]
    ds_read_b128 a[180:183], v4 offset:6144
    ds_read_b128 a[184:187], v5 offset:4096
    v_mfma_f32_16x16x32_bf16 v[84:87], v[164:167], a[128:131], v[84:87]
    ds_read_b64_tr_b16 v[160:161], v23 offset:43008
    ds_read_b64_tr_b16 v[162:163], v23 offset:43520
    v_mfma_f32_16x16x32_bf16 v[92:95], v[164:167], a[132:135], v[92:95]
    s_waitcnt lgkmcnt(15)
    buffer_store_dwordx4 v[224:227], v29, s[48:51], s80 offen offset:0 sc1
    ds_read_b128 a[188:191], v5 offset:6144
    v_mfma_f32_16x16x32_bf16 v[96:99], v[168:171], a[128:131], v[96:99]
    ds_read_b128 v[164:167], v18 offset:31808
    v_mfma_f32_16x16x32_bf16 v[104:107], v[168:171], a[132:135], v[104:107]
    v_mfma_f32_16x16x32_bf16 v[100:103], v[172:175], a[128:131], v[100:103]
    v_mfma_f32_16x16x32_bf16 v[108:111], v[172:175], a[132:135], v[108:111]
    v_mfma_f32_16x16x32_bf16 v[112:115], v[176:179], a[128:131], v[112:115]
    v_mfma_f32_16x16x32_bf16 v[116:119], v[176:179], a[132:135], v[116:119]
    s_waitcnt lgkmcnt(15)
    buffer_store_dwordx4 v[228:231], v29, s[48:51], s80 offen offset:1024 sc1
    s_waitcnt lgkmcnt(0)
    s_barrier
    v_mfma_f32_16x16x32_bf16 v[80:83], v[180:183], a[136:139], v[80:83]
    ds_read_b64_tr_b16 v[168:169], v20 offset:4096
    ds_read_b64_tr_b16 v[170:171], v20 offset:4608
    ds_read_b64_tr_b16 v[172:173], v21 offset:4096
    ds_read_b64_tr_b16 v[174:175], v21 offset:4608
    v_mfma_f32_16x16x32_bf16 v[88:91], v[180:183], a[140:143], v[88:91]
    v_mfma_f32_16x16x32_bf16 v[84:87], v[184:187], a[136:139], v[84:87]
    ds_read_b64_tr_b16 v[176:177], v22 offset:4096
    ds_read_b64_tr_b16 v[178:179], v22 offset:4608
    ds_read_b64_tr_b16 v[180:181], v23 offset:4096
    ds_read_b64_tr_b16 v[182:183], v23 offset:4608
    v_mfma_f32_16x16x32_bf16 v[92:95], v[184:187], a[140:143], v[92:95]
    buffer_store_dwordx4 v[232:235], v29, s[48:51], s80 offen offset:2048 sc1
    v_mfma_f32_16x16x32_bf16 v[96:99], v[188:191], a[136:139], v[96:99]
    ds_read_b128 v[184:187], v18 offset:31872
    v_mfma_f32_16x16x32_bf16 v[104:107], v[188:191], a[140:143], v[104:107]
    v_mfma_f32_16x16x32_bf16 v[100:103], v[160:163], a[136:139], v[100:103]
    ds_read_b64_tr_b16 v[188:189], v20 offset:45056
    ds_read_b64_tr_b16 v[190:191], v20 offset:45568
    v_mfma_f32_16x16x32_bf16 v[108:111], v[160:163], a[140:143], v[108:111]
    s_waitcnt vmcnt(3)
    ds_read_b128 a[192:195], v4 offset:8192
    ds_read_b128 a[196:199], v4 offset:10240
    v_mfma_f32_16x16x32_bf16 v[112:115], v[164:167], a[136:139], v[112:115]
    ds_read_b64_tr_b16 v[160:161], v21 offset:45056
    ds_read_b64_tr_b16 v[162:163], v21 offset:45568
    v_mfma_f32_16x16x32_bf16 v[116:119], v[164:167], a[140:143], v[116:119]
    buffer_store_dwordx4 v[236:239], v29, s[48:51], s80 offen offset:3072 sc1
    ds_read_b128 a[200:203], v5 offset:8192
    s_waitcnt lgkmcnt(8)
    v_mfma_f32_16x16x32_bf16 v[80:83], v[168:171], a[144:147], v[80:83]
    ds_read_b64_tr_b16 v[164:165], v22 offset:45056
    ds_read_b64_tr_b16 v[166:167], v22 offset:45568
    v_mfma_f32_16x16x32_bf16 v[88:91], v[168:171], a[148:151], v[88:91]
    ds_read_b128 a[204:207], v5 offset:10240
    s_add_u32 m0, s61, 12288
    s_add_u32 s6, s83, 128
    v_mfma_f32_16x16x32_bf16 v[84:87], v[172:175], a[144:147], v[84:87]
    ds_read_b64_tr_b16 v[168:169], v23 offset:45056
    ds_read_b64_tr_b16 v[170:171], v23 offset:45568
    v_mfma_f32_16x16x32_bf16 v[92:95], v[172:175], a[148:151], v[92:95]
    buffer_load_dwordx4 v32, s[24:27], s6 offen offset:0 lds
    v_mfma_f32_16x16x32_bf16 v[96:99], v[176:179], a[144:147], v[96:99]
    ds_read_b128 v[172:175], v18 offset:31936
    v_mfma_f32_16x16x32_bf16 v[104:107], v[176:179], a[148:151], v[104:107]
    v_mfma_f32_16x16x32_bf16 v[100:103], v[180:183], a[144:147], v[100:103]
    v_mfma_f32_16x16x32_bf16 v[108:111], v[180:183], a[148:151], v[108:111]
    buffer_load_dwordx4 v33, s[24:27], s6 offen offset:1024 lds
    s_waitcnt lgkmcnt(4)
    v_mfma_f32_16x16x32_bf16 v[112:115], v[184:187], a[144:147], v[112:115]
    v_mfma_f32_16x16x32_bf16 v[116:119], v[184:187], a[148:151], v[116:119]
    v_mfma_f32_16x16x32_bf16 v[80:83], v[188:191], a[152:155], v[80:83]
    v_mfma_f32_16x16x32_bf16 v[88:91], v[188:191], a[156:159], v[88:91]
    buffer_load_dwordx4 v34, s[24:27], s6 offen offset:2048 lds
    v_mfma_f32_16x16x32_bf16 v[84:87], v[160:163], a[152:155], v[84:87]
    v_mfma_f32_16x16x32_bf16 v[92:95], v[160:163], a[156:159], v[92:95]
    v_mfma_f32_16x16x32_bf16 v[96:99], v[164:167], a[152:155], v[96:99]
    v_mfma_f32_16x16x32_bf16 v[104:107], v[164:167], a[156:159], v[104:107]
    buffer_load_dwordx4 v35, s[24:27], s6 offen offset:3072 lds
    s_waitcnt lgkmcnt(0)
    v_mfma_f32_16x16x32_bf16 v[100:103], v[168:171], a[152:155], v[100:103]
    s_add_u32 m0, s61, 0
    v_mfma_f32_16x16x32_bf16 v[108:111], v[168:171], a[156:159], v[108:111]
    v_mfma_f32_16x16x32_bf16 v[112:115], v[172:175], a[152:155], v[112:115]
    v_mfma_f32_16x16x32_bf16 v[116:119], v[172:175], a[156:159], v[116:119]
    buffer_load_dwordx4 v32, s[24:27], s84 offen offset:0 lds
L_tail_17:
    s_waitcnt vmcnt(5)
    s_mov_b64 exec, 1
    buffer_store_dword v31, off, s[48:51], s81 sc1
    s_mov_b64 exec, -1
    buffer_load_dwordx4 v33, s[24:27], s84 offen offset:1024 lds
    buffer_load_dwordx4 v34, s[24:27], s84 offen offset:2048 lds
    buffer_load_dwordx4 v35, s[24:27], s84 offen offset:3072 lds
    s_barrier
    v_cmp_eq_u32 vcc, 1, v3
    s_nop 1
    v_cndmask_b32 v112, v112, v116, vcc
    v_mul_f32 v112, 0xbfb8aa3b, v112
    v_exp_f32 v112, v112
    s_nop 0
    v_add_f32 v112, 1.0, v112
    v_rcp_f32 v112, v112
    s_lshl2_add_u32 s75, s57, s56
    s_lshl_b32 s75, s75, 7
    s_add_u32 s75, s75, 786432
    v_and_b32 v36, 0x7c, v31
    buffer_store_dword v112, v36, s[48:51], s75 offen sc1
    s_lshl2_add_u32 s75, s57, s56
    s_mul_i32 s75, s75, 28
    s_mov_b32 s76, 26
    s_add_u32 s75, s75, s76
    s_lshl_b32 s75, s75, 11
    s_add_u32 s75, s75, 6291456
    v_cvt_pk_bf16_f32 v80, v80, v81
    s_waitcnt vmcnt(6)
    ds_read_b128 a[208:211], v4 offset:12288
    ds_read_b128 a[212:215], v4 offset:14336
    v_cvt_pk_bf16_f32 v81, v82, v83
    ds_read_b128 a[216:219], v5 offset:12288
    ds_read_b128 a[220:223], v5 offset:14336
    v_cvt_pk_bf16_f32 v82, v84, v85
    v_cvt_pk_bf16_f32 v83, v86, v87
    v_cvt_pk_bf16_f32 v84, v88, v89
    v_cvt_pk_bf16_f32 v85, v90, v91
    v_cvt_pk_bf16_f32 v86, v92, v93
    v_cvt_pk_bf16_f32 v87, v94, v95
    buffer_store_dwordx4 v[80:83], v29, s[48:51], s75 offen offset:0 sc1
    buffer_store_dwordx4 v[84:87], v29, s[48:51], s75 offen offset:1024 sc1
    v_cvt_pk_bf16_f32 v88, v96, v97
    v_cvt_pk_bf16_f32 v89, v98, v99
    v_cvt_pk_bf16_f32 v90, v100, v101
    v_cvt_pk_bf16_f32 v91, v102, v103
    v_cvt_pk_bf16_f32 v92, v104, v105
    v_cvt_pk_bf16_f32 v93, v106, v107
    v_cvt_pk_bf16_f32 v94, v108, v109
    v_cvt_pk_bf16_f32 v95, v110, v111
    buffer_store_dwordx4 v[88:91], v29, s[48:51], s75 offen offset:2048 sc1
    buffer_store_dwordx4 v[92:95], v29, s[48:51], s75 offen offset:3072 sc1
    s_lshl2_add_u32 s7, s57, s56
    s_lshl3_add_u32 s7, s7, s98
    s_lshl_b32 s7, s7, 7
    s_add_u32 s7, s7, 344064
    s_add_u32 m0, s61, 4096
    s_add_u32 s6, s84, 128
    buffer_load_dwordx4 v32, s[24:27], s6 offen offset:0 lds
    buffer_load_dwordx4 v33, s[24:27], s6 offen offset:1024 lds
    buffer_load_dwordx4 v34, s[24:27], s6 offen offset:2048 lds
    buffer_load_dwordx4 v35, s[24:27], s6 offen offset:3072 lds
    s_add_u32 m0, s61, 8192
    s_nop 0
    buffer_load_dwordx4 v32, s[24:27], s85 offen offset:0 lds
    buffer_load_dwordx4 v33, s[24:27], s85 offen offset:1024 lds
    buffer_load_dwordx4 v34, s[24:27], s85 offen offset:2048 lds
    buffer_load_dwordx4 v35, s[24:27], s85 offen offset:3072 lds
    s_waitcnt vmcnt(8)
    s_mov_b64 exec, 1
    buffer_store_dword v31, off, s[48:51], s7 sc1
    s_mov_b64 exec, -1
    s_mov_b32 s7, 0x80000000
    s_mov_b32 s32, 0x80000000
    s_mov_b32 s33, 0x80000000
    s_mov_b32 s62, 0x80000000
    s_mov_b32 s34, 0x80000000
    s_mov_b32 s35, 0x80000000
    v_lshrrev_b32 v36, 3, v0
    v_mul_u32_u24 v36, 640, v36
    v_and_b32 v37, 0x70, v29
    v_add_u32 v36, v36, v37
    s_add_u32 s75, s64, 0
    buffer_store_dwordx4 v[12:15], v36, s[40:43], s75 offen offset:512 sc1
    s_add_u32 s75, s64, 5120
    buffer_store_dwordx4 v[12:15], v36, s[40:43], s75 offen offset:512 sc1
    s_add_u32 s75, s64, 10240
    buffer_store_dwordx4 v[12:15], v36, s[40:43], s75 offen offset:512 sc1
    s_add_u32 s75, s64, 15360
    buffer_store_dwordx4 v[12:15], v36, s[40:43], s75 offen offset:512 sc1
    s_add_u32 s75, s64, 20480
    buffer_store_dwordx4 v[12:15], v36, s[40:43], s75 offen offset:512 sc1
    s_add_u32 s75, s64, 25600
    buffer_store_dwordx4 v[12:15], v36, s[40:43], s75 offen offset:512 sc1
    s_add_u32 s75, s64, 30720
    buffer_store_dwordx4 v[12:15], v36, s[40:43], s75 offen offset:512 sc1
    s_add_u32 s75, s64, 35840
    buffer_store_dwordx4 v[12:15], v36, s[40:43], s75 offen offset:512 sc1
    ds_read_b128 a[224:227], v4 offset:0
    ds_read_b128 a[228:231], v4 offset:2048
    ds_read_b128 a[232:235], v5 offset:0
    ds_read_b128 a[236:239], v5 offset:2048
    s_waitcnt vmcnt(13)
    ds_read_b128 a[240:243], v4 offset:4096
    ds_read_b128 a[244:247], v4 offset:6144
    ds_read_b128 a[248:251], v5 offset:4096
    ds_read_b128 a[252:255], v5 offset:6144
    s_waitcnt vmcnt(9)
    ds_read_b128 v[192:195], v4 offset:8192
    ds_read_b128 v[196:199], v4 offset:10240
    ds_read_b128 v[200:203], v5 offset:8192
    ds_read_b128 v[204:207], v5 offset:10240
    s_waitcnt lgkmcnt(12)
    s_add_u32 m0, s61, 12288
    s_add_u32 s6, s85, 128
    buffer_load_dwordx4 v32, s[24:27], s6 offen offset:0 lds
    buffer_load_dwordx4 v33, s[24:27], s6 offen offset:1024 lds
    buffer_load_dwordx4 v34, s[24:27], s6 offen offset:2048 lds
    buffer_load_dwordx4 v35, s[24:27], s6 offen offset:3072 lds
    s_waitcnt lgkmcnt(8)
    s_add_u32 m0, s61, 0
    s_nop 0
    buffer_load_dwordx4 v32, s[24:27], s86 offen offset:0 lds
    buffer_load_ushort v46, v43, s[28:31], 0 offen offset:0
    buffer_load_ushort v47, v43, s[28:31], 0 offen offset:32
    buffer_load_dword v45, v44, s[48:51], 0 offen sc1
    buffer_load_dwordx4 v33, s[24:27], s86 offen offset:1024 lds
    buffer_load_dwordx4 v34, s[24:27], s86 offen offset:2048 lds
    buffer_load_dwordx4 v35, s[24:27], s86 offen offset:3072 lds
    s_waitcnt lgkmcnt(4)
    s_add_u32 m0, s61, 4096
    s_add_u32 s6, s86, 128
    buffer_load_dwordx4 v32, s[24:27], s6 offen offset:0 lds
    buffer_load_dwordx4 v33, s[24:27], s6 offen offset:1024 lds
    buffer_load_dwordx4 v34, s[24:27], s6 offen offset:2048 lds
    buffer_load_dwordx4 v35, s[24:27], s6 offen offset:3072 lds
    s_waitcnt lgkmcnt(0)
    s_add_u32 m0, s61, 8192
    s_nop 0
    buffer_load_dwordx4 v32, s[24:27], s87 offen offset:0 lds
    buffer_load_dwordx4 v33, s[24:27], s87 offen offset:1024 lds
    buffer_load_dwordx4 v34, s[24:27], s87 offen offset:2048 lds
    buffer_load_dwordx4 v35, s[24:27], s87 offen offset:3072 lds
    s_waitcnt vmcnt(11)
    v_cmp_eq_u32 vcc, -1, v45
    s_nop 1
    s_cbranch_vccnz Lslow_20
Lback_21:
    s_add_u32 m0, s61, 28672
    s_nop 0
    buffer_load_dwordx4 v29, s[48:51], s90 offen offset:0 sc1 lds
    buffer_load_dwordx4 v29, s[48:51], s90 offen offset:1024 sc1 lds
    buffer_load_dwordx4 v29, s[48:51], s90 offen offset:2048 sc1 lds
    buffer_load_dwordx4 v29, s[48:51], s90 offen offset:3072 sc1 lds
    s_add_u32 m0, s61, 32768
    s_nop 0
    buffer_load_dwordx4 v29, s[48:51], s91 offen offset:0 sc1 lds
    buffer_load_dwordx4 v29, s[48:51], s91 offen offset:1024 sc1 lds
    buffer_load_dwordx4 v29, s[48:51], s91 offen offset:2048 sc1 lds
    buffer_load_dwordx4 v29, s[48:51], s91 offen offset:3072 sc1 lds
    s_add_u32 m0, s61, 36864
    s_nop 0
    buffer_load_dwordx4 v29, s[48:51], s92 offen offset:0 sc1 lds
    buffer_load_dwordx4 v29, s[48:51], s92 offen offset:1024 sc1 lds
    buffer_load_dwordx4 v29, s[48:51], s92 offen offset:2048 sc1 lds
    buffer_load_dwordx4 v29, s[48:51], s92 offen offset:3072 sc1 lds
    s_branch L_p2
L_role_h:
    s_mov_b32 s14, 2457600
    s_mov_b32 s15, 0x20000
    s_mul_i32 s67, s59, 640
    s_bfe_u32 s66, s99, 0x40000
    s_mul_i32 s66, s66, 245760
    s_add_u32 s66, s66, s67
    s_lshl_b32 s75, s56, 4
    v_add_u32 v38, s75, v1
    v_mul_u32_u24 v38, 3840, v38
    v_add_u32 v16, v38, v37
    v_add_u32 v17, 29696, v16
    s_add_u32 m0, s61, 32768
    s_nop 0
    buffer_load_dwordx4 v16, s[12:15], s66 offen offset:0 lds
    buffer_load_dwordx4 v17, s[12:15], s66 offen offset:1024 lds
    s_add_u32 m0, s61, 34688
    s_nop 0
    buffer_load_dwordx4 v16, s[12:15], s66 offen offset:128 lds
    buffer_load_dwordx4 v17, s[12:15], s66 offen offset:1152 lds
    s_mov_b32 s14, 2457600
    s_mov_b32 s15, 0x20000
    s_mov_b32 s46, 256
    s_mov_b32 s47, 0x20000
    s_mov_b32 s26, 8388608
    s_mov_b32 s27, 0x20000
    s_mov_b32 s18, 819200
    s_mov_b32 s19, 0x20000
    s_mov_b32 s30, 4096
    s_mov_b32 s31, 0x20000
    s_mov_b32 s34, 1105920
    s_mov_b32 s35, 0x20000
    s_mov_b32 s38, 1280
    s_mov_b32 s39, 0x20000
    s_mov_b32 s42, 2621440
    s_mov_b32 s43, 0x20000
    s_mov_b32 s68, 0xc0135761
    s_mov_b32 s69, 0xbdd2d3e8
    s_mov_b32 s74, 0
    v_add_u32 v30, 0x1000, v29
    v_lshlrev_b32 v31, 2, v0
    s_bfe_u32 s75, s2, 0x20001
    s_and_b32 s77, s2, 1
    s_bfe_u32 s4, s2, 0x30003
    s_lshl3_add_u32 s4, s75, s4
    s_lshr_b32 s5, s2, 6
    s_lshl2_add_u32 s5, s77, s5
    v_and_b32 v1, 31, v0
    v_lshrrev_b32 v2, 5, v0
    v_bfe_u32 v4, v0, 1, 3
    v_xor_b32 v4, v4, v2
    v_lshlrev_b32 v4, 4, v4
    v_lshl_add_u32 v4, v1, 7, v4
    v_xor_b32 v12, 0, v4
    v_add_u32 v12, s61, v12
    v_xor_b32 v13, 32, v4
    v_add_u32 v13, s61, v13
    v_xor_b32 v14, 64, v4
    v_add_u32 v14, s61, v14
    v_xor_b32 v15, 96, v4
    v_add_u32 v15, s61, v15
    v_bfe_u32 v5, v0, 2, 2
    v_lshl_add_u32 v5, v2, 3, v5
    v_lshlrev_b32 v5, 7, v5
    v_add_u32 v5, 16384, v5
    v_bfe_u32 v4, v0, 3, 1
    v_lshlrev_b32 v4, 6, v4
    v_and_b32 v1, 1, v0
    v_bfe_u32 v3, v0, 1, 1
    v_lshl_or_b32 v1, v1, 1, v3
    v_lshlrev_b32 v1, 3, v1
    v_bfe_u32 v3, v0, 4, 1
    v_lshl_add_u32 v36, v3, 5, v1
    v_xor_b32 v36, v36, v4
    v_add_u32 v20, v36, v5
    v_xor_b32 v21, 64, v20
    v_add_u32 v22, 81920, v20
    v_add_u32 v23, 81920, v21
    v_lshlrev_b32 v2, 7, v0
    s_waitcnt vmcnt(8)
    s_barrier
    v_mov_b32 v244, 1
    s_lshl_b32 s75, s56, 12
    s_mov_b64 exec, 1
    buffer_atomic_add v244, off, s[44:47], s75 sc1
    s_mov_b64 exec, -1
    s_bfe_u32 s66, s99, 0x40004
    s_mul_i32 s66, s66, 245760
    s_add_u32 s66, s66, s67
    s_add_u32 m0, s61, 4096
    s_nop 0
    buffer_load_dwordx4 v8, s[8:11], s63 offen offset:0 lds
    buffer_load_dwordx4 v9, s[8:11], s63 offen offset:1024 lds
    buffer_load_dwordx4 v10, s[8:11], s63 offen offset:2048 lds
    buffer_load_dwordx4 v11, s[8:11], s63 offen offset:3072 lds
    s_bfe_u32 s63, s99, 0x40008
    s_mul_i32 s63, s63, 128
    s_add_u32 s63, s63, s64
    s_add_u32 m0, s61, 36864
    s_nop 0
    buffer_load_dwordx4 v16, s[12:15], s66 offen offset:0 lds
    buffer_load_dwordx4 v17, s[12:15], s66 offen offset:1024 lds
    s_add_u32 m0, s61, 38784
    s_nop 0
    buffer_load_dwordx4 v16, s[12:15], s66 offen offset:128 lds
    buffer_load_dwordx4 v17, s[12:15], s66 offen offset:1152 lds
    s_and_b32 s75, s56, 1
    s_mul_i32 s76, s56, 320
    s_lshl_b32 s3, s75, 6
    s_sub_u32 s76, s76, s3
    s_mul_i32 s75, s75, 192
    s_sub_u32 s75, 256, s75
    s_mul_i32 s77, s76, 1
    v_add_u32 v36, 0, v0
    v_mul_u32_u24 v37, 0xccd, v36
    v_lshrrev_b32 v37, 16, v37
    v_mul_u32_u24 v40, 960, v37
    v_lshl_add_u32 v40, v36, 4, v40
    v_mul_u32_u24 v37, 20, v37
    v_sub_u32 v37, v36, v37
    v_lshrrev_b32 v37, 4, v37
    v_mad_u32_u24 v40, v37, s75, v40
    v_add_u32 v40, s77, v40
    v_add_u32 v36, 64, v0
    v_mul_u32_u24 v37, 0xccd, v36
    v_lshrrev_b32 v37, 16, v37
    v_mul_u32_u24 v41, 960, v37
    v_lshl_add_u32 v41, v36, 4, v41
    v_mul_u32_u24 v37, 20, v37
    v_sub_u32 v37, v36, v37
    v_lshrrev_b32 v37, 4, v37
    v_mad_u32_u24 v41, v37, s75, v41
    v_add_u32 v41, s77, v41
    v_subrev_u32 v41, 1024, v41
    v_add_u32 v36, 128, v0
    v_mul_u32_u24 v37, 0xccd, v36
    v_lshrrev_b32 v37, 16, v37
    v_mul_u32_u24 v42, 960, v37
    v_lshl_add_u32 v42, v36, 4, v42
    v_mul_u32_u24 v37, 20, v37
    v_sub_u32 v37, v36, v37
    v_lshrrev_b32 v37, 4, v37
    v_mad_u32_u24 v42, v37, s75, v42
    v_add_u32 v42, s77, v42
    v_subrev_u32 v42, 2048, v42
    v_add_u32 v36, 192, v0
    v_mul_u32_u24 v37, 0xccd, v36
    v_lshrrev_b32 v37, 16, v37
    v_mul_u32_u24 v43, 960, v37
    v_lshl_add_u32 v43, v36, 4, v43
    v_mul_u32_u24 v37, 20, v37
    v_sub_u32 v37, v36, v37
    v_lshrrev_b32 v37, 4, v37
    v_mad_u32_u24 v43, v37, s75, v43
    v_add_u32 v43, s77, v43
    v_subrev_u32 v43, 3072, v43
    v_add_u32 v36, 256, v0
    v_mul_u32_u24 v37, 0xccd, v36
    v_lshrrev_b32 v37, 16, v37
    v_mul_u32_u24 v44, 960, v37
    v_lshl_add_u32 v44, v36, 4, v44
    v_mul_u32_u24 v37, 20, v37
    v_sub_u32 v37, v36, v37
    v_lshrrev_b32 v37, 4, v37
    v_mad_u32_u24 v44, v37, s75, v44
    v_add_u32 v44, s77, v44
    s_lshl1_add_u32 s3, s57, s59
    s_mul_i32 s79, s3, 40960
    v_lshrrev_b32 v18, 5, v0
    v_bfe_u32 v19, v0, 2, 3
    v_lshl_add_u32 v18, v18, 4, v19
    v_mul_u32_u24 v18, 320, v18
    v_add_u32 v18, s61, v18
    v_and_b32 v36, 3, v0
    v_lshl_add_u32 v19, v36, 3, v18
    v_lshl_add_u32 v18, v36, 4, v18
    s_mul_i32 s80, s56, 96
    s_add_u32 s80, s80, s3
    s_mul_i32 s80, s80, 5120
    s_add_u32 s80, s80, 16879616
    s_cmp_lt_u32 s3, 27
    s_cselect_b32 s80, s80, 0x80000000
    s_lshl_b32 s7, s56, 5
    s_add_u32 s7, s7, s3
    s_lshl_b32 s7, s7, 7
    s_add_u32 s7, s7, 622592
    s_add_u32 s72, s67, 256
    s_bfe_u32 s71, s99, 0x40000
    s_mul_i32 s71, s71, 245760
    s_add_u32 s71, s71, s72
    v_bfe_u32 v25, v0, 4, 1
    v_mul_u32_u24 v25, 0xc000, v25
    v_and_b32 v36, 15, v0
    v_lshl_add_u32 v25, v36, 4, v25
    v_lshrrev_b32 v36, 5, v0
    v_lshl_add_u32 v25, v36, 8, v25
    s_lshl2_add_u32 s86, s57, s56
    s_mul_i32 s86, s86, 98304
    s_mul_i32 s3, s59, 10240
    s_add_u32 s86, s86, s3
    s_add_u32 s86, s86, 10485760
    s_bfe_u32 s66, s99, 0x40008
    s_mul_i32 s66, s66, 245760
    s_add_u32 s66, s66, s67
    s_add_u32 m0, s61, 8192
    s_nop 0
    buffer_load_dwordx4 v8, s[8:11], s63 offen offset:0 lds
    buffer_load_dwordx4 v9, s[8:11], s63 offen offset:1024 lds
    buffer_load_dwordx4 v10, s[8:11], s63 offen offset:2048 lds
    buffer_load_dwordx4 v11, s[8:11], s63 offen offset:3072 lds
    s_bfe_u32 s63, s99, 0x4000c
    s_mul_i32 s63, s63, 128
    s_add_u32 s63, s63, s64
    s_add_u32 m0, s61, 24576
    s_nop 0
    buffer_load_dwordx4 v16, s[12:15], s66 offen offset:0 lds
    buffer_load_dwordx4 v17, s[12:15], s66 offen offset:1024 lds
    s_add_u32 m0, s61, 26496
    s_nop 0
    buffer_load_dwordx4 v16, s[12:15], s66 offen offset:128 lds
    buffer_load_dwordx4 v17, s[12:15], s66 offen offset:1152 lds
    s_waitcnt vmcnt(17)
    s_barrier
    ds_read_b128 a[0:3], v12 offset:0
    ds_read_b128 a[4:7], v13 offset:0
    ds_read_b128 a[8:11], v14 offset:0
    ds_read_b128 a[12:15], v15 offset:0
    ds_read_b64_tr_b16 v[208:209], v20 offset:16384
    ds_read_b64_tr_b16 v[210:211], v20 offset:16896
    ds_read_b64_tr_b16 v[212:213], v21 offset:16384
    ds_read_b64_tr_b16 v[214:215], v21 offset:16896
    ds_read_b64_tr_b16 v[216:217], v20 offset:18432
    ds_read_b64_tr_b16 v[218:219], v20 offset:18944
    ds_read_b64_tr_b16 v[220:221], v21 offset:18432
    ds_read_b64_tr_b16 v[222:223], v21 offset:18944
    ds_read_b64_tr_b16 v[224:225], v20 offset:57344
    ds_read_b64_tr_b16 v[226:227], v20 offset:57856
    ds_read_b64_tr_b16 v[228:229], v21 offset:57344
    ds_read_b64_tr_b16 v[230:231], v21 offset:57856
    s_waitcnt lgkmcnt(10)
    v_mfma_f32_32x32x16_bf16 v[48:63], v[208:211], a[0:3], 0
    ds_read_b64_tr_b16 v[232:233], v20 offset:59392
    ds_read_b64_tr_b16 v[234:235], v20 offset:59904
    ds_read_b64_tr_b16 v[236:237], v21 offset:59392
    ds_read_b64_tr_b16 v[238:239], v21 offset:59904
    s_waitcnt lgkmcnt(12)
    v_mfma_f32_32x32x16_bf16 v[64:79], v[212:215], a[0:3], 0
    ds_read_b64_tr_b16 v[208:209], v22 offset:16384
    ds_read_b64_tr_b16 v[210:211], v22 offset:16896
    s_bfe_u32 s66, s99, 0x4000c
    s_mul_i32 s66, s66, 245760
    s_waitcnt lgkmcnt(6)
    v_mfma_f32_32x32x16_bf16 v[80:95], v[216:219], a[0:3], 0
    ds_read_b64_tr_b16 v[212:213], v23 offset:16384
    ds_read_b64_tr_b16 v[214:215], v23 offset:16896
    s_add_u32 s66, s66, s67
    s_add_u32 m0, s61, 12288
    s_lshr_b32 s98, s57, 1
    v_mfma_f32_32x32x16_bf16 v[96:111], v[220:223], a[0:3], 0
    ds_read_b64_tr_b16 v[216:217], v22 offset:18432
    ds_read_b64_tr_b16 v[218:219], v22 offset:18944
    buffer_load_dwordx4 v8, s[8:11], s63 offen offset:0 lds
    s_lshl3_add_u32 s98, s59, s98
    v_mfma_f32_32x32x16_bf16 v[48:63], v[224:227], a[4:7], v[48:63]
    ds_read_b64_tr_b16 v[220:221], v23 offset:18432
    ds_read_b64_tr_b16 v[222:223], v23 offset:18944
    s_and_b32 s96, s57, 1
    s_lshl2_add_u32 s96, s96, s56
    s_mul_i32 s75, s98, 51200
    v_mfma_f32_32x32x16_bf16 v[64:79], v[228:231], a[4:7], v[64:79]
    ds_read_b64_tr_b16 v[224:225], v22 offset:57344
    ds_read_b64_tr_b16 v[226:227], v22 offset:57856
    buffer_load_dwordx4 v9, s[8:11], s63 offen offset:1024 lds
    s_waitcnt lgkmcnt(6)
    v_mfma_f32_32x32x16_bf16 v[80:95], v[232:235], a[4:7], v[80:95]
    ds_read_b64_tr_b16 v[228:229], v23 offset:57344
    ds_read_b64_tr_b16 v[230:231], v23 offset:57856
    buffer_load_dwordx4 v10, s[8:11], s63 offen offset:2048 lds
    s_mul_i32 s76, s96, 160
    v_mfma_f32_32x32x16_bf16 v[96:111], v[236:239], a[4:7], v[96:111]
    ds_read_b64_tr_b16 v[232:233], v22 offset:59392
    ds_read_b64_tr_b16 v[234:235], v22 offset:59904
    buffer_load_dwordx4 v11, s[8:11], s63 offen offset:3072 lds
    s_bfe_u32 s63, s99, 0x40010
    s_mul_i32 s63, s63, 128
    s_add_u32 s63, s63, s64
    s_add_u32 m0, s61, 28672
    v_mfma_f32_32x32x16_bf16 v[48:63], v[208:211], a[8:11], v[48:63]
    ds_read_b64_tr_b16 v[236:237], v23 offset:59392
    ds_read_b64_tr_b16 v[238:239], v23 offset:59904
    buffer_load_dwordx4 v16, s[12:15], s66 offen offset:0 lds
    s_add_u32 s95, s75, s76
    v_mfma_f32_32x32x16_bf16 v[64:79], v[212:215], a[8:11], v[64:79]
    buffer_load_dwordx4 v17, s[12:15], s66 offen offset:1024 lds
    s_add_u32 m0, s61, 30592
    s_lshl_b32 s75, s56, 5
    s_sub_u32 s95, s95, s75
    s_waitcnt lgkmcnt(4)
    v_mfma_f32_32x32x16_bf16 v[80:95], v[216:219], a[8:11], v[80:95]
    buffer_load_dwordx4 v16, s[12:15], s66 offen offset:128 lds
    s_waitcnt vmcnt(15) lgkmcnt(0)
    s_barrier
    ds_read_b128 a[16:19], v12 offset:4096
    ds_read_b128 a[20:23], v13 offset:4096
    ds_read_b128 a[24:27], v14 offset:4096
    ds_read_b128 a[28:31], v15 offset:4096
    v_mfma_f32_32x32x16_bf16 v[96:111], v[220:223], a[8:11], v[96:111]
    ds_read_b64_tr_b16 v[208:209], v20 offset:20480
    ds_read_b64_tr_b16 v[210:211], v20 offset:20992
    ds_read_b64_tr_b16 v[212:213], v21 offset:20480
    ds_read_b64_tr_b16 v[214:215], v21 offset:20992
    buffer_load_dwordx4 v17, s[12:15], s66 offen offset:1152 lds
    s_bfe_u32 s66, s99, 0x40010
    s_mul_i32 s66, s66, 245760
    s_add_u32 s66, s66, s67
    s_add_u32 m0, s61, 0
    v_mfma_f32_32x32x16_bf16 v[48:63], v[224:227], a[12:15], v[48:63]
    ds_read_b64_tr_b16 v[216:217], v20 offset:22528
    ds_read_b64_tr_b16 v[218:219], v20 offset:23040
    ds_read_b64_tr_b16 v[220:221], v21 offset:22528
    ds_read_b64_tr_b16 v[222:223], v21 offset:23040
    s_mul_i32 s97, s56, 96
    v_mfma_f32_32x32x16_bf16 v[64:79], v[228:231], a[12:15], v[64:79]
    ds_read_b64_tr_b16 v[224:225], v20 offset:61440
    ds_read_b64_tr_b16 v[226:227], v20 offset:61952
    s_sub_u32 s97, 384, s97
    s_lshl2_add_u32 s75, s59, s56
    s_mul_i32 s90, s75, 640
    v_mfma_f32_32x32x16_bf16 v[80:95], v[232:235], a[12:15], v[80:95]
    ds_read_b64_tr_b16 v[228:229], v21 offset:61440
    ds_read_b64_tr_b16 v[230:231], v21 offset:61952
    s_add_u32 s90, s90, 802816
    s_lshl_b32 s87, s75, 13
    s_add_u32 s87, s87, 409600
    v_mfma_f32_32x32x16_bf16 v[96:111], v[236:239], a[12:15], v[96:111]
    ds_read_b64_tr_b16 v[232:233], v20 offset:63488
    ds_read_b64_tr_b16 v[234:235], v20 offset:64000
    s_lshl2_add_u32 s75, s57, s56
    s_lshl_b32 s89, s75, 7
    s_waitcnt lgkmcnt(6)
    v_mfma_f32_32x32x16_bf16 v[48:63], v[208:211], a[16:19], v[48:63]
    ds_read_b64_tr_b16 v[236:237], v21 offset:63488
    ds_read_b64_tr_b16 v[238:239], v21 offset:64000
    s_add_u32 s89, s89, 786432
    s_lshl_b32 s88, s75, 10
    s_add_u32 s88, s88, 344704
    v_mfma_f32_32x32x16_bf16 v[64:79], v[212:215], a[16:19], v[64:79]
    ds_read_b64_tr_b16 v[208:209], v22 offset:20480
    ds_read_b64_tr_b16 v[210:211], v22 offset:20992
    buffer_load_dwordx4 v8, s[8:11], s63 offen offset:0 lds
    s_lshl1_add_u32 s92, s75, s59
    v_mfma_f32_32x32x16_bf16 v[80:95], v[216:219], a[16:19], v[80:95]
    ds_read_b64_tr_b16 v[212:213], v23 offset:20480
    ds_read_b64_tr_b16 v[214:215], v23 offset:20992
    s_lshl_b32 s92, s92, 11
    s_add_u32 s92, s92, 1048576
    s_lshr_b32 s75, s56, 1
    v_mfma_f32_32x32x16_bf16 v[96:111], v[220:223], a[16:19], v[96:111]
    ds_read_b64_tr_b16 v[216:217], v22 offset:22528
    ds_read_b64_tr_b16 v[218:219], v22 offset:23040
    buffer_load_dwordx4 v9, s[8:11], s63 offen offset:1024 lds
    s_waitcnt lgkmcnt(6)
    v_mfma_f32_32x32x16_bf16 v[48:63], v[224:227], a[20:23], v[48:63]
    ds_read_b64_tr_b16 v[220:221], v23 offset:22528
    ds_read_b64_tr_b16 v[222:223], v23 offset:23040
    s_lshl1_add_u32 s75, s57, s75
    s_and_b32 s76, s56, 1
    s_lshl1_add_u32 s76, s59, s76
    v_mfma_f32_32x32x16_bf16 v[64:79], v[228:231], a[20:23], v[64:79]
    ds_read_b64_tr_b16 v[224:225], v22 offset:61440
    ds_read_b64_tr_b16 v[226:227], v22 offset:61952
    buffer_load_dwordx4 v10, s[8:11], s63 offen offset:2048 lds
    s_lshl2_add_u32 s85, s75, s76
    v_mfma_f32_32x32x16_bf16 v[80:95], v[232:235], a[20:23], v[80:95]
    ds_read_b64_tr_b16 v[228:229], v23 offset:61440
    ds_read_b64_tr_b16 v[230:231], v23 offset:61952
    buffer_load_dwordx4 v11, s[8:11], s63 offen offset:3072 lds
    s_bfe_u32 s63, s99, 0x40014
    s_mul_i32 s63, s63, 128
    s_add_u32 s63, s63, s64
    s_add_u32 m0, s61, 32768
    v_mfma_f32_32x32x16_bf16 v[96:111], v[236:239], a[20:23], v[96:111]
    ds_read_b64_tr_b16 v[232:233], v22 offset:63488
    ds_read_b64_tr_b16 v[234:235], v22 offset:64000
    buffer_load_dwordx4 v16, s[12:15], s66 offen offset:0 lds
    s_waitcnt lgkmcnt(6)
    v_mfma_f32_32x32x16_bf16 v[48:63], v[208:211], a[24:27], v[48:63]
    ds_read_b64_tr_b16 v[236:237], v23 offset:63488
    ds_read_b64_tr_b16 v[238:239], v23 offset:64000
    buffer_load_dwordx4 v17, s[12:15], s66 offen offset:1024 lds
    s_add_u32 m0, s61, 34688
    v_mfma_f32_32x32x16_bf16 v[64:79], v[212:215], a[24:27], v[64:79]
    buffer_load_dwordx4 v16, s[12:15], s66 offen offset:128 lds
    s_lshl_b32 s85, s85, 7
    s_add_u32 s85, s85, 753664
    s_lshl_b32 s75, s75, 5
    s_add_u32 s75, s75, s76
    v_mfma_f32_32x32x16_bf16 v[80:95], v[216:219], a[24:27], v[80:95]
    buffer_load_dwordx4 v17, s[12:15], s66 offen offset:1152 lds
    s_waitcnt vmcnt(16) lgkmcnt(0)
    s_barrier
    ds_read_b128 a[32:35], v12 offset:8192
    ds_read_b128 a[36:39], v13 offset:8192
    ds_read_b128 a[40:43], v14 offset:8192
    ds_read_b128 a[44:47], v15 offset:8192
    v_mfma_f32_32x32x16_bf16 v[96:111], v[220:223], a[24:27], v[96:111]
    ds_read_b64_tr_b16 v[208:209], v20 offset:8192
    ds_read_b64_tr_b16 v[210:211], v20 offset:8704
    ds_read_b64_tr_b16 v[212:213], v21 offset:8192
    ds_read_b64_tr_b16 v[214:215], v21 offset:8704
    s_bfe_u32 s66, s99, 0x40014
    v_mfma_f32_32x32x16_bf16 v[48:63], v[224:227], a[28:31], v[48:63]
    ds_read_b64_tr_b16 v[216:217], v20 offset:10240
    ds_read_b64_tr_b16 v[218:219], v20 offset:10752
    ds_read_b64_tr_b16 v[220:221], v21 offset:10240
    ds_read_b64_tr_b16 v[222:223], v21 offset:10752
    s_mul_i32 s66, s66, 245760
    v_mfma_f32_32x32x16_bf16 v[64:79], v[228:231], a[28:31], v[64:79]
    ds_read_b64_tr_b16 v[224:225], v20 offset:49152
    ds_read_b64_tr_b16 v[226:227], v20 offset:49664
    s_add_u32 s66, s66, s67
    s_lshl_b32 s75, s75, 7
    s_add_u32 s84, s75, 478720
    v_mfma_f32_32x32x16_bf16 v[80:95], v[232:235], a[28:31], v[80:95]
    ds_read_b64_tr_b16 v[228:229], v21 offset:49152
    ds_read_b64_tr_b16 v[230:231], v21 offset:49664
    s_lshr_b32 s91, s98, 1
    s_mul_i32 s91, s91, 212992
    s_add_u32 s91, s91, 26214400
    v_mfma_f32_32x32x16_bf16 v[96:111], v[236:239], a[28:31], v[96:111]
    ds_read_b64_tr_b16 v[232:233], v20 offset:51200
    ds_read_b64_tr_b16 v[234:235], v20 offset:51712
    s_add_u32 m0, s61, 4096
    s_mul_i32 s93, s96, 245760
    s_waitcnt lgkmcnt(6)
    v_mfma_f32_32x32x16_bf16 v[48:63], v[208:211], a[32:35], v[48:63]
    ds_read_b64_tr_b16 v[236:237], v21 offset:51200
    ds_read_b64_tr_b16 v[238:239], v21 offset:51712
    buffer_load_dwordx4 v8, s[8:11], s63 offen offset:0 lds
    s_add_u32 s93, s93, 16777216
    v_mfma_f32_32x32x16_bf16 v[64:79], v[212:215], a[32:35], v[64:79]
    ds_read_b64_tr_b16 v[208:209], v22 offset:8192
    ds_read_b64_tr_b16 v[210:211], v22 offset:8704
    s_lshl4_add_u32 s94, s96, s98
    s_lshl_b32 s94, s94, 7
    s_add_u32 s94, s94, 606208
    v_mfma_f32_32x32x16_bf16 v[80:95], v[216:219], a[32:35], v[80:95]
    ds_read_b64_tr_b16 v[212:213], v23 offset:8192
    ds_read_b64_tr_b16 v[214:215], v23 offset:8704
    buffer_load_dwordx4 v9, s[8:11], s63 offen offset:1024 lds
    v_lshrrev_b32 v24, 5, v0
    v_mfma_f32_32x32x16_bf16 v[96:111], v[220:223], a[32:35], v[96:111]
    ds_read_b64_tr_b16 v[216:217], v22 offset:10240
    ds_read_b64_tr_b16 v[218:219], v22 offset:10752
    v_mov_b32 v27, 0x80000000
    v_and_b32 v39, 0x7c, v31
    s_waitcnt lgkmcnt(6)
    v_mfma_f32_32x32x16_bf16 v[48:63], v[224:227], a[36:39], v[48:63]
    ds_read_b64_tr_b16 v[220:221], v23 offset:10240
    ds_read_b64_tr_b16 v[222:223], v23 offset:10752
    buffer_load_dwordx4 v10, s[8:11], s63 offen offset:2048 lds
    v_bfe_u32 v1, v0, 2, 2
    v_mfma_f32_32x32x16_bf16 v[64:79], v[228:231], a[36:39], v[64:79]
    ds_read_b64_tr_b16 v[224:225], v22 offset:49152
    ds_read_b64_tr_b16 v[226:227], v22 offset:49664
    v_mul_u32_u24 v1, 160, v1
    v_add_u32 v1, s61, v1
    v_mul_u32_u24 v3, 1280, v24
    v_mfma_f32_32x32x16_bf16 v[80:95], v[232:235], a[36:39], v[80:95]
    ds_read_b64_tr_b16 v[228:229], v23 offset:49152
    ds_read_b64_tr_b16 v[230:231], v23 offset:49664
    buffer_load_dwordx4 v11, s[8:11], s63 offen offset:3072 lds
    s_bfe_u32 s63, s99, 0x40018
    s_mul_i32 s63, s63, 128
    s_add_u32 s63, s63, s64
    s_add_u32 m0, s61, 36864
    v_mfma_f32_32x32x16_bf16 v[96:111], v[236:239], a[36:39], v[96:111]
    ds_read_b64_tr_b16 v[232:233], v22 offset:51200
    ds_read_b64_tr_b16 v[234:235], v22 offset:51712
    buffer_load_dwordx4 v16, s[12:15], s66 offen offset:0 lds
    s_waitcnt lgkmcnt(6)
    v_mfma_f32_32x32x16_bf16 v[48:63], v[208:211], a[40:43], v[48:63]
    ds_read_b64_tr_b16 v[236:237], v23 offset:51200
    ds_read_b64_tr_b16 v[238:239], v23 offset:51712
    buffer_load_dwordx4 v17, s[12:15], s66 offen offset:1024 lds
    s_add_u32 m0, s61, 38784
    v_mfma_f32_32x32x16_bf16 v[64:79], v[212:215], a[40:43], v[64:79]
    buffer_load_dwordx4 v16, s[12:15], s66 offen offset:128 lds
    v_and_b32 v4, 3, v0
    v_bfe_u32 v5, v0, 4, 1
    v_lshl_add_u32 v253, v5, 3, v1
    v_lshl_add_u32 v253, v4, 4, v253
    v_mfma_f32_32x32x16_bf16 v[80:95], v[216:219], a[40:43], v[80:95]
    buffer_load_dwordx4 v17, s[12:15], s66 offen offset:1152 lds
    s_waitcnt vmcnt(16) lgkmcnt(0)
    s_barrier
    ds_read_b128 a[48:51], v12 offset:12288
    ds_read_b128 a[52:55], v13 offset:12288
    ds_read_b128 a[56:59], v14 offset:12288
    ds_read_b128 a[60:63], v15 offset:12288
    v_mfma_f32_32x32x16_bf16 v[96:111], v[220:223], a[40:43], v[96:111]
    ds_read_b64_tr_b16 v[208:209], v20 offset:12288
    ds_read_b64_tr_b16 v[210:211], v20 offset:12800
    ds_read_b64_tr_b16 v[212:213], v21 offset:12288
    ds_read_b64_tr_b16 v[214:215], v21 offset:12800
    s_bfe_u32 s66, s99, 0x40018
    v_mfma_f32_32x32x16_bf16 v[48:63], v[224:227], a[44:47], v[48:63]
    ds_read_b64_tr_b16 v[216:217], v20 offset:14336
    ds_read_b64_tr_b16 v[218:219], v20 offset:14848
    ds_read_b64_tr_b16 v[220:221], v21 offset:14336
    ds_read_b64_tr_b16 v[222:223], v21 offset:14848
    s_mul_i32 s66, s66, 245760
    v_mfma_f32_32x32x16_bf16 v[64:79], v[228:231], a[44:47], v[64:79]
    ds_read_b64_tr_b16 v[224:225], v20 offset:53248
    ds_read_b64_tr_b16 v[226:227], v20 offset:53760
    s_add_u32 s66, s66, s67
    s_add_u32 m0, s61, 8192
    v_lshl_add_u32 v254, v4, 3, v1
    v_mfma_f32_32x32x16_bf16 v[80:95], v[232:235], a[44:47], v[80:95]
    ds_read_b64_tr_b16 v[228:229], v21 offset:53248
    ds_read_b64_tr_b16 v[230:231], v21 offset:53760
    v_add_u32 v251, v253, v3
    v_add_u32 v252, v254, v3
    v_cmp_eq_u32 s[82:83], 0, v5
    v_mfma_f32_32x32x16_bf16 v[96:111], v[236:239], a[44:47], v[96:111]
    ds_read_b64_tr_b16 v[232:233], v20 offset:55296
    ds_read_b64_tr_b16 v[234:235], v20 offset:55808
    buffer_load_dwordx4 v8, s[8:11], s63 offen offset:0 lds
    s_waitcnt lgkmcnt(6)
    v_mfma_f32_32x32x16_bf16 v[48:63], v[208:211], a[48:51], v[48:63]
    ds_read_b64_tr_b16 v[236:237], v21 offset:55296
    ds_read_b64_tr_b16 v[238:239], v21 offset:55808
    s_mul_i32 s75, s98, 5
    v_and_b32 v1, 15, v0
    v_lshlrev_b32 v1, 4, v1
    v_mfma_f32_32x32x16_bf16 v[64:79], v[212:215], a[48:51], v[64:79]
    ds_read_b64_tr_b16 v[208:209], v22 offset:12288
    ds_read_b64_tr_b16 v[210:211], v22 offset:12800
    buffer_load_dwordx4 v9, s[8:11], s63 offen offset:1024 lds
    v_lshl_add_u32 v1, v5, 10, v1
    v_mfma_f32_32x32x16_bf16 v[80:95], v[216:219], a[48:51], v[80:95]
    ds_read_b64_tr_b16 v[212:213], v23 offset:12288
    ds_read_b64_tr_b16 v[214:215], v23 offset:12800
    v_add_u32 v3, s75, v24
    v_add_u32 v3, 0, v3
    v_lshrrev_b32 v4, 2, v3
    v_mfma_f32_32x32x16_bf16 v[96:111], v[220:223], a[48:51], v[96:111]
    ds_read_b64_tr_b16 v[216:217], v22 offset:14336
    ds_read_b64_tr_b16 v[218:219], v22 offset:14848
    buffer_load_dwordx4 v10, s[8:11], s63 offen offset:2048 lds
    s_waitcnt lgkmcnt(6)
    v_mfma_f32_32x32x16_bf16 v[48:63], v[224:227], a[52:55], v[48:63]
    ds_read_b64_tr_b16 v[220:221], v23 offset:14336
    ds_read_b64_tr_b16 v[222:223], v23 offset:14848
    v_mul_u32_u24 v4, 5120, v4
    v_and_b32 v3, 3, v3
    v_lshl_add_u32 v3, v3, 8, v1
    v_mfma_f32_32x32x16_bf16 v[64:79], v[228:231], a[52:55], v[64:79]
    ds_read_b64_tr_b16 v[224:225], v22 offset:53248
    ds_read_b64_tr_b16 v[226:227], v22 offset:53760
    buffer_load_dwordx4 v11, s[8:11], s63 offen offset:3072 lds
    s_bfe_u32 s63, s99, 0x4001c
    v_mfma_f32_32x32x16_bf16 v[80:95], v[232:235], a[52:55], v[80:95]
    ds_read_b64_tr_b16 v[228:229], v23 offset:53248
    ds_read_b64_tr_b16 v[230:231], v23 offset:53760
    s_mul_i32 s63, s63, 128
    s_add_u32 s63, s63, s64
    s_add_u32 m0, s61, 24576
    v_add_u32 v248, v3, v4
    v_add_u32 v3, s75, v24
    v_mfma_f32_32x32x16_bf16 v[96:111], v[236:239], a[52:55], v[96:111]
    ds_read_b64_tr_b16 v[232:233], v22 offset:55296
    ds_read_b64_tr_b16 v[234:235], v22 offset:55808
    buffer_load_dwordx4 v16, s[12:15], s66 offen offset:0 lds
    s_waitcnt lgkmcnt(6)
    v_mfma_f32_32x32x16_bf16 v[48:63], v[208:211], a[56:59], v[48:63]
    ds_read_b64_tr_b16 v[236:237], v23 offset:55296
    ds_read_b64_tr_b16 v[238:239], v23 offset:55808
    buffer_load_dwordx4 v17, s[12:15], s66 offen offset:1024 lds
    s_add_u32 m0, s61, 26496
    v_mfma_f32_32x32x16_bf16 v[64:79], v[212:215], a[56:59], v[64:79]
    buffer_load_dwordx4 v16, s[12:15], s66 offen offset:128 lds
    v_add_u32 v3, 2, v3
    v_lshrrev_b32 v4, 2, v3
    v_mul_u32_u24 v4, 5120, v4
    v_and_b32 v3, 3, v3
    v_mfma_f32_32x32x16_bf16 v[80:95], v[216:219], a[56:59], v[80:95]
    buffer_load_dwordx4 v17, s[12:15], s66 offen offset:1152 lds
    s_waitcnt vmcnt(16) lgkmcnt(0)
    s_barrier
    ds_read_b128 a[64:67], v12 offset:0
    ds_read_b128 a[68:71], v13 offset:0
    ds_read_b128 a[72:75], v14 offset:0
    ds_read_b128 a[76:79], v15 offset:0
    v_mfma_f32_32x32x16_bf16 v[96:111], v[220:223], a[56:59], v[96:111]
    ds_read_b64_tr_b16 v[208:209], v20 offset:16384
    ds_read_b64_tr_b16 v[210:211], v20 offset:16896
    ds_read_b64_tr_b16 v[212:213], v21 offset:16384
    ds_read_b64_tr_b16 v[214:215], v21 offset:16896
    s_bfe_u32 s66, s99, 0x4001c
    v_mfma_f32_32x32x16_bf16 v[48:63], v[224:227], a[60:63], v[48:63]
    ds_read_b64_tr_b16 v[216:217], v20 offset:18432
    ds_read_b64_tr_b16 v[218:219], v20 offset:18944
    ds_read_b64_tr_b16 v[220:221], v21 offset:18432
    ds_read_b64_tr_b16 v[222:223], v21 offset:18944
    s_mul_i32 s66, s66, 245760
    v_mfma_f32_32x32x16_bf16 v[64:79], v[228:231], a[60:63], v[64:79]
    ds_read_b64_tr_b16 v[224:225], v20 offset:57344
    ds_read_b64_tr_b16 v[226:227], v20 offset:57856
    s_add_u32 s66, s66, s67
    s_add_u32 m0, s61, 12288
    v_lshl_add_u32 v3, v3, 8, v1
    v_mfma_f32_32x32x16_bf16 v[80:95], v[232:235], a[60:63], v[80:95]
    ds_read_b64_tr_b16 v[228:229], v21 offset:57344
    ds_read_b64_tr_b16 v[230:231], v21 offset:57856
    buffer_load_dwordx4 v8, s[8:11], s63 offen offset:0 lds
    v_add_u32 v249, v3, v4
    v_mfma_f32_32x32x16_bf16 v[96:111], v[236:239], a[60:63], v[96:111]
    ds_read_b64_tr_b16 v[232:233], v20 offset:59392
    ds_read_b64_tr_b16 v[234:235], v20 offset:59904
    v_add_u32 v3, s75, v24
    v_add_u32 v3, 4, v3
    s_waitcnt lgkmcnt(6)
    v_mfma_f32_32x32x16_bf16 v[48:63], v[208:211], a[64:67], v[48:63]
    ds_read_b64_tr_b16 v[236:237], v21 offset:59392
    ds_read_b64_tr_b16 v[238:239], v21 offset:59904
    buffer_load_dwordx4 v9, s[8:11], s63 offen offset:1024 lds
    v_lshrrev_b32 v4, 2, v3
    v_mfma_f32_32x32x16_bf16 v[64:79], v[212:215], a[64:67], v[64:79]
    ds_read_b64_tr_b16 v[208:209], v22 offset:16384
    ds_read_b64_tr_b16 v[210:211], v22 offset:16896
    v_mul_u32_u24 v4, 5120, v4
    v_and_b32 v3, 3, v3
    v_lshl_add_u32 v3, v3, 8, v1
    v_mfma_f32_32x32x16_bf16 v[80:95], v[216:219], a[64:67], v[80:95]
    ds_read_b64_tr_b16 v[212:213], v23 offset:16384
    ds_read_b64_tr_b16 v[214:215], v23 offset:16896
    buffer_load_dwordx4 v10, s[8:11], s63 offen offset:2048 lds
    v_add_u32 v250, v3, v4
    v_mfma_f32_32x32x16_bf16 v[96:111], v[220:223], a[64:67], v[96:111]
    ds_read_b64_tr_b16 v[216:217], v22 offset:18432
    ds_read_b64_tr_b16 v[218:219], v22 offset:18944
    v_cmp_gt_u32 vcc, 32, v0
    s_nop 1
    v_cndmask_b32 v250, v27, v250, vcc
    s_waitcnt lgkmcnt(6)
    v_mfma_f32_32x32x16_bf16 v[48:63], v[224:227], a[68:71], v[48:63]
    ds_read_b64_tr_b16 v[220:221], v23 offset:18432
    ds_read_b64_tr_b16 v[222:223], v23 offset:18944
    buffer_load_dwordx4 v11, s[8:11], s63 offen offset:3072 lds
    s_bfe_u32 s63, s65, 0x40000
    v_mfma_f32_32x32x16_bf16 v[64:79], v[228:231], a[68:71], v[64:79]
    ds_read_b64_tr_b16 v[224:225], v22 offset:57344
    ds_read_b64_tr_b16 v[226:227], v22 offset:57856
    s_mul_i32 s63, s63, 128
    s_add_u32 s63, s63, s64
    s_add_u32 m0, s61, 28672
    v_mfma_f32_32x32x16_bf16 v[80:95], v[232:235], a[68:71], v[80:95]
    ds_read_b64_tr_b16 v[228:229], v23 offset:57344
    ds_read_b64_tr_b16 v[230:231], v23 offset:57856
    buffer_load_dwordx4 v16, s[12:15], s66 offen offset:0 lds
    s_mul_i32 s75, s56, 50
    v_mfma_f32_32x32x16_bf16 v[96:111], v[236:239], a[68:71], v[96:111]
    ds_read_b64_tr_b16 v[232:233], v22 offset:59392
    ds_read_b64_tr_b16 v[234:235], v22 offset:59904
    buffer_load_dwordx4 v17, s[12:15], s66 offen offset:1024 lds
    s_add_u32 m0, s61, 30592
    s_waitcnt lgkmcnt(6)
    v_mfma_f32_32x32x16_bf16 v[48:63], v[208:211], a[72:75], v[48:63]
    ds_read_b64_tr_b16 v[236:237], v23 offset:59392
    ds_read_b64_tr_b16 v[238:239], v23 offset:59904
    buffer_load_dwordx4 v16, s[12:15], s66 offen offset:128 lds
    s_and_b32 s76, s98, 1
    v_mfma_f32_32x32x16_bf16 v[64:79], v[212:215], a[72:75], v[64:79]
    buffer_load_dwordx4 v17, s[12:15], s66 offen offset:1152 lds
    s_bfe_u32 s66, s65, 0x40000
    s_mul_i32 s66, s66, 245760
    s_add_u32 s66, s66, s67
    s_mul_i32 s76, s76, 40
    v_mfma_f32_32x32x16_bf16 v[80:95], v[216:219], a[72:75], v[80:95]
    v_add_u32 v1, s75, v0
    v_mul_u32_u24 v3, 0xccd, v1
    s_waitcnt vmcnt(16) lgkmcnt(0)
    s_barrier
    ds_read_b128 a[80:83], v12 offset:4096
    ds_read_b128 a[84:87], v13 offset:4096
    ds_read_b128 a[88:91], v14 offset:4096
    ds_read_b128 a[92:95], v15 offset:4096
    v_mfma_f32_32x32x16_bf16 v[96:111], v[220:223], a[72:75], v[96:111]
    ds_read_b64_tr_b16 v[208:209], v20 offset:20480
    ds_read_b64_tr_b16 v[210:211], v20 offset:20992
    ds_read_b64_tr_b16 v[212:213], v21 offset:20480
    ds_read_b64_tr_b16 v[214:215], v21 offset:20992
    s_add_u32 m0, s61, 0
    v_mfma_f32_32x32x16_bf16 v[48:63], v[224:227], a[76:79], v[48:63]
    ds_read_b64_tr_b16 v[216:217], v20 offset:22528
    ds_read_b64_tr_b16 v[218:219], v20 offset:23040
    ds_read_b64_tr_b16 v[220:221], v21 offset:22528
    ds_read_b64_tr_b16 v[222:223], v21 offset:23040
    v_lshrrev_b32 v3, 16, v3
    v_mfma_f32_32x32x16_bf16 v[64:79], v[228:231], a[76:79], v[64:79]
    ds_read_b64_tr_b16 v[224:225], v20 offset:61440
    ds_read_b64_tr_b16 v[226:227], v20 offset:61952
    buffer_load_dwordx4 v8, s[8:11], s63 offen offset:0 lds
    v_mul_u32_u24 v4, 20, v3
    v_mfma_f32_32x32x16_bf16 v[80:95], v[232:235], a[76:79], v[80:95]
    ds_read_b64_tr_b16 v[228:229], v21 offset:61440
    ds_read_b64_tr_b16 v[230:231], v21 offset:61952
    v_sub_u32 v1, v1, v4
    v_cmp_lt_u32 vcc, 4, v3
    s_nop 1
    v_cndmask_b32_e64 v4, 0, 20, vcc
    v_mfma_f32_32x32x16_bf16 v[96:111], v[236:239], a[76:79], v[96:111]
    ds_read_b64_tr_b16 v[232:233], v20 offset:63488
    ds_read_b64_tr_b16 v[234:235], v20 offset:64000
    buffer_load_dwordx4 v9, s[8:11], s63 offen offset:1024 lds
    s_waitcnt lgkmcnt(6)
    v_mfma_f32_32x32x16_bf16 v[48:63], v[208:211], a[80:83], v[48:63]
    ds_read_b64_tr_b16 v[236:237], v21 offset:63488
    ds_read_b64_tr_b16 v[238:239], v21 offset:64000
    v_add_u32 v1, v1, v4
    v_mul_u32_u24 v33, 96, v1
    v_lshl_add_u32 v33, v3, 3, v33
    v_mfma_f32_32x32x16_bf16 v[64:79], v[212:215], a[80:83], v[64:79]
    ds_read_b64_tr_b16 v[208:209], v22 offset:20480
    ds_read_b64_tr_b16 v[210:211], v22 offset:20992
    buffer_load_dwordx4 v10, s[8:11], s63 offen offset:2048 lds
    v_add_u32 v1, s76, v1
    v_mfma_f32_32x32x16_bf16 v[80:95], v[216:219], a[80:83], v[80:95]
    ds_read_b64_tr_b16 v[212:213], v23 offset:20480
    ds_read_b64_tr_b16 v[214:215], v23 offset:20992
    v_lshl_add_u32 v3, v3, 2, s76
    v_lshrrev_b32 v4, 4, v1
    v_lshlrev_b32 v3, 6, v3
    v_mfma_f32_32x32x16_bf16 v[96:111], v[220:223], a[80:83], v[96:111]
    ds_read_b64_tr_b16 v[216:217], v22 offset:22528
    ds_read_b64_tr_b16 v[218:219], v22 offset:23040
    buffer_load_dwordx4 v11, s[8:11], s63 offen offset:3072 lds
    s_waitcnt lgkmcnt(6)
    v_mfma_f32_32x32x16_bf16 v[48:63], v[224:227], a[84:87], v[48:63]
    ds_read_b64_tr_b16 v[220:221], v23 offset:22528
    ds_read_b64_tr_b16 v[222:223], v23 offset:23040
    s_bfe_u32 s63, s65, 0x40004
    s_mul_i32 s63, s63, 128
    s_add_u32 s63, s63, s64
    v_mfma_f32_32x32x16_bf16 v[64:79], v[228:231], a[84:87], v[64:79]
    ds_read_b64_tr_b16 v[224:225], v22 offset:61440
    ds_read_b64_tr_b16 v[226:227], v22 offset:61952
    s_add_u32 m0, s61, 32768
    v_lshl_add_u32 v3, v4, 11, v3
    v_and_b32 v1, 15, v1
    v_mfma_f32_32x32x16_bf16 v[80:95], v[232:235], a[84:87], v[80:95]
    ds_read_b64_tr_b16 v[228:229], v23 offset:61440
    ds_read_b64_tr_b16 v[230:231], v23 offset:61952
    buffer_load_dwordx4 v16, s[12:15], s66 offen offset:0 lds
    v_lshl_add_u32 v32, v1, 4, v3
    v_mfma_f32_32x32x16_bf16 v[96:111], v[236:239], a[84:87], v[96:111]
    ds_read_b64_tr_b16 v[232:233], v22 offset:63488
    ds_read_b64_tr_b16 v[234:235], v22 offset:64000
    buffer_load_dwordx4 v17, s[12:15], s66 offen offset:1024 lds
    s_add_u32 m0, s61, 34688
    s_waitcnt lgkmcnt(6)
    v_mfma_f32_32x32x16_bf16 v[48:63], v[208:211], a[88:91], v[48:63]
    ds_read_b64_tr_b16 v[236:237], v23 offset:63488
    ds_read_b64_tr_b16 v[238:239], v23 offset:64000
    buffer_load_dwordx4 v16, s[12:15], s66 offen offset:128 lds
    v_mov_b32 v1, 3840
    v_mfma_f32_32x32x16_bf16 v[64:79], v[212:215], a[88:91], v[64:79]
    buffer_load_dwordx4 v17, s[12:15], s66 offen offset:1152 lds
    s_bfe_u32 s66, s65, 0x40004
    s_mul_i32 s66, s66, 245760
    s_add_u32 s66, s66, s67
    v_cmp_gt_u32 vcc, 50, v0
    s_nop 1
    v_cndmask_b32 v32, v27, v32, vcc
    v_cndmask_b32 v33, v1, v33, vcc
    v_mfma_f32_32x32x16_bf16 v[80:95], v[216:219], a[88:91], v[80:95]
    v_and_b32 v1, 0x13, v0
    v_bfe_u32 v3, v0, 2, 1
    s_waitcnt vmcnt(16) lgkmcnt(0)
    s_barrier
    ds_read_b128 a[96:99], v12 offset:8192
    ds_read_b128 a[100:103], v13 offset:8192
    ds_read_b128 a[104:107], v14 offset:8192
    ds_read_b128 a[108:111], v15 offset:8192
    v_mfma_f32_32x32x16_bf16 v[96:111], v[220:223], a[88:91], v[96:111]
    ds_read_b64_tr_b16 v[208:209], v20 offset:8192
    ds_read_b64_tr_b16 v[210:211], v20 offset:8704
    ds_read_b64_tr_b16 v[212:213], v21 offset:8192
    ds_read_b64_tr_b16 v[214:215], v21 offset:8704
    s_add_u32 m0, s61, 4096
    v_mfma_f32_32x32x16_bf16 v[48:63], v[224:227], a[92:95], v[48:63]
    ds_read_b64_tr_b16 v[216:217], v20 offset:10240
    ds_read_b64_tr_b16 v[218:219], v20 offset:10752
    ds_read_b64_tr_b16 v[220:221], v21 offset:10240
    ds_read_b64_tr_b16 v[222:223], v21 offset:10752
    v_lshl_or_b32 v1, v3, 3, v1
    v_mfma_f32_32x32x16_bf16 v[64:79], v[228:231], a[92:95], v[64:79]
    ds_read_b64_tr_b16 v[224:225], v20 offset:49152
    ds_read_b64_tr_b16 v[226:227], v20 offset:49664
    buffer_load_dwordx4 v8, s[8:11], s63 offen offset:0 lds
    v_bfe_u32 v4, v0, 3, 1
    v_mfma_f32_32x32x16_bf16 v[80:95], v[232:235], a[92:95], v[80:95]
    ds_read_b64_tr_b16 v[228:229], v21 offset:49152
    ds_read_b64_tr_b16 v[230:231], v21 offset:49664
    v_lshl_or_b32 v1, v4, 2, v1
    v_mul_u32_u24 v34, 96, v1
    v_lshl_add_u32 v34, v24, 4, v34
    v_mfma_f32_32x32x16_bf16 v[96:111], v[236:239], a[92:95], v[96:111]
    ds_read_b64_tr_b16 v[232:233], v20 offset:51200
    ds_read_b64_tr_b16 v[234:235], v20 offset:51712
    buffer_load_dwordx4 v9, s[8:11], s63 offen offset:1024 lds
    s_waitcnt lgkmcnt(6)
    v_mfma_f32_32x32x16_bf16 v[48:63], v[208:211], a[96:99], v[48:63]
    ds_read_b64_tr_b16 v[236:237], v21 offset:51200
    ds_read_b64_tr_b16 v[238:239], v21 offset:51712
    v_and_b32 v1, 7, v1
    v_mul_u32_u24 v35, 96, v1
    v_lshl_add_u32 v35, v24, 4, v35
    v_mfma_f32_32x32x16_bf16 v[64:79], v[212:215], a[96:99], v[64:79]
    ds_read_b64_tr_b16 v[208:209], v22 offset:8192
    ds_read_b64_tr_b16 v[210:211], v22 offset:8704
    buffer_load_dwordx4 v10, s[8:11], s63 offen offset:2048 lds
    v_lshl_or_b32 v1, v1, 1, v3
    v_mfma_f32_32x32x16_bf16 v[80:95], v[216:219], a[96:99], v[80:95]
    ds_read_b64_tr_b16 v[212:213], v23 offset:8192
    ds_read_b64_tr_b16 v[214:215], v23 offset:8704
    v_mul_u32_u24 v38, 656, v1
    v_lshl_add_u32 v38, v24, 4, v38
    v_and_b32 v1, 31, v0
    v_mfma_f32_32x32x16_bf16 v[96:111], v[220:223], a[96:99], v[96:111]
    ds_read_b64_tr_b16 v[216:217], v22 offset:10240
    ds_read_b64_tr_b16 v[218:219], v22 offset:10752
    buffer_load_dwordx4 v11, s[8:11], s63 offen offset:3072 lds
    s_waitcnt lgkmcnt(6)
    v_mfma_f32_32x32x16_bf16 v[48:63], v[224:227], a[100:103], v[48:63]
    ds_read_b64_tr_b16 v[220:221], v23 offset:10240
    ds_read_b64_tr_b16 v[222:223], v23 offset:10752
    s_add_u32 m0, s61, 36864
    v_mul_u32_u24 v3, 5120, v24
    v_lshl_add_u32 v3, v1, 4, v3
    v_mfma_f32_32x32x16_bf16 v[64:79], v[228:231], a[100:103], v[64:79]
    ds_read_b64_tr_b16 v[224:225], v22 offset:49152
    ds_read_b64_tr_b16 v[226:227], v22 offset:49664
    buffer_load_dwordx4 v16, s[12:15], s66 offen offset:0 lds
    v_lshrrev_b32 v4, 2, v1
    v_mfma_f32_32x32x16_bf16 v[80:95], v[232:235], a[100:103], v[80:95]
    ds_read_b64_tr_b16 v[228:229], v23 offset:49152
    ds_read_b64_tr_b16 v[230:231], v23 offset:49664
    buffer_load_dwordx4 v17, s[12:15], s66 offen offset:1024 lds
    s_add_u32 m0, s61, 38784
    v_mfma_f32_32x32x16_bf16 v[96:111], v[236:239], a[100:103], v[96:111]
    ds_read_b64_tr_b16 v[232:233], v22 offset:51200
    ds_read_b64_tr_b16 v[234:235], v22 offset:51712
    buffer_load_dwordx4 v16, s[12:15], s66 offen offset:128 lds
    s_waitcnt lgkmcnt(6)
    v_mfma_f32_32x32x16_bf16 v[48:63], v[208:211], a[104:107], v[48:63]
    ds_read_b64_tr_b16 v[236:237], v23 offset:51200
    ds_read_b64_tr_b16 v[238:239], v23 offset:51712
    buffer_load_dwordx4 v17, s[12:15], s66 offen offset:1152 lds
    s_add_u32 m0, s61, 16384
    v_mfma_f32_32x32x16_bf16 v[64:79], v[212:215], a[104:107], v[64:79]
    v_lshl_add_u32 v36, v4, 6, v3
    v_mul_u32_u24 v3, 0x3334, v1
    v_lshrrev_b32 v3, 16, v3
    v_mul_u32_u24 v3, 656, v3
    v_lshl_add_u32 v3, v1, 3, v3
    s_mul_i32 s75, s56, 2784
    v_mfma_f32_32x32x16_bf16 v[80:95], v[216:219], a[104:107], v[80:95]
    v_lshl_add_u32 v3, v24, 2, v3
    v_add_u32 v37, s75, v3
    s_waitcnt vmcnt(16) lgkmcnt(0)
    s_barrier
    ds_read_b128 a[112:115], v12 offset:12288
    ds_read_b128 a[116:119], v13 offset:12288
    ds_read_b128 a[120:123], v14 offset:12288
    ds_read_b128 a[124:127], v15 offset:12288
    v_mfma_f32_32x32x16_bf16 v[96:111], v[220:223], a[104:107], v[96:111]
    ds_read_b64_tr_b16 v[208:209], v20 offset:12288
    ds_read_b64_tr_b16 v[210:211], v20 offset:12800
    ds_read_b64_tr_b16 v[212:213], v21 offset:12288
    ds_read_b64_tr_b16 v[214:215], v21 offset:12800
    v_mov_b32 v3, 10496
    v_mfma_f32_32x32x16_bf16 v[48:63], v[224:227], a[108:111], v[48:63]
    ds_read_b64_tr_b16 v[216:217], v20 offset:14336
    ds_read_b64_tr_b16 v[218:219], v20 offset:14848
    ds_read_b64_tr_b16 v[220:221], v21 offset:14336
    ds_read_b64_tr_b16 v[222:223], v21 offset:14848
    v_cmp_gt_u32 vcc, 20, v1
    s_nop 1
    v_cndmask_b32 v36, v27, v36, vcc
    v_cndmask_b32 v37, v3, v37, vcc
    v_mfma_f32_32x32x16_bf16 v[64:79], v[228:231], a[108:111], v[64:79]
    ds_read_b64_tr_b16 v[224:225], v20 offset:53248
    ds_read_b64_tr_b16 v[226:227], v20 offset:53760
    buffer_load_dwordx4 v16, s[12:15], s71 offen offset:0 lds
    v_mfma_f32_32x32x16_bf16 v[80:95], v[232:235], a[108:111], v[80:95]
    ds_read_b64_tr_b16 v[228:229], v21 offset:53248
    ds_read_b64_tr_b16 v[230:231], v21 offset:53760
    v_mfma_f32_32x32x16_bf16 v[96:111], v[236:239], a[108:111], v[96:111]
    ds_read_b64_tr_b16 v[232:233], v20 offset:55296
    ds_read_b64_tr_b16 v[234:235], v20 offset:55808
    buffer_load_dwordx4 v17, s[12:15], s71 offen offset:1024 lds
    s_waitcnt lgkmcnt(6)
    v_mfma_f32_32x32x16_bf16 v[48:63], v[208:211], a[112:115], v[48:63]
    ds_read_b64_tr_b16 v[236:237], v21 offset:55296
    ds_read_b64_tr_b16 v[238:239], v21 offset:55808
    s_add_u32 m0, s61, 18304
    v_mfma_f32_32x32x16_bf16 v[64:79], v[212:215], a[112:115], v[64:79]
    ds_read_b64_tr_b16 v[208:209], v22 offset:12288
    ds_read_b64_tr_b16 v[210:211], v22 offset:12800
    buffer_load_dwordx4 v16, s[12:15], s71 offen offset:128 lds
    v_mfma_f32_32x32x16_bf16 v[80:95], v[216:219], a[112:115], v[80:95]
    ds_read_b64_tr_b16 v[212:213], v23 offset:12288
    ds_read_b64_tr_b16 v[214:215], v23 offset:12800
    v_mfma_f32_32x32x16_bf16 v[96:111], v[220:223], a[112:115], v[96:111]
    ds_read_b64_tr_b16 v[216:217], v22 offset:14336
    ds_read_b64_tr_b16 v[218:219], v22 offset:14848
    buffer_load_dwordx4 v17, s[12:15], s71 offen offset:1152 lds
    s_waitcnt lgkmcnt(6)
    v_mfma_f32_32x32x16_bf16 v[48:63], v[224:227], a[116:119], v[48:63]
    ds_read_b64_tr_b16 v[220:221], v23 offset:14336
    ds_read_b64_tr_b16 v[222:223], v23 offset:14848
    s_add_u32 m0, s61, 20224
    v_mfma_f32_32x32x16_bf16 v[64:79], v[228:231], a[116:119], v[64:79]
    ds_read_b64_tr_b16 v[224:225], v22 offset:53248
    ds_read_b64_tr_b16 v[226:227], v22 offset:53760
    buffer_load_dwordx4 v16, s[12:15], s71 offen offset:256 lds
    v_mfma_f32_32x32x16_bf16 v[80:95], v[232:235], a[116:119], v[80:95]
    ds_read_b64_tr_b16 v[228:229], v23 offset:53248
    ds_read_b64_tr_b16 v[230:231], v23 offset:53760
    v_mfma_f32_32x32x16_bf16 v[96:111], v[236:239], a[116:119], v[96:111]
    ds_read_b64_tr_b16 v[232:233], v22 offset:55296
    ds_read_b64_tr_b16 v[234:235], v22 offset:55808
    buffer_load_dwordx4 v17, s[12:15], s71 offen offset:1280 lds
    s_waitcnt lgkmcnt(6)
    v_mfma_f32_32x32x16_bf16 v[48:63], v[208:211], a[120:123], v[48:63]
    ds_read_b64_tr_b16 v[236:237], v23 offset:55296
    ds_read_b64_tr_b16 v[238:239], v23 offset:55808
    s_bfe_u32 s71, s99, 0x40004
    s_mul_i32 s71, s71, 245760
    s_add_u32 s71, s71, s72
    v_mfma_f32_32x32x16_bf16 v[64:79], v[212:215], a[120:123], v[64:79]
    s_add_u32 m0, s61, 22528
    v_mfma_f32_32x32x16_bf16 v[80:95], v[216:219], a[120:123], v[80:95]
    buffer_load_dwordx4 v16, s[12:15], s71 offen offset:0 lds
    s_waitcnt vmcnt(15) lgkmcnt(0)
    s_barrier
    ds_read_b128 a[128:131], v12 offset:0
    ds_read_b128 a[132:135], v13 offset:0
    ds_read_b128 a[136:139], v14 offset:0
    ds_read_b128 a[140:143], v15 offset:0
    v_mfma_f32_32x32x16_bf16 v[96:111], v[220:223], a[120:123], v[96:111]
    ds_read_b64_tr_b16 v[208:209], v20 offset:16384
    ds_read_b64_tr_b16 v[210:211], v20 offset:16896
    ds_read_b64_tr_b16 v[212:213], v21 offset:16384
    ds_read_b64_tr_b16 v[214:215], v21 offset:16896
    v_mfma_f32_32x32x16_bf16 v[48:63], v[224:227], a[124:127], v[48:63]
    ds_read_b64_tr_b16 v[216:217], v20 offset:18432
    ds_read_b64_tr_b16 v[218:219], v20 offset:18944
    ds_read_b64_tr_b16 v[220:221], v21 offset:18432
    ds_read_b64_tr_b16 v[222:223], v21 offset:18944
    v_mfma_f32_32x32x16_bf16 v[64:79], v[228:231], a[124:127], v[64:79]
    ds_read_b64_tr_b16 v[224:225], v20 offset:57344
    ds_read_b64_tr_b16 v[226:227], v20 offset:57856
    buffer_load_dwordx4 v17, s[12:15], s71 offen offset:1024 lds
    v_mfma_f32_32x32x16_bf16 v[80:95], v[232:235], a[124:127], v[80:95]
    ds_read_b64_tr_b16 v[228:229], v21 offset:57344
    ds_read_b64_tr_b16 v[230:231], v21 offset:57856
    s_add_u32 m0, s61, 24448
    v_mfma_f32_32x32x16_bf16 v[96:111], v[236:239], a[124:127], v[96:111]
    ds_read_b64_tr_b16 v[232:233], v20 offset:59392
    ds_read_b64_tr_b16 v[234:235], v20 offset:59904
    buffer_load_dwordx4 v16, s[12:15], s71 offen offset:128 lds
    s_waitcnt lgkmcnt(6)
    v_mfma_f32_32x32x16_bf16 v[48:63], v[208:211], a[128:131], v[48:63]
    ds_read_b64_tr_b16 v[236:237], v21 offset:59392
    ds_read_b64_tr_b16 v[238:239], v21 offset:59904
    v_mfma_f32_32x32x16_bf16 v[64:79], v[212:215], a[128:131], v[64:79]
    ds_read_b64_tr_b16 v[208:209], v22 offset:16384
    ds_read_b64_tr_b16 v[210:211], v22 offset:16896
    buffer_load_dwordx4 v17, s[12:15], s71 offen offset:1152 lds
    v_mfma_f32_32x32x16_bf16 v[80:95], v[216:219], a[128:131], v[80:95]
    ds_read_b64_tr_b16 v[212:213], v23 offset:16384
    ds_read_b64_tr_b16 v[214:215], v23 offset:16896
    s_add_u32 m0, s61, 26368
    v_mfma_f32_32x32x16_bf16 v[96:111], v[220:223], a[128:131], v[96:111]
    ds_read_b64_tr_b16 v[216:217], v22 offset:18432
    ds_read_b64_tr_b16 v[218:219], v22 offset:18944
    buffer_load_dwordx4 v16, s[12:15], s71 offen offset:256 lds
    s_waitcnt lgkmcnt(6)
    v_mfma_f32_32x32x16_bf16 v[48:63], v[224:227], a[132:135], v[48:63]
    ds_read_b64_tr_b16 v[220:221], v23 offset:18432
    ds_read_b64_tr_b16 v[222:223], v23 offset:18944
    v_mfma_f32_32x32x16_bf16 v[64:79], v[228:231], a[132:135], v[64:79]
    ds_read_b64_tr_b16 v[224:225], v22 offset:57344
    ds_read_b64_tr_b16 v[226:227], v22 offset:57856
    buffer_load_dwordx4 v17, s[12:15], s71 offen offset:1280 lds
    s_bfe_u32 s71, s99, 0x40008
    v_mfma_f32_32x32x16_bf16 v[80:95], v[232:235], a[132:135], v[80:95]
    ds_read_b64_tr_b16 v[228:229], v23 offset:57344
    ds_read_b64_tr_b16 v[230:231], v23 offset:57856
    s_mul_i32 s71, s71, 245760
    s_add_u32 s71, s71, s72
    v_mfma_f32_32x32x16_bf16 v[96:111], v[236:239], a[132:135], v[96:111]
    ds_read_b64_tr_b16 v[232:233], v22 offset:59392
    ds_read_b64_tr_b16 v[234:235], v22 offset:59904
    s_waitcnt lgkmcnt(6)
    v_mfma_f32_32x32x16_bf16 v[48:63], v[208:211], a[136:139], v[48:63]
    ds_read_b64_tr_b16 v[236:237], v23 offset:59392
    ds_read_b64_tr_b16 v[238:239], v23 offset:59904
    v_mfma_f32_32x32x16_bf16 v[64:79], v[212:215], a[136:139], v[64:79]
    v_mfma_f32_32x32x16_bf16 v[80:95], v[216:219], a[136:139], v[80:95]
    s_waitcnt vmcnt(12) lgkmcnt(0)
    s_barrier
    ds_read_b128 a[144:147], v12 offset:4096
    ds_read_b128 a[148:151], v13 offset:4096
    ds_read_b128 a[152:155], v14 offset:4096
    ds_read_b128 a[156:159], v15 offset:4096
    v_mfma_f32_32x32x16_bf16 v[96:111], v[220:223], a[136:139], v[96:111]
    ds_read_b64_tr_b16 v[208:209], v20 offset:20480
    ds_read_b64_tr_b16 v[210:211], v20 offset:20992
    ds_read_b64_tr_b16 v[212:213], v21 offset:20480
    ds_read_b64_tr_b16 v[214:215], v21 offset:20992
    s_add_u32 m0, s61, 28672
    v_mfma_f32_32x32x16_bf16 v[48:63], v[224:227], a[140:143], v[48:63]
    ds_read_b64_tr_b16 v[216:217], v20 offset:22528
    ds_read_b64_tr_b16 v[218:219], v20 offset:23040
    ds_read_b64_tr_b16 v[220:221], v21 offset:22528
    ds_read_b64_tr_b16 v[222:223], v21 offset:23040
    v_mfma_f32_32x32x16_bf16 v[64:79], v[228:231], a[140:143], v[64:79]
    ds_read_b64_tr_b16 v[224:225], v20 offset:61440
    ds_read_b64_tr_b16 v[226:227], v20 offset:61952
    buffer_load_dwordx4 v16, s[12:15], s71 offen offset:0 lds
    v_mfma_f32_32x32x16_bf16 v[80:95], v[232:235], a[140:143], v[80:95]
    ds_read_b64_tr_b16 v[228:229], v21 offset:61440
    ds_read_b64_tr_b16 v[230:231], v21 offset:61952
    v_mfma_f32_32x32x16_bf16 v[96:111], v[236:239], a[140:143], v[96:111]
    ds_read_b64_tr_b16 v[232:233], v20 offset:63488
    ds_read_b64_tr_b16 v[234:235], v20 offset:64000
    buffer_load_dwordx4 v17, s[12:15], s71 offen offset:1024 lds
    s_waitcnt lgkmcnt(6)
    v_mfma_f32_32x32x16_bf16 v[48:63], v[208:211], a[144:147], v[48:63]
    ds_read_b64_tr_b16 v[236:237], v21 offset:63488
    ds_read_b64_tr_b16 v[238:239], v21 offset:64000
    s_add_u32 m0, s61, 30592
    v_mfma_f32_32x32x16_bf16 v[64:79], v[212:215], a[144:147], v[64:79]
    ds_read_b64_tr_b16 v[208:209], v22 offset:20480
    ds_read_b64_tr_b16 v[210:211], v22 offset:20992
    buffer_load_dwordx4 v16, s[12:15], s71 offen offset:128 lds
    v_mfma_f32_32x32x16_bf16 v[80:95], v[216:219], a[144:147], v[80:95]
    ds_read_b64_tr_b16 v[212:213], v23 offset:20480
    ds_read_b64_tr_b16 v[214:215], v23 offset:20992
    v_mfma_f32_32x32x16_bf16 v[96:111], v[220:223], a[144:147], v[96:111]
    ds_read_b64_tr_b16 v[216:217], v22 offset:22528
    ds_read_b64_tr_b16 v[218:219], v22 offset:23040
    buffer_load_dwordx4 v17, s[12:15], s71 offen offset:1152 lds
    s_waitcnt lgkmcnt(6)
    v_mfma_f32_32x32x16_bf16 v[48:63], v[224:227], a[148:151], v[48:63]
    ds_read_b64_tr_b16 v[220:221], v23 offset:22528
    ds_read_b64_tr_b16 v[222:223], v23 offset:23040
    s_add_u32 m0, s61, 32512
    v_mfma_f32_32x32x16_bf16 v[64:79], v[228:231], a[148:151], v[64:79]
    ds_read_b64_tr_b16 v[224:225], v22 offset:61440
    ds_read_b64_tr_b16 v[226:227], v22 offset:61952
    buffer_load_dwordx4 v16, s[12:15], s71 offen offset:256 lds
    v_mfma_f32_32x32x16_bf16 v[80:95], v[232:235], a[148:151], v[80:95]
    ds_read_b64_tr_b16 v[228:229], v23 offset:61440
    ds_read_b64_tr_b16 v[230:231], v23 offset:61952
    v_mfma_f32_32x32x16_bf16 v[96:111], v[236:239], a[148:151], v[96:111]
    ds_read_b64_tr_b16 v[232:233], v22 offset:63488
    ds_read_b64_tr_b16 v[234:235], v22 offset:64000
    buffer_load_dwordx4 v17, s[12:15], s71 offen offset:1280 lds
    s_waitcnt lgkmcnt(6)
    v_mfma_f32_32x32x16_bf16 v[48:63], v[208:211], a[152:155], v[48:63]
    ds_read_b64_tr_b16 v[236:237], v23 offset:63488
    ds_read_b64_tr_b16 v[238:239], v23 offset:64000
    s_bfe_u32 s71, s99, 0x4000c
    s_mul_i32 s71, s71, 245760
    s_add_u32 s71, s71, s72
    v_mfma_f32_32x32x16_bf16 v[64:79], v[212:215], a[152:155], v[64:79]
    v_mfma_f32_32x32x16_bf16 v[80:95], v[216:219], a[152:155], v[80:95]
    v_mfma_f32_32x32x16_bf16 v[96:111], v[220:223], a[152:155], v[96:111]
    s_waitcnt lgkmcnt(0)
    v_mfma_f32_32x32x16_bf16 v[48:63], v[224:227], a[156:159], v[48:63]
    v_mfma_f32_32x32x16_bf16 v[64:79], v[228:231], a[156:159], v[64:79]
    v_mfma_f32_32x32x16_bf16 v[80:95], v[232:235], a[156:159], v[80:95]
    v_mfma_f32_32x32x16_bf16 v[96:111], v[236:239], a[156:159], v[96:111]
L_h2:
    s_waitcnt vmcnt(12)
    s_barrier
    ds_read_b64_tr_b16 v[208:209], v20 offset:0
    ds_read_b64_tr_b16 v[210:211], v20 offset:512
    ds_read_b64_tr_b16 v[212:213], v21 offset:0
    ds_read_b64_tr_b16 v[214:215], v21 offset:512
    ds_read_b64_tr_b16 v[216:217], v20 offset:2048
    ds_read_b64_tr_b16 v[218:219], v20 offset:2560
    ds_read_b64_tr_b16 v[220:221], v21 offset:2048
    ds_read_b64_tr_b16 v[222:223], v21 offset:2560
    ds_read_b64_tr_b16 v[224:225], v20 offset:4096
    ds_read_b64_tr_b16 v[226:227], v20 offset:4608
    ds_read_b64_tr_b16 v[228:229], v21 offset:4096
    ds_read_b64_tr_b16 v[230:231], v21 offset:4608
    s_waitcnt lgkmcnt(10)
    v_mfma_f32_32x32x16_bf16 v[112:127], v[208:211], a[0:3], 0
    ds_read_b64_tr_b16 v[232:233], v20 offset:40960
    ds_read_b64_tr_b16 v[234:235], v20 offset:41472
    ds_read_b64_tr_b16 v[236:237], v21 offset:40960
    ds_read_b64_tr_b16 v[238:239], v21 offset:41472
    s_waitcnt lgkmcnt(12)
    v_mfma_f32_32x32x16_bf16 v[128:143], v[212:215], a[0:3], 0
    ds_read_b64_tr_b16 v[208:209], v20 offset:43008
    ds_read_b64_tr_b16 v[210:211], v20 offset:43520
    buffer_load_dword v47, off, s[44:47], 0 sc1
    s_waitcnt lgkmcnt(6)
    v_mfma_f32_32x32x16_bf16 v[144:159], v[216:219], a[0:3], 0
    ds_read_b64_tr_b16 v[212:213], v21 offset:43008
    ds_read_b64_tr_b16 v[214:215], v21 offset:43520
    s_add_u32 m0, s61, 0
    v_mfma_f32_32x32x16_bf16 v[160:175], v[220:223], a[0:3], 0
    ds_read_b64_tr_b16 v[216:217], v20 offset:45056
    ds_read_b64_tr_b16 v[218:219], v20 offset:45568
    buffer_load_dwordx4 v40, s[32:35], s79 offen offset:0 lds
    v_mfma_f32_32x32x16_bf16 v[176:191], v[224:227], a[0:3], 0
    ds_read_b64_tr_b16 v[220:221], v21 offset:45056
    ds_read_b64_tr_b16 v[222:223], v21 offset:45568
    v_mfma_f32_32x32x16_bf16 v[192:207], v[228:231], a[0:3], 0
    ds_read_b64_tr_b16 v[224:225], v22 offset:0
    ds_read_b64_tr_b16 v[226:227], v22 offset:512
    buffer_load_dwordx4 v41, s[32:35], s79 offen offset:1024 lds
    s_waitcnt lgkmcnt(6)
    v_mfma_f32_32x32x16_bf16 v[112:127], v[232:235], a[4:7], v[112:127]
    ds_read_b64_tr_b16 v[228:229], v23 offset:0
    ds_read_b64_tr_b16 v[230:231], v23 offset:512
    s_mov_b32 s100, 0x3fb8aa3b
    s_mov_b32 s101, 0x358637bd
    v_mfma_f32_32x32x16_bf16 v[128:143], v[236:239], a[4:7], v[128:143]
    ds_read_b64_tr_b16 v[232:233], v22 offset:2048
    ds_read_b64_tr_b16 v[234:235], v22 offset:2560
    v_mul_f32 v240, s100, v48
    v_mul_f32 v241, s100, v49
    v_mul_f32 v242, s100, v50
    v_mfma_f32_32x32x16_bf16 v[144:159], v[208:211], a[4:7], v[144:159]
    ds_read_b64_tr_b16 v[236:237], v23 offset:2048
    ds_read_b64_tr_b16 v[238:239], v23 offset:2560
    buffer_load_dwordx4 v42, s[32:35], s79 offen offset:2048 lds
    v_mul_f32 v243, s100, v51
    v_mfma_f32_32x32x16_bf16 v[160:175], v[212:215], a[4:7], v[160:175]
    ds_read_b64_tr_b16 v[208:209], v22 offset:4096
    ds_read_b64_tr_b16 v[210:211], v22 offset:4608
    v_exp_f32_e64 v240, v240 clamp
    s_waitcnt lgkmcnt(6)
    v_mfma_f32_32x32x16_bf16 v[176:191], v[216:219], a[4:7], v[176:191]
    ds_read_b64_tr_b16 v[212:213], v23 offset:4096
    ds_read_b64_tr_b16 v[214:215], v23 offset:4608
    buffer_load_dwordx4 v43, s[32:35], s79 offen offset:3072 lds
    v_mfma_f32_32x32x16_bf16 v[192:207], v[220:223], a[4:7], v[192:207]
    ds_read_b64_tr_b16 v[216:217], v22 offset:40960
    ds_read_b64_tr_b16 v[218:219], v22 offset:41472
    s_add_u32 m0, s61, 4096
    v_exp_f32_e64 v241, v241 clamp
    v_mfma_f32_32x32x16_bf16 v[112:127], v[224:227], a[8:11], v[112:127]
    ds_read_b64_tr_b16 v[220:221], v23 offset:40960
    ds_read_b64_tr_b16 v[222:223], v23 offset:41472
    v_exp_f32_e64 v242, v242 clamp
    v_mfma_f32_32x32x16_bf16 v[128:143], v[228:231], a[8:11], v[128:143]
    ds_read_b64_tr_b16 v[224:225], v22 offset:43008
    ds_read_b64_tr_b16 v[226:227], v22 offset:43520
    buffer_load_dwordx4 v44, s[32:35], s79 offen offset:0 lds
    s_waitcnt lgkmcnt(6)
    v_mfma_f32_32x32x16_bf16 v[144:159], v[232:235], a[8:11], v[144:159]
    ds_read_b64_tr_b16 v[228:229], v23 offset:43008
    ds_read_b64_tr_b16 v[230:231], v23 offset:43520
    s_add_u32 s79, s79, 20480
    s_add_u32 m0, s61, 5120
    v_mfma_f32_32x32x16_bf16 v[160:175], v[236:239], a[8:11], v[160:175]
    ds_read_b64_tr_b16 v[232:233], v22 offset:45056
    ds_read_b64_tr_b16 v[234:235], v22 offset:45568
    buffer_load_dwordx4 v40, s[32:35], s79 offen offset:0 lds
    v_mfma_f32_32x32x16_bf16 v[176:191], v[208:211], a[8:11], v[176:191]
    ds_read_b64_tr_b16 v[236:237], v23 offset:45056
    ds_read_b64_tr_b16 v[238:239], v23 offset:45568
    v_exp_f32_e64 v243, v243 clamp
    v_max_f32 v48, s101, v48
    v_mfma_f32_32x32x16_bf16 v[192:207], v[212:215], a[8:11], v[192:207]
    v_max_f32 v49, s101, v49
    v_max_f32 v50, s101, v50
    v_max_f32 v51, s101, v51
    v_add_f32 v48, v48, v240
    v_add_f32 v49, v49, v241
    s_waitcnt lgkmcnt(4)
    v_mfma_f32_32x32x16_bf16 v[112:127], v[216:219], a[12:15], v[112:127]
    buffer_load_dwordx4 v41, s[32:35], s79 offen offset:1024 lds
    s_waitcnt vmcnt(14) lgkmcnt(0)
    s_barrier
    v_mfma_f32_32x32x16_bf16 v[128:143], v[220:223], a[12:15], v[128:143]
    ds_read_b64_tr_b16 v[208:209], v20 offset:6144
    ds_read_b64_tr_b16 v[210:211], v20 offset:6656
    ds_read_b64_tr_b16 v[212:213], v21 offset:6144
    ds_read_b64_tr_b16 v[214:215], v21 offset:6656
    v_add_f32 v50, v50, v242
    v_mfma_f32_32x32x16_bf16 v[144:159], v[224:227], a[12:15], v[144:159]
    ds_read_b64_tr_b16 v[216:217], v20 offset:8192
    ds_read_b64_tr_b16 v[218:219], v20 offset:8704
    ds_read_b64_tr_b16 v[220:221], v21 offset:8192
    ds_read_b64_tr_b16 v[222:223], v21 offset:8704
    v_add_f32 v51, v51, v243
    v_mfma_f32_32x32x16_bf16 v[160:175], v[228:231], a[12:15], v[160:175]
    ds_read_b64_tr_b16 v[224:225], v20 offset:10240
    ds_read_b64_tr_b16 v[226:227], v20 offset:10752
    buffer_load_dwordx4 v42, s[32:35], s79 offen offset:2048 lds
    s_waitcnt vmcnt(8)
    v_cmp_gt_u32 vcc, 32, v47
    s_nop 1
    s_cbranch_vccnz Lslow_22
Lback_23:
    v_mfma_f32_32x32x16_bf16 v[176:191], v[232:235], a[12:15], v[176:191]
    ds_read_b64_tr_b16 v[228:229], v21 offset:10240
    ds_read_b64_tr_b16 v[230:231], v21 offset:10752
    v_mul_f32 v240, s100, v52
    v_mul_f32 v241, s100, v53
    v_mul_f32 v242, s100, v54
    v_mfma_f32_32x32x16_bf16 v[192:207], v[236:239], a[12:15], v[192:207]
    ds_read_b64_tr_b16 v[232:233], v20 offset:47104
    ds_read_b64_tr_b16 v[234:235], v20 offset:47616
    buffer_load_dwordx4 v43, s[32:35], s79 offen offset:3072 lds
    s_waitcnt lgkmcnt(6)
    v_mfma_f32_32x32x16_bf16 v[112:127], v[208:211], a[16:19], v[112:127]
    ds_read_b64_tr_b16 v[236:237], v21 offset:47104
    ds_read_b64_tr_b16 v[238:239], v21 offset:47616
    s_add_u32 m0, s61, 9216
    v_mul_f32 v243, s100, v55
    v_mfma_f32_32x32x16_bf16 v[128:143], v[212:215], a[16:19], v[128:143]
    ds_read_b64_tr_b16 v[208:209], v20 offset:49152
    ds_read_b64_tr_b16 v[210:211], v20 offset:49664
    buffer_load_dwordx4 v44, s[32:35], s79 offen offset:0 lds
    s_add_u32 s79, s79, 20480
    v_mfma_f32_32x32x16_bf16 v[144:159], v[216:219], a[16:19], v[144:159]
    ds_read_b64_tr_b16 v[212:213], v21 offset:49152
    ds_read_b64_tr_b16 v[214:215], v21 offset:49664
    s_add_u32 m0, s61, 34816
    v_add_u32 v1, 0, v0
    v_mul_u32_u24 v3, 0x199a, v1
    v_mfma_f32_32x32x16_bf16 v[160:175], v[220:223], a[16:19], v[160:175]
    ds_read_b64_tr_b16 v[216:217], v20 offset:51200
    ds_read_b64_tr_b16 v[218:219], v20 offset:51712
    v_lshrrev_b32 v3, 16, v3
    v_mul_u32_u24 v4, 10, v3
    s_waitcnt lgkmcnt(6)
    v_mfma_f32_32x32x16_bf16 v[176:191], v[224:227], a[16:19], v[176:191]
    ds_read_b64_tr_b16 v[220:221], v21 offset:51200
    ds_read_b64_tr_b16 v[222:223], v21 offset:51712
    buffer_load_dwordx4 v16, s[12:15], s71 offen offset:0 lds
    v_sub_u32 v4, v1, v4
    v_mfma_f32_32x32x16_bf16 v[192:207], v[228:231], a[16:19], v[192:207]
    ds_read_b64_tr_b16 v[224:225], v22 offset:6144
    ds_read_b64_tr_b16 v[226:227], v22 offset:6656
    v_lshrrev_b32 v4, 3, v4
    v_mul_u32_u24 v3, 1120, v3
    v_mad_u32_u24 v3, v4, s97, v3
    v_mfma_f32_32x32x16_bf16 v[112:127], v[232:235], a[20:23], v[112:127]
    ds_read_b64_tr_b16 v[228:229], v23 offset:6144
    ds_read_b64_tr_b16 v[230:231], v23 offset:6656
    buffer_load_dwordx4 v17, s[12:15], s71 offen offset:1024 lds
    s_add_u32 m0, s61, 36736
    v_mfma_f32_32x32x16_bf16 v[128:143], v[236:239], a[20:23], v[128:143]
    ds_read_b64_tr_b16 v[232:233], v22 offset:8192
    ds_read_b64_tr_b16 v[234:235], v22 offset:8704
    buffer_load_dwordx4 v16, s[12:15], s71 offen offset:128 lds
    s_waitcnt lgkmcnt(6)
    v_mfma_f32_32x32x16_bf16 v[144:159], v[208:211], a[20:23], v[144:159]
    ds_read_b64_tr_b16 v[236:237], v23 offset:8192
    ds_read_b64_tr_b16 v[238:239], v23 offset:8704
    buffer_load_dwordx4 v17, s[12:15], s71 offen offset:1152 lds
    s_add_u32 m0, s61, 38656
    v_mfma_f32_32x32x16_bf16 v[160:175], v[212:215], a[20:23], v[160:175]
    ds_read_b64_tr_b16 v[208:209], v22 offset:10240
    ds_read_b64_tr_b16 v[210:211], v22 offset:10752
    buffer_load_dwordx4 v16, s[12:15], s71 offen offset:256 lds
    v_lshl_add_u32 v40, v0, 4, v3
    v_mfma_f32_32x32x16_bf16 v[176:191], v[216:219], a[20:23], v[176:191]
    ds_read_b64_tr_b16 v[212:213], v23 offset:10240
    ds_read_b64_tr_b16 v[214:215], v23 offset:10752
    buffer_load_dwordx4 v17, s[12:15], s71 offen offset:1280 lds
    s_bfe_u32 s71, s99, 0x40010
    s_mul_i32 s71, s71, 245760
    s_add_u32 s71, s71, s72
    s_add_u32 m0, s61, 16384
    v_mfma_f32_32x32x16_bf16 v[192:207], v[220:223], a[20:23], v[192:207]
    ds_read_b64_tr_b16 v[216:217], v22 offset:47104
    ds_read_b64_tr_b16 v[218:219], v22 offset:47616
    v_add_u32 v1, 64, v0
    v_mul_u32_u24 v3, 0x199a, v1
    s_waitcnt lgkmcnt(6)
    v_mfma_f32_32x32x16_bf16 v[112:127], v[224:227], a[24:27], v[112:127]
    ds_read_b64_tr_b16 v[220:221], v23 offset:47104
    ds_read_b64_tr_b16 v[222:223], v23 offset:47616
    v_lshrrev_b32 v3, 16, v3
    v_mul_u32_u24 v4, 10, v3
    v_sub_u32 v4, v1, v4
    v_mfma_f32_32x32x16_bf16 v[128:143], v[228:231], a[24:27], v[128:143]
    ds_read_b64_tr_b16 v[224:225], v22 offset:49152
    ds_read_b64_tr_b16 v[226:227], v22 offset:49664
    v_lshrrev_b32 v4, 3, v4
    v_mul_u32_u24 v3, 1120, v3
    v_mad_u32_u24 v3, v4, s97, v3
    v_mfma_f32_32x32x16_bf16 v[144:159], v[232:235], a[24:27], v[144:159]
    ds_read_b64_tr_b16 v[228:229], v23 offset:49152
    ds_read_b64_tr_b16 v[230:231], v23 offset:49664
    v_lshl_add_u32 v41, v0, 4, v3
    v_add_u32 v1, 128, v0
    v_mul_u32_u24 v3, 0x199a, v1
    v_mfma_f32_32x32x16_bf16 v[160:175], v[236:239], a[24:27], v[160:175]
    ds_read_b64_tr_b16 v[232:233], v22 offset:51200
    ds_read_b64_tr_b16 v[234:235], v22 offset:51712
    buffer_load_dwordx4 v16, s[12:15], s71 offen offset:0 lds
    s_waitcnt lgkmcnt(6)
    v_mfma_f32_32x32x16_bf16 v[176:191], v[208:211], a[24:27], v[176:191]
    ds_read_b64_tr_b16 v[236:237], v23 offset:51200
    ds_read_b64_tr_b16 v[238:239], v23 offset:51712
    v_lshrrev_b32 v3, 16, v3
    v_mul_u32_u24 v4, 10, v3
    v_sub_u32 v4, v1, v4
    v_mfma_f32_32x32x16_bf16 v[192:207], v[212:215], a[24:27], v[192:207]
    v_lshrrev_b32 v4, 3, v4
    v_mul_u32_u24 v3, 1120, v3
    v_mad_u32_u24 v3, v4, s97, v3
    v_lshl_add_u32 v42, v0, 4, v3
    v_add_u32 v1, 192, v0
    v_mfma_f32_32x32x16_bf16 v[112:127], v[216:219], a[28:31], v[112:127]
    buffer_load_dwordx4 v17, s[12:15], s71 offen offset:1024 lds
    s_waitcnt lgkmcnt(0)
    s_barrier
    v_mfma_f32_32x32x16_bf16 v[128:143], v[220:223], a[28:31], v[128:143]
    ds_read_b64_tr_b16 v[208:209], v20 offset:12288
    ds_read_b64_tr_b16 v[210:211], v20 offset:12800
    ds_read_b64_tr_b16 v[212:213], v21 offset:12288
    ds_read_b64_tr_b16 v[214:215], v21 offset:12800
    s_add_u32 m0, s61, 18304
    v_mfma_f32_32x32x16_bf16 v[144:159], v[224:227], a[28:31], v[144:159]
    ds_read_b64_tr_b16 v[216:217], v20 offset:14336
    ds_read_b64_tr_b16 v[218:219], v20 offset:14848
    ds_read_b64_tr_b16 v[220:221], v21 offset:14336
    ds_read_b64_tr_b16 v[222:223], v21 offset:14848
    v_mul_u32_u24 v3, 0x199a, v1
    v_mfma_f32_32x32x16_bf16 v[160:175], v[228:231], a[28:31], v[160:175]
    ds_read_b64_tr_b16 v[224:225], v20 offset:16384
    ds_read_b64_tr_b16 v[226:227], v20 offset:16896
    buffer_load_dwordx4 v16, s[12:15], s71 offen offset:128 lds
    v_lshrrev_b32 v3, 16, v3
    v_mfma_f32_32x32x16_bf16 v[176:191], v[232:235], a[28:31], v[176:191]
    ds_read_b64_tr_b16 v[228:229], v21 offset:16384
    ds_read_b64_tr_b16 v[230:231], v21 offset:16896
    v_mul_u32_u24 v4, 10, v3
    v_sub_u32 v4, v1, v4
    v_lshrrev_b32 v4, 3, v4
    v_mfma_f32_32x32x16_bf16 v[192:207], v[236:239], a[28:31], v[192:207]
    ds_read_b64_tr_b16 v[232:233], v20 offset:53248
    ds_read_b64_tr_b16 v[234:235], v20 offset:53760
    buffer_load_dwordx4 v17, s[12:15], s71 offen offset:1152 lds
    s_waitcnt lgkmcnt(6)
    v_mfma_f32_32x32x16_bf16 v[112:127], v[208:211], a[32:35], v[112:127]
    ds_read_b64_tr_b16 v[236:237], v21 offset:53248
    ds_read_b64_tr_b16 v[238:239], v21 offset:53760
    s_add_u32 m0, s61, 20224
    v_mul_u32_u24 v3, 1120, v3
    v_mad_u32_u24 v3, v4, s97, v3
    v_mfma_f32_32x32x16_bf16 v[128:143], v[212:215], a[32:35], v[128:143]
    ds_read_b64_tr_b16 v[208:209], v20 offset:55296
    ds_read_b64_tr_b16 v[210:211], v20 offset:55808
    buffer_load_dwordx4 v16, s[12:15], s71 offen offset:256 lds
    v_lshl_add_u32 v43, v0, 4, v3
    v_mfma_f32_32x32x16_bf16 v[144:159], v[216:219], a[32:35], v[144:159]
    ds_read_b64_tr_b16 v[212:213], v21 offset:55296
    ds_read_b64_tr_b16 v[214:215], v21 offset:55808
    v_add_u32 v1, 256, v0
    v_mul_u32_u24 v3, 0x199a, v1
    v_lshrrev_b32 v3, 16, v3
    v_mfma_f32_32x32x16_bf16 v[160:175], v[220:223], a[32:35], v[160:175]
    ds_read_b64_tr_b16 v[216:217], v20 offset:57344
    ds_read_b64_tr_b16 v[218:219], v20 offset:57856
    buffer_load_dwordx4 v17, s[12:15], s71 offen offset:1280 lds
    s_waitcnt lgkmcnt(6)
    v_mfma_f32_32x32x16_bf16 v[176:191], v[224:227], a[32:35], v[176:191]
    ds_read_b64_tr_b16 v[220:221], v21 offset:57344
    ds_read_b64_tr_b16 v[222:223], v21 offset:57856
    s_bfe_u32 s71, s99, 0x40014
    s_mul_i32 s71, s71, 245760
    s_add_u32 s71, s71, s72
    v_mfma_f32_32x32x16_bf16 v[192:207], v[228:231], a[32:35], v[192:207]
    ds_read_b64_tr_b16 v[224:225], v22 offset:12288
    ds_read_b64_tr_b16 v[226:227], v22 offset:12800
    s_add_u32 m0, s61, 22528
    v_mul_u32_u24 v4, 10, v3
    v_sub_u32 v4, v1, v4
    v_mfma_f32_32x32x16_bf16 v[112:127], v[232:235], a[36:39], v[112:127]
    ds_read_b64_tr_b16 v[228:229], v23 offset:12288
    ds_read_b64_tr_b16 v[230:231], v23 offset:12800
    buffer_load_dwordx4 v16, s[12:15], s71 offen offset:0 lds
    v_lshrrev_b32 v4, 3, v4
    v_mfma_f32_32x32x16_bf16 v[128:143], v[236:239], a[36:39], v[128:143]
    ds_read_b64_tr_b16 v[232:233], v22 offset:14336
    ds_read_b64_tr_b16 v[234:235], v22 offset:14848
    v_mul_u32_u24 v3, 1120, v3
    v_mad_u32_u24 v3, v4, s97, v3
    s_waitcnt lgkmcnt(6)
    v_mfma_f32_32x32x16_bf16 v[144:159], v[208:211], a[36:39], v[144:159]
    ds_read_b64_tr_b16 v[236:237], v23 offset:14336
    ds_read_b64_tr_b16 v[238:239], v23 offset:14848
    buffer_load_dwordx4 v17, s[12:15], s71 offen offset:1024 lds
    v_lshl_add_u32 v44, v1, 4, v3
    v_mfma_f32_32x32x16_bf16 v[160:175], v[212:215], a[36:39], v[160:175]
    ds_read_b64_tr_b16 v[208:209], v22 offset:16384
    ds_read_b64_tr_b16 v[210:211], v22 offset:16896
    s_add_u32 m0, s61, 24448
    v_exp_f32_e64 v240, v240 clamp
    v_mfma_f32_32x32x16_bf16 v[176:191], v[216:219], a[36:39], v[176:191]
    ds_read_b64_tr_b16 v[212:213], v23 offset:16384
    ds_read_b64_tr_b16 v[214:215], v23 offset:16896
    buffer_load_dwordx4 v16, s[12:15], s71 offen offset:128 lds
    v_mfma_f32_32x32x16_bf16 v[192:207], v[220:223], a[36:39], v[192:207]
    ds_read_b64_tr_b16 v[216:217], v22 offset:53248
    ds_read_b64_tr_b16 v[218:219], v22 offset:53760
    v_exp_f32_e64 v241, v241 clamp
    s_waitcnt lgkmcnt(6)
    v_mfma_f32_32x32x16_bf16 v[112:127], v[224:227], a[40:43], v[112:127]
    ds_read_b64_tr_b16 v[220:221], v23 offset:53248
    ds_read_b64_tr_b16 v[222:223], v23 offset:53760
    buffer_load_dwordx4 v17, s[12:15], s71 offen offset:1152 lds
    v_mfma_f32_32x32x16_bf16 v[128:143], v[228:231], a[40:43], v[128:143]
    ds_read_b64_tr_b16 v[224:225], v22 offset:55296
    ds_read_b64_tr_b16 v[226:227], v22 offset:55808
    s_add_u32 m0, s61, 26368
    v_exp_f32_e64 v242, v242 clamp
    v_mfma_f32_32x32x16_bf16 v[144:159], v[232:235], a[40:43], v[144:159]
    ds_read_b64_tr_b16 v[228:229], v23 offset:55296
    ds_read_b64_tr_b16 v[230:231], v23 offset:55808
    buffer_load_dwordx4 v16, s[12:15], s71 offen offset:256 lds
    v_mfma_f32_32x32x16_bf16 v[160:175], v[236:239], a[40:43], v[160:175]
    ds_read_b64_tr_b16 v[232:233], v22 offset:57344
    ds_read_b64_tr_b16 v[234:235], v22 offset:57856
    v_exp_f32_e64 v243, v243 clamp
    s_waitcnt lgkmcnt(6)
    v_mfma_f32_32x32x16_bf16 v[176:191], v[208:211], a[40:43], v[176:191]
    ds_read_b64_tr_b16 v[236:237], v23 offset:57344
    ds_read_b64_tr_b16 v[238:239], v23 offset:57856
    buffer_load_dwordx4 v17, s[12:15], s71 offen offset:1280 lds
    s_bfe_u32 s71, s99, 0x40018
    v_mfma_f32_32x32x16_bf16 v[192:207], v[212:215], a[40:43], v[192:207]
    s_mul_i32 s71, s71, 245760
    s_add_u32 s71, s71, s72
    v_max_f32 v52, s101, v52
    v_max_f32 v53, s101, v53
    v_max_f32 v54, s101, v54
    v_mfma_f32_32x32x16_bf16 v[112:127], v[216:219], a[44:47], v[112:127]
    v_max_f32 v55, s101, v55
    v_add_f32 v52, v52, v240
    s_waitcnt vmcnt(12) lgkmcnt(0)
    s_barrier
    v_mfma_f32_32x32x16_bf16 v[128:143], v[220:223], a[44:47], v[128:143]
    ds_read_b64_tr_b16 v[208:209], v20 offset:18432
    ds_read_b64_tr_b16 v[210:211], v20 offset:18944
    ds_read_b64_tr_b16 v[212:213], v21 offset:18432
    ds_read_b64_tr_b16 v[214:215], v21 offset:18944
    s_add_u32 m0, s61, 28672
    v_mfma_f32_32x32x16_bf16 v[144:159], v[224:227], a[44:47], v[144:159]
    ds_read_b64_tr_b16 v[216:217], v20 offset:20480
    ds_read_b64_tr_b16 v[218:219], v20 offset:20992
    ds_read_b64_tr_b16 v[220:221], v21 offset:20480
    ds_read_b64_tr_b16 v[222:223], v21 offset:20992
    v_add_f32 v53, v53, v241
    v_mfma_f32_32x32x16_bf16 v[160:175], v[228:231], a[44:47], v[160:175]
    ds_read_b64_tr_b16 v[224:225], v20 offset:22528
    ds_read_b64_tr_b16 v[226:227], v20 offset:23040
    buffer_load_dwordx4 v16, s[12:15], s71 offen offset:0 lds
    ds_read_b64_tr_b16 a[160:161], v18 offset:0
    v_mfma_f32_32x32x16_bf16 v[176:191], v[232:235], a[44:47], v[176:191]
    ds_read_b64_tr_b16 v[228:229], v21 offset:22528
    ds_read_b64_tr_b16 v[230:231], v21 offset:23040
    ds_read_b64_tr_b16 a[162:163], v18 offset:2560
    ds_read_b64_tr_b16 a[164:165], v18 offset:8
    v_add_f32 v54, v54, v242
    v_mfma_f32_32x32x16_bf16 v[192:207], v[236:239], a[44:47], v[192:207]
    ds_read_b64_tr_b16 v[232:233], v20 offset:59392
    ds_read_b64_tr_b16 v[234:235], v20 offset:59904
    buffer_load_dwordx4 v17, s[12:15], s71 offen offset:1024 lds
    s_waitcnt lgkmcnt(9)
    v_mfma_f32_32x32x16_bf16 v[112:127], v[208:211], a[48:51], v[112:127]
    ds_read_b64_tr_b16 v[236:237], v21 offset:59392
    ds_read_b64_tr_b16 v[238:239], v21 offset:59904
    ds_read_b64_tr_b16 a[166:167], v18 offset:2568
    ds_read_b64_tr_b16 a[168:169], v18 offset:64
    s_add_u32 m0, s61, 30592
    v_mfma_f32_32x32x16_bf16 v[128:143], v[212:215], a[48:51], v[128:143]
    ds_read_b64_tr_b16 v[208:209], v20 offset:61440
    ds_read_b64_tr_b16 v[210:211], v20 offset:61952
    buffer_load_dwordx4 v16, s[12:15], s71 offen offset:128 lds
    ds_read_b64_tr_b16 a[170:171], v18 offset:2624
    v_mfma_f32_32x32x16_bf16 v[144:159], v[216:219], a[48:51], v[144:159]
    ds_read_b64_tr_b16 v[212:213], v21 offset:61440
    ds_read_b64_tr_b16 v[214:215], v21 offset:61952
    ds_read_b64_tr_b16 a[172:173], v18 offset:72
    ds_read_b64_tr_b16 a[174:175], v18 offset:2632
    v_add_f32 v55, v55, v243
    v_mfma_f32_32x32x16_bf16 v[160:175], v[220:223], a[48:51], v[160:175]
    ds_read_b64_tr_b16 v[216:217], v20 offset:63488
    ds_read_b64_tr_b16 v[218:219], v20 offset:64000
    buffer_load_dwordx4 v17, s[12:15], s71 offen offset:1152 lds
    s_waitcnt lgkmcnt(11)
    v_mfma_f32_32x32x16_bf16 v[176:191], v[224:227], a[48:51], v[176:191]
    ds_read_b64_tr_b16 v[220:221], v21 offset:63488
    ds_read_b64_tr_b16 v[222:223], v21 offset:64000
    ds_read_b64_tr_b16 a[176:177], v19 offset:256
    ds_read_b64_tr_b16 a[178:179], v19 offset:2816
    s_add_u32 m0, s61, 32512
    v_mfma_f32_32x32x16_bf16 v[192:207], v[228:231], a[48:51], v[192:207]
    ds_read_b64_tr_b16 v[224:225], v22 offset:18432
    ds_read_b64_tr_b16 v[226:227], v22 offset:18944
    buffer_load_dwordx4 v16, s[12:15], s71 offen offset:256 lds
    ds_read_b64_tr_b16 a[180:181], v18 offset:128
    v_mfma_f32_32x32x16_bf16 v[112:127], v[232:235], a[52:55], v[112:127]
    ds_read_b64_tr_b16 v[228:229], v23 offset:18432
    ds_read_b64_tr_b16 v[230:231], v23 offset:18944
    ds_read_b64_tr_b16 a[182:183], v18 offset:2688
    ds_read_b64_tr_b16 a[184:185], v18 offset:136
    v_mul_f32 v240, s100, v56
    v_mfma_f32_32x32x16_bf16 v[128:143], v[236:239], a[52:55], v[128:143]
    ds_read_b64_tr_b16 v[232:233], v22 offset:20480
    ds_read_b64_tr_b16 v[234:235], v22 offset:20992
    buffer_load_dwordx4 v17, s[12:15], s71 offen offset:1280 lds
    s_waitcnt lgkmcnt(11)
    v_mfma_f32_32x32x16_bf16 v[144:159], v[208:211], a[52:55], v[144:159]
    ds_read_b64_tr_b16 v[236:237], v23 offset:20480
    ds_read_b64_tr_b16 v[238:239], v23 offset:20992
    ds_read_b64_tr_b16 a[186:187], v18 offset:2696
    ds_read_b64_tr_b16 a[188:189], v18 offset:192
    s_bfe_u32 s71, s99, 0x4001c
    v_mfma_f32_32x32x16_bf16 v[160:175], v[212:215], a[52:55], v[160:175]
    ds_read_b64_tr_b16 v[208:209], v22 offset:22528
    ds_read_b64_tr_b16 v[210:211], v22 offset:23040
    ds_read_b64_tr_b16 a[190:191], v18 offset:2752
    ds_read_b64_tr_b16 a[192:193], v18 offset:200
    s_mul_i32 s71, s71, 245760
    v_mfma_f32_32x32x16_bf16 v[176:191], v[216:219], a[52:55], v[176:191]
    ds_read_b64_tr_b16 v[212:213], v23 offset:22528
    ds_read_b64_tr_b16 v[214:215], v23 offset:23040
    ds_read_b64_tr_b16 a[194:195], v18 offset:2760
    ds_read_b64_tr_b16 a[196:197], v19 offset:288
    s_add_u32 s71, s71, s72
    v_mfma_f32_32x32x16_bf16 v[192:207], v[220:223], a[52:55], v[192:207]
    ds_read_b64_tr_b16 v[216:217], v22 offset:59392
    ds_read_b64_tr_b16 v[218:219], v22 offset:59904
    buffer_store_dwordx4 a[160:163], v29, s[48:51], s80 offen offset:0 sc1
    s_waitcnt lgkmcnt(12)
    v_mfma_f32_32x32x16_bf16 v[112:127], v[224:227], a[56:59], v[112:127]
    ds_read_b64_tr_b16 v[220:221], v23 offset:59392
    ds_read_b64_tr_b16 v[222:223], v23 offset:59904
    ds_read_b64_tr_b16 a[198:199], v19 offset:2848
    v_mul_f32 v241, s100, v57
    v_mul_f32 v242, s100, v58
    v_mfma_f32_32x32x16_bf16 v[128:143], v[228:231], a[56:59], v[128:143]
    ds_read_b64_tr_b16 v[224:225], v22 offset:61440
    ds_read_b64_tr_b16 v[226:227], v22 offset:61952
    v_mul_f32 v243, s100, v59
    v_exp_f32_e64 v240, v240 clamp
    v_mfma_f32_32x32x16_bf16 v[144:159], v[232:235], a[56:59], v[144:159]
    ds_read_b64_tr_b16 v[228:229], v23 offset:61440
    ds_read_b64_tr_b16 v[230:231], v23 offset:61952
    buffer_store_dwordx4 a[164:167], v29, s[48:51], s80 offen offset:1024 sc1
    v_mfma_f32_32x32x16_bf16 v[160:175], v[236:239], a[56:59], v[160:175]
    ds_read_b64_tr_b16 v[232:233], v22 offset:63488
    ds_read_b64_tr_b16 v[234:235], v22 offset:64000
    v_exp_f32_e64 v241, v241 clamp
    s_waitcnt lgkmcnt(7)
    v_mfma_f32_32x32x16_bf16 v[176:191], v[208:211], a[56:59], v[176:191]
    ds_read_b64_tr_b16 v[236:237], v23 offset:63488
    ds_read_b64_tr_b16 v[238:239], v23 offset:64000
    v_exp_f32_e64 v242, v242 clamp
    v_mfma_f32_32x32x16_bf16 v[192:207], v[212:215], a[56:59], v[192:207]
    v_exp_f32_e64 v243, v243 clamp
    v_max_f32 v56, s101, v56
    v_max_f32 v57, s101, v57
    v_max_f32 v58, s101, v58
    v_max_f32 v59, s101, v59
    v_mfma_f32_32x32x16_bf16 v[112:127], v[216:219], a[60:63], v[112:127]
    buffer_store_dwordx4 a[168:171], v29, s[48:51], s80 offen offset:2048 sc1
    s_waitcnt vmcnt(15) lgkmcnt(0)
    s_barrier
    v_mfma_f32_32x32x16_bf16 v[128:143], v[220:223], a[60:63], v[128:143]
    ds_read_b64_tr_b16 v[208:209], v20 offset:0
    ds_read_b64_tr_b16 v[210:211], v20 offset:512
    ds_read_b64_tr_b16 v[212:213], v21 offset:0
    ds_read_b64_tr_b16 v[214:215], v21 offset:512
    s_add_u32 m0, s61, 34816
    v_mfma_f32_32x32x16_bf16 v[144:159], v[224:227], a[60:63], v[144:159]
    ds_read_b64_tr_b16 v[216:217], v20 offset:2048
    ds_read_b64_tr_b16 v[218:219], v20 offset:2560
    ds_read_b64_tr_b16 v[220:221], v21 offset:2048
    ds_read_b64_tr_b16 v[222:223], v21 offset:2560
    v_add_f32 v56, v56, v240
    v_mfma_f32_32x32x16_bf16 v[160:175], v[228:231], a[60:63], v[160:175]
    ds_read_b64_tr_b16 v[224:225], v20 offset:4096
    ds_read_b64_tr_b16 v[226:227], v20 offset:4608
    buffer_load_dwordx4 v16, s[12:15], s71 offen offset:0 lds
    v_add_f32 v57, v57, v241
    v_mfma_f32_32x32x16_bf16 v[176:191], v[232:235], a[60:63], v[176:191]
    ds_read_b64_tr_b16 v[228:229], v21 offset:4096
    ds_read_b64_tr_b16 v[230:231], v21 offset:4608
    v_add_f32 v58, v58, v242
    v_add_f32 v59, v59, v243
    v_mul_f32 v240, s100, v60
    v_mfma_f32_32x32x16_bf16 v[192:207], v[236:239], a[60:63], v[192:207]
    ds_read_b64_tr_b16 v[232:233], v20 offset:40960
    ds_read_b64_tr_b16 v[234:235], v20 offset:41472
    buffer_load_dwordx4 v17, s[12:15], s71 offen offset:1024 lds
    s_waitcnt lgkmcnt(6)
    v_mfma_f32_32x32x16_bf16 v[112:127], v[208:211], a[64:67], v[112:127]
    ds_read_b64_tr_b16 v[236:237], v21 offset:40960
    ds_read_b64_tr_b16 v[238:239], v21 offset:41472
    s_add_u32 m0, s61, 36736
    v_mul_f32 v241, s100, v61
    v_mul_f32 v242, s100, v62
    v_mfma_f32_32x32x16_bf16 v[128:143], v[212:215], a[64:67], v[128:143]
    ds_read_b64_tr_b16 v[208:209], v20 offset:43008
    ds_read_b64_tr_b16 v[210:211], v20 offset:43520
    buffer_load_dwordx4 v16, s[12:15], s71 offen offset:128 lds
    v_mul_f32 v243, s100, v63
    v_mfma_f32_32x32x16_bf16 v[144:159], v[216:219], a[64:67], v[144:159]
    ds_read_b64_tr_b16 v[212:213], v21 offset:43008
    ds_read_b64_tr_b16 v[214:215], v21 offset:43520
    v_exp_f32_e64 v240, v240 clamp
    v_mfma_f32_32x32x16_bf16 v[160:175], v[220:223], a[64:67], v[160:175]
    ds_read_b64_tr_b16 v[216:217], v20 offset:45056
    ds_read_b64_tr_b16 v[218:219], v20 offset:45568
    buffer_load_dwordx4 v17, s[12:15], s71 offen offset:1152 lds
    s_waitcnt lgkmcnt(6)
    v_mfma_f32_32x32x16_bf16 v[176:191], v[224:227], a[64:67], v[176:191]
    ds_read_b64_tr_b16 v[220:221], v21 offset:45056
    ds_read_b64_tr_b16 v[222:223], v21 offset:45568
    s_add_u32 m0, s61, 38656
    v_exp_f32_e64 v241, v241 clamp
    v_mfma_f32_32x32x16_bf16 v[192:207], v[228:231], a[64:67], v[192:207]
    ds_read_b64_tr_b16 v[224:225], v22 offset:0
    ds_read_b64_tr_b16 v[226:227], v22 offset:512
    buffer_load_dwordx4 v16, s[12:15], s71 offen offset:256 lds
    v_mfma_f32_32x32x16_bf16 v[112:127], v[232:235], a[68:71], v[112:127]
    ds_read_b64_tr_b16 v[228:229], v23 offset:0
    ds_read_b64_tr_b16 v[230:231], v23 offset:512
    v_exp_f32_e64 v242, v242 clamp
    v_mfma_f32_32x32x16_bf16 v[128:143], v[236:239], a[68:71], v[128:143]
    ds_read_b64_tr_b16 v[232:233], v22 offset:2048
    ds_read_b64_tr_b16 v[234:235], v22 offset:2560
    buffer_load_dwordx4 v17, s[12:15], s71 offen offset:1280 lds
    s_waitcnt lgkmcnt(6)
    v_mfma_f32_32x32x16_bf16 v[144:159], v[208:211], a[68:71], v[144:159]
    ds_read_b64_tr_b16 v[236:237], v23 offset:2048
    ds_read_b64_tr_b16 v[238:239], v23 offset:2560
    s_bfe_u32 s71, s65, 0x40000
    s_mul_i32 s71, s71, 245760
    s_add_u32 s71, s71, s72
    v_mfma_f32_32x32x16_bf16 v[160:175], v[212:215], a[68:71], v[160:175]
    ds_read_b64_tr_b16 v[208:209], v22 offset:4096
    ds_read_b64_tr_b16 v[210:211], v22 offset:4608
    buffer_store_dwordx4 a[172:175], v29, s[48:51], s80 offen offset:3072 sc1
    v_mfma_f32_32x32x16_bf16 v[176:191], v[216:219], a[68:71], v[176:191]
    ds_read_b64_tr_b16 v[212:213], v23 offset:4096
    ds_read_b64_tr_b16 v[214:215], v23 offset:4608
    v_exp_f32_e64 v243, v243 clamp
    v_max_f32 v60, s101, v60
    v_mfma_f32_32x32x16_bf16 v[192:207], v[220:223], a[68:71], v[192:207]
    ds_read_b64_tr_b16 v[216:217], v22 offset:40960
    ds_read_b64_tr_b16 v[218:219], v22 offset:41472
    v_max_f32 v61, s101, v61
    v_max_f32 v62, s101, v62
    s_waitcnt lgkmcnt(6)
    v_mfma_f32_32x32x16_bf16 v[112:127], v[224:227], a[72:75], v[112:127]
    ds_read_b64_tr_b16 v[220:221], v23 offset:40960
    ds_read_b64_tr_b16 v[222:223], v23 offset:41472
    buffer_store_dwordx4 a[176:179], v30, s[48:51], s80 offen offset:0 sc1
    v_max_f32 v63, s101, v63
    v_mfma_f32_32x32x16_bf16 v[128:143], v[228:231], a[72:75], v[128:143]
    ds_read_b64_tr_b16 v[224:225], v22 offset:43008
    ds_read_b64_tr_b16 v[226:227], v22 offset:43520
    v_add_f32 v60, v60, v240
    v_add_f32 v61, v61, v241
    v_add_f32 v62, v62, v242
    v_mfma_f32_32x32x16_bf16 v[144:159], v[232:235], a[72:75], v[144:159]
    ds_read_b64_tr_b16 v[228:229], v23 offset:43008
    ds_read_b64_tr_b16 v[230:231], v23 offset:43520
    s_add_u32 s80, s80, 245760
    v_add_f32 v63, v63, v243
    v_mul_f32 v240, s100, v64
    v_mfma_f32_32x32x16_bf16 v[160:175], v[236:239], a[72:75], v[160:175]
    ds_read_b64_tr_b16 v[232:233], v22 offset:45056
    ds_read_b64_tr_b16 v[234:235], v22 offset:45568
    v_mul_f32 v241, s100, v65
    v_mul_f32 v242, s100, v66
    s_waitcnt lgkmcnt(6)
    v_mfma_f32_32x32x16_bf16 v[176:191], v[208:211], a[72:75], v[176:191]
    ds_read_b64_tr_b16 v[236:237], v23 offset:45056
    ds_read_b64_tr_b16 v[238:239], v23 offset:45568
    buffer_store_dwordx4 a[180:183], v29, s[48:51], s80 offen offset:0 sc1
    v_mul_f32 v243, s100, v67
    v_mfma_f32_32x32x16_bf16 v[192:207], v[212:215], a[72:75], v[192:207]
    v_exp_f32_e64 v240, v240 clamp
    v_exp_f32_e64 v241, v241 clamp
    v_exp_f32_e64 v242, v242 clamp
    v_mfma_f32_32x32x16_bf16 v[112:127], v[216:219], a[76:79], v[112:127]
    v_exp_f32_e64 v243, v243 clamp
    s_waitcnt vmcnt(18) lgkmcnt(0)
    s_barrier
    v_mfma_f32_32x32x16_bf16 v[128:143], v[220:223], a[76:79], v[128:143]
    ds_read_b64_tr_b16 v[208:209], v20 offset:6144
    ds_read_b64_tr_b16 v[210:211], v20 offset:6656
    ds_read_b64_tr_b16 v[212:213], v21 offset:6144
    ds_read_b64_tr_b16 v[214:215], v21 offset:6656
    v_max_f32 v64, s101, v64
    v_mfma_f32_32x32x16_bf16 v[144:159], v[224:227], a[76:79], v[144:159]
    ds_read_b64_tr_b16 v[216:217], v20 offset:8192
    ds_read_b64_tr_b16 v[218:219], v20 offset:8704
    ds_read_b64_tr_b16 v[220:221], v21 offset:8192
    ds_read_b64_tr_b16 v[222:223], v21 offset:8704
    v_max_f32 v65, s101, v65
    v_mfma_f32_32x32x16_bf16 v[160:175], v[228:231], a[76:79], v[160:175]
    ds_read_b64_tr_b16 v[224:225], v20 offset:10240
    ds_read_b64_tr_b16 v[226:227], v20 offset:10752
    buffer_store_dwordx4 a[184:187], v29, s[48:51], s80 offen offset:1024 sc1
    v_max_f32 v66, s101, v66
    v_mfma_f32_32x32x16_bf16 v[176:191], v[232:235], a[76:79], v[176:191]
    ds_read_b64_tr_b16 v[228:229], v21 offset:10240
    ds_read_b64_tr_b16 v[230:231], v21 offset:10752
    v_max_f32 v67, s101, v67
    v_add_f32 v64, v64, v240
    v_add_f32 v65, v65, v241
    v_mfma_f32_32x32x16_bf16 v[192:207], v[236:239], a[76:79], v[192:207]
    ds_read_b64_tr_b16 v[232:233], v20 offset:47104
    ds_read_b64_tr_b16 v[234:235], v20 offset:47616
    s_add_u32 m0, s61, 16384
    v_add_f32 v66, v66, v242
    s_waitcnt lgkmcnt(6)
    v_mfma_f32_32x32x16_bf16 v[112:127], v[208:211], a[80:83], v[112:127]
    ds_read_b64_tr_b16 v[236:237], v21 offset:47104
    ds_read_b64_tr_b16 v[238:239], v21 offset:47616
    buffer_load_dwordx4 v16, s[12:15], s71 offen offset:0 lds
    v_mfma_f32_32x32x16_bf16 v[128:143], v[212:215], a[80:83], v[128:143]
    ds_read_b64_tr_b16 v[208:209], v20 offset:49152
    ds_read_b64_tr_b16 v[210:211], v20 offset:49664
    v_add_f32 v67, v67, v243
    v_mul_f32 v240, s100, v68
    v_mul_f32 v241, s100, v69
    v_mfma_f32_32x32x16_bf16 v[144:159], v[216:219], a[80:83], v[144:159]
    ds_read_b64_tr_b16 v[212:213], v21 offset:49152
    ds_read_b64_tr_b16 v[214:215], v21 offset:49664
    buffer_load_dwordx4 v17, s[12:15], s71 offen offset:1024 lds
    v_mul_f32 v242, s100, v70
    v_mfma_f32_32x32x16_bf16 v[160:175], v[220:223], a[80:83], v[160:175]
    ds_read_b64_tr_b16 v[216:217], v20 offset:51200
    ds_read_b64_tr_b16 v[218:219], v20 offset:51712
    s_mov_b32 m0, s61
    v_mul_f32 v243, s100, v71
    s_waitcnt lgkmcnt(6)
    v_mfma_f32_32x32x16_bf16 v[176:191], v[224:227], a[80:83], v[176:191]
    ds_read_b64_tr_b16 v[220:221], v21 offset:51200
    ds_read_b64_tr_b16 v[222:223], v21 offset:51712
    buffer_load_dwordx4 v40, s[16:19], s95 offen offset:0 lds
    v_mfma_f32_32x32x16_bf16 v[192:207], v[228:231], a[80:83], v[192:207]
    ds_read_b64_tr_b16 v[224:225], v22 offset:6144
    ds_read_b64_tr_b16 v[226:227], v22 offset:6656
    v_exp_f32_e64 v240, v240 clamp
    v_mfma_f32_32x32x16_bf16 v[112:127], v[232:235], a[84:87], v[112:127]
    ds_read_b64_tr_b16 v[228:229], v23 offset:6144
    ds_read_b64_tr_b16 v[230:231], v23 offset:6656
    v_exp_f32_e64 v241, v241 clamp
    v_mfma_f32_32x32x16_bf16 v[128:143], v[236:239], a[84:87], v[128:143]
    ds_read_b64_tr_b16 v[232:233], v22 offset:8192
    ds_read_b64_tr_b16 v[234:235], v22 offset:8704
    buffer_load_dwordx4 v41, s[16:19], s95 offen offset:1024 lds
    s_waitcnt lgkmcnt(6)
    v_mfma_f32_32x32x16_bf16 v[144:159], v[208:211], a[84:87], v[144:159]
    ds_read_b64_tr_b16 v[236:237], v23 offset:8192
    ds_read_b64_tr_b16 v[238:239], v23 offset:8704
    v_exp_f32_e64 v242, v242 clamp
    v_mfma_f32_32x32x16_bf16 v[160:175], v[212:215], a[84:87], v[160:175]
    ds_read_b64_tr_b16 v[208:209], v22 offset:10240
    ds_read_b64_tr_b16 v[210:211], v22 offset:10752
    v_exp_f32_e64 v243, v243 clamp
    v_max_f32 v68, s101, v68
    v_mfma_f32_32x32x16_bf16 v[176:191], v[216:219], a[84:87], v[176:191]
    ds_read_b64_tr_b16 v[212:213], v23 offset:10240
    ds_read_b64_tr_b16 v[214:215], v23 offset:10752
    v_max_f32 v69, s101, v69
    v_max_f32 v70, s101, v70
    v_max_f32 v71, s101, v71
    v_mfma_f32_32x32x16_bf16 v[192:207], v[220:223], a[84:87], v[192:207]
    ds_read_b64_tr_b16 v[216:217], v22 offset:47104
    ds_read_b64_tr_b16 v[218:219], v22 offset:47616
    buffer_load_dwordx4 v42, s[16:19], s95 offen offset:2048 lds
    s_waitcnt lgkmcnt(6)
    v_mfma_f32_32x32x16_bf16 v[112:127], v[224:227], a[88:91], v[112:127]
    ds_read_b64_tr_b16 v[220:221], v23 offset:47104
    ds_read_b64_tr_b16 v[222:223], v23 offset:47616
    v_add_f32 v68, v68, v240
    v_add_f32 v69, v69, v241
    v_add_f32 v70, v70, v242
    v_mfma_f32_32x32x16_bf16 v[128:143], v[228:231], a[88:91], v[128:143]
    ds_read_b64_tr_b16 v[224:225], v22 offset:49152
    ds_read_b64_tr_b16 v[226:227], v22 offset:49664
    v_add_f32 v71, v71, v243
    v_mul_f32 v240, s100, v72
    v_mul_f32 v241, s100, v73
    v_mfma_f32_32x32x16_bf16 v[144:159], v[232:235], a[88:91], v[144:159]
    ds_read_b64_tr_b16 v[228:229], v23 offset:49152
    ds_read_b64_tr_b16 v[230:231], v23 offset:49664
    buffer_load_dwordx4 v43, s[16:19], s95 offen offset:3072 lds
    v_mul_f32 v242, s100, v74
    v_mfma_f32_32x32x16_bf16 v[160:175], v[236:239], a[88:91], v[160:175]
    ds_read_b64_tr_b16 v[232:233], v22 offset:51200
    ds_read_b64_tr_b16 v[234:235], v22 offset:51712
    v_mul_f32 v243, s100, v75
    s_waitcnt lgkmcnt(6)
    v_mfma_f32_32x32x16_bf16 v[176:191], v[208:211], a[88:91], v[176:191]
    ds_read_b64_tr_b16 v[236:237], v23 offset:51200
    ds_read_b64_tr_b16 v[238:239], v23 offset:51712
    s_add_u32 m0, s61, 4096
    v_exp_f32_e64 v240, v240 clamp
    v_mfma_f32_32x32x16_bf16 v[192:207], v[212:215], a[88:91], v[192:207]
    v_exp_f32_e64 v241, v241 clamp
    v_exp_f32_e64 v242, v242 clamp
    v_mfma_f32_32x32x16_bf16 v[112:127], v[216:219], a[92:95], v[112:127]
    buffer_load_dwordx4 v44, s[16:19], s95 offen offset:0 lds
    s_waitcnt vmcnt(20) lgkmcnt(0)
    s_barrier
    v_mfma_f32_32x32x16_bf16 v[128:143], v[220:223], a[92:95], v[128:143]
    ds_read_b64_tr_b16 v[208:209], v20 offset:12288
    ds_read_b64_tr_b16 v[210:211], v20 offset:12800
    ds_read_b64_tr_b16 v[212:213], v21 offset:12288
    ds_read_b64_tr_b16 v[214:215], v21 offset:12800
    s_add_u32 s95, s95, 40960
    v_mfma_f32_32x32x16_bf16 v[144:159], v[224:227], a[92:95], v[144:159]
    ds_read_b64_tr_b16 v[216:217], v20 offset:14336
    ds_read_b64_tr_b16 v[218:219], v20 offset:14848
    ds_read_b64_tr_b16 v[220:221], v21 offset:14336
    ds_read_b64_tr_b16 v[222:223], v21 offset:14848
    s_add_u32 m0, s61, 5120
    v_mfma_f32_32x32x16_bf16 v[160:175], v[228:231], a[92:95], v[160:175]
    ds_read_b64_tr_b16 v[224:225], v20 offset:16384
    ds_read_b64_tr_b16 v[226:227], v20 offset:16896
    buffer_load_dwordx4 v40, s[16:19], s95 offen offset:0 lds
    v_mfma_f32_32x32x16_bf16 v[176:191], v[232:235], a[92:95], v[176:191]
    ds_read_b64_tr_b16 v[228:229], v21 offset:16384
    ds_read_b64_tr_b16 v[230:231], v21 offset:16896
    v_exp_f32_e64 v243, v243 clamp
    v_max_f32 v72, s101, v72
    v_mfma_f32_32x32x16_bf16 v[192:207], v[236:239], a[92:95], v[192:207]
    ds_read_b64_tr_b16 v[232:233], v20 offset:53248
    ds_read_b64_tr_b16 v[234:235], v20 offset:53760
    v_max_f32 v73, s101, v73
    v_max_f32 v74, s101, v74
    s_waitcnt lgkmcnt(6)
    v_mfma_f32_32x32x16_bf16 v[112:127], v[208:211], a[96:99], v[112:127]
    ds_read_b64_tr_b16 v[236:237], v21 offset:53248
    ds_read_b64_tr_b16 v[238:239], v21 offset:53760
    buffer_load_dwordx4 v41, s[16:19], s95 offen offset:1024 lds
    v_max_f32 v75, s101, v75
    v_mfma_f32_32x32x16_bf16 v[128:143], v[212:215], a[96:99], v[128:143]
    ds_read_b64_tr_b16 v[208:209], v20 offset:55296
    ds_read_b64_tr_b16 v[210:211], v20 offset:55808
    v_add_f32 v72, v72, v240
    v_add_f32 v73, v73, v241
    v_add_f32 v74, v74, v242
    v_mfma_f32_32x32x16_bf16 v[144:159], v[216:219], a[96:99], v[144:159]
    ds_read_b64_tr_b16 v[212:213], v21 offset:55296
    ds_read_b64_tr_b16 v[214:215], v21 offset:55808
    s_add_u32 m0, s61, 18304
    v_add_f32 v75, v75, v243
    v_cvt_pk_bf16_f32 v48, v48, v49
    v_mfma_f32_32x32x16_bf16 v[160:175], v[220:223], a[96:99], v[160:175]
    ds_read_b64_tr_b16 v[216:217], v20 offset:57344
    ds_read_b64_tr_b16 v[218:219], v20 offset:57856
    buffer_load_dwordx4 v16, s[12:15], s71 offen offset:128 lds
    s_waitcnt lgkmcnt(6)
    v_mfma_f32_32x32x16_bf16 v[176:191], v[224:227], a[96:99], v[176:191]
    ds_read_b64_tr_b16 v[220:221], v21 offset:57344
    ds_read_b64_tr_b16 v[222:223], v21 offset:57856
    v_cvt_pk_bf16_f32 v49, v50, v51
    v_cvt_pk_bf16_f32 v50, v52, v53
    v_cvt_pk_bf16_f32 v51, v54, v55
    v_mfma_f32_32x32x16_bf16 v[192:207], v[228:231], a[96:99], v[192:207]
    ds_read_b64_tr_b16 v[224:225], v22 offset:12288
    ds_read_b64_tr_b16 v[226:227], v22 offset:12800
    buffer_store_dwordx4 v[48:51], v25, s[48:51], s86 offen offset:0 sc1
    v_mul_f32 v240, s100, v76
    v_mfma_f32_32x32x16_bf16 v[112:127], v[232:235], a[100:103], v[112:127]
    ds_read_b64_tr_b16 v[228:229], v23 offset:12288
    ds_read_b64_tr_b16 v[230:231], v23 offset:12800
    v_mul_f32 v241, s100, v77
    v_mul_f32 v242, s100, v78
    v_mul_f32 v243, s100, v79
    v_mfma_f32_32x32x16_bf16 v[128:143], v[236:239], a[100:103], v[128:143]
    ds_read_b64_tr_b16 v[232:233], v22 offset:14336
    ds_read_b64_tr_b16 v[234:235], v22 offset:14848
    buffer_load_dwordx4 v17, s[12:15], s71 offen offset:1152 lds
    s_add_u32 m0, s61, 20224
    s_waitcnt lgkmcnt(6)
    v_mfma_f32_32x32x16_bf16 v[144:159], v[208:211], a[100:103], v[144:159]
    ds_read_b64_tr_b16 v[236:237], v23 offset:14336
    ds_read_b64_tr_b16 v[238:239], v23 offset:14848
    buffer_load_dwordx4 v16, s[12:15], s71 offen offset:256 lds
    v_mfma_f32_32x32x16_bf16 v[160:175], v[212:215], a[100:103], v[160:175]
    ds_read_b64_tr_b16 v[208:209], v22 offset:16384
    ds_read_b64_tr_b16 v[210:211], v22 offset:16896
    buffer_load_dwordx4 v17, s[12:15], s71 offen offset:1280 lds
    s_bfe_u32 s71, s65, 0x40004
    s_mul_i32 s71, s71, 245760
    s_add_u32 s71, s71, s72
    s_add_u32 m0, s61, 22528
    v_mfma_f32_32x32x16_bf16 v[176:191], v[216:219], a[100:103], v[176:191]
    ds_read_b64_tr_b16 v[212:213], v23 offset:16384
    ds_read_b64_tr_b16 v[214:215], v23 offset:16896
    v_exp_f32_e64 v240, v240 clamp
    v_mfma_f32_32x32x16_bf16 v[192:207], v[220:223], a[100:103], v[192:207]
    ds_read_b64_tr_b16 v[216:217], v22 offset:53248
    ds_read_b64_tr_b16 v[218:219], v22 offset:53760
    v_exp_f32_e64 v241, v241 clamp
    s_waitcnt lgkmcnt(6)
    v_mfma_f32_32x32x16_bf16 v[112:127], v[224:227], a[104:107], v[112:127]
    ds_read_b64_tr_b16 v[220:221], v23 offset:53248
    ds_read_b64_tr_b16 v[222:223], v23 offset:53760
    v_exp_f32_e64 v242, v242 clamp
    v_mfma_f32_32x32x16_bf16 v[128:143], v[228:231], a[104:107], v[128:143]
    ds_read_b64_tr_b16 v[224:225], v22 offset:55296
    ds_read_b64_tr_b16 v[226:227], v22 offset:55808
    v_exp_f32_e64 v243, v243 clamp
    v_max_f32 v76, s101, v76
    v_mfma_f32_32x32x16_bf16 v[144:159], v[232:235], a[104:107], v[144:159]
    ds_read_b64_tr_b16 v[228:229], v23 offset:55296
    ds_read_b64_tr_b16 v[230:231], v23 offset:55808
    buffer_load_dwordx4 v16, s[12:15], s71 offen offset:0 lds
    v_max_f32 v77, s101, v77
    v_mfma_f32_32x32x16_bf16 v[160:175], v[236:239], a[104:107], v[160:175]
    ds_read_b64_tr_b16 v[232:233], v22 offset:57344
    ds_read_b64_tr_b16 v[234:235], v22 offset:57856
    v_max_f32 v78, s101, v78
    v_max_f32 v79, s101, v79
    s_waitcnt lgkmcnt(6)
    v_mfma_f32_32x32x16_bf16 v[176:191], v[208:211], a[104:107], v[176:191]
    ds_read_b64_tr_b16 v[236:237], v23 offset:57344
    ds_read_b64_tr_b16 v[238:239], v23 offset:57856
    buffer_load_dwordx4 v17, s[12:15], s71 offen offset:1024 lds
    v_add_f32 v76, v76, v240
    v_mfma_f32_32x32x16_bf16 v[192:207], v[212:215], a[104:107], v[192:207]
    s_add_u32 m0, s61, 24448
    v_add_f32 v77, v77, v241
    v_add_f32 v78, v78, v242
    v_add_f32 v79, v79, v243
    v_cvt_pk_bf16_f32 v52, v56, v57
    v_mfma_f32_32x32x16_bf16 v[112:127], v[216:219], a[108:111], v[112:127]
    v_cvt_pk_bf16_f32 v53, v58, v59
    v_cvt_pk_bf16_f32 v54, v60, v61
    s_waitcnt vmcnt(20) lgkmcnt(0)
    s_barrier
    v_mfma_f32_32x32x16_bf16 v[128:143], v[220:223], a[108:111], v[128:143]
    ds_read_b64_tr_b16 v[208:209], v20 offset:18432
    ds_read_b64_tr_b16 v[210:211], v20 offset:18944
    ds_read_b64_tr_b16 v[212:213], v21 offset:18432
    ds_read_b64_tr_b16 v[214:215], v21 offset:18944
    v_cvt_pk_bf16_f32 v55, v62, v63
    v_mfma_f32_32x32x16_bf16 v[144:159], v[224:227], a[108:111], v[144:159]
    ds_read_b64_tr_b16 v[216:217], v20 offset:20480
    ds_read_b64_tr_b16 v[218:219], v20 offset:20992
    ds_read_b64_tr_b16 v[220:221], v21 offset:20480
    ds_read_b64_tr_b16 v[222:223], v21 offset:20992
    v_mfma_f32_32x32x16_bf16 v[160:175], v[228:231], a[108:111], v[160:175]
    ds_read_b64_tr_b16 v[224:225], v20 offset:22528
    ds_read_b64_tr_b16 v[226:227], v20 offset:23040
    buffer_store_dwordx4 v[52:55], v25, s[48:51], s86 offen offset:512 sc1
    v_mul_f32 v240, s100, v80
    v_mfma_f32_32x32x16_bf16 v[176:191], v[232:235], a[108:111], v[176:191]
    ds_read_b64_tr_b16 v[228:229], v21 offset:22528
    ds_read_b64_tr_b16 v[230:231], v21 offset:23040
    v_mul_f32 v241, s100, v81
    v_mul_f32 v242, s100, v82
    v_mul_f32 v243, s100, v83
    v_mfma_f32_32x32x16_bf16 v[192:207], v[236:239], a[108:111], v[192:207]
    ds_read_b64_tr_b16 v[232:233], v20 offset:59392
    ds_read_b64_tr_b16 v[234:235], v20 offset:59904
    v_exp_f32_e64 v240, v240 clamp
    s_waitcnt lgkmcnt(6)
    v_mfma_f32_32x32x16_bf16 v[112:127], v[208:211], a[112:115], v[112:127]
    ds_read_b64_tr_b16 v[236:237], v21 offset:59392
    ds_read_b64_tr_b16 v[238:239], v21 offset:59904
    buffer_load_dwordx4 v16, s[12:15], s71 offen offset:128 lds
    v_mfma_f32_32x32x16_bf16 v[128:143], v[212:215], a[112:115], v[128:143]
    ds_read_b64_tr_b16 v[208:209], v20 offset:61440
    ds_read_b64_tr_b16 v[210:211], v20 offset:61952
    v_exp_f32_e64 v241, v241 clamp
    v_mfma_f32_32x32x16_bf16 v[144:159], v[216:219], a[112:115], v[144:159]
    ds_read_b64_tr_b16 v[212:213], v21 offset:61440
    ds_read_b64_tr_b16 v[214:215], v21 offset:61952
    buffer_load_dwordx4 v17, s[12:15], s71 offen offset:1152 lds
    v_mfma_f32_32x32x16_bf16 v[160:175], v[220:223], a[112:115], v[160:175]
    ds_read_b64_tr_b16 v[216:217], v20 offset:63488
    ds_read_b64_tr_b16 v[218:219], v20 offset:64000
    s_add_u32 m0, s61, 26368
    s_waitcnt lgkmcnt(6)
    v_mfma_f32_32x32x16_bf16 v[176:191], v[224:227], a[112:115], v[176:191]
    ds_read_b64_tr_b16 v[220:221], v21 offset:63488
    ds_read_b64_tr_b16 v[222:223], v21 offset:64000
    buffer_load_dwordx4 v16, s[12:15], s71 offen offset:256 lds
    v_mfma_f32_32x32x16_bf16 v[192:207], v[228:231], a[112:115], v[192:207]
    ds_read_b64_tr_b16 v[224:225], v22 offset:18432
    ds_read_b64_tr_b16 v[226:227], v22 offset:18944
    v_exp_f32_e64 v242, v242 clamp
    v_mfma_f32_32x32x16_bf16 v[112:127], v[232:235], a[116:119], v[112:127]
    ds_read_b64_tr_b16 v[228:229], v23 offset:18432
    ds_read_b64_tr_b16 v[230:231], v23 offset:18944
    buffer_load_dwordx4 v17, s[12:15], s71 offen offset:1280 lds
    v_mfma_f32_32x32x16_bf16 v[128:143], v[236:239], a[116:119], v[128:143]
    ds_read_b64_tr_b16 v[232:233], v22 offset:20480
    ds_read_b64_tr_b16 v[234:235], v22 offset:20992
    v_exp_f32_e64 v243, v243 clamp
    s_waitcnt lgkmcnt(6)
    v_mfma_f32_32x32x16_bf16 v[144:159], v[208:211], a[116:119], v[144:159]
    ds_read_b64_tr_b16 v[236:237], v23 offset:20480
    ds_read_b64_tr_b16 v[238:239], v23 offset:20992
    buffer_store_dwordx4 a[188:191], v29, s[48:51], s80 offen offset:2048 sc1
    v_max_f32 v80, s101, v80
    v_mfma_f32_32x32x16_bf16 v[160:175], v[212:215], a[116:119], v[160:175]
    ds_read_b64_tr_b16 v[208:209], v22 offset:22528
    ds_read_b64_tr_b16 v[210:211], v22 offset:23040
    v_max_f32 v81, s101, v81
    v_max_f32 v82, s101, v82
    v_max_f32 v83, s101, v83
    v_mfma_f32_32x32x16_bf16 v[176:191], v[216:219], a[116:119], v[176:191]
    ds_read_b64_tr_b16 v[212:213], v23 offset:22528
    ds_read_b64_tr_b16 v[214:215], v23 offset:23040
    v_add_f32 v80, v80, v240
    v_add_f32 v81, v81, v241
    v_add_f32 v82, v82, v242
    v_mfma_f32_32x32x16_bf16 v[192:207], v[220:223], a[116:119], v[192:207]
    ds_read_b64_tr_b16 v[216:217], v22 offset:59392
    ds_read_b64_tr_b16 v[218:219], v22 offset:59904
    v_add_f32 v83, v83, v243
    v_cvt_pk_bf16_f32 v56, v64, v65
    s_waitcnt lgkmcnt(6)
    v_mfma_f32_32x32x16_bf16 v[112:127], v[224:227], a[120:123], v[112:127]
    ds_read_b64_tr_b16 v[220:221], v23 offset:59392
    ds_read_b64_tr_b16 v[222:223], v23 offset:59904
    buffer_store_dwordx4 a[192:195], v29, s[48:51], s80 offen offset:3072 sc1
    v_cvt_pk_bf16_f32 v57, v66, v67
    v_mfma_f32_32x32x16_bf16 v[128:143], v[228:231], a[120:123], v[128:143]
    ds_read_b64_tr_b16 v[224:225], v22 offset:61440
    ds_read_b64_tr_b16 v[226:227], v22 offset:61952
    v_cvt_pk_bf16_f32 v58, v68, v69
    v_cvt_pk_bf16_f32 v59, v70, v71
    v_mfma_f32_32x32x16_bf16 v[144:159], v[232:235], a[120:123], v[144:159]
    ds_read_b64_tr_b16 v[228:229], v23 offset:61440
    ds_read_b64_tr_b16 v[230:231], v23 offset:61952
    v_mfma_f32_32x32x16_bf16 v[160:175], v[236:239], a[120:123], v[160:175]
    ds_read_b64_tr_b16 v[232:233], v22 offset:63488
    ds_read_b64_tr_b16 v[234:235], v22 offset:64000
    buffer_store_dwordx4 v[56:59], v25, s[48:51], s86 offen offset:1024 sc1
    s_waitcnt lgkmcnt(6)
    v_mfma_f32_32x32x16_bf16 v[176:191], v[208:211], a[120:123], v[176:191]
    ds_read_b64_tr_b16 v[236:237], v23 offset:63488
    ds_read_b64_tr_b16 v[238:239], v23 offset:64000
    v_mul_f32 v240, s100, v84
    v_mul_f32 v241, s100, v85
    v_mul_f32 v242, s100, v86
    v_mfma_f32_32x32x16_bf16 v[192:207], v[212:215], a[120:123], v[192:207]
    v_mul_f32 v243, s100, v87
    v_exp_f32_e64 v240, v240 clamp
    v_exp_f32_e64 v241, v241 clamp
    v_mfma_f32_32x32x16_bf16 v[112:127], v[216:219], a[124:127], v[112:127]
    v_exp_f32_e64 v242, v242 clamp
    s_waitcnt vmcnt(10) lgkmcnt(0)
    s_barrier
    v_mfma_f32_32x32x16_bf16 v[128:143], v[220:223], a[124:127], v[128:143]
    ds_read_b64_tr_b16 v[208:209], v20 offset:0
    ds_read_b64_tr_b16 v[210:211], v20 offset:512
    ds_read_b64_tr_b16 v[212:213], v21 offset:0
    ds_read_b64_tr_b16 v[214:215], v21 offset:512
    v_mfma_f32_32x32x16_bf16 v[144:159], v[224:227], a[124:127], v[144:159]
    ds_read_b64_tr_b16 v[216:217], v20 offset:2048
    ds_read_b64_tr_b16 v[218:219], v20 offset:2560
    ds_read_b64_tr_b16 v[220:221], v21 offset:2048
    ds_read_b64_tr_b16 v[222:223], v21 offset:2560
    v_mfma_f32_32x32x16_bf16 v[160:175], v[228:231], a[124:127], v[160:175]
    ds_read_b64_tr_b16 v[224:225], v20 offset:4096
    ds_read_b64_tr_b16 v[226:227], v20 offset:4608
    buffer_store_dwordx4 a[196:199], v30, s[48:51], s80 offen offset:0 sc1
    ds_read_b64_tr_b16 a[220:221], v251 offset:0
    v_mfma_f32_32x32x16_bf16 v[176:191], v[232:235], a[124:127], v[176:191]
    ds_read_b64_tr_b16 v[228:229], v21 offset:4096
    ds_read_b64_tr_b16 v[230:231], v21 offset:4608
    ds_read_b64_tr_b16 a[222:223], v251 offset:640
    ds_read_b64_tr_b16 a[224:225], v251 offset:2560
    v_mfma_f32_32x32x16_bf16 v[192:207], v[236:239], a[124:127], v[192:207]
    ds_read_b64_tr_b16 v[232:233], v20 offset:40960
    ds_read_b64_tr_b16 v[234:235], v20 offset:41472
    ds_read_b64_tr_b16 a[226:227], v251 offset:3200
    ds_read_b64_tr_b16 a[228:229], v253 offset:5120
    s_waitcnt lgkmcnt(11)
    v_mfma_f32_32x32x16_bf16 v[112:127], v[208:211], a[128:131], v[112:127]
    ds_read_b64_tr_b16 v[236:237], v21 offset:40960
    ds_read_b64_tr_b16 v[238:239], v21 offset:41472
    ds_read_b64_tr_b16 a[230:231], v253 offset:5760
    ds_read_b64_tr_b16 a[232:233], v251 offset:64
    v_mfma_f32_32x32x16_bf16 v[128:143], v[212:215], a[128:131], v[128:143]
    ds_read_b64_tr_b16 v[208:209], v20 offset:43008
    ds_read_b64_tr_b16 v[210:211], v20 offset:43520
    ds_read_b64_tr_b16 a[234:235], v251 offset:704
    ds_read_b64_tr_b16 a[236:237], v251 offset:2624
    v_mfma_f32_32x32x16_bf16 v[144:159], v[216:219], a[128:131], v[144:159]
    ds_read_b64_tr_b16 v[212:213], v21 offset:43008
    ds_read_b64_tr_b16 v[214:215], v21 offset:43520
    ds_read_b64_tr_b16 a[238:239], v251 offset:3264
    ds_read_b64_tr_b16 a[240:241], v253 offset:5184
    v_mfma_f32_32x32x16_bf16 v[160:175], v[220:223], a[128:131], v[160:175]
    ds_read_b64_tr_b16 v[216:217], v20 offset:45056
    ds_read_b64_tr_b16 v[218:219], v20 offset:45568
    ds_read_b64_tr_b16 a[242:243], v253 offset:5824
    ds_read_b64_tr_b16 a[244:245], v252 offset:128
    s_waitcnt lgkmcnt(14)
    v_mfma_f32_32x32x16_bf16 v[176:191], v[224:227], a[128:131], v[176:191]
    ds_read_b64_tr_b16 v[220:221], v21 offset:45056
    ds_read_b64_tr_b16 v[222:223], v21 offset:45568
    ds_read_b64_tr_b16 a[246:247], v252 offset:768
    ds_read_b64_tr_b16 a[248:249], v252 offset:2688
    v_mfma_f32_32x32x16_bf16 v[192:207], v[228:231], a[128:131], v[192:207]
    ds_read_b64_tr_b16 v[224:225], v22 offset:0
    ds_read_b64_tr_b16 v[226:227], v22 offset:512
    ds_read_b64_tr_b16 a[250:251], v252 offset:3328
    ds_read_b64_tr_b16 a[252:253], v254 offset:5248
    v_mfma_f32_32x32x16_bf16 v[112:127], v[232:235], a[132:135], v[112:127]
    ds_read_b64_tr_b16 v[228:229], v23 offset:0
    ds_read_b64_tr_b16 v[230:231], v23 offset:512
    ds_read_b64_tr_b16 a[254:255], v254 offset:5888
    v_exp_f32_e64 v243, v243 clamp
    v_mfma_f32_32x32x16_bf16 v[128:143], v[236:239], a[132:135], v[128:143]
    ds_read_b64_tr_b16 v[232:233], v22 offset:2048
    ds_read_b64_tr_b16 v[234:235], v22 offset:2560
    v_max_f32 v84, s101, v84
    v_max_f32 v85, s101, v85
    s_waitcnt lgkmcnt(11)
    v_mfma_f32_32x32x16_bf16 v[144:159], v[208:211], a[132:135], v[144:159]
    ds_read_b64_tr_b16 v[236:237], v23 offset:2048
    ds_read_b64_tr_b16 v[238:239], v23 offset:2560
    v_max_f32 v86, s101, v86
    v_max_f32 v87, s101, v87
    v_add_f32 v84, v84, v240
    v_mfma_f32_32x32x16_bf16 v[160:175], v[212:215], a[132:135], v[160:175]
    ds_read_b64_tr_b16 v[208:209], v22 offset:4096
    ds_read_b64_tr_b16 v[210:211], v22 offset:4608
    v_add_f32 v85, v85, v241
    v_add_f32 v86, v86, v242
    v_add_f32 v87, v87, v243
    v_mfma_f32_32x32x16_bf16 v[176:191], v[216:219], a[132:135], v[176:191]
    ds_read_b64_tr_b16 v[212:213], v23 offset:4096
    ds_read_b64_tr_b16 v[214:215], v23 offset:4608
    v_cvt_pk_bf16_f32 v60, v72, v73
    v_cvt_pk_bf16_f32 v61, v74, v75
    v_cvt_pk_bf16_f32 v62, v76, v77
    v_mfma_f32_32x32x16_bf16 v[192:207], v[220:223], a[132:135], v[192:207]
    ds_read_b64_tr_b16 v[216:217], v22 offset:40960
    ds_read_b64_tr_b16 v[218:219], v22 offset:41472
    v_cvt_pk_bf16_f32 v63, v78, v79
    s_waitcnt lgkmcnt(6)
    v_mfma_f32_32x32x16_bf16 v[112:127], v[224:227], a[136:139], v[112:127]
    ds_read_b64_tr_b16 v[220:221], v23 offset:40960
    ds_read_b64_tr_b16 v[222:223], v23 offset:41472
    buffer_store_dwordx4 v[60:63], v25, s[48:51], s86 offen offset:1536 sc1
    v_mul_f32 v240, s100, v88
    v_mfma_f32_32x32x16_bf16 v[128:143], v[228:231], a[136:139], v[128:143]
    ds_read_b64_tr_b16 v[224:225], v22 offset:43008
    ds_read_b64_tr_b16 v[226:227], v22 offset:43520
    v_mul_f32 v241, s100, v89
    v_mul_f32 v242, s100, v90
    v_mul_f32 v243, s100, v91
    v_mfma_f32_32x32x16_bf16 v[144:159], v[232:235], a[136:139], v[144:159]
    ds_read_b64_tr_b16 v[228:229], v23 offset:43008
    ds_read_b64_tr_b16 v[230:231], v23 offset:43520
    v_exp_f32_e64 v240, v240 clamp
    v_mfma_f32_32x32x16_bf16 v[160:175], v[236:239], a[136:139], v[160:175]
    ds_read_b64_tr_b16 v[232:233], v22 offset:45056
    ds_read_b64_tr_b16 v[234:235], v22 offset:45568
    v_exp_f32_e64 v241, v241 clamp
    s_waitcnt lgkmcnt(6)
    v_mfma_f32_32x32x16_bf16 v[176:191], v[208:211], a[136:139], v[176:191]
    ds_read_b64_tr_b16 v[236:237], v23 offset:45056
    ds_read_b64_tr_b16 v[238:239], v23 offset:45568
    v_exp_f32_e64 v242, v242 clamp
    v_mfma_f32_32x32x16_bf16 v[192:207], v[212:215], a[136:139], v[192:207]
    v_exp_f32_e64 v243, v243 clamp
    v_max_f32 v88, s101, v88
    v_max_f32 v89, s101, v89
    v_max_f32 v90, s101, v90
    v_max_f32 v91, s101, v91
    v_mfma_f32_32x32x16_bf16 v[112:127], v[216:219], a[140:143], v[112:127]
    v_add_f32 v88, v88, v240
    v_add_f32 v89, v89, v241
    s_waitcnt vmcnt(5) lgkmcnt(0)
    s_barrier
    v_mfma_f32_32x32x16_bf16 v[128:143], v[220:223], a[140:143], v[128:143]
    ds_read_b64_tr_b16 v[208:209], v20 offset:6144
    ds_read_b64_tr_b16 v[210:211], v20 offset:6656
    ds_read_b64_tr_b16 v[212:213], v21 offset:6144
    ds_read_b64_tr_b16 v[214:215], v21 offset:6656
    v_add_f32 v90, v90, v242
    v_mfma_f32_32x32x16_bf16 v[144:159], v[224:227], a[140:143], v[144:159]
    ds_read_b64_tr_b16 v[216:217], v20 offset:8192
    ds_read_b64_tr_b16 v[218:219], v20 offset:8704
    ds_read_b64_tr_b16 v[220:221], v21 offset:8192
    ds_read_b64_tr_b16 v[222:223], v21 offset:8704
    v_add_f32 v91, v91, v243
    v_mfma_f32_32x32x16_bf16 v[160:175], v[228:231], a[140:143], v[160:175]
    ds_read_b64_tr_b16 v[224:225], v20 offset:10240
    ds_read_b64_tr_b16 v[226:227], v20 offset:10752
    v_cvt_pk_bf16_f32 v64, v80, v81
    v_cvt_pk_bf16_f32 v65, v82, v83
    v_cvt_pk_bf16_f32 v66, v84, v85
    v_mfma_f32_32x32x16_bf16 v[176:191], v[232:235], a[140:143], v[176:191]
    ds_read_b64_tr_b16 v[228:229], v21 offset:10240
    ds_read_b64_tr_b16 v[230:231], v21 offset:10752
    v_cvt_pk_bf16_f32 v67, v86, v87
    v_mfma_f32_32x32x16_bf16 v[192:207], v[236:239], a[140:143], v[192:207]
    ds_read_b64_tr_b16 v[232:233], v20 offset:47104
    ds_read_b64_tr_b16 v[234:235], v20 offset:47616
    buffer_store_dwordx4 v[64:67], v25, s[48:51], s86 offen offset:2048 sc1
    s_waitcnt lgkmcnt(6)
    v_mfma_f32_32x32x16_bf16 v[112:127], v[208:211], a[144:147], v[112:127]
    ds_read_b64_tr_b16 v[236:237], v21 offset:47104
    ds_read_b64_tr_b16 v[238:239], v21 offset:47616
    v_mul_f32 v240, s100, v92
    v_mul_f32 v241, s100, v93
    v_mul_f32 v242, s100, v94
    v_mfma_f32_32x32x16_bf16 v[128:143], v[212:215], a[144:147], v[128:143]
    ds_read_b64_tr_b16 v[208:209], v20 offset:49152
    ds_read_b64_tr_b16 v[210:211], v20 offset:49664
    v_mul_f32 v243, s100, v95
    v_exp_f32_e64 v240, v240 clamp
    v_mfma_f32_32x32x16_bf16 v[144:159], v[216:219], a[144:147], v[144:159]
    ds_read_b64_tr_b16 v[212:213], v21 offset:49152
    ds_read_b64_tr_b16 v[214:215], v21 offset:49664
    v_exp_f32_e64 v241, v241 clamp
    v_mfma_f32_32x32x16_bf16 v[160:175], v[220:223], a[144:147], v[160:175]
    ds_read_b64_tr_b16 v[216:217], v20 offset:51200
    ds_read_b64_tr_b16 v[218:219], v20 offset:51712
    v_exp_f32_e64 v242, v242 clamp
    s_waitcnt lgkmcnt(6)
    v_mfma_f32_32x32x16_bf16 v[176:191], v[224:227], a[144:147], v[176:191]
    ds_read_b64_tr_b16 v[220:221], v21 offset:51200
    ds_read_b64_tr_b16 v[222:223], v21 offset:51712
    v_exp_f32_e64 v243, v243 clamp
    v_max_f32 v92, s101, v92
    v_mfma_f32_32x32x16_bf16 v[192:207], v[228:231], a[144:147], v[192:207]
    ds_read_b64_tr_b16 v[224:225], v22 offset:6144
    ds_read_b64_tr_b16 v[226:227], v22 offset:6656
    v_max_f32 v93, s101, v93
    v_max_f32 v94, s101, v94
    v_max_f32 v95, s101, v95
    v_mfma_f32_32x32x16_bf16 v[112:127], v[232:235], a[148:151], v[112:127]
    ds_read_b64_tr_b16 v[228:229], v23 offset:6144
    ds_read_b64_tr_b16 v[230:231], v23 offset:6656
    v_add_f32 v92, v92, v240
    v_add_f32 v93, v93, v241
    v_add_f32 v94, v94, v242
    v_mfma_f32_32x32x16_bf16 v[128:143], v[236:239], a[148:151], v[128:143]
    ds_read_b64_tr_b16 v[232:233], v22 offset:8192
    ds_read_b64_tr_b16 v[234:235], v22 offset:8704
    s_waitcnt vmcnt(2)
    s_mov_b64 exec, 1
    buffer_store_dword v31, off, s[48:51], s7 sc1
    s_mov_b64 exec, -1
    s_waitcnt lgkmcnt(6)
    v_mfma_f32_32x32x16_bf16 v[144:159], v[208:211], a[148:151], v[144:159]
    ds_read_b64_tr_b16 v[236:237], v23 offset:8192
    ds_read_b64_tr_b16 v[238:239], v23 offset:8704
    v_add_f32 v95, v95, v243
    v_cvt_pk_bf16_f32 v68, v88, v89
    v_cvt_pk_bf16_f32 v69, v90, v91
    v_mfma_f32_32x32x16_bf16 v[160:175], v[212:215], a[148:151], v[160:175]
    ds_read_b64_tr_b16 v[208:209], v22 offset:10240
    ds_read_b64_tr_b16 v[210:211], v22 offset:10752
    v_cvt_pk_bf16_f32 v70, v92, v93
    v_cvt_pk_bf16_f32 v71, v94, v95
    v_mfma_f32_32x32x16_bf16 v[176:191], v[216:219], a[148:151], v[176:191]
    ds_read_b64_tr_b16 v[212:213], v23 offset:10240
    ds_read_b64_tr_b16 v[214:215], v23 offset:10752
    buffer_store_dwordx4 v[68:71], v25, s[48:51], s86 offen offset:2560 sc1
    v_mfma_f32_32x32x16_bf16 v[192:207], v[220:223], a[148:151], v[192:207]
    ds_read_b64_tr_b16 v[216:217], v22 offset:47104
    ds_read_b64_tr_b16 v[218:219], v22 offset:47616
    s_waitcnt lgkmcnt(6)
    v_mfma_f32_32x32x16_bf16 v[112:127], v[224:227], a[152:155], v[112:127]
    ds_read_b64_tr_b16 v[220:221], v23 offset:47104
    ds_read_b64_tr_b16 v[222:223], v23 offset:47616
    v_mfma_f32_32x32x16_bf16 v[128:143], v[228:231], a[152:155], v[128:143]
    ds_read_b64_tr_b16 v[224:225], v22 offset:49152
    ds_read_b64_tr_b16 v[226:227], v22 offset:49664
    v_mfma_f32_32x32x16_bf16 v[144:159], v[232:235], a[152:155], v[144:159]
    ds_read_b64_tr_b16 v[228:229], v23 offset:49152
    ds_read_b64_tr_b16 v[230:231], v23 offset:49664
    v_mfma_f32_32x32x16_bf16 v[160:175], v[236:239], a[152:155], v[160:175]
    ds_read_b64_tr_b16 v[232:233], v22 offset:51200
    ds_read_b64_tr_b16 v[234:235], v22 offset:51712
    s_waitcnt lgkmcnt(6)
    v_mfma_f32_32x32x16_bf16 v[176:191], v[208:211], a[152:155], v[176:191]
    ds_read_b64_tr_b16 v[236:237], v23 offset:51200
    ds_read_b64_tr_b16 v[238:239], v23 offset:51712
    v_mfma_f32_32x32x16_bf16 v[192:207], v[212:215], a[152:155], v[192:207]
    v_mfma_f32_32x32x16_bf16 v[112:127], v[216:219], a[156:159], v[112:127]
    v_mfma_f32_32x32x16_bf16 v[128:143], v[220:223], a[156:159], v[128:143]
    s_waitcnt lgkmcnt(0)
    v_mfma_f32_32x32x16_bf16 v[144:159], v[224:227], a[156:159], v[144:159]
    v_mfma_f32_32x32x16_bf16 v[160:175], v[228:231], a[156:159], v[160:175]
    v_mfma_f32_32x32x16_bf16 v[176:191], v[232:235], a[156:159], v[176:191]
    v_mfma_f32_32x32x16_bf16 v[192:207], v[236:239], a[156:159], v[192:207]
L_h3:
    s_barrier
    v_mov_b32 v208, 0
    v_mov_b32 v209, 0
    v_mov_b32 v210, 0
    v_mov_b32 v211, 0
    s_lshl_b32 s75, s56, 10
    v_add_u32 v1, s75, v29
    v_pk_mul_f32 v[240:241], v[96:97], s[100:101] op_sel_hi:[1,0]
    v_pk_mul_f32 v[242:243], v[98:99], s[100:101] op_sel_hi:[1,0]
    v_pk_mul_f32 v[244:245], v[100:101], s[100:101] op_sel_hi:[1,0]
    v_pk_mul_f32 v[246:247], v[102:103], s[100:101] op_sel_hi:[1,0]
    v_exp_f32_e64 v240, v240 clamp
    v_exp_f32_e64 v241, v241 clamp
    v_exp_f32_e64 v242, v242 clamp
    v_exp_f32_e64 v243, v243 clamp
    v_exp_f32_e64 v244, v244 clamp
    v_exp_f32_e64 v245, v245 clamp
    v_exp_f32_e64 v246, v246 clamp
    v_exp_f32_e64 v247, v247 clamp
    ds_write_b128 v1, v[208:211] offset:49152
    v_max_f32 v96, s101, v96
    v_max_f32 v97, s101, v97
    v_max_f32 v98, s101, v98
    v_max_f32 v99, s101, v99
    v_max_f32 v100, s101, v100
    v_max_f32 v101, s101, v101
    v_max_f32 v102, s101, v102
    v_max_f32 v103, s101, v103
    v_pk_add_f32 v[96:97], v[96:97], v[240:241]
    v_pk_add_f32 v[98:99], v[98:99], v[242:243]
    v_pk_add_f32 v[100:101], v[100:101], v[244:245]
    v_pk_add_f32 v[102:103], v[102:103], v[246:247]
    v_cvt_pk_bf16_f32 v72, v96, v97
    v_cvt_pk_bf16_f32 v73, v98, v99
    v_cvt_pk_bf16_f32 v74, v100, v101
    v_cvt_pk_bf16_f32 v75, v102, v103
    buffer_store_dwordx4 v[72:75], v25, s[48:51], s86 offen offset:3072 sc1
    v_pk_mul_f32 v[240:241], v[104:105], s[100:101] op_sel_hi:[1,0]
    v_pk_mul_f32 v[242:243], v[106:107], s[100:101] op_sel_hi:[1,0]
    v_pk_mul_f32 v[244:245], v[108:109], s[100:101] op_sel_hi:[1,0]
    v_pk_mul_f32 v[246:247], v[110:111], s[100:101] op_sel_hi:[1,0]
    v_exp_f32_e64 v240, v240 clamp
    v_exp_f32_e64 v241, v241 clamp
    v_exp_f32_e64 v242, v242 clamp
    v_exp_f32_e64 v243, v243 clamp
    v_exp_f32_e64 v244, v244 clamp
    v_exp_f32_e64 v245, v245 clamp
    v_exp_f32_e64 v246, v246 clamp
    v_exp_f32_e64 v247, v247 clamp
    ds_write_b128 v1, v[208:211] offset:45056
    v_max_f32 v104, s101, v104
    v_max_f32 v105, s101, v105
    v_max_f32 v106, s101, v106
    v_max_f32 v107, s101, v107
    v_max_f32 v108, s101, v108
    v_max_f32 v109, s101, v109
    v_max_f32 v110, s101, v110
    v_max_f32 v111, s101, v111
    v_pk_add_f32 v[104:105], v[104:105], v[240:241]
    v_pk_add_f32 v[106:107], v[106:107], v[242:243]
    v_pk_add_f32 v[108:109], v[108:109], v[244:245]
    v_pk_add_f32 v[110:111], v[110:111], v[246:247]
    v_cvt_pk_bf16_f32 v76, v104, v105
    v_cvt_pk_bf16_f32 v77, v106, v107
    v_cvt_pk_bf16_f32 v78, v108, v109
    v_cvt_pk_bf16_f32 v79, v110, v111
    buffer_store_dwordx4 v[76:79], v25, s[48:51], s86 offen offset:3584 sc1
    v_pk_mul_f32 v[240:241], v[112:113], s[100:101] op_sel_hi:[1,0]
    v_pk_mul_f32 v[242:243], v[114:115], s[100:101] op_sel_hi:[1,0]
    v_pk_mul_f32 v[244:245], v[116:117], s[100:101] op_sel_hi:[1,0]
    v_pk_mul_f32 v[246:247], v[118:119], s[100:101] op_sel_hi:[1,0]
    v_exp_f32_e64 v240, v240 clamp
    v_exp_f32_e64 v241, v241 clamp
    v_exp_f32_e64 v242, v242 clamp
    v_exp_f32_e64 v243, v243 clamp
    v_exp_f32_e64 v244, v244 clamp
    v_exp_f32_e64 v245, v245 clamp
    v_exp_f32_e64 v246, v246 clamp
    v_exp_f32_e64 v247, v247 clamp
    ds_write_b128 v1, v[208:211] offset:40960
    v_max_f32 v112, s101, v112
    v_max_f32 v113, s101, v113
    v_max_f32 v114, s101, v114
    v_max_f32 v115, s101, v115
    v_max_f32 v116, s101, v116
    v_max_f32 v117, s101, v117
    v_max_f32 v118, s101, v118
    v_max_f32 v119, s101, v119
    v_pk_add_f32 v[112:113], v[112:113], v[240:241]
    v_pk_add_f32 v[114:115], v[114:115], v[242:243]
    v_pk_add_f32 v[116:117], v[116:117], v[244:245]
    v_pk_add_f32 v[118:119], v[118:119], v[246:247]
    v_cvt_pk_bf16_f32 v80, v112, v113
    v_cvt_pk_bf16_f32 v81, v114, v115
    v_cvt_pk_bf16_f32 v82, v116, v117
    v_cvt_pk_bf16_f32 v83, v118, v119
    s_add_u32 s86, s86, 4096
    buffer_store_dwordx4 v[80:83], v25, s[48:51], s86 offen offset:0 sc1
    v_pk_mul_f32 v[240:241], v[120:121], s[100:101] op_sel_hi:[1,0]
    v_pk_mul_f32 v[242:243], v[122:123], s[100:101] op_sel_hi:[1,0]
    v_pk_mul_f32 v[244:245], v[124:125], s[100:101] op_sel_hi:[1,0]
    v_pk_mul_f32 v[246:247], v[126:127], s[100:101] op_sel_hi:[1,0]
    v_exp_f32_e64 v240, v240 clamp
    v_exp_f32_e64 v241, v241 clamp
    v_exp_f32_e64 v242, v242 clamp
    v_exp_f32_e64 v243, v243 clamp
    v_exp_f32_e64 v244, v244 clamp
    v_exp_f32_e64 v245, v245 clamp
    v_exp_f32_e64 v246, v246 clamp
    v_exp_f32_e64 v247, v247 clamp
    ds_write_b128 v1, v[208:211] offset:8192
    v_max_f32 v120, s101, v120
    v_max_f32 v121, s101, v121
    v_max_f32 v122, s101, v122
    v_max_f32 v123, s101, v123
    v_max_f32 v124, s101, v124
    v_max_f32 v125, s101, v125
    v_max_f32 v126, s101, v126
    v_max_f32 v127, s101, v127
    v_pk_add_f32 v[120:121], v[120:121], v[240:241]
    v_pk_add_f32 v[122:123], v[122:123], v[242:243]
    v_pk_add_f32 v[124:125], v[124:125], v[244:245]
    v_pk_add_f32 v[126:127], v[126:127], v[246:247]
    v_cvt_pk_bf16_f32 v84, v120, v121
    v_cvt_pk_bf16_f32 v85, v122, v123
    v_cvt_pk_bf16_f32 v86, v124, v125
    v_cvt_pk_bf16_f32 v87, v126, v127
    buffer_store_dwordx4 v[84:87], v25, s[48:51], s86 offen offset:512 sc1
    v_pk_mul_f32 v[240:241], v[128:129], s[100:101] op_sel_hi:[1,0]
    v_pk_mul_f32 v[242:243], v[130:131], s[100:101] op_sel_hi:[1,0]
    v_pk_mul_f32 v[244:245], v[132:133], s[100:101] op_sel_hi:[1,0]
    v_pk_mul_f32 v[246:247], v[134:135], s[100:101] op_sel_hi:[1,0]
    v_exp_f32_e64 v240, v240 clamp
    v_exp_f32_e64 v241, v241 clamp
    v_exp_f32_e64 v242, v242 clamp
    v_exp_f32_e64 v243, v243 clamp
    v_exp_f32_e64 v244, v244 clamp
    v_exp_f32_e64 v245, v245 clamp
    v_exp_f32_e64 v246, v246 clamp
    v_exp_f32_e64 v247, v247 clamp
    v_max_f32 v128, s101, v128
    v_max_f32 v129, s101, v129
    v_max_f32 v130, s101, v130
    v_max_f32 v131, s101, v131
    v_max_f32 v132, s101, v132
    v_max_f32 v133, s101, v133
    v_max_f32 v134, s101, v134
    v_max_f32 v135, s101, v135
    v_pk_add_f32 v[128:129], v[128:129], v[240:241]
    v_pk_add_f32 v[130:131], v[130:131], v[242:243]
    v_pk_add_f32 v[132:133], v[132:133], v[244:245]
    v_pk_add_f32 v[134:135], v[134:135], v[246:247]
    v_cvt_pk_bf16_f32 v88, v128, v129
    v_cvt_pk_bf16_f32 v89, v130, v131
    v_cvt_pk_bf16_f32 v90, v132, v133
    v_cvt_pk_bf16_f32 v91, v134, v135
    buffer_store_dwordx4 v[88:91], v25, s[48:51], s86 offen offset:1024 sc1
    v_pk_mul_f32 v[240:241], v[136:137], s[100:101] op_sel_hi:[1,0]
    v_pk_mul_f32 v[242:243], v[138:139], s[100:101] op_sel_hi:[1,0]
    v_pk_mul_f32 v[244:245], v[140:141], s[100:101] op_sel_hi:[1,0]
    v_pk_mul_f32 v[246:247], v[142:143], s[100:101] op_sel_hi:[1,0]
    v_exp_f32_e64 v240, v240 clamp
    v_exp_f32_e64 v241, v241 clamp
    v_exp_f32_e64 v242, v242 clamp
    v_exp_f32_e64 v243, v243 clamp
    v_exp_f32_e64 v244, v244 clamp
    v_exp_f32_e64 v245, v245 clamp
    v_exp_f32_e64 v246, v246 clamp
    v_exp_f32_e64 v247, v247 clamp
    v_max_f32 v136, s101, v136
    v_max_f32 v137, s101, v137
    v_max_f32 v138, s101, v138
    v_max_f32 v139, s101, v139
    v_max_f32 v140, s101, v140
    v_max_f32 v141, s101, v141
    v_max_f32 v142, s101, v142
    v_max_f32 v143, s101, v143
    v_pk_add_f32 v[136:137], v[136:137], v[240:241]
    v_pk_add_f32 v[138:139], v[138:139], v[242:243]
    v_pk_add_f32 v[140:141], v[140:141], v[244:245]
    v_pk_add_f32 v[142:143], v[142:143], v[246:247]
    v_cvt_pk_bf16_f32 v92, v136, v137
    v_cvt_pk_bf16_f32 v93, v138, v139
    v_cvt_pk_bf16_f32 v94, v140, v141
    v_cvt_pk_bf16_f32 v95, v142, v143
    buffer_store_dwordx4 v[92:95], v25, s[48:51], s86 offen offset:1536 sc1
    v_pk_mul_f32 v[240:241], v[144:145], s[100:101] op_sel_hi:[1,0]
    v_pk_mul_f32 v[242:243], v[146:147], s[100:101] op_sel_hi:[1,0]
    v_pk_mul_f32 v[244:245], v[148:149], s[100:101] op_sel_hi:[1,0]
    v_pk_mul_f32 v[246:247], v[150:151], s[100:101] op_sel_hi:[1,0]
    v_exp_f32_e64 v240, v240 clamp
    v_exp_f32_e64 v241, v241 clamp
    v_exp_f32_e64 v242, v242 clamp
    v_exp_f32_e64 v243, v243 clamp
    v_exp_f32_e64 v244, v244 clamp
    v_exp_f32_e64 v245, v245 clamp
    v_exp_f32_e64 v246, v246 clamp
    v_exp_f32_e64 v247, v247 clamp
    v_max_f32 v144, s101, v144
    v_max_f32 v145, s101, v145
    v_max_f32 v146, s101, v146
    v_max_f32 v147, s101, v147
    v_max_f32 v148, s101, v148
    v_max_f32 v149, s101, v149
    v_max_f32 v150, s101, v150
    v_max_f32 v151, s101, v151
    v_pk_add_f32 v[144:145], v[144:145], v[240:241]
    v_pk_add_f32 v[146:147], v[146:147], v[242:243]
    v_pk_add_f32 v[148:149], v[148:149], v[244:245]
    v_pk_add_f32 v[150:151], v[150:151], v[246:247]
    v_cvt_pk_bf16_f32 v96, v144, v145
    v_cvt_pk_bf16_f32 v97, v146, v147
    v_cvt_pk_bf16_f32 v98, v148, v149
    v_cvt_pk_bf16_f32 v99, v150, v151
    buffer_store_dwordx4 v[96:99], v25, s[48:51], s86 offen offset:2048 sc1
    v_pk_mul_f32 v[240:241], v[152:153], s[100:101] op_sel_hi:[1,0]
    v_pk_mul_f32 v[242:243], v[154:155], s[100:101] op_sel_hi:[1,0]
    v_pk_mul_f32 v[244:245], v[156:157], s[100:101] op_sel_hi:[1,0]
    v_pk_mul_f32 v[246:247], v[158:159], s[100:101] op_sel_hi:[1,0]
    v_exp_f32_e64 v240, v240 clamp
    v_exp_f32_e64 v241, v241 clamp
    v_exp_f32_e64 v242, v242 clamp
    v_exp_f32_e64 v243, v243 clamp
    v_exp_f32_e64 v244, v244 clamp
    v_exp_f32_e64 v245, v245 clamp
    v_exp_f32_e64 v246, v246 clamp
    v_exp_f32_e64 v247, v247 clamp
    v_max_f32 v152, s101, v152
    v_max_f32 v153, s101, v153
    v_max_f32 v154, s101, v154
    v_max_f32 v155, s101, v155
    v_max_f32 v156, s101, v156
    v_max_f32 v157, s101, v157
    v_max_f32 v158, s101, v158
    v_max_f32 v159, s101, v159
    v_pk_add_f32 v[152:153], v[152:153], v[240:241]
    v_pk_add_f32 v[154:155], v[154:155], v[242:243]
    v_pk_add_f32 v[156:157], v[156:157], v[244:245]
    v_pk_add_f32 v[158:159], v[158:159], v[246:247]
    v_cvt_pk_bf16_f32 v100, v152, v153
    v_cvt_pk_bf16_f32 v101, v154, v155
    v_cvt_pk_bf16_f32 v102, v156, v157
    v_cvt_pk_bf16_f32 v103, v158, v159
    buffer_store_dwordx4 v[100:103], v25, s[48:51], s86 offen offset:2560 sc1
    v_pk_mul_f32 v[240:241], v[160:161], s[100:101] op_sel_hi:[1,0]
    v_pk_mul_f32 v[242:243], v[162:163], s[100:101] op_sel_hi:[1,0]
    v_pk_mul_f32 v[244:245], v[164:165], s[100:101] op_sel_hi:[1,0]
    v_pk_mul_f32 v[246:247], v[166:167], s[100:101] op_sel_hi:[1,0]
    v_exp_f32_e64 v240, v240 clamp
    v_exp_f32_e64 v241, v241 clamp
    v_exp_f32_e64 v242, v242 clamp
    v_exp_f32_e64 v243, v243 clamp
    v_exp_f32_e64 v244, v244 clamp
    v_exp_f32_e64 v245, v245 clamp
    v_exp_f32_e64 v246, v246 clamp
    v_exp_f32_e64 v247, v247 clamp
    v_max_f32 v160, s101, v160
    v_max_f32 v161, s101, v161
    v_max_f32 v162, s101, v162
    v_max_f32 v163, s101, v163
    v_max_f32 v164, s101, v164
    v_max_f32 v165, s101, v165
    v_max_f32 v166, s101, v166
    v_max_f32 v167, s101, v167
    v_pk_add_f32 v[160:161], v[160:161], v[240:241]
    v_pk_add_f32 v[162:163], v[162:163], v[242:243]
    v_pk_add_f32 v[164:165], v[164:165], v[244:245]
    v_pk_add_f32 v[166:167], v[166:167], v[246:247]
    v_cvt_pk_bf16_f32 v104, v160, v161
    v_cvt_pk_bf16_f32 v105, v162, v163
    v_cvt_pk_bf16_f32 v106, v164, v165
    v_cvt_pk_bf16_f32 v107, v166, v167
    buffer_store_dwordx4 v[104:107], v25, s[48:51], s86 offen offset:3072 sc1
    v_pk_mul_f32 v[240:241], v[168:169], s[100:101] op_sel_hi:[1,0]
    v_pk_mul_f32 v[242:243], v[170:171], s[100:101] op_sel_hi:[1,0]
    v_pk_mul_f32 v[244:245], v[172:173], s[100:101] op_sel_hi:[1,0]
    v_pk_mul_f32 v[246:247], v[174:175], s[100:101] op_sel_hi:[1,0]
    v_exp_f32_e64 v240, v240 clamp
    v_exp_f32_e64 v241, v241 clamp
    v_exp_f32_e64 v242, v242 clamp
    v_exp_f32_e64 v243, v243 clamp
    v_exp_f32_e64 v244, v244 clamp
    v_exp_f32_e64 v245, v245 clamp
    v_exp_f32_e64 v246, v246 clamp
    v_exp_f32_e64 v247, v247 clamp
    v_max_f32 v168, s101, v168
    v_max_f32 v169, s101, v169
    v_max_f32 v170, s101, v170
    v_max_f32 v171, s101, v171
    v_max_f32 v172, s101, v172
    v_max_f32 v173, s101, v173
    v_max_f32 v174, s101, v174
    v_max_f32 v175, s101, v175
    v_pk_add_f32 v[168:169], v[168:169], v[240:241]
    v_pk_add_f32 v[170:171], v[170:171], v[242:243]
    v_pk_add_f32 v[172:173], v[172:173], v[244:245]
    v_pk_add_f32 v[174:175], v[174:175], v[246:247]
    v_cvt_pk_bf16_f32 v108, v168, v169
    v_cvt_pk_bf16_f32 v109, v170, v171
    v_cvt_pk_bf16_f32 v110, v172, v173
    v_cvt_pk_bf16_f32 v111, v174, v175
    buffer_store_dwordx4 v[108:111], v25, s[48:51], s86 offen offset:3584 sc1
    v_pk_mul_f32 v[240:241], v[176:177], s[100:101] op_sel_hi:[1,0]
    v_pk_mul_f32 v[242:243], v[178:179], s[100:101] op_sel_hi:[1,0]
    v_pk_mul_f32 v[244:245], v[180:181], s[100:101] op_sel_hi:[1,0]
    v_pk_mul_f32 v[246:247], v[182:183], s[100:101] op_sel_hi:[1,0]
    v_exp_f32_e64 v240, v240 clamp
    v_exp_f32_e64 v241, v241 clamp
    v_exp_f32_e64 v242, v242 clamp
    v_exp_f32_e64 v243, v243 clamp
    v_exp_f32_e64 v244, v244 clamp
    v_exp_f32_e64 v245, v245 clamp
    v_exp_f32_e64 v246, v246 clamp
    v_exp_f32_e64 v247, v247 clamp
    v_max_f32 v176, s101, v176
    v_max_f32 v177, s101, v177
    v_max_f32 v178, s101, v178
    v_max_f32 v179, s101, v179
    v_max_f32 v180, s101, v180
    v_max_f32 v181, s101, v181
    v_max_f32 v182, s101, v182
    v_max_f32 v183, s101, v183
    v_pk_add_f32 v[176:177], v[176:177], v[240:241]
    v_pk_add_f32 v[178:179], v[178:179], v[242:243]
    v_pk_add_f32 v[180:181], v[180:181], v[244:245]
    v_pk_add_f32 v[182:183], v[182:183], v[246:247]
    v_cvt_pk_bf16_f32 v112, v176, v177
    v_cvt_pk_bf16_f32 v113, v178, v179
    v_cvt_pk_bf16_f32 v114, v180, v181
    v_cvt_pk_bf16_f32 v115, v182, v183
    s_add_u32 s86, s86, 4096
    buffer_store_dwordx4 v[112:115], v25, s[48:51], s86 offen offset:0 sc1
    v_pk_mul_f32 v[240:241], v[184:185], s[100:101] op_sel_hi:[1,0]
    v_pk_mul_f32 v[242:243], v[186:187], s[100:101] op_sel_hi:[1,0]
    v_pk_mul_f32 v[244:245], v[188:189], s[100:101] op_sel_hi:[1,0]
    v_pk_mul_f32 v[246:247], v[190:191], s[100:101] op_sel_hi:[1,0]
    v_exp_f32_e64 v240, v240 clamp
    v_exp_f32_e64 v241, v241 clamp
    v_exp_f32_e64 v242, v242 clamp
    v_exp_f32_e64 v243, v243 clamp
    v_exp_f32_e64 v244, v244 clamp
    v_exp_f32_e64 v245, v245 clamp
    v_exp_f32_e64 v246, v246 clamp
    v_exp_f32_e64 v247, v247 clamp
    v_max_f32 v184, s101, v184
    v_max_f32 v185, s101, v185
    v_max_f32 v186, s101, v186
    v_max_f32 v187, s101, v187
    v_max_f32 v188, s101, v188
    v_max_f32 v189, s101, v189
    v_max_f32 v190, s101, v190
    v_max_f32 v191, s101, v191
    v_pk_add_f32 v[184:185], v[184:185], v[240:241]
    v_pk_add_f32 v[186:187], v[186:187], v[242:243]
    v_pk_add_f32 v[188:189], v[188:189], v[244:245]
    v_pk_add_f32 v[190:191], v[190:191], v[246:247]
    v_cvt_pk_bf16_f32 v116, v184, v185
    v_cvt_pk_bf16_f32 v117, v186, v187
    v_cvt_pk_bf16_f32 v118, v188, v189
    v_cvt_pk_bf16_f32 v119, v190, v191
    buffer_store_dwordx4 v[116:119], v25, s[48:51], s86 offen offset:512 sc1
    v_pk_mul_f32 v[240:241], v[192:193], s[100:101] op_sel_hi:[1,0]
    v_pk_mul_f32 v[242:243], v[194:195], s[100:101] op_sel_hi:[1,0]
    v_pk_mul_f32 v[244:245], v[196:197], s[100:101] op_sel_hi:[1,0]
    v_pk_mul_f32 v[246:247], v[198:199], s[100:101] op_sel_hi:[1,0]
    v_exp_f32_e64 v240, v240 clamp
    v_exp_f32_e64 v241, v241 clamp
    v_exp_f32_e64 v242, v242 clamp
    v_exp_f32_e64 v243, v243 clamp
    v_exp_f32_e64 v244, v244 clamp
    v_exp_f32_e64 v245, v245 clamp
    v_exp_f32_e64 v246, v246 clamp
    v_exp_f32_e64 v247, v247 clamp
    v_max_f32 v192, s101, v192
    v_max_f32 v193, s101, v193
    v_max_f32 v194, s101, v194
    v_max_f32 v195, s101, v195
    v_max_f32 v196, s101, v196
    v_max_f32 v197, s101, v197
    v_max_f32 v198, s101, v198
    v_max_f32 v199, s101, v199
    v_pk_add_f32 v[192:193], v[192:193], v[240:241]
    v_pk_add_f32 v[194:195], v[194:195], v[242:243]
    v_pk_add_f32 v[196:197], v[196:197], v[244:245]
    v_pk_add_f32 v[198:199], v[198:199], v[246:247]
    v_cvt_pk_bf16_f32 v120, v192, v193
    v_cvt_pk_bf16_f32 v121, v194, v195
    v_cvt_pk_bf16_f32 v122, v196, v197
    v_cvt_pk_bf16_f32 v123, v198, v199
    buffer_store_dwordx4 v[120:123], v25, s[48:51], s86 offen offset:1024 sc1
    v_pk_mul_f32 v[240:241], v[200:201], s[100:101] op_sel_hi:[1,0]
    v_pk_mul_f32 v[242:243], v[202:203], s[100:101] op_sel_hi:[1,0]
    v_pk_mul_f32 v[244:245], v[204:205], s[100:101] op_sel_hi:[1,0]
    v_pk_mul_f32 v[246:247], v[206:207], s[100:101] op_sel_hi:[1,0]
    v_exp_f32_e64 v240, v240 clamp
    v_exp_f32_e64 v241, v241 clamp
    v_exp_f32_e64 v242, v242 clamp
    v_exp_f32_e64 v243, v243 clamp
    v_exp_f32_e64 v244, v244 clamp
    v_exp_f32_e64 v245, v245 clamp
    v_exp_f32_e64 v246, v246 clamp
    v_exp_f32_e64 v247, v247 clamp
    v_max_f32 v200, s101, v200
    v_max_f32 v201, s101, v201
    v_max_f32 v202, s101, v202
    v_max_f32 v203, s101, v203
    v_max_f32 v204, s101, v204
    v_max_f32 v205, s101, v205
    v_max_f32 v206, s101, v206
    v_max_f32 v207, s101, v207
    v_pk_add_f32 v[200:201], v[200:201], v[240:241]
    v_pk_add_f32 v[202:203], v[202:203], v[242:243]
    v_pk_add_f32 v[204:205], v[204:205], v[244:245]
    v_pk_add_f32 v[206:207], v[206:207], v[246:247]
    v_cvt_pk_bf16_f32 v124, v200, v201
    v_cvt_pk_bf16_f32 v125, v202, v203
    v_cvt_pk_bf16_f32 v126, v204, v205
    v_cvt_pk_bf16_f32 v127, v206, v207
    buffer_store_dwordx4 v[124:127], v25, s[48:51], s86 offen offset:1536 sc1
    s_add_u32 s75, s56, 1
    s_and_b32 s75, s75, 3
    s_lshl2_add_u32 s75, s4, s75
    s_mul_i32 s75, s75, 48
    s_mul_i32 s76, s56, 5
    s_add_u32 s75, s75, s76
    s_lshl_b32 s75, s75, 10
    s_add_u32 s63, s75, 10485760
    s_add_u32 s75, s56, 2
    s_and_b32 s75, s75, 3
    s_lshl2_add_u32 s75, s4, s75
    s_mul_i32 s75, s75, 48
    s_mul_i32 s76, s56, 5
    s_add_u32 s75, s75, s76
    s_lshl_b32 s75, s75, 10
    s_add_u32 s64, s75, 10485760
    s_add_u32 s75, s56, 3
    s_and_b32 s75, s75, 3
    s_lshl2_add_u32 s75, s4, s75
    s_mul_i32 s75, s75, 48
    s_mul_i32 s76, s56, 5
    s_add_u32 s75, s75, s76
    s_lshl_b32 s75, s75, 10
    s_add_u32 s65, s75, 10485760
    s_add_u32 s75, s56, 4
    s_and_b32 s75, s75, 3
    s_lshl2_add_u32 s75, s4, s75
    s_mul_i32 s75, s75, 48
    s_mul_i32 s76, s56, 5
    s_add_u32 s75, s75, s76
    s_lshl_b32 s75, s75, 10
    s_add_u32 s71, s75, 10485760
    s_mul_i32 s75, s5, 48
    s_add_u32 s75, s75, s76
    s_mul_i32 s75, s75, 5120
    s_add_u32 s72, s75, 16777216
    s_mul_i32 s75, s56, 10240
    s_add_u32 s99, s72, s75
    s_add_u32 s99, s99, 102400
    s_lshr_b32 s75, s5, 1
    s_lshl_b32 s75, s75, 12
    s_mul_i32 s76, s56, 896
    s_add_u32 s75, s75, s76
    s_add_u32 s76, s75, 622592
    v_min_u32 v16, 768, v2
    v_add_u32 v16, s76, v16
    s_lshl2_add_u32 s75, s5, s56
    s_lshl_b32 s75, s75, 9
    s_add_u32 s75, s75, 606208
    v_min_u32 v17, 384, v2
    v_add_u32 v17, s75, v17
    s_lshl_b32 s73, s4, 12
    s_add_u32 s73, s73, 475136
    s_lshr_b32 s75, s56, 1
    s_lshl_b32 s75, s75, 8
    s_add_u32 s75, s75, s73
    s_add_u32 s75, s75, 3584
    v_and_b32 v18, 0x80, v2
    v_add_u32 v28, s75, v18
    s_lshr_b32 s75, s56, 1
    s_lshl1_add_u32 s75, s4, s75
    s_lshl_b32 s75, s75, 8
    s_add_u32 s75, s75, 753664
    v_add_u32 v26, s75, v18
    s_mul_i32 s75, s56, 7
    s_add_u32 s75, s75, 1
    s_and_b32 s75, s75, 0xfe
    v_and_b32 v18, 7, v0
    v_add_u32 v18, s75, v18
    v_min_u32 v18, 27, v18
    v_lshlrev_b32 v18, 7, v18
    v_add_u32 v18, s73, v18
    s_cmp_eq_u32 s56, 3
    s_cselect_b32 s75, 0x80000000, 0
    v_add_u32 v22, s75, v29
    buffer_load_dword v19, v16, s[48:51], 0 offen sc1
    s_waitcnt vmcnt(1)
    s_mov_b64 exec, 1
    buffer_store_dword v31, off, s[48:51], s84 sc1
    s_mov_b64 exec, -1
    s_waitcnt vmcnt(1)
    v_cmp_eq_u32 vcc, -1, v19
    s_nop 1
    s_cbranch_vccnz Lslow_24
Lback_25:
    buffer_load_dwordx4 a[96:99], v29, s[48:51], s99 offen offset:0 sc1
    buffer_load_dwordx4 a[100:103], v29, s[48:51], s99 offen offset:1024 sc1
    buffer_load_dwordx4 a[104:107], v29, s[48:51], s99 offen offset:2048 sc1
    buffer_load_dwordx4 a[108:111], v29, s[48:51], s99 offen offset:3072 sc1
    s_add_u32 s99, s99, 4096
    buffer_load_dwordx4 a[112:115], v29, s[48:51], s99 offen offset:0 sc1
    buffer_load_dwordx4 a[116:119], v29, s[48:51], s99 offen offset:1024 sc1
    buffer_load_dwordx4 a[120:123], v29, s[48:51], s99 offen offset:2048 sc1
    buffer_load_dwordx4 a[124:127], v29, s[48:51], s99 offen offset:3072 sc1
    s_add_u32 s99, s99, 4096
    buffer_load_dwordx4 a[128:131], v29, s[48:51], s99 offen offset:0 sc1
    buffer_load_dwordx4 a[132:135], v29, s[48:51], s99 offen offset:1024 sc1
    buffer_load_dwordx4 a[136:139], v29, s[48:51], s99 offen offset:2048 sc1
    buffer_load_dwordx4 a[140:143], v29, s[48:51], s99 offen offset:3072 sc1
    s_add_u32 s99, s99, 4096
    buffer_load_dwordx4 a[144:147], v29, s[48:51], s99 offen offset:0 sc1
    buffer_load_dwordx4 a[148:151], v29, s[48:51], s99 offen offset:1024 sc1
    buffer_load_dwordx4 a[152:155], v29, s[48:51], s99 offen offset:2048 sc1
    buffer_load_dwordx4 a[156:159], v29, s[48:51], s99 offen offset:3072 sc1
    buffer_load_dword v208, v2, s[48:51], s87 offen sc1
    buffer_load_dword v209, off, s[48:51], s88 sc1
    s_waitcnt vmcnt(0)
    v_max_u32 v213, v208, v209
    v_cmp_eq_u32 vcc, -1, v213
    s_nop 1
    s_cbranch_vccnz Lslow_26
Lback_27:
    s_waitcnt lgkmcnt(0)
    s_barrier
    buffer_load_dwordx4 v[208:211], v36, s[48:51], s90 offen sc1
    s_add_u32 s90, s90, 10240
    buffer_load_dwordx4 v[212:215], v36, s[48:51], s90 offen sc1
    s_add_u32 s90, s90, 10240
    buffer_load_dwordx4 v[216:219], v36, s[48:51], s90 offen sc1
    s_add_u32 s90, s90, 10240
    buffer_load_dwordx4 v[220:223], v36, s[48:51], s90 offen sc1
    s_add_u32 s90, s90, 10240
    buffer_load_dwordx4 v[224:227], v36, s[48:51], s90 offen sc1
    s_add_u32 s90, s90, 10240
    buffer_load_dwordx4 v[228:231], v36, s[48:51], s90 offen sc1
    s_add_u32 s90, s90, 10240
    buffer_load_dwordx4 v[232:235], v36, s[48:51], s90 offen sc1
    s_add_u32 s90, s90, 10240
    buffer_load_dwordx4 v[236:239], v36, s[48:51], s90 offen sc1
    buffer_load_dword v46, v39, s[48:51], s89 offen sc1
    buffer_load_dwordx4 v[128:131], v32, s[48:51], s91 offen sc1
    s_add_u32 s91, s91, 13312
    buffer_load_dwordx4 v[132:135], v32, s[48:51], s91 offen sc1
    s_add_u32 s91, s91, 13312
    buffer_load_dwordx4 v[136:139], v32, s[48:51], s91 offen sc1
    s_add_u32 s91, s91, 13312
    buffer_load_dwordx4 v[140:143], v32, s[48:51], s91 offen sc1
    s_add_u32 s91, s91, 13312
    buffer_load_dwordx4 v[144:147], v32, s[48:51], s91 offen sc1
    s_add_u32 s91, s91, 13312
    buffer_load_dwordx4 v[148:151], v32, s[48:51], s91 offen sc1
    s_add_u32 s91, s91, 13312
    buffer_load_dwordx4 v[152:155], v32, s[48:51], s91 offen sc1
    s_add_u32 s91, s91, 13312
    buffer_load_dwordx4 v[156:159], v32, s[48:51], s91 offen sc1
    s_add_u32 s91, s91, 13312
    buffer_load_dwordx4 v[160:163], v32, s[48:51], s91 offen sc1
    s_add_u32 s91, s91, 13312
    buffer_load_dwordx4 v[164:167], v32, s[48:51], s91 offen sc1
    s_add_u32 s91, s91, 13312
    buffer_load_dwordx4 v[168:171], v32, s[48:51], s91 offen sc1
    s_add_u32 s91, s91, 13312
    buffer_load_dwordx4 v[172:175], v32, s[48:51], s91 offen sc1
    s_waitcnt vmcnt(19)
    v_pk_add_f32 v[208:209], v[208:209], v[212:213]
    v_pk_add_f32 v[210:211], v[210:211], v[214:215]
    s_waitcnt vmcnt(18)
    v_pk_add_f32 v[208:209], v[208:209], v[216:217]
    v_pk_add_f32 v[210:211], v[210:211], v[218:219]
    s_waitcnt vmcnt(17)
    v_pk_add_f32 v[208:209], v[208:209], v[220:221]
    v_pk_add_f32 v[210:211], v[210:211], v[222:223]
    s_waitcnt vmcnt(16)
    v_pk_add_f32 v[208:209], v[208:209], v[224:225]
    v_pk_add_f32 v[210:211], v[210:211], v[226:227]
    s_waitcnt vmcnt(15)
    v_pk_add_f32 v[208:209], v[208:209], v[228:229]
    v_pk_add_f32 v[210:211], v[210:211], v[230:231]
    s_waitcnt vmcnt(14)
    v_pk_add_f32 v[208:209], v[208:209], v[232:233]
    v_pk_add_f32 v[210:211], v[210:211], v[234:235]
    s_waitcnt vmcnt(13)
    v_pk_add_f32 v[208:209], v[208:209], v[236:237]
    v_pk_add_f32 v[210:211], v[210:211], v[238:239]
    s_nop 1
    v_permlane32_swap_b32 v208, v210
    v_permlane32_swap_b32 v209, v211
    v_pk_add_f32 v[208:209], v[208:209], v[210:211]
    v_cvt_pk_bf16_f32 v208, v208, v209
    ds_write_b32 v37, v208 offset:40960
    s_add_u32 s91, s91, 13312
    buffer_load_dwordx4 v[176:179], v32, s[48:51], s91 offen sc1
    s_add_u32 s91, s91, 13312
    buffer_load_dwordx4 v[180:183], v32, s[48:51], s91 offen sc1
    s_waitcnt lgkmcnt(0)
    s_barrier
    ds_read_b128 a[36:39], v38 offset:40960
    ds_read_b128 a[40:43], v38 offset:40992
    ds_read_b128 a[44:47], v38 offset:41024
    ds_read_b128 a[48:51], v38 offset:41056
    ds_read_b128 a[52:55], v38 offset:41088
    ds_read_b128 a[56:59], v38 offset:41120
    s_waitcnt lgkmcnt(5)
    v_mfma_f32_32x32x16_bf16 v[192:207], a[36:39], v[48:51], 0
    ds_read_b128 a[60:63], v38 offset:41152
    s_add_u32 s91, s91, 13312
    buffer_load_dwordx4 v[184:187], v32, s[48:51], s91 offen sc1
    s_waitcnt lgkmcnt(5)
    v_mfma_f32_32x32x16_bf16 v[192:207], a[40:43], v[52:55], v[192:207]
    ds_read_b128 a[64:67], v38 offset:41184
    s_waitcnt lgkmcnt(5)
    v_mfma_f32_32x32x16_bf16 v[192:207], a[44:47], v[56:59], v[192:207]
    ds_read_b128 a[36:39], v38 offset:41216
    s_add_u32 s91, s91, 13312
    buffer_load_dwordx4 v[188:191], v32, s[48:51], s91 offen sc1
    s_waitcnt lgkmcnt(5)
    v_mfma_f32_32x32x16_bf16 v[192:207], a[48:51], v[60:63], v[192:207]
    ds_read_b128 a[40:43], v38 offset:41248
    s_waitcnt lgkmcnt(5)
    v_mfma_f32_32x32x16_bf16 v[192:207], a[52:55], v[64:67], v[192:207]
    ds_read_b128 a[44:47], v38 offset:41280
    s_waitcnt lgkmcnt(5)
    v_mfma_f32_32x32x16_bf16 v[192:207], a[56:59], v[68:71], v[192:207]
    ds_read_b128 a[48:51], v38 offset:41312
    s_waitcnt lgkmcnt(5)
    v_mfma_f32_32x32x16_bf16 v[192:207], a[60:63], v[72:75], v[192:207]
    ds_read_b128 a[52:55], v38 offset:41344
    s_waitcnt lgkmcnt(5)
    v_mfma_f32_32x32x16_bf16 v[192:207], a[64:67], v[76:79], v[192:207]
    ds_read_b128 a[56:59], v38 offset:41376
    s_waitcnt lgkmcnt(5)
    v_mfma_f32_32x32x16_bf16 v[192:207], a[36:39], v[80:83], v[192:207]
    ds_read_b128 a[60:63], v38 offset:41408
    s_waitcnt lgkmcnt(5)
    v_mfma_f32_32x32x16_bf16 v[192:207], a[40:43], v[84:87], v[192:207]
    ds_read_b128 a[64:67], v38 offset:41440
    s_waitcnt lgkmcnt(5)
    v_mfma_f32_32x32x16_bf16 v[192:207], a[44:47], v[88:91], v[192:207]
    ds_read_b128 a[36:39], v38 offset:41472
    s_waitcnt lgkmcnt(5)
    v_mfma_f32_32x32x16_bf16 v[192:207], a[48:51], v[92:95], v[192:207]
    ds_read_b128 a[40:43], v38 offset:41504
    s_waitcnt lgkmcnt(5)
    v_mfma_f32_32x32x16_bf16 v[192:207], a[52:55], v[96:99], v[192:207]
    ds_read_b128 a[44:47], v38 offset:41536
    s_waitcnt lgkmcnt(5)
    v_mfma_f32_32x32x16_bf16 v[192:207], a[56:59], v[100:103], v[192:207]
    ds_read_b128 a[48:51], v38 offset:41568
    s_waitcnt lgkmcnt(5)
    v_mfma_f32_32x32x16_bf16 v[192:207], a[60:63], v[104:107], v[192:207]
    s_waitcnt lgkmcnt(4)
    v_mfma_f32_32x32x16_bf16 v[192:207], a[64:67], v[108:111], v[192:207]
    s_waitcnt lgkmcnt(3)
    v_mfma_f32_32x32x16_bf16 v[192:207], a[36:39], v[112:115], v[192:207]
    s_waitcnt lgkmcnt(2)
    v_mfma_f32_32x32x16_bf16 v[192:207], a[40:43], v[116:119], v[192:207]
    s_waitcnt lgkmcnt(1)
    v_mfma_f32_32x32x16_bf16 v[192:207], a[44:47], v[120:123], v[192:207]
    s_waitcnt lgkmcnt(0)
    v_mfma_f32_32x32x16_bf16 v[192:207], a[48:51], v[124:127], v[192:207]
    s_waitcnt vmcnt(14)
    v_pk_add_f32 v[128:129], v[128:129], v[132:133]
    v_pk_add_f32 v[130:131], v[130:131], v[134:135]
    s_waitcnt vmcnt(13)
    v_pk_add_f32 v[128:129], v[128:129], v[136:137]
    v_pk_add_f32 v[130:131], v[130:131], v[138:139]
    s_waitcnt vmcnt(12)
    v_pk_add_f32 v[128:129], v[128:129], v[140:141]
    v_pk_add_f32 v[130:131], v[130:131], v[142:143]
    s_waitcnt vmcnt(11)
    v_pk_add_f32 v[128:129], v[128:129], v[144:145]
    v_pk_add_f32 v[130:131], v[130:131], v[146:147]
    s_waitcnt vmcnt(10)
    v_pk_add_f32 v[128:129], v[128:129], v[148:149]
    v_pk_add_f32 v[130:131], v[130:131], v[150:151]
    s_waitcnt vmcnt(9)
    v_pk_add_f32 v[128:129], v[128:129], v[152:153]
    v_pk_add_f32 v[130:131], v[130:131], v[154:155]
    v_add_f32 v192, 0x358637bd, v192
    v_add_f32 v193, 0x358637bd, v193
    v_add_f32 v194, 0x358637bd, v194
    v_add_f32 v195, 0x358637bd, v195
    v_add_f32 v196, 0x358637bd, v196
    v_add_f32 v197, 0x358637bd, v197
    v_add_f32 v198, 0x358637bd, v198
    v_add_f32 v199, 0x358637bd, v199
    v_rcp_f32 v192, v192
    v_rcp_f32 v193, v193
    v_rcp_f32 v194, v194
    v_rcp_f32 v195, v195
    v_rcp_f32 v196, v196
    v_rcp_f32 v197, v197
    v_rcp_f32 v198, v198
    v_rcp_f32 v199, v199
    v_mul_f32 v192, v192, v46
    v_mul_f32 v193, v193, v46
    v_mul_f32 v194, v194, v46
    v_mul_f32 v195, v195, v46
    v_mul_f32 v196, v196, v46
    v_mul_f32 v197, v197, v46
    v_mul_f32 v198, v198, v46
    v_mul_f32 v199, v199, v46
    buffer_store_dwordx4 v[192:195], v29, s[48:51], s92 offen offset:0 sc1
    buffer_store_dwordx4 v[196:199], v29, s[48:51], s92 offen offset:1024 sc1
    s_add_u32 s99, s99, 4096
    buffer_load_dwordx4 a[160:163], v29, s[48:51], s99 offen offset:0 sc1
    buffer_load_dwordx4 a[164:167], v29, s[48:51], s99 offen offset:1024 sc1
    buffer_load_dwordx4 a[168:171], v29, s[48:51], s99 offen offset:2048 sc1
    buffer_load_dwordx4 a[172:175], v29, s[48:51], s99 offen offset:3072 sc1
    s_waitcnt vmcnt(14)
    v_pk_add_f32 v[128:129], v[128:129], v[156:157]
    v_pk_add_f32 v[130:131], v[130:131], v[158:159]
    s_waitcnt vmcnt(13)
    v_pk_add_f32 v[128:129], v[128:129], v[160:161]
    v_pk_add_f32 v[130:131], v[130:131], v[162:163]
    s_waitcnt vmcnt(12)
    v_pk_add_f32 v[128:129], v[128:129], v[164:165]
    v_pk_add_f32 v[130:131], v[130:131], v[166:167]
    s_waitcnt vmcnt(11)
    v_pk_add_f32 v[128:129], v[128:129], v[168:169]
    v_pk_add_f32 v[130:131], v[130:131], v[170:171]
    s_waitcnt vmcnt(10)
    v_pk_add_f32 v[128:129], v[128:129], v[172:173]
    v_pk_add_f32 v[130:131], v[130:131], v[174:175]
    s_waitcnt vmcnt(9)
    v_pk_add_f32 v[128:129], v[128:129], v[176:177]
    v_pk_add_f32 v[130:131], v[130:131], v[178:179]
    s_waitcnt vmcnt(8)
    v_pk_add_f32 v[128:129], v[128:129], v[180:181]
    v_pk_add_f32 v[130:131], v[130:131], v[182:183]
    s_waitcnt vmcnt(7)
    v_pk_add_f32 v[128:129], v[128:129], v[184:185]
    v_pk_add_f32 v[130:131], v[130:131], v[186:187]
    s_waitcnt vmcnt(6)
    v_pk_add_f32 v[128:129], v[128:129], v[188:189]
    v_pk_add_f32 v[130:131], v[130:131], v[190:191]
    v_cvt_pk_bf16_f32 v128, v128, v129
    v_cvt_pk_bf16_f32 v129, v130, v131
    ds_write_b64 v33, v[128:129] offset:8192
    s_waitcnt lgkmcnt(0)
    s_barrier
    ds_read_b128 a[40:43], v34 offset:8192
    ds_read_b128 a[44:47], v34 offset:8224
    ds_read_b128 a[48:51], v34 offset:8256
    ds_read_b128 a[52:55], v35 offset:11296
    ds_read_b128 a[56:59], v35 offset:11328
    s_waitcnt lgkmcnt(4)
    v_mfma_f32_32x32x16_bf16 v[48:63], a[40:43], a[220:223], 0
    s_waitcnt lgkmcnt(3)
    v_mfma_f32_32x32x16_bf16 v[48:63], a[44:47], a[224:227], v[48:63]
    s_waitcnt lgkmcnt(2)
    v_mfma_f32_32x32x16_bf16 v[48:63], a[48:51], a[228:231], v[48:63]
    s_waitcnt lgkmcnt(1)
    v_mfma_f32_32x32x16_bf16 v[64:79], a[52:55], a[224:227], 0
    s_waitcnt lgkmcnt(0)
    v_mfma_f32_32x32x16_bf16 v[64:79], a[56:59], a[228:231], v[64:79]
    v_mfma_f32_32x32x16_bf16 v[80:95], a[40:43], a[232:235], 0
    v_mfma_f32_32x32x16_bf16 v[80:95], a[44:47], a[236:239], v[80:95]
    v_mfma_f32_32x32x16_bf16 v[80:95], a[48:51], a[240:243], v[80:95]
    s_barrier
    s_waitcnt vmcnt(4)
    s_mov_b64 exec, 1
    buffer_store_dword v31, off, s[48:51], s85 sc1
    s_mov_b64 exec, -1
    v_mfma_f32_32x32x16_bf16 v[96:111], a[52:55], a[236:239], 0
    v_cvt_pk_bf16_f32 v208, v48, v49
    v_cvt_pk_bf16_f32 v209, v50, v51
    v_mfma_f32_32x32x16_bf16 v[96:111], a[56:59], a[240:243], v[96:111]
    v_cvt_pk_bf16_f32 v210, v52, v53
    v_cvt_pk_bf16_f32 v211, v54, v55
    buffer_store_dwordx4 v[208:211], v248, s[48:51], s93 offen offset:0 sc1
    v_mfma_f32_32x32x16_bf16 v[112:127], a[40:43], a[244:247], 0
    v_cvt_pk_bf16_f32 v212, v56, v57
    v_cvt_pk_bf16_f32 v213, v58, v59
    v_mfma_f32_32x32x16_bf16 v[112:127], a[44:47], a[248:251], v[112:127]
    v_cvt_pk_bf16_f32 v214, v60, v61
    v_cvt_pk_bf16_f32 v215, v62, v63
    buffer_store_dwordx4 v[212:215], v249, s[48:51], s93 offen offset:0 sc1
    v_mfma_f32_32x32x16_bf16 v[112:127], a[48:51], a[252:255], v[112:127]
    v_cvt_pk_bf16_f32 v216, v64, v65
    v_cvt_pk_bf16_f32 v217, v66, v67
    v_mfma_f32_32x32x16_bf16 v[128:143], a[52:55], a[248:251], 0
    v_cvt_pk_bf16_f32 v218, v68, v69
    v_cvt_pk_bf16_f32 v219, v70, v71
    buffer_store_dwordx4 v[216:219], v250, s[48:51], s93 offen offset:0 sc1
    v_mfma_f32_32x32x16_bf16 v[128:143], a[56:59], a[252:255], v[128:143]
    v_cvt_pk_bf16_f32 v220, v80, v81
    v_cvt_pk_bf16_f32 v221, v82, v83
    v_cvt_pk_bf16_f32 v222, v84, v85
    v_cvt_pk_bf16_f32 v223, v86, v87
    buffer_store_dwordx4 v[220:223], v248, s[48:51], s93 offen offset:2048 sc1
    v_cvt_pk_bf16_f32 v224, v88, v89
    v_cvt_pk_bf16_f32 v225, v90, v91
    v_cvt_pk_bf16_f32 v226, v92, v93
    v_cvt_pk_bf16_f32 v227, v94, v95
    buffer_store_dwordx4 v[224:227], v249, s[48:51], s93 offen offset:2048 sc1
    v_cvt_pk_bf16_f32 v228, v96, v97
    v_cvt_pk_bf16_f32 v229, v98, v99
    v_cvt_pk_bf16_f32 v230, v100, v101
    v_cvt_pk_bf16_f32 v231, v102, v103
    buffer_store_dwordx4 v[228:231], v250, s[48:51], s93 offen offset:2048 sc1
    s_mov_b64 exec, s[82:83]
    s_add_u32 s93, s93, 4096
    v_cvt_pk_bf16_f32 v232, v112, v113
    v_cvt_pk_bf16_f32 v233, v114, v115
    v_cvt_pk_bf16_f32 v234, v116, v117
    v_cvt_pk_bf16_f32 v235, v118, v119
    buffer_store_dwordx4 v[232:235], v248, s[48:51], s93 offen offset:0 sc1
    v_cvt_pk_bf16_f32 v236, v120, v121
    v_cvt_pk_bf16_f32 v237, v122, v123
    v_cvt_pk_bf16_f32 v238, v124, v125
    v_cvt_pk_bf16_f32 v239, v126, v127
    buffer_store_dwordx4 v[236:239], v249, s[48:51], s93 offen offset:0 sc1
    v_cvt_pk_bf16_f32 v240, v128, v129
    v_cvt_pk_bf16_f32 v241, v130, v131
    v_cvt_pk_bf16_f32 v242, v132, v133
    v_cvt_pk_bf16_f32 v243, v134, v135
    buffer_store_dwordx4 v[240:243], v250, s[48:51], s93 offen offset:0 sc1
    s_mov_b64 exec, -1
    buffer_load_dword v19, v28, s[48:51], 0 offen sc1
    v_lshrrev_b32 v4, 5, v0
    v_add3_u32 v4, v4, s56, 1
    v_and_b32 v5, 1, v4
    v_bfe_u32 v4, v4, 1, 1
    v_and_b32 v1, 0xf0, v29
    v_lshl_add_u32 v1, v5, 8, v1
    v_bfe_u32 v5, v0, 4, 1
    v_lshl_add_u32 v1, v5, 9, v1
    v_lshl_add_u32 v4, v4, 12, v1
    v_xor_b32 v5, 0x1000, v4
    s_lshl3_add_u32 s3, s4, s56
    s_lshl_b32 s3, s3, 10
    s_add_u32 s3, s3, 1048576
    s_waitcnt vmcnt(1)
    s_mov_b64 exec, 1
    buffer_store_dword v31, off, s[48:51], s94 sc1
    s_mov_b64 exec, -1
    s_mov_b32 s7, 0x80000000
    s_waitcnt vmcnt(1)
    v_cmp_eq_u32 vcc, -1, v19
    s_nop 1
    s_cbranch_vccnz Lslow_28
Lback_29:
    buffer_load_dword v19, v26, s[48:51], 0 offen sc1
    buffer_load_dwordx4 v[192:195], v29, s[48:51], s63 offen offset:0 sc1
    buffer_load_dwordx4 v[196:199], v29, s[48:51], s64 offen offset:0 sc1
    buffer_load_dwordx4 v[200:203], v29, s[48:51], s65 offen offset:0 sc1
    buffer_load_dwordx4 v[204:207], v29, s[48:51], s71 offen offset:0 sc1
    buffer_load_dwordx4 v[208:211], v29, s[48:51], s63 offen offset:1024 sc1
    buffer_load_dwordx4 v[212:215], v29, s[48:51], s64 offen offset:1024 sc1
    buffer_load_dwordx4 v[216:219], v29, s[48:51], s65 offen offset:1024 sc1
    buffer_load_dwordx4 v[220:223], v29, s[48:51], s71 offen offset:1024 sc1
    buffer_load_dwordx4 v[224:227], v29, s[48:51], s63 offen offset:2048 sc1
    buffer_load_dwordx4 v[228:231], v29, s[48:51], s64 offen offset:2048 sc1
    buffer_load_dwordx4 v[232:235], v29, s[48:51], s65 offen offset:2048 sc1
    buffer_load_dwordx4 v[236:239], v29, s[48:51], s71 offen offset:2048 sc1
    buffer_load_dwordx4 v[240:243], v29, s[48:51], s63 offen offset:3072 sc1
    buffer_load_dwordx4 v[244:247], v29, s[48:51], s64 offen offset:3072 sc1
    buffer_load_dwordx4 v[248:251], v29, s[48:51], s65 offen offset:3072 sc1
    buffer_load_dwordx4 v[252:255], v29, s[48:51], s71 offen offset:3072 sc1
    s_waitcnt vmcnt(16)
    v_cmp_eq_u32 vcc, -1, v19
    s_nop 1
    s_cbranch_vccnz Lslow_30
Lback_31:
    s_add_u32 m0, s61, 0
    s_nop 0
    buffer_load_dwordx4 v4, s[48:51], s3 offen sc1 lds
    s_add_u32 m0, s61, 1024
    s_nop 0
    buffer_load_dwordx4 v5, s[48:51], s3 offen sc1 lds
    s_waitcnt vmcnt(0)
    s_branch L_p3
Lslow_1:
    s_add_u32 s74, s74, 1
    s_cmp_ge_u32 s74, 1048576
    s_cbranch_scc1 L_end
    buffer_load_dword v47, off, s[44:47], 0 sc1
    s_waitcnt vmcnt(0)
    v_cmp_gt_u32 vcc, 32, v47
    s_nop 4
    s_cbranch_vccnz Lslow_1
    s_branch Lback_2
Lslow_4:
    s_add_u32 s74, s74, 1
    s_cmp_ge_u32 s74, 1048576
    s_cbranch_scc1 L_end
    buffer_load_dword v192, v31, s[48:51], s7 offen offset:0 sc1
    buffer_load_dword v193, v31, s[48:51], s7 offen offset:256 sc1
    buffer_load_dword v194, v31, s[48:51], s7 offen offset:512 sc1
    buffer_load_dword v195, v31, s[48:51], s7 offen offset:768 sc1
    buffer_load_dword v196, v31, s[48:51], s7 offen offset:1024 sc1
    buffer_load_dword v197, v31, s[48:51], s7 offen offset:1280 sc1
    buffer_load_dword v198, v31, s[48:51], s7 offen offset:1536 sc1
    buffer_load_dword v199, v31, s[48:51], s7 offen offset:1792 sc1
    buffer_load_dword v200, v31, s[48:51], s7 offen offset:2048 sc1
    buffer_load_dword v201, v31, s[48:51], s7 offen offset:2304 sc1
    buffer_load_dword v202, v31, s[48:51], s7 offen offset:2560 sc1
    buffer_load_dword v203, v31, s[48:51], s7 offen offset:2816 sc1
    buffer_load_dword v204, v31, s[48:51], s7 offen offset:3072 sc1
    buffer_load_dword v205, v31, s[48:51], s7 offen offset:3328 sc1
    s_waitcnt vmcnt(0)
    v_max3_u32 v206, v192, v193, v194
    v_max3_u32 v206, v206, v195, v196
    v_max3_u32 v206, v206, v197, v198
    v_max3_u32 v206, v206, v199, v200
    v_max3_u32 v206, v206, v201, v202
    v_max3_u32 v206, v206, v203, v204
    v_max_u32 v206, v206, v205
    v_add_f32 v192, v192, v194
    v_add_f32 v193, v193, v195
    v_add_f32 v192, v192, v196
    v_add_f32 v193, v193, v197
    v_add_f32 v192, v192, v198
    v_add_f32 v193, v193, v199
    v_add_f32 v192, v192, v200
    v_add_f32 v193, v193, v201
    v_add_f32 v192, v192, v202
    v_add_f32 v193, v193, v203
    v_add_f32 v192, v192, v204
    v_add_f32 v193, v193, v205
    v_cmp_eq_u32 vcc, -1, v206
    s_nop 4
    s_cbranch_vccnz Lslow_4
    s_branch Lback_5
Lslow_6:
    s_add_u32 s74, s74, 1
    s_cmp_ge_u32 s74, 1048576
    s_cbranch_scc1 L_end
    buffer_load_dword v45, v44, s[48:51], 0 offen sc1
    s_waitcnt vmcnt(0)
    v_cmp_eq_u32 vcc, -1, v45
    s_nop 4
    s_cbranch_vccnz Lslow_6
    s_branch Lback_7
Lslow_8:
    s_add_u32 s74, s74, 1
    s_cmp_ge_u32 s74, 1048576
    s_cbranch_scc1 L_end
    buffer_load_dword v47, off, s[44:47], 0 sc1
    s_waitcnt vmcnt(0)
    v_cmp_gt_u32 vcc, 32, v47
    s_nop 4
    s_cbranch_vccnz Lslow_8
    s_branch Lback_9
Lslow_11:
    s_add_u32 s74, s74, 1
    s_cmp_ge_u32 s74, 1048576
    s_cbranch_scc1 L_end
    buffer_load_dword v192, v31, s[48:51], s7 offen offset:0 sc1
    buffer_load_dword v193, v31, s[48:51], s7 offen offset:256 sc1
    buffer_load_dword v194, v31, s[48:51], s7 offen offset:512 sc1
    buffer_load_dword v195, v31, s[48:51], s7 offen offset:768 sc1
    buffer_load_dword v196, v31, s[48:51], s7 offen offset:1024 sc1
    buffer_load_dword v197, v31, s[48:51], s7 offen offset:1280 sc1
    buffer_load_dword v198, v31, s[48:51], s7 offen offset:1536 sc1
    buffer_load_dword v199, v31, s[48:51], s7 offen offset:1792 sc1
    buffer_load_dword v200, v31, s[48:51], s7 offen offset:2048 sc1
    buffer_load_dword v201, v31, s[48:51], s7 offen offset:2304 sc1
    buffer_load_dword v202, v31, s[48:51], s7 offen offset:2560 sc1
    buffer_load_dword v203, v31, s[48:51], s7 offen offset:2816 sc1
    buffer_load_dword v204, v31, s[48:51], s7 offen offset:3072 sc1
    buffer_load_dword v205, v31, s[48:51], s7 offen offset:3328 sc1
    s_waitcnt vmcnt(0)
    v_max3_u32 v206, v192, v193, v194
    v_max3_u32 v206, v206, v195, v196
    v_max3_u32 v206, v206, v197, v198
    v_max3_u32 v206, v206, v199, v200
    v_max3_u32 v206, v206, v201, v202
    v_max3_u32 v206, v206, v203, v204
    v_max_u32 v206, v206, v205
    v_add_f32 v192, v192, v194
    v_add_f32 v193, v193, v195
    v_add_f32 v192, v192, v196
    v_add_f32 v193, v193, v197
    v_add_f32 v192, v192, v198
    v_add_f32 v193, v193, v199
    v_add_f32 v192, v192, v200
    v_add_f32 v193, v193, v201
    v_add_f32 v192, v192, v202
    v_add_f32 v193, v193, v203
    v_add_f32 v192, v192, v204
    v_add_f32 v193, v193, v205
    v_cmp_eq_u32 vcc, -1, v206
    s_nop 4
    s_cbranch_vccnz Lslow_11
    s_branch Lback_12
Lslow_13:
    s_add_u32 s74, s74, 1
    s_cmp_ge_u32 s74, 1048576
    s_cbranch_scc1 L_end
    buffer_load_dword v45, v44, s[48:51], 0 offen sc1
    s_waitcnt vmcnt(0)
    v_cmp_eq_u32 vcc, -1, v45
    s_nop 4
    s_cbranch_vccnz Lslow_13
    s_branch Lback_14
Lslow_15:
    s_add_u32 s74, s74, 1
    s_cmp_ge_u32 s74, 1048576
    s_cbranch_scc1 L_end
    buffer_load_dword v47, off, s[44:47], 0 sc1
    s_waitcnt vmcnt(0)
    v_cmp_gt_u32 vcc, 32, v47
    s_nop 4
    s_cbranch_vccnz Lslow_15
    s_branch Lback_16
Lslow_18:
    s_add_u32 s74, s74, 1
    s_cmp_ge_u32 s74, 1048576
    s_cbranch_scc1 L_end
    buffer_load_dword v192, v31, s[48:51], s7 offen offset:0 sc1
    buffer_load_dword v193, v31, s[48:51], s7 offen offset:256 sc1
    buffer_load_dword v194, v31, s[48:51], s7 offen offset:512 sc1
    buffer_load_dword v195, v31, s[48:51], s7 offen offset:768 sc1
    buffer_load_dword v196, v31, s[48:51], s7 offen offset:1024 sc1
    buffer_load_dword v197, v31, s[48:51], s7 offen offset:1280 sc1
    buffer_load_dword v198, v31, s[48:51], s7 offen offset:1536 sc1
    buffer_load_dword v199, v31, s[48:51], s7 offen offset:1792 sc1
    buffer_load_dword v200, v31, s[48:51], s7 offen offset:2048 sc1
    buffer_load_dword v201, v31, s[48:51], s7 offen offset:2304 sc1
    buffer_load_dword v202, v31, s[48:51], s7 offen offset:2560 sc1
    buffer_load_dword v203, v31, s[48:51], s7 offen offset:2816 sc1
    buffer_load_dword v204, v31, s[48:51], s7 offen offset:3072 sc1
    buffer_load_dword v205, v31, s[48:51], s7 offen offset:3328 sc1
    s_waitcnt vmcnt(0)
    v_max3_u32 v206, v192, v193, v194
    v_max3_u32 v206, v206, v195, v196
    v_max3_u32 v206, v206, v197, v198
    v_max3_u32 v206, v206, v199, v200
    v_max3_u32 v206, v206, v201, v202
    v_max3_u32 v206, v206, v203, v204
    v_max_u32 v206, v206, v205
    v_add_f32 v192, v192, v194
    v_add_f32 v193, v193, v195
    v_add_f32 v192, v192, v196
    v_add_f32 v193, v193, v197
    v_add_f32 v192, v192, v198
    v_add_f32 v193, v193, v199
    v_add_f32 v192, v192, v200
    v_add_f32 v193, v193, v201
    v_add_f32 v192, v192, v202
    v_add_f32 v193, v193, v203
    v_add_f32 v192, v192, v204
    v_add_f32 v193, v193, v205
    v_cmp_eq_u32 vcc, -1, v206
    s_nop 4
    s_cbranch_vccnz Lslow_18
    s_branch Lback_19
Lslow_20:
    s_add_u32 s74, s74, 1
    s_cmp_ge_u32 s74, 1048576
    s_cbranch_scc1 L_end
    buffer_load_dword v45, v44, s[48:51], 0 offen sc1
    s_waitcnt vmcnt(0)
    v_cmp_eq_u32 vcc, -1, v45
    s_nop 4
    s_cbranch_vccnz Lslow_20
    s_branch Lback_21
Lslow_22:
    s_add_u32 s74, s74, 1
    s_cmp_ge_u32 s74, 1048576
    s_cbranch_scc1 L_end
    buffer_load_dword v47, off, s[44:47], 0 sc1
    s_waitcnt vmcnt(0)
    v_cmp_gt_u32 vcc, 32, v47
    s_nop 4
    s_cbranch_vccnz Lslow_22
    s_branch Lback_23
Lslow_24:
    s_add_u32 s74, s74, 1
    s_cmp_ge_u32 s74, 1048576
    s_cbranch_scc1 L_end
    buffer_load_dword v19, v16, s[48:51], 0 offen sc1
    s_waitcnt vmcnt(0)
    v_cmp_eq_u32 vcc, -1, v19
    s_nop 4
    s_cbranch_vccnz Lslow_24
    s_branch Lback_25
Lslow_26:
    s_add_u32 s74, s74, 1
    s_cmp_ge_u32 s74, 1048576
    s_cbranch_scc1 L_end
    buffer_load_dword v208, v2, s[48:51], s87 offen sc1
    buffer_load_dword v209, off, s[48:51], s88 sc1
    s_waitcnt vmcnt(0)
    v_max_u32 v213, v208, v209
    v_cmp_eq_u32 vcc, -1, v213
    s_nop 4
    s_cbranch_vccnz Lslow_26
    s_branch Lback_27
Lslow_28:
    s_add_u32 s74, s74, 1
    s_cmp_ge_u32 s74, 1048576
    s_cbranch_scc1 L_end
    buffer_load_dword v19, v28, s[48:51], 0 offen sc1
    s_waitcnt vmcnt(0)
    v_cmp_eq_u32 vcc, -1, v19
    s_nop 4
    s_cbranch_vccnz Lslow_28
    s_branch Lback_29
Lslow_30:
    s_add_u32 s74, s74, 1
    s_cmp_ge_u32 s74, 1048576
    s_cbranch_scc1 L_end
    buffer_load_dword v19, v26, s[48:51], 0 offen sc1
    s_waitcnt vmcnt(0)
    v_cmp_eq_u32 vcc, -1, v19
    s_nop 4
    s_cbranch_vccnz Lslow_30
    s_branch Lback_31
Lslow_32:
    s_add_u32 s74, s74, 1
    s_cmp_ge_u32 s74, 1048576
    s_cbranch_scc1 L_end
    buffer_load_dword v45, v44, s[48:51], s66 offen sc1
    s_waitcnt vmcnt(0)
    v_cmp_eq_u32 vcc, -1, v45
    s_nop 4
    s_cbranch_vccnz Lslow_32
    s_branch Lback_33
Lslow_34:
    s_add_u32 s74, s74, 1
    s_cmp_ge_u32 s74, 1048576
    s_cbranch_scc1 L_end
    buffer_load_dword v19, v16, s[48:51], 0 offen sc1
    s_waitcnt vmcnt(0)
    v_cmp_eq_u32 vcc, -1, v19
    s_nop 4
    s_cbranch_vccnz Lslow_34
    s_branch Lback_35
Lslow_36:
    s_add_u32 s74, s74, 1
    s_cmp_ge_u32 s74, 1048576
    s_cbranch_scc1 L_end
    buffer_load_dword v19, v28, s[48:51], 0 offen sc1
    s_waitcnt vmcnt(0)
    v_cmp_eq_u32 vcc, -1, v19
    s_nop 4
    s_cbranch_vccnz Lslow_36
    s_branch Lback_37
Lslow_38:
    s_add_u32 s74, s74, 1
    s_cmp_ge_u32 s74, 1048576
    s_cbranch_scc1 L_end
    buffer_load_dword v45, off, s[48:51], s80 sc1
    s_waitcnt vmcnt(0)
    v_cmp_eq_u32 vcc, -1, v45
    s_nop 4
    s_cbranch_vccnz Lslow_38
    s_branch Lback_39
Lslow_40:
    s_add_u32 s74, s74, 1
    s_cmp_ge_u32 s74, 1048576
    s_cbranch_scc1 L_end
    buffer_load_dword v19, v26, s[48:51], 0 offen sc1
    s_waitcnt vmcnt(0)
    v_cmp_eq_u32 vcc, -1, v19
    s_nop 4
    s_cbranch_vccnz Lslow_40
    s_branch Lback_41
Lslow_42:
    s_add_u32 s74, s74, 1
    s_cmp_ge_u32 s74, 1048576
    s_cbranch_scc1 L_end
    buffer_load_dword v19, v17, s[48:51], 0 offen sc1
    s_waitcnt vmcnt(0)
    v_cmp_eq_u32 vcc, -1, v19
    s_nop 4
    s_cbranch_vccnz Lslow_42
    s_branch Lback_43
Lslow_44:
    s_add_u32 s74, s74, 1
    s_cmp_ge_u32 s74, 1048576
    s_cbranch_scc1 L_end
    buffer_load_dword v19, v18, s[48:51], 0 offen sc1
    s_waitcnt vmcnt(0)
    v_cmp_eq_u32 vcc, -1, v19
    s_nop 4
    s_cbranch_vccnz Lslow_44
    s_branch Lback_45
L_code_end:
    s_endpgm
.section .rodata,"a"
.p2align 6
.amdhsa_kernel gated_mix__linear_attn_block__mixer_gmlp__prompt_kernel
  .amdhsa_next_free_vgpr 512
  .amdhsa_next_free_sgpr 102
  .amdhsa_accum_offset 256
  .amdhsa_group_segment_fixed_size 0
  .amdhsa_kernarg_size 96
  .amdhsa_user_sgpr_count 2
  .amdhsa_user_sgpr_kernarg_segment_ptr 1
  .amdhsa_system_sgpr_workgroup_id_x 1
.end_amdhsa_kernel
```
